```python
import torch

def _softmax(x, axis=-1):
    return torch.softmax(x, dim=axis)

def _gelu(x):
    return torch.nn.functional.gelu(x, approximate='tanh')

def _silu(x):
    return torch.nn.functional.silu(x)

def _sigmoid(x):
    return torch.sigmoid(x)

def _layernorm(x, axis=-1, eps=1e-05):
    m = x.mean(dim=axis, keepdim=True)
    v = x.var(dim=axis, keepdim=True, unbiased=False)
    return (x - m) / torch.sqrt(v + eps)

def _scatter_add(tgt, idx, src, axis=0):
    return tgt.clone().index_add_(axis, idx, src)

def _segment_sum(src, seg, n):
    out = torch.zeros((n,) + src.shape[1:], dtype=src.dtype)
    return out.index_add_(0, seg, src)

def _pad(x, pw):
    flat = tuple((v for pair in reversed(pw) for v in pair))
    return torch.nn.functional.pad(x, flat)
kernel_name = 'sequential_preLN__mha_block__mixer_gmlp__prompt'

def setup_inputs():

    _w = lambda a: (lambda t: t.to(torch.bfloat16) if t.is_floating_point() else t)(torch.as_tensor(a))

    def _A_setup():
        B, S, D, H = (1, 2048, 576, 32)
        return {'x': _w((lambda *s: torch.randn(*s, dtype=torch.bfloat16) * 0.05)(B, S, D)), 'wqkv': _w((lambda *s: torch.randn(*s, dtype=torch.bfloat16) * 0.05)(D, 3 * D)), 'wo': _w((lambda *s: torch.randn(*s, dtype=torch.bfloat16) * 0.05)(D, D))}
    _A_in = _A_setup()

    def _B_setup():
        B, S, D, F = (1, 2048, 576, 4608)
        Fh = F // 2
        return {'x': _w((lambda *s: torch.randn(*s, dtype=torch.bfloat16) * 0.05)(B, S, D)), 'w_in': _w((lambda *s: torch.randn(*s, dtype=torch.bfloat16) * 0.8)(D, 2 * Fh)), 'w_sp': _w(0.01 * (lambda *s: torch.randn(*s, dtype=torch.bfloat16) * 0.8)(S, S)), 'b_sp': _w(1.0 + 0.01 * (lambda *s: torch.randn(*s, dtype=torch.bfloat16) * 0.05)(S)), 'w_out': _w((lambda *s: torch.randn(*s, dtype=torch.bfloat16) * 0.05)(Fh, D))}
    _B_in = _B_setup()
    return {'A_x': _A_in['x'], 'A_wqkv': _A_in['wqkv'], 'A_wo': _A_in['wo'], 'B_x': _B_in['x'], 'B_w_in': _B_in['w_in'], 'B_w_sp': _B_in['w_sp'], 'B_b_sp': _B_in['b_sp'], 'B_w_out': _B_in['w_out']}

def reference(A_x, A_wqkv, A_wo, B_x, B_w_in, B_w_sp, B_b_sp, B_w_out):

    def _A_ref(x, wqkv, wo):
        B, S, D = x.shape
        H = 32
        Dh = D // H
        qkv = (lambda x, *d: x.permute(*d))((x @ wqkv).reshape(B, S, 3, H, Dh), 2, 0, 3, 1, 4)
        q, k, v = (qkv[0], qkv[1], qkv[2])
        scores = torch.einsum('bhqd,bhkd->bhqk', q, k) * Dh ** (-0.5)
        p = _softmax(scores, axis=-1)
        o = torch.einsum('bhqk,bhkd->bhqd', p, v)
        return (lambda x, *d: x.permute(*d))(o, 0, 2, 1, 3).reshape(B, S, D) @ wo

    def _B_ref(x, w_in, w_sp, b_sp, w_out):
        B, S, D = x.shape
        F = w_in.shape[-1]
        Fh = F // 2
        z = _gelu(torch.einsum('bsd,df->bsf', x, w_in))
        z1 = z[..., :Fh].clone()
        z2 = _layernorm(z[..., Fh:], axis=-1)
        g = torch.einsum('ts,bsf->btf', w_sp, z2) + b_sp[None, :, None]
        return torch.einsum('bsf,fd->bsd', z1 * g, w_out)
    x = A_x
    h = x + _A_ref(_layernorm(x, axis=-1), A_wqkv, A_wo)
    h2 = h + _B_ref(_layernorm(h, axis=-1), B_w_in, B_w_sp, B_b_sp, B_w_out)
    return h2
```

```asm
; @launch kernel=qkv_kernel grid=(256,1,1) block=(256,1,1) lds=142336
; @launch kernel=attn_kernel grid=(256,1,1) block=(512,1,1) lds=163840
; @launch kernel=post_kernel grid=(256,1,1) block=(256,1,1) lds=157696
.amdgcn_target "amdgcn-amd-amdhsa--gfx950"
.text
.p2align 8
L_text_begin:
.globl qkv_kernel
.p2align 8
.type qkv_kernel,@function
qkv_kernel:
    s_cmp_ge_u32 s2, 256
    s_cbranch_scc1 L_end_qkv_kernel
    s_load_dwordx16 s[4:19], s[0:1], 0
    s_load_dwordx2 s[20:21], s[0:1], 64
    s_load_dwordx2 s[22:23], s[0:1], 80
    s_cmp_lt_u32 s2, 64
    s_cbranch_scc1 L_qkv_hlp
    s_sub_u32 s2, s2, 64
    v_and_b32 v1, 63, v0
    v_lshrrev_b32 v216, 6, v0
    v_and_b32 v2, 15, v0
    v_readfirstlane_b32 s40, v216
    v_lshrrev_b32 v3, 4, v1
    v_lshlrev_b32 v4, 4, v1
    s_and_b32 s44, s2, 7
    s_lshr_b32 s45, s2, 3
    s_mul_i32 s46, s45, 43
    s_lshr_b32 s46, s46, 8
    s_mul_i32 s47, s46, 6
    s_sub_u32 s45, s45, s47
    s_lshr_b32 s41, s44, 1
    s_lshl_b32 s41, s41, 2
    s_add_u32 s41, s41, s46
    s_and_b32 s42, s44, 1
    s_mul_i32 s42, s42, 6
    s_add_u32 s42, s42, s45
    s_lshl_b32 s43, s41, 7
    s_lshl_b32 s44, s40, 5
    s_add_u32 s43, s43, s44
    s_lshl_b32 s48, s40, 14
    s_mul_i32 s49, s40, 4608
    s_add_u32 s49, s49, 65536
    s_mul_i32 s50, s43, 1152
    s_mul_i32 s51, s42, 288
    v_lshrrev_b32 v216, 3, v1
    v_lshrrev_b32 v217, 1, v216
    v_xor_b32 v217, v217, v1
    v_and_b32 v217, 7, v217
    v_mul_u32_u24 v216, 1152, v216
    v_lshl_add_u32 v6, v217, 4, v216
    v_xor_b32 v7, 64, v6
    v_add_u32 v7, 9216, v7
    v_add_u32 v8, 18432, v6
    v_add_u32 v9, 18432, v7
    s_mul_i32 s44, s40, 288
    v_add_u32 v224, s44, v1
    v_add_u32 v216, 0, v224
    v_mul_u32_u24 v217, 3641, v216
    v_lshrrev_b32 v217, 16, v217
    v_mul_u32_u24 v218, 18, v217
    v_sub_u32 v218, v216, v218
    v_and_b32 v219, 8, v217
    v_xor_b32 v219, v219, v218
    v_cmp_gt_u32 vcc, 16, v218
    s_nop 0
    v_mul_u32_u24 v217, 3456, v217
    v_cndmask_b32 v218, v218, v219, vcc
    v_lshl_add_u32 v10, v218, 4, v217
    v_add_u32 v216, 64, v224
    v_mul_u32_u24 v217, 3641, v216
    v_lshrrev_b32 v217, 16, v217
    v_mul_u32_u24 v218, 18, v217
    v_sub_u32 v218, v216, v218
    v_and_b32 v219, 8, v217
    v_xor_b32 v219, v219, v218
    v_cmp_gt_u32 vcc, 16, v218
    s_nop 0
    v_mul_u32_u24 v217, 3456, v217
    v_cndmask_b32 v218, v218, v219, vcc
    v_lshl_add_u32 v11, v218, 4, v217
    v_add_u32 v216, 128, v224
    v_mul_u32_u24 v217, 3641, v216
    v_lshrrev_b32 v217, 16, v217
    v_mul_u32_u24 v218, 18, v217
    v_sub_u32 v218, v216, v218
    v_and_b32 v219, 8, v217
    v_xor_b32 v219, v219, v218
    v_cmp_gt_u32 vcc, 16, v218
    s_nop 0
    v_mul_u32_u24 v217, 3456, v217
    v_cndmask_b32 v218, v218, v219, vcc
    v_lshl_add_u32 v12, v218, 4, v217
    v_add_u32 v216, 192, v224
    v_mul_u32_u24 v217, 3641, v216
    v_lshrrev_b32 v217, 16, v217
    v_mul_u32_u24 v218, 18, v217
    v_sub_u32 v218, v216, v218
    v_and_b32 v219, 8, v217
    v_xor_b32 v219, v219, v218
    v_cmp_gt_u32 vcc, 16, v218
    s_nop 0
    v_mul_u32_u24 v217, 3456, v217
    v_cndmask_b32 v218, v218, v219, vcc
    v_lshl_add_u32 v13, v218, 4, v217
    v_add_u32 v216, 256, v224
    v_mul_u32_u24 v217, 3641, v216
    v_lshrrev_b32 v217, 16, v217
    v_mul_u32_u24 v218, 18, v217
    v_sub_u32 v218, v216, v218
    v_and_b32 v219, 8, v217
    v_xor_b32 v219, v219, v218
    v_cmp_gt_u32 vcc, 16, v218
    s_nop 0
    v_mul_u32_u24 v217, 3456, v217
    v_cndmask_b32 v218, v218, v219, vcc
    v_lshl_add_u32 v14, v218, 4, v217
    s_waitcnt lgkmcnt(0)
    s_mov_b32 s24, s4
    s_mov_b32 s25, s5
    s_mov_b32 s26, 2359296
    s_mov_b32 s27, 0x20000
    s_mov_b32 s28, s6
    s_mov_b32 s29, s7
    s_mov_b32 s30, 1990656
    s_mov_b32 s31, 0x20000
    s_lshr_b32 s44, s2, 3
    s_lshl_b32 s44, s44, 2
    s_add_u32 s44, s44, s40
    s_bfe_u32 s45, s2, 0x20001
    s_mul_i32 s45, s45, 589824
    s_mul_i32 s46, s44, 6144
    s_add_u32 s45, s45, s46
    v_min_u32 v216, 47, v1
    v_lshlrev_b32 v216, 7, v216
    v_min_u32 v217, 41, v1
    v_mul_u32_u24 v218, 4682, v217
    v_lshrrev_b32 v218, 16, v218
    v_mul_u32_u24 v219, 14, v218
    v_sub_u32 v219, v217, v219
    v_mul_u32_u24 v218, 3456, v218
    v_lshl_add_u32 v218, v219, 7, v218
    s_mul_i32 s46, s44, 20736
    s_and_b32 s47, s2, 1
    s_mul_i32 s47, s47, 1664
    s_add_u32 s46, s46, s47
    s_add_u32 s47, s46, 10368
    s_add_u32 m0, s49, 0
    s_nop 0
    buffer_load_dwordx4 v10, s[28:31], s51 offen lds
    s_add_u32 m0, s49, 1024
    s_nop 0
    buffer_load_dwordx4 v11, s[28:31], s51 offen lds
    s_add_u32 m0, s49, 2048
    s_nop 0
    buffer_load_dwordx4 v12, s[28:31], s51 offen lds
    s_add_u32 m0, s49, 3072
    s_nop 0
    buffer_load_dwordx4 v13, s[28:31], s51 offen lds
    s_add_u32 m0, s49, 4096
    s_mov_b32 exec_hi, 0
    buffer_load_dwordx4 v14, s[28:31], s51 offen lds
    s_mov_b32 exec_hi, -1
    s_add_u32 s51, s51, 221184
    s_add_u32 m0, s48, 0
    s_nop 0
    buffer_load_dwordx4 v6, s[24:27], s50 offen lds
    s_add_u32 m0, s48, 1024
    s_nop 0
    buffer_load_dwordx4 v7, s[24:27], s50 offen lds
    s_add_u32 m0, s48, 2048
    s_nop 0
    buffer_load_dwordx4 v8, s[24:27], s50 offen lds
    s_add_u32 m0, s48, 3072
    s_nop 0
    buffer_load_dwordx4 v9, s[24:27], s50 offen lds
    s_add_u32 s50, s50, 128
    s_cmp_ge_u32 s42, 8
    s_cselect_b32 s63, 4, 0
    s_add_u32 s63, s63, s40
    s_cmp_eq_u32 s63, 0
    s_cbranch_scc1 L_pgqkv_kernel_1
    s_cmp_eq_u32 s63, 1
    s_cbranch_scc1 L_pgqkv_kernel_2
    s_cmp_eq_u32 s63, 2
    s_cbranch_scc1 L_pgqkv_kernel_3
    s_cmp_eq_u32 s63, 4
    s_cbranch_scc1 L_pgqkv_kernel_4
    s_cmp_eq_u32 s63, 5
    s_cbranch_scc1 L_pgqkv_kernel_5
    s_cmp_eq_u32 s63, 6
    s_cbranch_scc1 L_pgqkv_kernel_6
L_hopqkv_kernel_1:
    s_add_u32 s32, s22, 0
    s_addc_u32 s33, s23, 0
    s_mov_b32 s34, 9437184
    s_mov_b32 s35, 0x20000
    v_lshrrev_b32 v216, 1, v2
    v_xor_b32 v217, v216, v3
    v_lshlrev_b32 v218, 7, v2
    v_lshl_add_u32 v15, v217, 4, v218
    v_add_u32 v15, s48, v15
    v_xor_b32 v16, 64, v15
    v_lshrrev_b32 v216, 2, v2
    v_lshl_add_u32 v216, v3, 3, v216
    v_mul_u32_u24 v216, 288, v216
    v_and_b32 v217, 3, v1
    v_lshl_add_u32 v216, v217, 3, v216
    v_add_u32 v216, 65536, v216
    v_and_b32 v217, 1, v3
    v_lshlrev_b32 v217, 7, v217
    v_mov_b32 v5, 0x3f803f80
    s_lshl_b32 s44, s40, 8
    s_add_u32 s44, s44, 141312
    v_lshlrev_b32 v22, 2, v2
    v_add_u32 v22, s44, v22
    v_lshlrev_b32 v23, 4, v3
    v_add_u32 v23, s44, v23
    s_lshl_b32 s54, s40, 1
    s_add_u32 s54, s54, 0
    s_sub_u32 s44, s54, 9
    s_cmp_ge_u32 s54, 9
    s_cselect_b32 s54, s44, s54
    s_cmp_lt_u32 s54, 4
    s_cselect_b32 s44, 1, -1
    s_cmp_eq_u32 s54, 8
    s_cselect_b32 s44, 0, s44
    s_lshl_b32 s45, s54, 5
    v_mad_i32_i24 v24, v217, s44, v216
    v_add_u32 v24, s45, v24
    v_add_u32 v33, 36864, v24
    s_lshl_b32 s55, s40, 1
    s_add_u32 s55, s55, 1
    s_sub_u32 s44, s55, 9
    s_cmp_ge_u32 s55, 9
    s_cselect_b32 s55, s44, s55
    s_cmp_lt_u32 s55, 4
    s_cselect_b32 s44, 1, -1
    s_cmp_eq_u32 s55, 8
    s_cselect_b32 s44, 0, s44
    s_lshl_b32 s45, s55, 5
    v_mad_i32_i24 v25, v217, s44, v216
    v_add_u32 v25, s45, v25
    v_add_u32 v34, 36864, v25
    s_lshl_b32 s56, s40, 1
    s_add_u32 s56, s56, 2
    s_sub_u32 s44, s56, 9
    s_cmp_ge_u32 s56, 9
    s_cselect_b32 s56, s44, s56
    s_cmp_lt_u32 s56, 4
    s_cselect_b32 s44, 1, -1
    s_cmp_eq_u32 s56, 8
    s_cselect_b32 s44, 0, s44
    s_lshl_b32 s45, s56, 5
    v_mad_i32_i24 v26, v217, s44, v216
    v_add_u32 v26, s45, v26
    v_add_u32 v35, 36864, v26
    s_lshl_b32 s57, s40, 1
    s_add_u32 s57, s57, 3
    s_sub_u32 s44, s57, 9
    s_cmp_ge_u32 s57, 9
    s_cselect_b32 s57, s44, s57
    s_cmp_lt_u32 s57, 4
    s_cselect_b32 s44, 1, -1
    s_cmp_eq_u32 s57, 8
    s_cselect_b32 s44, 0, s44
    s_lshl_b32 s45, s57, 5
    v_mad_i32_i24 v27, v217, s44, v216
    v_add_u32 v27, s45, v27
    v_add_u32 v36, 36864, v27
    s_lshl_b32 s58, s40, 1
    s_add_u32 s58, s58, 4
    s_sub_u32 s44, s58, 9
    s_cmp_ge_u32 s58, 9
    s_cselect_b32 s58, s44, s58
    s_cmp_lt_u32 s58, 4
    s_cselect_b32 s44, 1, -1
    s_cmp_eq_u32 s58, 8
    s_cselect_b32 s44, 0, s44
    s_lshl_b32 s45, s58, 5
    v_mad_i32_i24 v28, v217, s44, v216
    v_add_u32 v28, s45, v28
    v_add_u32 v37, 36864, v28
    s_lshl_b32 s59, s40, 1
    s_add_u32 s59, s59, 5
    s_sub_u32 s44, s59, 9
    s_cmp_ge_u32 s59, 9
    s_cselect_b32 s59, s44, s59
    s_cmp_lt_u32 s59, 4
    s_cselect_b32 s44, 1, -1
    s_cmp_eq_u32 s59, 8
    s_cselect_b32 s44, 0, s44
    s_lshl_b32 s45, s59, 5
    v_mad_i32_i24 v29, v217, s44, v216
    v_add_u32 v29, s45, v29
    v_add_u32 v38, 36864, v29
    s_lshl_b32 s60, s40, 1
    s_add_u32 s60, s60, 6
    s_sub_u32 s44, s60, 9
    s_cmp_ge_u32 s60, 9
    s_cselect_b32 s60, s44, s60
    s_cmp_lt_u32 s60, 4
    s_cselect_b32 s44, 1, -1
    s_cmp_eq_u32 s60, 8
    s_cselect_b32 s44, 0, s44
    s_lshl_b32 s45, s60, 5
    v_mad_i32_i24 v30, v217, s44, v216
    v_add_u32 v30, s45, v30
    v_add_u32 v39, 36864, v30
    s_lshl_b32 s61, s40, 1
    s_add_u32 s61, s61, 7
    s_sub_u32 s44, s61, 9
    s_cmp_ge_u32 s61, 9
    s_cselect_b32 s61, s44, s61
    s_cmp_lt_u32 s61, 4
    s_cselect_b32 s44, 1, -1
    s_cmp_eq_u32 s61, 8
    s_cselect_b32 s44, 0, s44
    s_lshl_b32 s45, s61, 5
    v_mad_i32_i24 v31, v217, s44, v216
    v_add_u32 v31, s45, v31
    v_add_u32 v40, 36864, v31
    s_lshl_b32 s62, s40, 1
    s_add_u32 s62, s62, 8
    s_sub_u32 s44, s62, 9
    s_cmp_ge_u32 s62, 9
    s_cselect_b32 s62, s44, s62
    s_cmp_lt_u32 s62, 4
    s_cselect_b32 s44, 1, -1
    s_cmp_eq_u32 s62, 8
    s_cselect_b32 s44, 0, s44
    s_lshl_b32 s45, s62, 5
    v_mad_i32_i24 v32, v217, s44, v216
    v_add_u32 v32, s45, v32
    v_add_u32 v41, 36864, v32
    v_accvgpr_write_b32 a28, v5
    v_accvgpr_write_b32 a29, v5
    v_accvgpr_write_b32 a30, v5
    v_accvgpr_write_b32 a31, v5
    s_add_u32 m0, s49, 18432
    s_nop 0
    buffer_load_dwordx4 v10, s[28:31], s51 offen lds
    s_add_u32 m0, s49, 19456
    s_nop 0
    buffer_load_dwordx4 v11, s[28:31], s51 offen lds
    s_add_u32 m0, s49, 20480
    s_nop 0
    buffer_load_dwordx4 v12, s[28:31], s51 offen lds
    s_add_u32 m0, s49, 21504
    s_nop 0
    buffer_load_dwordx4 v13, s[28:31], s51 offen lds
    s_add_u32 m0, s49, 22528
    s_mov_b32 exec_hi, 0
    buffer_load_dwordx4 v14, s[28:31], s51 offen lds
    s_mov_b32 exec_hi, -1
    s_add_u32 s51, s51, 221184
    s_add_u32 m0, s48, 4096
    s_nop 0
    buffer_load_dwordx4 v6, s[24:27], s50 offen lds
    s_add_u32 m0, s48, 5120
    s_nop 0
    buffer_load_dwordx4 v7, s[24:27], s50 offen lds
    s_add_u32 m0, s48, 6144
    s_nop 0
    buffer_load_dwordx4 v8, s[24:27], s50 offen lds
    s_add_u32 m0, s48, 7168
    s_nop 0
    buffer_load_dwordx4 v9, s[24:27], s50 offen lds
    s_add_u32 s50, s50, 128
    s_getpc_b64 s[36:37]
Lpc_qkv_kernel_1:
    s_sub_u32 s36, s36, Lpc_qkv_kernel_1-L_text_begin
    s_subb_u32 s37, s37, 0
    s_mov_b32 s38, L_text_end-L_text_begin
    s_mov_b32 s39, 0x20000
    s_lshr_b32 s44, s2, 3
    s_mul_i32 s44, s44, 4
    s_add_u32 s44, s44, s40
    s_and_b32 s44, s44, 15
    s_lshl_b32 s44, s44, 13
    v_lshlrev_b32 v249, 7, v1
    buffer_load_dword v250, v249, s[36:39], s44 offen
    s_cmp_ge_u32 s42, 8
    s_cbranch_scc1 L_qkv_ori1
    s_branch L_qkv_ori0
L_qkv_hlp:
    v_and_b32 v1, 63, v0
    v_lshrrev_b32 v2, 6, v0
    v_mul_u32_u24 v3, 3456, v1
    v_readfirstlane_b32 s40, v2
    v_mul_u32_u24 v4, 1152, v1
    s_sub_u32 s41, s2, 0
    s_lshr_b32 s41, s41, 3
    s_lshl_b32 s41, s41, 2
    s_add_u32 s41, s41, s40
    s_and_b32 s42, s2, 1
    s_mul_i32 s42, s42, 1664
    s_bfe_u32 s43, s2, 0x20001
    s_mul_i32 s43, s43, 589824
    s_getpc_b64 s[32:33]
Lpc_qkv_kernel_2:
    s_sub_u32 s32, s32, Lpc_qkv_kernel_2-L_text_begin
    s_subb_u32 s33, s33, 0
    s_mov_b32 s34, L_text_end-L_text_begin
    s_mov_b32 s35, 0x20000
    s_lshr_b32 s44, s2, 3
    s_mul_i32 s44, s44, 4
    s_add_u32 s44, s44, s40
    s_and_b32 s44, s44, 15
    s_lshl_b32 s44, s44, 13
    v_lshlrev_b32 v52, 7, v1
    buffer_load_dword v53, v52, s[32:35], s44 offen
L_qkv_nc:
    s_waitcnt lgkmcnt(0)
    s_mov_b32 s24, s4
    s_mov_b32 s25, s5
    s_mov_b32 s26, 2359296
    s_mov_b32 s27, 0x20000
    s_mov_b32 s28, s6
    s_mov_b32 s29, s7
    s_mov_b32 s30, 1990656
    s_mov_b32 s31, 0x20000
    s_mov_b32 s47, s41
    s_cmp_ge_u32 s41, 176
    s_cbranch_scc1 L_qkv_h2
    s_mul_i32 s44, s41, 2979
    s_lshr_b32 s44, s44, 16
    s_mul_i32 s45, s44, 22
    s_sub_u32 s45, s41, s45
    s_add_u32 s44, s44, 1
    s_cmp_ge_u32 s45, 14
    s_cbranch_scc1 L_qkv_hx0
    s_mul_i32 s46, s44, 221184
    s_lshl_b32 s45, s45, 7
    s_add_u32 s46, s46, s45
    s_add_u32 s46, s46, s42
    buffer_load_dword v8, v3, s[28:31], s46 offen
    s_branch L_qkv_hj0
L_qkv_hx0:
    s_sub_u32 s45, s45, 14
    s_mul_i32 s45, s45, 73728
    s_lshl_b32 s46, s44, 7
    s_add_u32 s46, s46, s45
    s_add_u32 s46, s46, s43
    buffer_load_dword v8, v4, s[24:27], s46 offen
L_qkv_hj0:
    s_add_u32 s41, s41, 32
    s_cmp_ge_u32 s41, 176
    s_cbranch_scc1 L_qkv_h2
    s_mul_i32 s44, s41, 2979
    s_lshr_b32 s44, s44, 16
    s_mul_i32 s45, s44, 22
    s_sub_u32 s45, s41, s45
    s_add_u32 s44, s44, 1
    s_cmp_ge_u32 s45, 14
    s_cbranch_scc1 L_qkv_hx1
    s_mul_i32 s46, s44, 221184
    s_lshl_b32 s45, s45, 7
    s_add_u32 s46, s46, s45
    s_add_u32 s46, s46, s42
    buffer_load_dword v9, v3, s[28:31], s46 offen
    s_branch L_qkv_hj1
L_qkv_hx1:
    s_sub_u32 s45, s45, 14
    s_mul_i32 s45, s45, 73728
    s_lshl_b32 s46, s44, 7
    s_add_u32 s46, s46, s45
    s_add_u32 s46, s46, s43
    buffer_load_dword v9, v4, s[24:27], s46 offen
L_qkv_hj1:
    s_add_u32 s41, s41, 32
    s_waitcnt vmcnt(1)
    s_cmp_ge_u32 s41, 176
    s_cbranch_scc1 L_qkv_h2
    s_mul_i32 s44, s41, 2979
    s_lshr_b32 s44, s44, 16
    s_mul_i32 s45, s44, 22
    s_sub_u32 s45, s41, s45
    s_add_u32 s44, s44, 1
    s_cmp_ge_u32 s45, 14
    s_cbranch_scc1 L_qkv_hx2
    s_mul_i32 s46, s44, 221184
    s_lshl_b32 s45, s45, 7
    s_add_u32 s46, s46, s45
    s_add_u32 s46, s46, s42
    buffer_load_dword v10, v3, s[28:31], s46 offen
    s_branch L_qkv_hj2
L_qkv_hx2:
    s_sub_u32 s45, s45, 14
    s_mul_i32 s45, s45, 73728
    s_lshl_b32 s46, s44, 7
    s_add_u32 s46, s46, s45
    s_add_u32 s46, s46, s43
    buffer_load_dword v10, v4, s[24:27], s46 offen
L_qkv_hj2:
    s_add_u32 s41, s41, 32
    s_waitcnt vmcnt(1)
    s_cmp_ge_u32 s41, 176
    s_cbranch_scc1 L_qkv_h2
    s_mul_i32 s44, s41, 2979
    s_lshr_b32 s44, s44, 16
    s_mul_i32 s45, s44, 22
    s_sub_u32 s45, s41, s45
    s_add_u32 s44, s44, 1
    s_cmp_ge_u32 s45, 14
    s_cbranch_scc1 L_qkv_hx3
    s_mul_i32 s46, s44, 221184
    s_lshl_b32 s45, s45, 7
    s_add_u32 s46, s46, s45
    s_add_u32 s46, s46, s42
    buffer_load_dword v11, v3, s[28:31], s46 offen
    s_branch L_qkv_hj3
L_qkv_hx3:
    s_sub_u32 s45, s45, 14
    s_mul_i32 s45, s45, 73728
    s_lshl_b32 s46, s44, 7
    s_add_u32 s46, s46, s45
    s_add_u32 s46, s46, s43
    buffer_load_dword v11, v4, s[24:27], s46 offen
L_qkv_hj3:
    s_add_u32 s41, s41, 32
    s_waitcnt vmcnt(1)
    s_cmp_ge_u32 s41, 176
    s_cbranch_scc1 L_qkv_h2
    s_mul_i32 s44, s41, 2979
    s_lshr_b32 s44, s44, 16
    s_mul_i32 s45, s44, 22
    s_sub_u32 s45, s41, s45
    s_add_u32 s44, s44, 1
    s_cmp_ge_u32 s45, 14
    s_cbranch_scc1 L_qkv_hx4
    s_mul_i32 s46, s44, 221184
    s_lshl_b32 s45, s45, 7
    s_add_u32 s46, s46, s45
    s_add_u32 s46, s46, s42
    buffer_load_dword v12, v3, s[28:31], s46 offen
    s_branch L_qkv_hj4
L_qkv_hx4:
    s_sub_u32 s45, s45, 14
    s_mul_i32 s45, s45, 73728
    s_lshl_b32 s46, s44, 7
    s_add_u32 s46, s46, s45
    s_add_u32 s46, s46, s43
    buffer_load_dword v12, v4, s[24:27], s46 offen
L_qkv_hj4:
    s_add_u32 s41, s41, 32
    s_waitcnt vmcnt(1)
    s_cmp_ge_u32 s41, 176
    s_cbranch_scc1 L_qkv_h2
    s_mul_i32 s44, s41, 2979
    s_lshr_b32 s44, s44, 16
    s_mul_i32 s45, s44, 22
    s_sub_u32 s45, s41, s45
    s_add_u32 s44, s44, 1
    s_cmp_ge_u32 s45, 14
    s_cbranch_scc1 L_qkv_hx5
    s_mul_i32 s46, s44, 221184
    s_lshl_b32 s45, s45, 7
    s_add_u32 s46, s46, s45
    s_add_u32 s46, s46, s42
    buffer_load_dword v13, v3, s[28:31], s46 offen
    s_branch L_qkv_hj5
L_qkv_hx5:
    s_sub_u32 s45, s45, 14
    s_mul_i32 s45, s45, 73728
    s_lshl_b32 s46, s44, 7
    s_add_u32 s46, s46, s45
    s_add_u32 s46, s46, s43
    buffer_load_dword v13, v4, s[24:27], s46 offen
L_qkv_hj5:
    s_add_u32 s41, s41, 32
L_qkv_h2:
    s_sub_u32 s41, s2, 0
    s_lshl_b32 s41, s41, 2
    s_add_u32 s41, s41, s40
    s_lshl_b32 s41, s41, 13
    s_waitcnt vmcnt(0)
    v_lshl_add_u32 v3, v1, 7, s41
    v_add_u32 v4, 2097152, v3
    v_add_u32 v5, 4194304, v3
    v_add_u32 v6, 6291456, v3
    s_mov_b32 s24, s18
    s_mov_b32 s25, s19
    s_mov_b32 s26, 2654208
    s_mov_b32 s27, 0x20000
    buffer_load_dword v20, v3, s[24:27], 0 offen
    buffer_load_dword v21, v4, s[24:27], 0 offen
    s_lshr_b32 s41, s41, 13
    s_sub_u32 s42, s41, 64
    s_cmp_lt_u32 s42, 27
    s_cbranch_scc1 L_qkv_tab
    s_sub_u32 s41, 255, s41
    s_cmp_ge_u32 s41, 32
    s_cbranch_scc1 L_end_qkv_kernel
    s_mul_i32 s41, s41, 73728
    v_lshrrev_b32 v3, 4, v1
    v_mul_u32_u24 v3, 18432, v3
    v_and_b32 v4, 15, v1
    v_lshl_add_u32 v3, v4, 7, v3
    s_add_u32 s24, s22, 16793600
    s_addc_u32 s25, s23, 0
    s_mov_b32 s26, 2342912
    s_mov_b32 s27, 0x20000
    buffer_load_dword v30, v3, s[24:27], s41 offen
L_end_qkv_kernel:
    s_endpgm
.p2align 12
L_pgqkv_kernel_1:
    s_branch L_hopqkv_kernel_1
L_pgqkv_kernel_1_s:
L_qkv_ori0:
    s_waitcnt vmcnt(14)
    s_waitcnt vmcnt(10)
    s_barrier
    ds_read_b128 v[114:117], v15 offset:0
    ds_read_b128 v[118:121], v15 offset:2048
    ds_read_b64_tr_b16 v[42:43], v24 offset:0
    ds_read_b64_tr_b16 v[44:45], v24 offset:1152
    ds_read_b64_tr_b16 v[46:47], v25 offset:0
    ds_read_b64_tr_b16 v[48:49], v25 offset:1152
    ds_read_b64_tr_b16 v[50:51], v26 offset:0
    ds_read_b64_tr_b16 v[52:53], v26 offset:1152
    ds_read_b64_tr_b16 v[54:55], v27 offset:0
    ds_read_b64_tr_b16 v[56:57], v27 offset:1152
    ds_read_b64_tr_b16 v[58:59], v28 offset:0
    ds_read_b64_tr_b16 v[60:61], v28 offset:1152
    ds_read_b64_tr_b16 v[62:63], v29 offset:0
    ds_read_b64_tr_b16 v[64:65], v29 offset:1152
    ds_read_b64_tr_b16 v[66:67], v30 offset:0
    ds_read_b64_tr_b16 v[68:69], v30 offset:1152
    ds_read_b64_tr_b16 v[70:71], v31 offset:0
    ds_read_b64_tr_b16 v[72:73], v31 offset:1152
    ds_read_b64_tr_b16 v[74:75], v32 offset:0
    ds_read_b64_tr_b16 v[76:77], v32 offset:1152
    s_waitcnt lgkmcnt(0)
    v_mfma_f32_16x16x32_bf16 v[130:133], v[42:45], v[114:117], 0
    ds_read_b128 v[122:125], v16 offset:0
    v_mfma_f32_16x16x32_bf16 v[134:137], v[42:45], v[118:121], 0
    ds_read_b128 v[126:129], v16 offset:2048
    v_mfma_f32_16x16x32_bf16 a[0:3], a[28:31], v[114:117], 0
    ds_read_b64_tr_b16 v[78:79], v24 offset:9216
    ds_read_b64_tr_b16 v[80:81], v24 offset:10368
    v_mfma_f32_16x16x32_bf16 v[138:141], v[46:49], v[114:117], 0
    ds_read_b64_tr_b16 v[82:83], v25 offset:9216
    ds_read_b64_tr_b16 v[84:85], v25 offset:10368
    v_mfma_f32_16x16x32_bf16 v[142:145], v[46:49], v[118:121], 0
    ds_read_b64_tr_b16 v[86:87], v26 offset:9216
    ds_read_b64_tr_b16 v[88:89], v26 offset:10368
    v_mfma_f32_16x16x32_bf16 v[146:149], v[50:53], v[114:117], 0
    ds_read_b64_tr_b16 v[90:91], v27 offset:9216
    ds_read_b64_tr_b16 v[92:93], v27 offset:10368
    v_mfma_f32_16x16x32_bf16 a[4:7], v[114:117], v[114:117], 0
    ds_read_b64_tr_b16 v[94:95], v28 offset:9216
    ds_read_b64_tr_b16 v[96:97], v28 offset:10368
    v_mfma_f32_16x16x32_bf16 v[150:153], v[50:53], v[118:121], 0
    v_mfma_f32_16x16x32_bf16 v[154:157], v[54:57], v[114:117], 0
    ds_read_b64_tr_b16 v[98:99], v29 offset:9216
    ds_read_b64_tr_b16 v[100:101], v29 offset:10368
    v_mfma_f32_16x16x32_bf16 v[158:161], v[54:57], v[118:121], 0
    s_add_u32 m0, s48, 8192
    s_nop 0
    buffer_load_dwordx4 v6, s[24:27], s50 offen lds
    v_mfma_f32_16x16x32_bf16 a[8:11], a[28:31], v[118:121], 0
    ds_read_b64_tr_b16 v[102:103], v30 offset:9216
    ds_read_b64_tr_b16 v[104:105], v30 offset:10368
    v_mfma_f32_16x16x32_bf16 v[162:165], v[58:61], v[114:117], 0
    s_add_u32 m0, s48, 9216
    s_nop 0
    buffer_load_dwordx4 v7, s[24:27], s50 offen lds
    v_mfma_f32_16x16x32_bf16 v[166:169], v[58:61], v[118:121], 0
    ds_read_b64_tr_b16 v[106:107], v31 offset:9216
    ds_read_b64_tr_b16 v[108:109], v31 offset:10368
    v_mfma_f32_16x16x32_bf16 v[170:173], v[62:65], v[114:117], 0
    s_add_u32 m0, s48, 10240
    s_nop 0
    buffer_load_dwordx4 v8, s[24:27], s50 offen lds
    v_mfma_f32_16x16x32_bf16 a[12:15], v[118:121], v[118:121], 0
    ds_read_b64_tr_b16 v[110:111], v32 offset:9216
    ds_read_b64_tr_b16 v[112:113], v32 offset:10368
    v_mfma_f32_16x16x32_bf16 v[174:177], v[62:65], v[118:121], 0
    s_add_u32 m0, s48, 11264
    s_nop 0
    buffer_load_dwordx4 v9, s[24:27], s50 offen lds
    s_add_u32 s50, s50, 128
    v_mfma_f32_16x16x32_bf16 v[178:181], v[66:69], v[114:117], 0
    s_add_u32 m0, s48, 12288
    s_nop 0
    buffer_load_dwordx4 v6, s[24:27], s50 offen lds
    v_mfma_f32_16x16x32_bf16 v[182:185], v[66:69], v[118:121], 0
    s_add_u32 m0, s48, 13312
    s_nop 0
    buffer_load_dwordx4 v7, s[24:27], s50 offen lds
    v_mfma_f32_16x16x32_bf16 a[16:19], a[28:31], v[42:45], 0
    s_add_u32 m0, s48, 14336
    s_nop 0
    buffer_load_dwordx4 v8, s[24:27], s50 offen lds
    v_mfma_f32_16x16x32_bf16 v[186:189], v[70:73], v[114:117], 0
    v_mfma_f32_16x16x32_bf16 v[190:193], v[70:73], v[118:121], 0
    s_add_u32 m0, s48, 15360
    s_nop 0
    buffer_load_dwordx4 v9, s[24:27], s50 offen lds
    s_add_u32 s50, s50, 128
    v_mfma_f32_16x16x32_bf16 v[194:197], v[74:77], v[114:117], 0
    v_mfma_f32_16x16x32_bf16 a[20:23], a[28:31], v[46:49], 0
    v_mfma_f32_16x16x32_bf16 v[198:201], v[74:77], v[118:121], 0
    v_mfma_f32_16x16x32_bf16 a[24:27], a[28:31], v[50:53], 0
    s_waitcnt vmcnt(13)
    s_waitcnt vmcnt(9)
    s_barrier
    s_waitcnt lgkmcnt(0)
    v_mfma_f32_16x16x32_bf16 v[130:133], v[78:81], v[122:125], v[130:133]
    ds_read_b128 v[114:117], v15 offset:4096
    v_mfma_f32_16x16x32_bf16 v[134:137], v[78:81], v[126:129], v[134:137]
    ds_read_b128 v[118:121], v15 offset:6144
    v_mfma_f32_16x16x32_bf16 a[0:3], a[28:31], v[122:125], a[0:3]
    ds_read_b64_tr_b16 v[42:43], v24 offset:18432
    ds_read_b64_tr_b16 v[44:45], v24 offset:19584
    v_mfma_f32_16x16x32_bf16 v[138:141], v[82:85], v[122:125], v[138:141]
    ds_read_b64_tr_b16 v[46:47], v25 offset:18432
    ds_read_b64_tr_b16 v[48:49], v25 offset:19584
    v_mfma_f32_16x16x32_bf16 v[142:145], v[82:85], v[126:129], v[142:145]
    ds_read_b64_tr_b16 v[50:51], v26 offset:18432
    ds_read_b64_tr_b16 v[52:53], v26 offset:19584
    v_mfma_f32_16x16x32_bf16 v[146:149], v[86:89], v[122:125], v[146:149]
    ds_read_b64_tr_b16 v[54:55], v27 offset:18432
    ds_read_b64_tr_b16 v[56:57], v27 offset:19584
    v_mfma_f32_16x16x32_bf16 a[4:7], v[122:125], v[122:125], a[4:7]
    ds_read_b64_tr_b16 v[58:59], v28 offset:18432
    ds_read_b64_tr_b16 v[60:61], v28 offset:19584
    v_mfma_f32_16x16x32_bf16 v[150:153], v[86:89], v[126:129], v[150:153]
    v_mfma_f32_16x16x32_bf16 v[154:157], v[90:93], v[122:125], v[154:157]
    ds_read_b64_tr_b16 v[62:63], v29 offset:18432
    ds_read_b64_tr_b16 v[64:65], v29 offset:19584
    v_mfma_f32_16x16x32_bf16 v[158:161], v[90:93], v[126:129], v[158:161]
    s_add_u32 m0, s49, 36864
    s_nop 0
    buffer_load_dwordx4 v10, s[28:31], s51 offen lds
    v_mfma_f32_16x16x32_bf16 a[8:11], a[28:31], v[126:129], a[8:11]
    ds_read_b64_tr_b16 v[66:67], v30 offset:18432
    ds_read_b64_tr_b16 v[68:69], v30 offset:19584
    v_mfma_f32_16x16x32_bf16 v[162:165], v[94:97], v[122:125], v[162:165]
    s_add_u32 m0, s49, 37888
    s_nop 0
    buffer_load_dwordx4 v11, s[28:31], s51 offen lds
    v_mfma_f32_16x16x32_bf16 v[166:169], v[94:97], v[126:129], v[166:169]
    ds_read_b64_tr_b16 v[70:71], v31 offset:18432
    ds_read_b64_tr_b16 v[72:73], v31 offset:19584
    v_mfma_f32_16x16x32_bf16 v[170:173], v[98:101], v[122:125], v[170:173]
    s_add_u32 m0, s49, 38912
    s_nop 0
    buffer_load_dwordx4 v12, s[28:31], s51 offen lds
    v_mfma_f32_16x16x32_bf16 a[12:15], v[126:129], v[126:129], a[12:15]
    ds_read_b64_tr_b16 v[74:75], v32 offset:18432
    ds_read_b64_tr_b16 v[76:77], v32 offset:19584
    v_mfma_f32_16x16x32_bf16 v[174:177], v[98:101], v[126:129], v[174:177]
    s_add_u32 m0, s49, 39936
    s_nop 0
    buffer_load_dwordx4 v13, s[28:31], s51 offen lds
    v_mfma_f32_16x16x32_bf16 v[178:181], v[102:105], v[122:125], v[178:181]
    s_add_u32 m0, s49, 40960
    s_mov_b32 exec_hi, 0
    buffer_load_dwordx4 v14, s[28:31], s51 offen lds
    s_mov_b32 exec_hi, -1
    s_add_u32 s51, s51, 221184
    v_mfma_f32_16x16x32_bf16 v[182:185], v[102:105], v[126:129], v[182:185]
    s_add_u32 m0, s49, 55296
    s_nop 0
    buffer_load_dwordx4 v10, s[28:31], s51 offen lds
    v_mfma_f32_16x16x32_bf16 a[16:19], a[28:31], v[78:81], a[16:19]
    s_add_u32 m0, s49, 56320
    s_nop 0
    buffer_load_dwordx4 v11, s[28:31], s51 offen lds
    v_mfma_f32_16x16x32_bf16 v[186:189], v[106:109], v[122:125], v[186:189]
    v_mfma_f32_16x16x32_bf16 v[190:193], v[106:109], v[126:129], v[190:193]
    s_add_u32 m0, s49, 57344
    s_nop 0
    buffer_load_dwordx4 v12, s[28:31], s51 offen lds
    v_mfma_f32_16x16x32_bf16 v[194:197], v[110:113], v[122:125], v[194:197]
    v_mfma_f32_16x16x32_bf16 a[20:23], a[28:31], v[82:85], a[20:23]
    s_add_u32 m0, s49, 58368
    s_nop 0
    buffer_load_dwordx4 v13, s[28:31], s51 offen lds
    v_mfma_f32_16x16x32_bf16 v[198:201], v[110:113], v[126:129], v[198:201]
    s_add_u32 m0, s49, 59392
    s_mov_b32 exec_hi, 0
    buffer_load_dwordx4 v14, s[28:31], s51 offen lds
    s_mov_b32 exec_hi, -1
    s_add_u32 s51, s51, 221184
    v_mfma_f32_16x16x32_bf16 a[24:27], a[28:31], v[86:89], a[24:27]
    s_waitcnt lgkmcnt(0)
    v_mfma_f32_16x16x32_bf16 v[130:133], v[42:45], v[114:117], v[130:133]
    ds_read_b128 v[122:125], v16 offset:4096
    v_mfma_f32_16x16x32_bf16 v[134:137], v[42:45], v[118:121], v[134:137]
    ds_read_b128 v[126:129], v16 offset:6144
    v_mfma_f32_16x16x32_bf16 a[0:3], a[28:31], v[114:117], a[0:3]
    ds_read_b64_tr_b16 v[78:79], v24 offset:27648
    ds_read_b64_tr_b16 v[80:81], v24 offset:28800
    v_mfma_f32_16x16x32_bf16 v[138:141], v[46:49], v[114:117], v[138:141]
    ds_read_b64_tr_b16 v[82:83], v25 offset:27648
    ds_read_b64_tr_b16 v[84:85], v25 offset:28800
    v_mfma_f32_16x16x32_bf16 v[142:145], v[46:49], v[118:121], v[142:145]
    ds_read_b64_tr_b16 v[86:87], v26 offset:27648
    ds_read_b64_tr_b16 v[88:89], v26 offset:28800
    v_mfma_f32_16x16x32_bf16 v[146:149], v[50:53], v[114:117], v[146:149]
    ds_read_b64_tr_b16 v[90:91], v27 offset:27648
    ds_read_b64_tr_b16 v[92:93], v27 offset:28800
    v_mfma_f32_16x16x32_bf16 a[4:7], v[114:117], v[114:117], a[4:7]
    ds_read_b64_tr_b16 v[94:95], v28 offset:27648
    ds_read_b64_tr_b16 v[96:97], v28 offset:28800
    v_mfma_f32_16x16x32_bf16 v[150:153], v[50:53], v[118:121], v[150:153]
    v_mfma_f32_16x16x32_bf16 v[154:157], v[54:57], v[114:117], v[154:157]
    ds_read_b64_tr_b16 v[98:99], v29 offset:27648
    ds_read_b64_tr_b16 v[100:101], v29 offset:28800
    v_mfma_f32_16x16x32_bf16 v[158:161], v[54:57], v[118:121], v[158:161]
    v_mfma_f32_16x16x32_bf16 a[8:11], a[28:31], v[118:121], a[8:11]
    ds_read_b64_tr_b16 v[102:103], v30 offset:27648
    ds_read_b64_tr_b16 v[104:105], v30 offset:28800
    v_mfma_f32_16x16x32_bf16 v[162:165], v[58:61], v[114:117], v[162:165]
    v_mfma_f32_16x16x32_bf16 v[166:169], v[58:61], v[118:121], v[166:169]
    ds_read_b64_tr_b16 v[106:107], v31 offset:27648
    ds_read_b64_tr_b16 v[108:109], v31 offset:28800
    v_mfma_f32_16x16x32_bf16 v[170:173], v[62:65], v[114:117], v[170:173]
    s_add_u32 m0, s48, 0
    s_nop 0
    buffer_load_dwordx4 v6, s[24:27], s50 offen lds
    v_mfma_f32_16x16x32_bf16 a[12:15], v[118:121], v[118:121], a[12:15]
    ds_read_b64_tr_b16 v[110:111], v32 offset:27648
    ds_read_b64_tr_b16 v[112:113], v32 offset:28800
    v_mfma_f32_16x16x32_bf16 v[174:177], v[62:65], v[118:121], v[174:177]
    v_mfma_f32_16x16x32_bf16 v[178:181], v[66:69], v[114:117], v[178:181]
    s_add_u32 m0, s48, 1024
    s_nop 0
    buffer_load_dwordx4 v7, s[24:27], s50 offen lds
    v_mfma_f32_16x16x32_bf16 v[182:185], v[66:69], v[118:121], v[182:185]
    v_mfma_f32_16x16x32_bf16 a[16:19], a[28:31], v[42:45], a[16:19]
    s_add_u32 m0, s48, 2048
    s_nop 0
    buffer_load_dwordx4 v8, s[24:27], s50 offen lds
    v_mfma_f32_16x16x32_bf16 v[186:189], v[70:73], v[114:117], v[186:189]
    v_mfma_f32_16x16x32_bf16 v[190:193], v[70:73], v[118:121], v[190:193]
    s_add_u32 m0, s48, 3072
    s_nop 0
    buffer_load_dwordx4 v9, s[24:27], s50 offen lds
    s_add_u32 s50, s50, 128
    v_mfma_f32_16x16x32_bf16 v[194:197], v[74:77], v[114:117], v[194:197]
    v_mfma_f32_16x16x32_bf16 a[20:23], a[28:31], v[46:49], a[20:23]
    v_mfma_f32_16x16x32_bf16 v[198:201], v[74:77], v[118:121], v[198:201]
    v_mfma_f32_16x16x32_bf16 a[24:27], a[28:31], v[50:53], a[24:27]
    s_waitcnt vmcnt(9)
    s_barrier
    s_waitcnt lgkmcnt(0)
    v_mfma_f32_16x16x32_bf16 v[130:133], v[78:81], v[122:125], v[130:133]
    ds_read_b128 v[114:117], v15 offset:8192
    v_mfma_f32_16x16x32_bf16 v[134:137], v[78:81], v[126:129], v[134:137]
    ds_read_b128 v[118:121], v15 offset:10240
    v_mfma_f32_16x16x32_bf16 a[0:3], a[28:31], v[122:125], a[0:3]
    ds_read_b64_tr_b16 v[42:43], v33 offset:0
    ds_read_b64_tr_b16 v[44:45], v33 offset:1152
    v_mfma_f32_16x16x32_bf16 v[138:141], v[82:85], v[122:125], v[138:141]
    ds_read_b64_tr_b16 v[46:47], v34 offset:0
    ds_read_b64_tr_b16 v[48:49], v34 offset:1152
    v_mfma_f32_16x16x32_bf16 v[142:145], v[82:85], v[126:129], v[142:145]
    ds_read_b64_tr_b16 v[50:51], v35 offset:0
    ds_read_b64_tr_b16 v[52:53], v35 offset:1152
    v_mfma_f32_16x16x32_bf16 v[146:149], v[86:89], v[122:125], v[146:149]
    ds_read_b64_tr_b16 v[54:55], v36 offset:0
    ds_read_b64_tr_b16 v[56:57], v36 offset:1152
    v_mfma_f32_16x16x32_bf16 a[4:7], v[122:125], v[122:125], a[4:7]
    ds_read_b64_tr_b16 v[58:59], v37 offset:0
    ds_read_b64_tr_b16 v[60:61], v37 offset:1152
    v_mfma_f32_16x16x32_bf16 v[150:153], v[86:89], v[126:129], v[150:153]
    v_mfma_f32_16x16x32_bf16 v[154:157], v[90:93], v[122:125], v[154:157]
    ds_read_b64_tr_b16 v[62:63], v38 offset:0
    ds_read_b64_tr_b16 v[64:65], v38 offset:1152
    v_mfma_f32_16x16x32_bf16 v[158:161], v[90:93], v[126:129], v[158:161]
    v_mfma_f32_16x16x32_bf16 a[8:11], a[28:31], v[126:129], a[8:11]
    ds_read_b64_tr_b16 v[66:67], v39 offset:0
    ds_read_b64_tr_b16 v[68:69], v39 offset:1152
    v_mfma_f32_16x16x32_bf16 v[162:165], v[94:97], v[122:125], v[162:165]
    v_mfma_f32_16x16x32_bf16 v[166:169], v[94:97], v[126:129], v[166:169]
    ds_read_b64_tr_b16 v[70:71], v40 offset:0
    ds_read_b64_tr_b16 v[72:73], v40 offset:1152
    v_mfma_f32_16x16x32_bf16 v[170:173], v[98:101], v[122:125], v[170:173]
    s_add_u32 m0, s49, 0
    s_nop 0
    buffer_load_dwordx4 v10, s[28:31], s51 offen lds
    v_mfma_f32_16x16x32_bf16 a[12:15], v[126:129], v[126:129], a[12:15]
    ds_read_b64_tr_b16 v[74:75], v41 offset:0
    ds_read_b64_tr_b16 v[76:77], v41 offset:1152
    v_mfma_f32_16x16x32_bf16 v[174:177], v[98:101], v[126:129], v[174:177]
    v_mfma_f32_16x16x32_bf16 v[178:181], v[102:105], v[122:125], v[178:181]
    s_add_u32 m0, s49, 1024
    s_nop 0
    buffer_load_dwordx4 v11, s[28:31], s51 offen lds
    v_mfma_f32_16x16x32_bf16 v[182:185], v[102:105], v[126:129], v[182:185]
    v_mfma_f32_16x16x32_bf16 a[16:19], a[28:31], v[78:81], a[16:19]
    s_add_u32 m0, s49, 2048
    s_nop 0
    buffer_load_dwordx4 v12, s[28:31], s51 offen lds
    v_mfma_f32_16x16x32_bf16 v[186:189], v[106:109], v[122:125], v[186:189]
    v_mfma_f32_16x16x32_bf16 v[190:193], v[106:109], v[126:129], v[190:193]
    s_add_u32 m0, s49, 3072
    s_nop 0
    buffer_load_dwordx4 v13, s[28:31], s51 offen lds
    v_mfma_f32_16x16x32_bf16 v[194:197], v[110:113], v[122:125], v[194:197]
    v_mfma_f32_16x16x32_bf16 a[20:23], a[28:31], v[82:85], a[20:23]
    s_add_u32 m0, s49, 4096
    s_mov_b32 exec_hi, 0
    buffer_load_dwordx4 v14, s[28:31], s51 offen lds
    s_mov_b32 exec_hi, -1
    s_add_u32 s51, s51, 221184
    v_mfma_f32_16x16x32_bf16 v[198:201], v[110:113], v[126:129], v[198:201]
    v_mfma_f32_16x16x32_bf16 a[24:27], a[28:31], v[86:89], a[24:27]
    s_waitcnt lgkmcnt(0)
    v_mfma_f32_16x16x32_bf16 v[130:133], v[42:45], v[114:117], v[130:133]
    ds_read_b128 v[122:125], v16 offset:8192
    v_mfma_f32_16x16x32_bf16 v[134:137], v[42:45], v[118:121], v[134:137]
    ds_read_b128 v[126:129], v16 offset:10240
    v_mfma_f32_16x16x32_bf16 a[0:3], a[28:31], v[114:117], a[0:3]
    ds_read_b64_tr_b16 v[78:79], v33 offset:9216
    ds_read_b64_tr_b16 v[80:81], v33 offset:10368
    v_mfma_f32_16x16x32_bf16 v[138:141], v[46:49], v[114:117], v[138:141]
    ds_read_b64_tr_b16 v[82:83], v34 offset:9216
    ds_read_b64_tr_b16 v[84:85], v34 offset:10368
    v_mfma_f32_16x16x32_bf16 v[142:145], v[46:49], v[118:121], v[142:145]
    ds_read_b64_tr_b16 v[86:87], v35 offset:9216
    ds_read_b64_tr_b16 v[88:89], v35 offset:10368
    v_mfma_f32_16x16x32_bf16 v[146:149], v[50:53], v[114:117], v[146:149]
    ds_read_b64_tr_b16 v[90:91], v36 offset:9216
    ds_read_b64_tr_b16 v[92:93], v36 offset:10368
    v_mfma_f32_16x16x32_bf16 a[4:7], v[114:117], v[114:117], a[4:7]
    ds_read_b64_tr_b16 v[94:95], v37 offset:9216
    ds_read_b64_tr_b16 v[96:97], v37 offset:10368
    v_mfma_f32_16x16x32_bf16 v[150:153], v[50:53], v[118:121], v[150:153]
    v_mfma_f32_16x16x32_bf16 v[154:157], v[54:57], v[114:117], v[154:157]
    ds_read_b64_tr_b16 v[98:99], v38 offset:9216
    ds_read_b64_tr_b16 v[100:101], v38 offset:10368
    v_mfma_f32_16x16x32_bf16 v[158:161], v[54:57], v[118:121], v[158:161]
    v_mfma_f32_16x16x32_bf16 a[8:11], a[28:31], v[118:121], a[8:11]
    ds_read_b64_tr_b16 v[102:103], v39 offset:9216
    ds_read_b64_tr_b16 v[104:105], v39 offset:10368
    v_mfma_f32_16x16x32_bf16 v[162:165], v[58:61], v[114:117], v[162:165]
    v_mfma_f32_16x16x32_bf16 v[166:169], v[58:61], v[118:121], v[166:169]
    ds_read_b64_tr_b16 v[106:107], v40 offset:9216
    ds_read_b64_tr_b16 v[108:109], v40 offset:10368
    v_mfma_f32_16x16x32_bf16 v[170:173], v[62:65], v[114:117], v[170:173]
    s_add_u32 m0, s48, 4096
    s_nop 0
    buffer_load_dwordx4 v6, s[24:27], s50 offen lds
    v_mfma_f32_16x16x32_bf16 a[12:15], v[118:121], v[118:121], a[12:15]
    ds_read_b64_tr_b16 v[110:111], v41 offset:9216
    ds_read_b64_tr_b16 v[112:113], v41 offset:10368
    v_mfma_f32_16x16x32_bf16 v[174:177], v[62:65], v[118:121], v[174:177]
    v_mfma_f32_16x16x32_bf16 v[178:181], v[66:69], v[114:117], v[178:181]
    s_add_u32 m0, s48, 5120
    s_nop 0
    buffer_load_dwordx4 v7, s[24:27], s50 offen lds
    v_mfma_f32_16x16x32_bf16 v[182:185], v[66:69], v[118:121], v[182:185]
    v_mfma_f32_16x16x32_bf16 a[16:19], a[28:31], v[42:45], a[16:19]
    s_add_u32 m0, s48, 6144
    s_nop 0
    buffer_load_dwordx4 v8, s[24:27], s50 offen lds
    v_mfma_f32_16x16x32_bf16 v[186:189], v[70:73], v[114:117], v[186:189]
    v_mfma_f32_16x16x32_bf16 v[190:193], v[70:73], v[118:121], v[190:193]
    s_add_u32 m0, s48, 7168
    s_nop 0
    buffer_load_dwordx4 v9, s[24:27], s50 offen lds
    s_add_u32 s50, s50, 128
    v_mfma_f32_16x16x32_bf16 v[194:197], v[74:77], v[114:117], v[194:197]
    v_mfma_f32_16x16x32_bf16 a[20:23], a[28:31], v[46:49], a[20:23]
    v_mfma_f32_16x16x32_bf16 v[198:201], v[74:77], v[118:121], v[198:201]
    v_mfma_f32_16x16x32_bf16 a[24:27], a[28:31], v[50:53], a[24:27]
    s_waitcnt vmcnt(13)
    s_barrier
    s_waitcnt lgkmcnt(0)
    v_mfma_f32_16x16x32_bf16 v[130:133], v[78:81], v[122:125], v[130:133]
    ds_read_b128 v[114:117], v15 offset:12288
    v_mfma_f32_16x16x32_bf16 v[134:137], v[78:81], v[126:129], v[134:137]
    ds_read_b128 v[118:121], v15 offset:14336
    v_mfma_f32_16x16x32_bf16 a[0:3], a[28:31], v[122:125], a[0:3]
    ds_read_b64_tr_b16 v[42:43], v33 offset:18432
    ds_read_b64_tr_b16 v[44:45], v33 offset:19584
    v_mfma_f32_16x16x32_bf16 v[138:141], v[82:85], v[122:125], v[138:141]
    ds_read_b64_tr_b16 v[46:47], v34 offset:18432
    ds_read_b64_tr_b16 v[48:49], v34 offset:19584
    v_mfma_f32_16x16x32_bf16 v[142:145], v[82:85], v[126:129], v[142:145]
    ds_read_b64_tr_b16 v[50:51], v35 offset:18432
    ds_read_b64_tr_b16 v[52:53], v35 offset:19584
    v_mfma_f32_16x16x32_bf16 v[146:149], v[86:89], v[122:125], v[146:149]
    ds_read_b64_tr_b16 v[54:55], v36 offset:18432
    ds_read_b64_tr_b16 v[56:57], v36 offset:19584
    v_mfma_f32_16x16x32_bf16 a[4:7], v[122:125], v[122:125], a[4:7]
    ds_read_b64_tr_b16 v[58:59], v37 offset:18432
    ds_read_b64_tr_b16 v[60:61], v37 offset:19584
    v_mfma_f32_16x16x32_bf16 v[150:153], v[86:89], v[126:129], v[150:153]
    v_mfma_f32_16x16x32_bf16 v[154:157], v[90:93], v[122:125], v[154:157]
    ds_read_b64_tr_b16 v[62:63], v38 offset:18432
    ds_read_b64_tr_b16 v[64:65], v38 offset:19584
    v_mfma_f32_16x16x32_bf16 v[158:161], v[90:93], v[126:129], v[158:161]
    v_mfma_f32_16x16x32_bf16 a[8:11], a[28:31], v[126:129], a[8:11]
    ds_read_b64_tr_b16 v[66:67], v39 offset:18432
    ds_read_b64_tr_b16 v[68:69], v39 offset:19584
    v_mfma_f32_16x16x32_bf16 v[162:165], v[94:97], v[122:125], v[162:165]
    v_mfma_f32_16x16x32_bf16 v[166:169], v[94:97], v[126:129], v[166:169]
    ds_read_b64_tr_b16 v[70:71], v40 offset:18432
    ds_read_b64_tr_b16 v[72:73], v40 offset:19584
    v_mfma_f32_16x16x32_bf16 v[170:173], v[98:101], v[122:125], v[170:173]
    s_add_u32 m0, s49, 18432
    s_nop 0
    buffer_load_dwordx4 v10, s[28:31], s51 offen lds
    v_mfma_f32_16x16x32_bf16 a[12:15], v[126:129], v[126:129], a[12:15]
    ds_read_b64_tr_b16 v[74:75], v41 offset:18432
    ds_read_b64_tr_b16 v[76:77], v41 offset:19584
    v_mfma_f32_16x16x32_bf16 v[174:177], v[98:101], v[126:129], v[174:177]
    v_mfma_f32_16x16x32_bf16 v[178:181], v[102:105], v[122:125], v[178:181]
    s_add_u32 m0, s49, 19456
    s_nop 0
    buffer_load_dwordx4 v11, s[28:31], s51 offen lds
    v_mfma_f32_16x16x32_bf16 v[182:185], v[102:105], v[126:129], v[182:185]
    v_mfma_f32_16x16x32_bf16 a[16:19], a[28:31], v[78:81], a[16:19]
    s_add_u32 m0, s49, 20480
    s_nop 0
    buffer_load_dwordx4 v12, s[28:31], s51 offen lds
    v_mfma_f32_16x16x32_bf16 v[186:189], v[106:109], v[122:125], v[186:189]
    v_mfma_f32_16x16x32_bf16 v[190:193], v[106:109], v[126:129], v[190:193]
    s_add_u32 m0, s49, 21504
    s_nop 0
    buffer_load_dwordx4 v13, s[28:31], s51 offen lds
    v_mfma_f32_16x16x32_bf16 v[194:197], v[110:113], v[122:125], v[194:197]
    v_mfma_f32_16x16x32_bf16 a[20:23], a[28:31], v[82:85], a[20:23]
    s_add_u32 m0, s49, 22528
    s_mov_b32 exec_hi, 0
    buffer_load_dwordx4 v14, s[28:31], s51 offen lds
    s_mov_b32 exec_hi, -1
    s_add_u32 s51, s51, 221184
    v_mfma_f32_16x16x32_bf16 v[198:201], v[110:113], v[126:129], v[198:201]
    v_mfma_f32_16x16x32_bf16 a[24:27], a[28:31], v[86:89], a[24:27]
    s_waitcnt lgkmcnt(0)
    v_mfma_f32_16x16x32_bf16 v[130:133], v[42:45], v[114:117], v[130:133]
    ds_read_b128 v[122:125], v16 offset:12288
    v_mfma_f32_16x16x32_bf16 v[134:137], v[42:45], v[118:121], v[134:137]
    ds_read_b128 v[126:129], v16 offset:14336
    v_mfma_f32_16x16x32_bf16 a[0:3], a[28:31], v[114:117], a[0:3]
    ds_read_b64_tr_b16 v[78:79], v33 offset:27648
    ds_read_b64_tr_b16 v[80:81], v33 offset:28800
    v_mfma_f32_16x16x32_bf16 v[138:141], v[46:49], v[114:117], v[138:141]
    ds_read_b64_tr_b16 v[82:83], v34 offset:27648
    ds_read_b64_tr_b16 v[84:85], v34 offset:28800
    v_mfma_f32_16x16x32_bf16 v[142:145], v[46:49], v[118:121], v[142:145]
    ds_read_b64_tr_b16 v[86:87], v35 offset:27648
    ds_read_b64_tr_b16 v[88:89], v35 offset:28800
    v_mfma_f32_16x16x32_bf16 v[146:149], v[50:53], v[114:117], v[146:149]
    ds_read_b64_tr_b16 v[90:91], v36 offset:27648
    ds_read_b64_tr_b16 v[92:93], v36 offset:28800
    v_mfma_f32_16x16x32_bf16 a[4:7], v[114:117], v[114:117], a[4:7]
    ds_read_b64_tr_b16 v[94:95], v37 offset:27648
    ds_read_b64_tr_b16 v[96:97], v37 offset:28800
    v_mfma_f32_16x16x32_bf16 v[150:153], v[50:53], v[118:121], v[150:153]
    v_mfma_f32_16x16x32_bf16 v[154:157], v[54:57], v[114:117], v[154:157]
    ds_read_b64_tr_b16 v[98:99], v38 offset:27648
    ds_read_b64_tr_b16 v[100:101], v38 offset:28800
    v_mfma_f32_16x16x32_bf16 v[158:161], v[54:57], v[118:121], v[158:161]
    v_mfma_f32_16x16x32_bf16 a[8:11], a[28:31], v[118:121], a[8:11]
    ds_read_b64_tr_b16 v[102:103], v39 offset:27648
    ds_read_b64_tr_b16 v[104:105], v39 offset:28800
    v_mfma_f32_16x16x32_bf16 v[162:165], v[58:61], v[114:117], v[162:165]
    v_mfma_f32_16x16x32_bf16 v[166:169], v[58:61], v[118:121], v[166:169]
    ds_read_b64_tr_b16 v[106:107], v40 offset:27648
    ds_read_b64_tr_b16 v[108:109], v40 offset:28800
    v_mfma_f32_16x16x32_bf16 v[170:173], v[62:65], v[114:117], v[170:173]
    s_add_u32 m0, s48, 8192
    s_nop 0
    buffer_load_dwordx4 v6, s[24:27], s50 offen lds
    v_mfma_f32_16x16x32_bf16 a[12:15], v[118:121], v[118:121], a[12:15]
    ds_read_b64_tr_b16 v[110:111], v41 offset:27648
    ds_read_b64_tr_b16 v[112:113], v41 offset:28800
    v_mfma_f32_16x16x32_bf16 v[174:177], v[62:65], v[118:121], v[174:177]
    v_mfma_f32_16x16x32_bf16 v[178:181], v[66:69], v[114:117], v[178:181]
    s_add_u32 m0, s48, 9216
    s_nop 0
    buffer_load_dwordx4 v7, s[24:27], s50 offen lds
    v_mfma_f32_16x16x32_bf16 v[182:185], v[66:69], v[118:121], v[182:185]
    v_mfma_f32_16x16x32_bf16 a[16:19], a[28:31], v[42:45], a[16:19]
    s_add_u32 m0, s48, 10240
    s_nop 0
    buffer_load_dwordx4 v8, s[24:27], s50 offen lds
    v_mfma_f32_16x16x32_bf16 v[186:189], v[70:73], v[114:117], v[186:189]
    v_mfma_f32_16x16x32_bf16 v[190:193], v[70:73], v[118:121], v[190:193]
    s_add_u32 m0, s48, 11264
    s_nop 0
    buffer_load_dwordx4 v9, s[24:27], s50 offen lds
    s_add_u32 s50, s50, 128
    v_mfma_f32_16x16x32_bf16 v[194:197], v[74:77], v[114:117], v[194:197]
    v_mfma_f32_16x16x32_bf16 a[20:23], a[28:31], v[46:49], a[20:23]
    v_mfma_f32_16x16x32_bf16 v[198:201], v[74:77], v[118:121], v[198:201]
    v_mfma_f32_16x16x32_bf16 a[24:27], a[28:31], v[50:53], a[24:27]
    s_waitcnt vmcnt(13)
    s_barrier
    s_waitcnt lgkmcnt(0)
    v_mfma_f32_16x16x32_bf16 v[130:133], v[78:81], v[122:125], v[130:133]
    ds_read_b128 v[114:117], v15 offset:0
    v_mfma_f32_16x16x32_bf16 v[134:137], v[78:81], v[126:129], v[134:137]
    ds_read_b128 v[118:121], v15 offset:2048
    v_mfma_f32_16x16x32_bf16 a[0:3], a[28:31], v[122:125], a[0:3]
    ds_read_b64_tr_b16 v[42:43], v24 offset:0
    ds_read_b64_tr_b16 v[44:45], v24 offset:1152
    v_mfma_f32_16x16x32_bf16 v[138:141], v[82:85], v[122:125], v[138:141]
    ds_read_b64_tr_b16 v[46:47], v25 offset:0
    ds_read_b64_tr_b16 v[48:49], v25 offset:1152
    v_mfma_f32_16x16x32_bf16 v[142:145], v[82:85], v[126:129], v[142:145]
    ds_read_b64_tr_b16 v[50:51], v26 offset:0
    ds_read_b64_tr_b16 v[52:53], v26 offset:1152
    v_mfma_f32_16x16x32_bf16 v[146:149], v[86:89], v[122:125], v[146:149]
    ds_read_b64_tr_b16 v[54:55], v27 offset:0
    ds_read_b64_tr_b16 v[56:57], v27 offset:1152
    v_mfma_f32_16x16x32_bf16 a[4:7], v[122:125], v[122:125], a[4:7]
    ds_read_b64_tr_b16 v[58:59], v28 offset:0
    ds_read_b64_tr_b16 v[60:61], v28 offset:1152
    v_mfma_f32_16x16x32_bf16 v[150:153], v[86:89], v[126:129], v[150:153]
    v_mfma_f32_16x16x32_bf16 v[154:157], v[90:93], v[122:125], v[154:157]
    ds_read_b64_tr_b16 v[62:63], v29 offset:0
    ds_read_b64_tr_b16 v[64:65], v29 offset:1152
    v_mfma_f32_16x16x32_bf16 v[158:161], v[90:93], v[126:129], v[158:161]
    v_mfma_f32_16x16x32_bf16 a[8:11], a[28:31], v[126:129], a[8:11]
    ds_read_b64_tr_b16 v[66:67], v30 offset:0
    ds_read_b64_tr_b16 v[68:69], v30 offset:1152
    v_mfma_f32_16x16x32_bf16 v[162:165], v[94:97], v[122:125], v[162:165]
    v_mfma_f32_16x16x32_bf16 v[166:169], v[94:97], v[126:129], v[166:169]
    ds_read_b64_tr_b16 v[70:71], v31 offset:0
    ds_read_b64_tr_b16 v[72:73], v31 offset:1152
    v_mfma_f32_16x16x32_bf16 v[170:173], v[98:101], v[122:125], v[170:173]
    s_add_u32 m0, s49, 36864
    s_nop 0
    buffer_load_dwordx4 v10, s[28:31], s51 offen lds
    v_mfma_f32_16x16x32_bf16 a[12:15], v[126:129], v[126:129], a[12:15]
    ds_read_b64_tr_b16 v[74:75], v32 offset:0
    ds_read_b64_tr_b16 v[76:77], v32 offset:1152
    v_mfma_f32_16x16x32_bf16 v[174:177], v[98:101], v[126:129], v[174:177]
    v_mfma_f32_16x16x32_bf16 v[178:181], v[102:105], v[122:125], v[178:181]
    s_add_u32 m0, s49, 37888
    s_nop 0
    buffer_load_dwordx4 v11, s[28:31], s51 offen lds
    v_mfma_f32_16x16x32_bf16 v[182:185], v[102:105], v[126:129], v[182:185]
    v_mfma_f32_16x16x32_bf16 a[16:19], a[28:31], v[78:81], a[16:19]
    s_add_u32 m0, s49, 38912
    s_nop 0
    buffer_load_dwordx4 v12, s[28:31], s51 offen lds
    v_mfma_f32_16x16x32_bf16 v[186:189], v[106:109], v[122:125], v[186:189]
    v_mfma_f32_16x16x32_bf16 v[190:193], v[106:109], v[126:129], v[190:193]
    s_add_u32 m0, s49, 39936
    s_nop 0
    buffer_load_dwordx4 v13, s[28:31], s51 offen lds
    v_mfma_f32_16x16x32_bf16 v[194:197], v[110:113], v[122:125], v[194:197]
    v_mfma_f32_16x16x32_bf16 a[20:23], a[28:31], v[82:85], a[20:23]
    s_add_u32 m0, s49, 40960
    s_mov_b32 exec_hi, 0
    buffer_load_dwordx4 v14, s[28:31], s51 offen lds
    s_mov_b32 exec_hi, -1
    s_branch L_pgqkv_kernel_2_s
.p2align 12
L_pgqkv_kernel_2:
    s_branch L_hopqkv_kernel_1
L_pgqkv_kernel_2_s:
    s_add_u32 s51, s51, 221184
    v_mfma_f32_16x16x32_bf16 v[198:201], v[110:113], v[126:129], v[198:201]
    v_mfma_f32_16x16x32_bf16 a[24:27], a[28:31], v[86:89], a[24:27]
    s_waitcnt lgkmcnt(0)
    v_mfma_f32_16x16x32_bf16 v[130:133], v[42:45], v[114:117], v[130:133]
    ds_read_b128 v[122:125], v16 offset:0
    v_mfma_f32_16x16x32_bf16 v[134:137], v[42:45], v[118:121], v[134:137]
    ds_read_b128 v[126:129], v16 offset:2048
    v_mfma_f32_16x16x32_bf16 a[0:3], a[28:31], v[114:117], a[0:3]
    ds_read_b64_tr_b16 v[78:79], v24 offset:9216
    ds_read_b64_tr_b16 v[80:81], v24 offset:10368
    v_mfma_f32_16x16x32_bf16 v[138:141], v[46:49], v[114:117], v[138:141]
    ds_read_b64_tr_b16 v[82:83], v25 offset:9216
    ds_read_b64_tr_b16 v[84:85], v25 offset:10368
    v_mfma_f32_16x16x32_bf16 v[142:145], v[46:49], v[118:121], v[142:145]
    ds_read_b64_tr_b16 v[86:87], v26 offset:9216
    ds_read_b64_tr_b16 v[88:89], v26 offset:10368
    v_mfma_f32_16x16x32_bf16 v[146:149], v[50:53], v[114:117], v[146:149]
    ds_read_b64_tr_b16 v[90:91], v27 offset:9216
    ds_read_b64_tr_b16 v[92:93], v27 offset:10368
    v_mfma_f32_16x16x32_bf16 a[4:7], v[114:117], v[114:117], a[4:7]
    ds_read_b64_tr_b16 v[94:95], v28 offset:9216
    ds_read_b64_tr_b16 v[96:97], v28 offset:10368
    v_mfma_f32_16x16x32_bf16 v[150:153], v[50:53], v[118:121], v[150:153]
    v_mfma_f32_16x16x32_bf16 v[154:157], v[54:57], v[114:117], v[154:157]
    ds_read_b64_tr_b16 v[98:99], v29 offset:9216
    ds_read_b64_tr_b16 v[100:101], v29 offset:10368
    v_mfma_f32_16x16x32_bf16 v[158:161], v[54:57], v[118:121], v[158:161]
    v_mfma_f32_16x16x32_bf16 a[8:11], a[28:31], v[118:121], a[8:11]
    ds_read_b64_tr_b16 v[102:103], v30 offset:9216
    ds_read_b64_tr_b16 v[104:105], v30 offset:10368
    v_mfma_f32_16x16x32_bf16 v[162:165], v[58:61], v[114:117], v[162:165]
    v_mfma_f32_16x16x32_bf16 v[166:169], v[58:61], v[118:121], v[166:169]
    ds_read_b64_tr_b16 v[106:107], v31 offset:9216
    ds_read_b64_tr_b16 v[108:109], v31 offset:10368
    v_mfma_f32_16x16x32_bf16 v[170:173], v[62:65], v[114:117], v[170:173]
    s_add_u32 m0, s48, 12288
    s_nop 0
    buffer_load_dwordx4 v6, s[24:27], s50 offen lds
    v_mfma_f32_16x16x32_bf16 a[12:15], v[118:121], v[118:121], a[12:15]
    ds_read_b64_tr_b16 v[110:111], v32 offset:9216
    ds_read_b64_tr_b16 v[112:113], v32 offset:10368
    v_mfma_f32_16x16x32_bf16 v[174:177], v[62:65], v[118:121], v[174:177]
    v_mfma_f32_16x16x32_bf16 v[178:181], v[66:69], v[114:117], v[178:181]
    s_add_u32 m0, s48, 13312
    s_nop 0
    buffer_load_dwordx4 v7, s[24:27], s50 offen lds
    v_mfma_f32_16x16x32_bf16 v[182:185], v[66:69], v[118:121], v[182:185]
    v_mfma_f32_16x16x32_bf16 a[16:19], a[28:31], v[42:45], a[16:19]
    s_add_u32 m0, s48, 14336
    s_nop 0
    buffer_load_dwordx4 v8, s[24:27], s50 offen lds
    v_mfma_f32_16x16x32_bf16 v[186:189], v[70:73], v[114:117], v[186:189]
    v_mfma_f32_16x16x32_bf16 v[190:193], v[70:73], v[118:121], v[190:193]
    s_add_u32 m0, s48, 15360
    s_nop 0
    buffer_load_dwordx4 v9, s[24:27], s50 offen lds
    s_add_u32 s50, s50, 128
    v_mfma_f32_16x16x32_bf16 v[194:197], v[74:77], v[114:117], v[194:197]
    v_mfma_f32_16x16x32_bf16 a[20:23], a[28:31], v[46:49], a[20:23]
    v_mfma_f32_16x16x32_bf16 v[198:201], v[74:77], v[118:121], v[198:201]
    v_mfma_f32_16x16x32_bf16 a[24:27], a[28:31], v[50:53], a[24:27]
    s_waitcnt vmcnt(13)
    s_barrier
    s_waitcnt lgkmcnt(0)
    v_mfma_f32_16x16x32_bf16 v[130:133], v[78:81], v[122:125], v[130:133]
    ds_read_b128 v[114:117], v15 offset:4096
    v_mfma_f32_16x16x32_bf16 v[134:137], v[78:81], v[126:129], v[134:137]
    ds_read_b128 v[118:121], v15 offset:6144
    v_mfma_f32_16x16x32_bf16 a[0:3], a[28:31], v[122:125], a[0:3]
    ds_read_b64_tr_b16 v[42:43], v24 offset:18432
    ds_read_b64_tr_b16 v[44:45], v24 offset:19584
    v_mfma_f32_16x16x32_bf16 v[138:141], v[82:85], v[122:125], v[138:141]
    ds_read_b64_tr_b16 v[46:47], v25 offset:18432
    ds_read_b64_tr_b16 v[48:49], v25 offset:19584
    v_mfma_f32_16x16x32_bf16 v[142:145], v[82:85], v[126:129], v[142:145]
    ds_read_b64_tr_b16 v[50:51], v26 offset:18432
    ds_read_b64_tr_b16 v[52:53], v26 offset:19584
    v_mfma_f32_16x16x32_bf16 v[146:149], v[86:89], v[122:125], v[146:149]
    ds_read_b64_tr_b16 v[54:55], v27 offset:18432
    ds_read_b64_tr_b16 v[56:57], v27 offset:19584
    v_mfma_f32_16x16x32_bf16 a[4:7], v[122:125], v[122:125], a[4:7]
    ds_read_b64_tr_b16 v[58:59], v28 offset:18432
    ds_read_b64_tr_b16 v[60:61], v28 offset:19584
    v_mfma_f32_16x16x32_bf16 v[150:153], v[86:89], v[126:129], v[150:153]
    v_mfma_f32_16x16x32_bf16 v[154:157], v[90:93], v[122:125], v[154:157]
    ds_read_b64_tr_b16 v[62:63], v29 offset:18432
    ds_read_b64_tr_b16 v[64:65], v29 offset:19584
    v_mfma_f32_16x16x32_bf16 v[158:161], v[90:93], v[126:129], v[158:161]
    v_mfma_f32_16x16x32_bf16 a[8:11], a[28:31], v[126:129], a[8:11]
    ds_read_b64_tr_b16 v[66:67], v30 offset:18432
    ds_read_b64_tr_b16 v[68:69], v30 offset:19584
    v_mfma_f32_16x16x32_bf16 v[162:165], v[94:97], v[122:125], v[162:165]
    v_mfma_f32_16x16x32_bf16 v[166:169], v[94:97], v[126:129], v[166:169]
    ds_read_b64_tr_b16 v[70:71], v31 offset:18432
    ds_read_b64_tr_b16 v[72:73], v31 offset:19584
    v_mfma_f32_16x16x32_bf16 v[170:173], v[98:101], v[122:125], v[170:173]
    s_add_u32 m0, s49, 55296
    s_nop 0
    buffer_load_dwordx4 v10, s[28:31], s51 offen lds
    v_mfma_f32_16x16x32_bf16 a[12:15], v[126:129], v[126:129], a[12:15]
    ds_read_b64_tr_b16 v[74:75], v32 offset:18432
    ds_read_b64_tr_b16 v[76:77], v32 offset:19584
    v_mfma_f32_16x16x32_bf16 v[174:177], v[98:101], v[126:129], v[174:177]
    v_mfma_f32_16x16x32_bf16 v[178:181], v[102:105], v[122:125], v[178:181]
    s_add_u32 m0, s49, 56320
    s_nop 0
    buffer_load_dwordx4 v11, s[28:31], s51 offen lds
    v_mfma_f32_16x16x32_bf16 v[182:185], v[102:105], v[126:129], v[182:185]
    v_mfma_f32_16x16x32_bf16 a[16:19], a[28:31], v[78:81], a[16:19]
    s_add_u32 m0, s49, 57344
    s_nop 0
    buffer_load_dwordx4 v12, s[28:31], s51 offen lds
    v_mfma_f32_16x16x32_bf16 v[186:189], v[106:109], v[122:125], v[186:189]
    v_mfma_f32_16x16x32_bf16 v[190:193], v[106:109], v[126:129], v[190:193]
    s_add_u32 m0, s49, 58368
    s_nop 0
    buffer_load_dwordx4 v13, s[28:31], s51 offen lds
    v_mfma_f32_16x16x32_bf16 v[194:197], v[110:113], v[122:125], v[194:197]
    v_mfma_f32_16x16x32_bf16 a[20:23], a[28:31], v[82:85], a[20:23]
    s_add_u32 m0, s49, 59392
    s_mov_b32 exec_hi, 0
    buffer_load_dwordx4 v14, s[28:31], s51 offen lds
    s_mov_b32 exec_hi, -1
    s_add_u32 s51, s51, 221184
    v_mfma_f32_16x16x32_bf16 v[198:201], v[110:113], v[126:129], v[198:201]
    v_mfma_f32_16x16x32_bf16 a[24:27], a[28:31], v[86:89], a[24:27]
    s_waitcnt lgkmcnt(0)
    v_mfma_f32_16x16x32_bf16 v[130:133], v[42:45], v[114:117], v[130:133]
    ds_read_b128 v[122:125], v16 offset:4096
    v_mfma_f32_16x16x32_bf16 v[134:137], v[42:45], v[118:121], v[134:137]
    ds_read_b128 v[126:129], v16 offset:6144
    v_mfma_f32_16x16x32_bf16 a[0:3], a[28:31], v[114:117], a[0:3]
    ds_read_b64_tr_b16 v[78:79], v24 offset:27648
    ds_read_b64_tr_b16 v[80:81], v24 offset:28800
    v_mfma_f32_16x16x32_bf16 v[138:141], v[46:49], v[114:117], v[138:141]
    ds_read_b64_tr_b16 v[82:83], v25 offset:27648
    ds_read_b64_tr_b16 v[84:85], v25 offset:28800
    v_mfma_f32_16x16x32_bf16 v[142:145], v[46:49], v[118:121], v[142:145]
    ds_read_b64_tr_b16 v[86:87], v26 offset:27648
    ds_read_b64_tr_b16 v[88:89], v26 offset:28800
    v_mfma_f32_16x16x32_bf16 v[146:149], v[50:53], v[114:117], v[146:149]
    ds_read_b64_tr_b16 v[90:91], v27 offset:27648
    ds_read_b64_tr_b16 v[92:93], v27 offset:28800
    v_mfma_f32_16x16x32_bf16 a[4:7], v[114:117], v[114:117], a[4:7]
    ds_read_b64_tr_b16 v[94:95], v28 offset:27648
    ds_read_b64_tr_b16 v[96:97], v28 offset:28800
    v_mfma_f32_16x16x32_bf16 v[150:153], v[50:53], v[118:121], v[150:153]
    v_mfma_f32_16x16x32_bf16 v[154:157], v[54:57], v[114:117], v[154:157]
    ds_read_b64_tr_b16 v[98:99], v29 offset:27648
    ds_read_b64_tr_b16 v[100:101], v29 offset:28800
    v_mfma_f32_16x16x32_bf16 v[158:161], v[54:57], v[118:121], v[158:161]
    v_mfma_f32_16x16x32_bf16 a[8:11], a[28:31], v[118:121], a[8:11]
    ds_read_b64_tr_b16 v[102:103], v30 offset:27648
    ds_read_b64_tr_b16 v[104:105], v30 offset:28800
    v_mfma_f32_16x16x32_bf16 v[162:165], v[58:61], v[114:117], v[162:165]
    v_mfma_f32_16x16x32_bf16 v[166:169], v[58:61], v[118:121], v[166:169]
    ds_read_b64_tr_b16 v[106:107], v31 offset:27648
    ds_read_b64_tr_b16 v[108:109], v31 offset:28800
    v_mfma_f32_16x16x32_bf16 v[170:173], v[62:65], v[114:117], v[170:173]
    s_add_u32 m0, s48, 0
    s_nop 0
    buffer_load_dwordx4 v6, s[24:27], s50 offen lds
    v_mfma_f32_16x16x32_bf16 a[12:15], v[118:121], v[118:121], a[12:15]
    ds_read_b64_tr_b16 v[110:111], v32 offset:27648
    ds_read_b64_tr_b16 v[112:113], v32 offset:28800
    v_mfma_f32_16x16x32_bf16 v[174:177], v[62:65], v[118:121], v[174:177]
    v_mfma_f32_16x16x32_bf16 v[178:181], v[66:69], v[114:117], v[178:181]
    s_add_u32 m0, s48, 1024
    s_nop 0
    buffer_load_dwordx4 v7, s[24:27], s50 offen lds
    v_mfma_f32_16x16x32_bf16 v[182:185], v[66:69], v[118:121], v[182:185]
    v_mfma_f32_16x16x32_bf16 a[16:19], a[28:31], v[42:45], a[16:19]
    s_add_u32 m0, s48, 2048
    s_nop 0
    buffer_load_dwordx4 v8, s[24:27], s50 offen lds
    v_mfma_f32_16x16x32_bf16 v[186:189], v[70:73], v[114:117], v[186:189]
    v_mfma_f32_16x16x32_bf16 v[190:193], v[70:73], v[118:121], v[190:193]
    s_add_u32 m0, s48, 3072
    s_nop 0
    buffer_load_dwordx4 v9, s[24:27], s50 offen lds
    s_add_u32 s50, s50, 128
    v_mfma_f32_16x16x32_bf16 v[194:197], v[74:77], v[114:117], v[194:197]
    v_mfma_f32_16x16x32_bf16 a[20:23], a[28:31], v[46:49], a[20:23]
    v_mfma_f32_16x16x32_bf16 v[198:201], v[74:77], v[118:121], v[198:201]
    v_mfma_f32_16x16x32_bf16 a[24:27], a[28:31], v[50:53], a[24:27]
    s_waitcnt vmcnt(13)
    s_barrier
    s_waitcnt lgkmcnt(0)
    v_mfma_f32_16x16x32_bf16 v[130:133], v[78:81], v[122:125], v[130:133]
    ds_read_b128 v[114:117], v15 offset:8192
    v_mfma_f32_16x16x32_bf16 v[134:137], v[78:81], v[126:129], v[134:137]
    ds_read_b128 v[118:121], v15 offset:10240
    v_mfma_f32_16x16x32_bf16 a[0:3], a[28:31], v[122:125], a[0:3]
    ds_read_b64_tr_b16 v[42:43], v33 offset:0
    ds_read_b64_tr_b16 v[44:45], v33 offset:1152
    v_mfma_f32_16x16x32_bf16 v[138:141], v[82:85], v[122:125], v[138:141]
    ds_read_b64_tr_b16 v[46:47], v34 offset:0
    ds_read_b64_tr_b16 v[48:49], v34 offset:1152
    v_mfma_f32_16x16x32_bf16 v[142:145], v[82:85], v[126:129], v[142:145]
    ds_read_b64_tr_b16 v[50:51], v35 offset:0
    ds_read_b64_tr_b16 v[52:53], v35 offset:1152
    v_mfma_f32_16x16x32_bf16 v[146:149], v[86:89], v[122:125], v[146:149]
    ds_read_b64_tr_b16 v[54:55], v36 offset:0
    ds_read_b64_tr_b16 v[56:57], v36 offset:1152
    v_mfma_f32_16x16x32_bf16 a[4:7], v[122:125], v[122:125], a[4:7]
    ds_read_b64_tr_b16 v[58:59], v37 offset:0
    ds_read_b64_tr_b16 v[60:61], v37 offset:1152
    v_mfma_f32_16x16x32_bf16 v[150:153], v[86:89], v[126:129], v[150:153]
    v_mfma_f32_16x16x32_bf16 v[154:157], v[90:93], v[122:125], v[154:157]
    ds_read_b64_tr_b16 v[62:63], v38 offset:0
    ds_read_b64_tr_b16 v[64:65], v38 offset:1152
    v_mfma_f32_16x16x32_bf16 v[158:161], v[90:93], v[126:129], v[158:161]
    v_mfma_f32_16x16x32_bf16 a[8:11], a[28:31], v[126:129], a[8:11]
    ds_read_b64_tr_b16 v[66:67], v39 offset:0
    ds_read_b64_tr_b16 v[68:69], v39 offset:1152
    v_mfma_f32_16x16x32_bf16 v[162:165], v[94:97], v[122:125], v[162:165]
    v_mfma_f32_16x16x32_bf16 v[166:169], v[94:97], v[126:129], v[166:169]
    ds_read_b64_tr_b16 v[70:71], v40 offset:0
    ds_read_b64_tr_b16 v[72:73], v40 offset:1152
    v_mfma_f32_16x16x32_bf16 v[170:173], v[98:101], v[122:125], v[170:173]
    s_add_u32 m0, s49, 0
    s_nop 0
    buffer_load_dwordx4 v10, s[28:31], s51 offen lds
    v_mfma_f32_16x16x32_bf16 a[12:15], v[126:129], v[126:129], a[12:15]
    ds_read_b64_tr_b16 v[74:75], v41 offset:0
    ds_read_b64_tr_b16 v[76:77], v41 offset:1152
    v_mfma_f32_16x16x32_bf16 v[174:177], v[98:101], v[126:129], v[174:177]
    v_mfma_f32_16x16x32_bf16 v[178:181], v[102:105], v[122:125], v[178:181]
    s_add_u32 m0, s49, 1024
    s_nop 0
    buffer_load_dwordx4 v11, s[28:31], s51 offen lds
    v_mfma_f32_16x16x32_bf16 v[182:185], v[102:105], v[126:129], v[182:185]
    v_mfma_f32_16x16x32_bf16 a[16:19], a[28:31], v[78:81], a[16:19]
    s_add_u32 m0, s49, 2048
    s_nop 0
    buffer_load_dwordx4 v12, s[28:31], s51 offen lds
    v_mfma_f32_16x16x32_bf16 v[186:189], v[106:109], v[122:125], v[186:189]
    v_mfma_f32_16x16x32_bf16 v[190:193], v[106:109], v[126:129], v[190:193]
    s_add_u32 m0, s49, 3072
    s_nop 0
    buffer_load_dwordx4 v13, s[28:31], s51 offen lds
    v_mfma_f32_16x16x32_bf16 v[194:197], v[110:113], v[122:125], v[194:197]
    v_mfma_f32_16x16x32_bf16 a[20:23], a[28:31], v[82:85], a[20:23]
    s_add_u32 m0, s49, 4096
    s_mov_b32 exec_hi, 0
    buffer_load_dwordx4 v14, s[28:31], s51 offen lds
    s_mov_b32 exec_hi, -1
    s_add_u32 s51, s51, 221184
    v_mfma_f32_16x16x32_bf16 v[198:201], v[110:113], v[126:129], v[198:201]
    v_mfma_f32_16x16x32_bf16 a[24:27], a[28:31], v[86:89], a[24:27]
    s_waitcnt lgkmcnt(0)
    v_mfma_f32_16x16x32_bf16 v[130:133], v[42:45], v[114:117], v[130:133]
    ds_read_b128 v[122:125], v16 offset:8192
    v_mfma_f32_16x16x32_bf16 v[134:137], v[42:45], v[118:121], v[134:137]
    ds_read_b128 v[126:129], v16 offset:10240
    v_mfma_f32_16x16x32_bf16 a[0:3], a[28:31], v[114:117], a[0:3]
    ds_read_b64_tr_b16 v[78:79], v33 offset:9216
    ds_read_b64_tr_b16 v[80:81], v33 offset:10368
    v_mfma_f32_16x16x32_bf16 v[138:141], v[46:49], v[114:117], v[138:141]
    ds_read_b64_tr_b16 v[82:83], v34 offset:9216
    ds_read_b64_tr_b16 v[84:85], v34 offset:10368
    v_mfma_f32_16x16x32_bf16 v[142:145], v[46:49], v[118:121], v[142:145]
    ds_read_b64_tr_b16 v[86:87], v35 offset:9216
    ds_read_b64_tr_b16 v[88:89], v35 offset:10368
    v_mfma_f32_16x16x32_bf16 v[146:149], v[50:53], v[114:117], v[146:149]
    ds_read_b64_tr_b16 v[90:91], v36 offset:9216
    ds_read_b64_tr_b16 v[92:93], v36 offset:10368
    v_mfma_f32_16x16x32_bf16 a[4:7], v[114:117], v[114:117], a[4:7]
    ds_read_b64_tr_b16 v[94:95], v37 offset:9216
    ds_read_b64_tr_b16 v[96:97], v37 offset:10368
    v_mfma_f32_16x16x32_bf16 v[150:153], v[50:53], v[118:121], v[150:153]
    v_mfma_f32_16x16x32_bf16 v[154:157], v[54:57], v[114:117], v[154:157]
    ds_read_b64_tr_b16 v[98:99], v38 offset:9216
    ds_read_b64_tr_b16 v[100:101], v38 offset:10368
    v_mfma_f32_16x16x32_bf16 v[158:161], v[54:57], v[118:121], v[158:161]
    v_mfma_f32_16x16x32_bf16 a[8:11], a[28:31], v[118:121], a[8:11]
    ds_read_b64_tr_b16 v[102:103], v39 offset:9216
    ds_read_b64_tr_b16 v[104:105], v39 offset:10368
    v_mfma_f32_16x16x32_bf16 v[162:165], v[58:61], v[114:117], v[162:165]
    v_mfma_f32_16x16x32_bf16 v[166:169], v[58:61], v[118:121], v[166:169]
    ds_read_b64_tr_b16 v[106:107], v40 offset:9216
    ds_read_b64_tr_b16 v[108:109], v40 offset:10368
    v_mfma_f32_16x16x32_bf16 v[170:173], v[62:65], v[114:117], v[170:173]
    s_lshl_b32 s44, s2, 2
    s_add_u32 s44, s44, s40
    s_cmp_lt_u32 s44, 648
    s_cselect_b32 s36, s12, s8
    v_mfma_f32_16x16x32_bf16 a[12:15], v[118:121], v[118:121], a[12:15]
    ds_read_b64_tr_b16 v[110:111], v41 offset:9216
    ds_read_b64_tr_b16 v[112:113], v41 offset:10368
    v_mfma_f32_16x16x32_bf16 v[174:177], v[62:65], v[118:121], v[174:177]
    v_mfma_f32_16x16x32_bf16 v[178:181], v[66:69], v[114:117], v[178:181]
    s_cselect_b32 s37, s13, s9
    s_mov_b32 s38, 663552
    s_cselect_b32 s38, 5308416, s38
    s_cselect_b32 s45, 0, 648
    v_mfma_f32_16x16x32_bf16 v[182:185], v[66:69], v[118:121], v[182:185]
    v_mfma_f32_16x16x32_bf16 a[16:19], a[28:31], v[42:45], a[16:19]
    s_mov_b32 s39, 0x20000
    s_sub_u32 s44, s44, s45
    s_lshl_b32 s44, s44, 13
    v_mfma_f32_16x16x32_bf16 v[186:189], v[70:73], v[114:117], v[186:189]
    v_mfma_f32_16x16x32_bf16 v[190:193], v[70:73], v[118:121], v[190:193]
    v_lshl_add_u32 v252, v1, 7, s44
    v_mfma_f32_16x16x32_bf16 v[194:197], v[74:77], v[114:117], v[194:197]
    v_mfma_f32_16x16x32_bf16 a[20:23], a[28:31], v[46:49], a[20:23]
    buffer_load_dword v252, v252, s[36:39], 0 offen
    v_mfma_f32_16x16x32_bf16 v[198:201], v[74:77], v[118:121], v[198:201]
    v_mfma_f32_16x16x32_bf16 a[24:27], a[28:31], v[50:53], a[24:27]
    s_waitcnt vmcnt(10)
    s_barrier
    s_waitcnt lgkmcnt(0)
    v_mfma_f32_16x16x32_bf16 v[130:133], v[78:81], v[122:125], v[130:133]
    ds_read_b128 v[114:117], v15 offset:12288
    s_lshl_b32 s44, s40, 7
    v_mfma_f32_16x16x32_bf16 v[134:137], v[78:81], v[126:129], v[134:137]
    ds_read_b128 v[118:121], v15 offset:14336
    s_add_u32 s44, s44, 139264
    v_mfma_f32_16x16x32_bf16 a[0:3], a[28:31], v[122:125], a[0:3]
    ds_read_b64_tr_b16 v[42:43], v33 offset:18432
    ds_read_b64_tr_b16 v[44:45], v33 offset:19584
    v_mfma_f32_16x16x32_bf16 v[138:141], v[82:85], v[122:125], v[138:141]
    ds_read_b64_tr_b16 v[46:47], v34 offset:18432
    ds_read_b64_tr_b16 v[48:49], v34 offset:19584
    v_mfma_f32_16x16x32_bf16 v[142:145], v[82:85], v[126:129], v[142:145]
    ds_read_b64_tr_b16 v[50:51], v35 offset:18432
    ds_read_b64_tr_b16 v[52:53], v35 offset:19584
    v_mfma_f32_16x16x32_bf16 v[146:149], v[86:89], v[122:125], v[146:149]
    ds_read_b64_tr_b16 v[54:55], v36 offset:18432
    ds_read_b64_tr_b16 v[56:57], v36 offset:19584
    v_mfma_f32_16x16x32_bf16 a[4:7], v[122:125], v[122:125], a[4:7]
    ds_read_b64_tr_b16 v[58:59], v37 offset:18432
    ds_read_b64_tr_b16 v[60:61], v37 offset:19584
    v_mfma_f32_16x16x32_bf16 v[150:153], v[86:89], v[126:129], v[150:153]
    v_lshlrev_b32 v236, 2, v2
    v_lshlrev_b32 v237, 4, v3
    v_mfma_f32_16x16x32_bf16 v[154:157], v[90:93], v[122:125], v[154:157]
    ds_read_b64_tr_b16 v[62:63], v38 offset:18432
    ds_read_b64_tr_b16 v[64:65], v38 offset:19584
    v_mfma_f32_16x16x32_bf16 v[158:161], v[90:93], v[126:129], v[158:161]
    v_add_u32 v236, s44, v236
    v_add_u32 v237, s44, v237
    v_mfma_f32_16x16x32_bf16 a[8:11], a[28:31], v[126:129], a[8:11]
    ds_read_b64_tr_b16 v[66:67], v39 offset:18432
    ds_read_b64_tr_b16 v[68:69], v39 offset:19584
    v_mfma_f32_16x16x32_bf16 v[162:165], v[94:97], v[122:125], v[162:165]
    s_lshr_b32 s44, s42, 2
    s_mul_i32 s52, s44, 2359296
    v_mfma_f32_16x16x32_bf16 v[166:169], v[94:97], v[126:129], v[166:169]
    ds_read_b64_tr_b16 v[70:71], v40 offset:18432
    ds_read_b64_tr_b16 v[72:73], v40 offset:19584
    v_mfma_f32_16x16x32_bf16 v[170:173], v[98:101], v[122:125], v[170:173]
    s_cmp_eq_u32 s44, 0
    s_cselect_b32 s53, 0x3eae1a93, 1.0
    v_mfma_f32_16x16x32_bf16 a[12:15], v[126:129], v[126:129], a[12:15]
    ds_read_b64_tr_b16 v[74:75], v41 offset:18432
    ds_read_b64_tr_b16 v[76:77], v41 offset:19584
    v_mfma_f32_16x16x32_bf16 v[174:177], v[98:101], v[126:129], v[174:177]
    s_and_b32 s44, s42, 3
    s_mul_i32 s44, s44, 589824
    v_mfma_f32_16x16x32_bf16 v[178:181], v[102:105], v[122:125], v[178:181]
    s_add_u32 s52, s52, s44
    s_lshl_b32 s44, s41, 2
    v_mfma_f32_16x16x32_bf16 v[182:185], v[102:105], v[126:129], v[182:185]
    s_add_u32 s44, s44, s40
    s_mul_i32 s44, s44, 1152
    v_mfma_f32_16x16x32_bf16 a[16:19], a[28:31], v[78:81], a[16:19]
    s_add_u32 s52, s52, s44
    v_mul_u32_u24 v241, 296, v2
    v_mfma_f32_16x16x32_bf16 v[186:189], v[106:109], v[122:125], v[186:189]
    v_lshl_add_u32 v241, v3, 3, v241
    v_add_u32 v241, s48, v241
    v_mfma_f32_16x16x32_bf16 v[190:193], v[106:109], v[126:129], v[190:193]
    v_lshl_add_u32 v6, s54, 5, v241
    v_lshl_add_u32 v7, s55, 5, v241
    v_mfma_f32_16x16x32_bf16 v[194:197], v[110:113], v[122:125], v[194:197]
    v_lshl_add_u32 v8, s56, 5, v241
    v_lshl_add_u32 v9, s57, 5, v241
    v_mfma_f32_16x16x32_bf16 a[20:23], a[28:31], v[82:85], a[20:23]
    v_lshl_add_u32 v10, s58, 5, v241
    v_lshl_add_u32 v11, s59, 5, v241
    v_mfma_f32_16x16x32_bf16 v[198:201], v[110:113], v[126:129], v[198:201]
    v_lshl_add_u32 v12, s60, 5, v241
    v_lshl_add_u32 v13, s61, 5, v241
    v_mfma_f32_16x16x32_bf16 a[24:27], a[28:31], v[86:89], a[24:27]
    v_lshl_add_u32 v14, s62, 5, v241
    v_and_b32 v238, 31, v1
    s_waitcnt lgkmcnt(0)
    v_mfma_f32_16x16x32_bf16 v[130:133], v[42:45], v[114:117], v[130:133]
    ds_read_b128 v[122:125], v16 offset:12288
    v_lshlrev_b32 v240, 2, v238
    v_mfma_f32_16x16x32_bf16 v[134:137], v[42:45], v[118:121], v[134:137]
    ds_read_b128 v[126:129], v16 offset:14336
    v_mul_u32_u24 v238, 296, v238
    v_mfma_f32_16x16x32_bf16 a[0:3], a[28:31], v[114:117], a[0:3]
    ds_read_b64_tr_b16 v[78:79], v33 offset:27648
    ds_read_b64_tr_b16 v[80:81], v33 offset:28800
    v_mfma_f32_16x16x32_bf16 v[138:141], v[46:49], v[114:117], v[138:141]
    ds_read_b64_tr_b16 v[82:83], v34 offset:27648
    ds_read_b64_tr_b16 v[84:85], v34 offset:28800
    v_mfma_f32_16x16x32_bf16 v[142:145], v[46:49], v[118:121], v[142:145]
    ds_read_b64_tr_b16 v[86:87], v35 offset:27648
    ds_read_b64_tr_b16 v[88:89], v35 offset:28800
    v_mfma_f32_16x16x32_bf16 v[146:149], v[50:53], v[114:117], v[146:149]
    ds_read_b64_tr_b16 v[90:91], v36 offset:27648
    ds_read_b64_tr_b16 v[92:93], v36 offset:28800
    v_mfma_f32_16x16x32_bf16 a[4:7], v[114:117], v[114:117], a[4:7]
    ds_read_b64_tr_b16 v[94:95], v37 offset:27648
    ds_read_b64_tr_b16 v[96:97], v37 offset:28800
    v_mfma_f32_16x16x32_bf16 v[150:153], v[50:53], v[118:121], v[150:153]
    v_add_u32 v238, s48, v238
    v_lshrrev_b32 v241, 5, v1
    v_mfma_f32_16x16x32_bf16 v[154:157], v[54:57], v[114:117], v[154:157]
    ds_read_b64_tr_b16 v[98:99], v38 offset:27648
    ds_read_b64_tr_b16 v[100:101], v38 offset:28800
    v_mfma_f32_16x16x32_bf16 v[158:161], v[54:57], v[118:121], v[158:161]
    v_mad_u32_u24 v239, v241, 36, v238
    v_lshl_add_u32 v238, v241, 4, v238
    v_mfma_f32_16x16x32_bf16 a[8:11], a[28:31], v[118:121], a[8:11]
    ds_read_b64_tr_b16 v[102:103], v39 offset:27648
    ds_read_b64_tr_b16 v[104:105], v39 offset:28800
    v_mfma_f32_16x16x32_bf16 v[162:165], v[58:61], v[114:117], v[162:165]
    v_mul_u32_u24 v241, 73728, v241
    v_add_u32 v240, v240, v241
    v_mfma_f32_16x16x32_bf16 v[166:169], v[58:61], v[118:121], v[166:169]
    ds_read_b64_tr_b16 v[106:107], v40 offset:27648
    ds_read_b64_tr_b16 v[108:109], v40 offset:28800
    v_mfma_f32_16x16x32_bf16 v[170:173], v[62:65], v[114:117], v[170:173]
    v_and_b32 v241, 3, v2
    v_lshrrev_b32 v242, 2, v2
    v_mfma_f32_16x16x32_bf16 a[12:15], v[118:121], v[118:121], a[12:15]
    ds_read_b64_tr_b16 v[110:111], v41 offset:27648
    ds_read_b64_tr_b16 v[112:113], v41 offset:28800
    v_mfma_f32_16x16x32_bf16 v[174:177], v[62:65], v[118:121], v[174:177]
    v_cmp_eq_u32 s[36:37], 1, v241
    v_cmp_eq_u32 s[38:39], 3, v241
    v_mfma_f32_16x16x32_bf16 v[178:181], v[66:69], v[114:117], v[178:181]
    v_cmp_le_u32 s[50:51], 2, v241
    v_cmp_eq_u32 vcc, v242, v3
    v_mfma_f32_16x16x32_bf16 v[182:185], v[66:69], v[118:121], v[182:185]
    v_mfma_f32_16x16x32_bf16 a[16:19], a[28:31], v[42:45], a[16:19]
    v_mfma_f32_16x16x32_bf16 v[186:189], v[70:73], v[114:117], v[186:189]
    v_mfma_f32_16x16x32_bf16 v[190:193], v[70:73], v[118:121], v[190:193]
    v_mfma_f32_16x16x32_bf16 v[194:197], v[74:77], v[114:117], v[194:197]
    v_mfma_f32_16x16x32_bf16 a[20:23], a[28:31], v[46:49], a[20:23]
    v_mfma_f32_16x16x32_bf16 v[198:201], v[74:77], v[118:121], v[198:201]
    v_mfma_f32_16x16x32_bf16 a[24:27], a[28:31], v[50:53], a[24:27]
    s_waitcnt vmcnt(1)
    s_barrier
    s_waitcnt lgkmcnt(0)
    v_mfma_f32_16x16x32_bf16 v[130:133], v[78:81], v[122:125], v[130:133]
    ds_read_b128 v[114:117], v15 offset:0
    v_mfma_f32_16x16x32_bf16 v[134:137], v[78:81], v[126:129], v[134:137]
    ds_read_b128 v[118:121], v15 offset:2048
    v_mfma_f32_16x16x32_bf16 a[0:3], a[28:31], v[122:125], a[0:3]
    ds_read_b64_tr_b16 v[42:43], v24 offset:0
    ds_read_b64_tr_b16 v[44:45], v24 offset:1152
    v_mfma_f32_16x16x32_bf16 v[138:141], v[82:85], v[122:125], v[138:141]
    ds_read_b64_tr_b16 v[46:47], v25 offset:0
    ds_read_b64_tr_b16 v[48:49], v25 offset:1152
    v_mfma_f32_16x16x32_bf16 v[142:145], v[82:85], v[126:129], v[142:145]
    ds_read_b64_tr_b16 v[50:51], v26 offset:0
    ds_read_b64_tr_b16 v[52:53], v26 offset:1152
    v_mfma_f32_16x16x32_bf16 v[146:149], v[86:89], v[122:125], v[146:149]
    ds_read_b64_tr_b16 v[54:55], v27 offset:0
    ds_read_b64_tr_b16 v[56:57], v27 offset:1152
    v_mfma_f32_16x16x32_bf16 a[4:7], v[122:125], v[122:125], a[4:7]
    ds_read_b64_tr_b16 v[58:59], v28 offset:0
    ds_read_b64_tr_b16 v[60:61], v28 offset:1152
    v_mfma_f32_16x16x32_bf16 v[150:153], v[86:89], v[126:129], v[150:153]
    v_mfma_f32_16x16x32_bf16 v[154:157], v[90:93], v[122:125], v[154:157]
    ds_read_b64_tr_b16 v[62:63], v29 offset:0
    ds_read_b64_tr_b16 v[64:65], v29 offset:1152
    v_mfma_f32_16x16x32_bf16 v[158:161], v[90:93], v[126:129], v[158:161]
    v_mfma_f32_16x16x32_bf16 a[8:11], a[28:31], v[126:129], a[8:11]
    ds_read_b64_tr_b16 v[66:67], v30 offset:0
    ds_read_b64_tr_b16 v[68:69], v30 offset:1152
    v_mfma_f32_16x16x32_bf16 v[162:165], v[94:97], v[122:125], v[162:165]
    v_mfma_f32_16x16x32_bf16 v[166:169], v[94:97], v[126:129], v[166:169]
    ds_read_b64_tr_b16 v[70:71], v31 offset:0
    ds_read_b64_tr_b16 v[72:73], v31 offset:1152
    v_mfma_f32_16x16x32_bf16 v[170:173], v[98:101], v[122:125], v[170:173]
    v_mfma_f32_16x16x32_bf16 a[12:15], v[126:129], v[126:129], a[12:15]
    ds_read_b64_tr_b16 v[74:75], v32 offset:0
    ds_read_b64_tr_b16 v[76:77], v32 offset:1152
    v_mfma_f32_16x16x32_bf16 v[174:177], v[98:101], v[126:129], v[174:177]
    v_mfma_f32_16x16x32_bf16 v[178:181], v[102:105], v[122:125], v[178:181]
    v_mfma_f32_16x16x32_bf16 v[182:185], v[102:105], v[126:129], v[182:185]
    v_mfma_f32_16x16x32_bf16 a[16:19], a[28:31], v[78:81], a[16:19]
    v_mfma_f32_16x16x32_bf16 v[186:189], v[106:109], v[122:125], v[186:189]
    v_mfma_f32_16x16x32_bf16 v[190:193], v[106:109], v[126:129], v[190:193]
    v_mfma_f32_16x16x32_bf16 v[194:197], v[110:113], v[122:125], v[194:197]
    v_mfma_f32_16x16x32_bf16 a[20:23], a[28:31], v[82:85], a[20:23]
    v_mfma_f32_16x16x32_bf16 v[198:201], v[110:113], v[126:129], v[198:201]
    v_mfma_f32_16x16x32_bf16 a[24:27], a[28:31], v[86:89], a[24:27]
    s_waitcnt lgkmcnt(0)
    v_mfma_f32_16x16x32_bf16 a[16:19], a[28:31], v[42:45], a[16:19]
    ds_read_b128 v[122:125], v16 offset:0
    v_mfma_f32_16x16x32_bf16 a[20:23], a[28:31], v[46:49], a[20:23]
    ds_read_b128 v[126:129], v16 offset:2048
    v_mfma_f32_16x16x32_bf16 a[24:27], a[28:31], v[50:53], a[24:27]
    ds_read_b64_tr_b16 v[78:79], v24 offset:9216
    ds_read_b64_tr_b16 v[80:81], v24 offset:10368
    v_mfma_f32_16x16x32_bf16 a[0:3], a[28:31], v[114:117], a[0:3]
    ds_read_b64_tr_b16 v[82:83], v25 offset:9216
    ds_read_b64_tr_b16 v[84:85], v25 offset:10368
    v_mfma_f32_16x16x32_bf16 a[4:7], v[114:117], v[114:117], a[4:7]
    ds_read_b64_tr_b16 v[86:87], v26 offset:9216
    ds_read_b64_tr_b16 v[88:89], v26 offset:10368
    v_mfma_f32_16x16x32_bf16 a[8:11], a[28:31], v[118:121], a[8:11]
    ds_read_b64_tr_b16 v[90:91], v27 offset:9216
    ds_read_b64_tr_b16 v[92:93], v27 offset:10368
    v_mfma_f32_16x16x32_bf16 a[12:15], v[118:121], v[118:121], a[12:15]
    ds_read_b64_tr_b16 v[94:95], v28 offset:9216
    ds_read_b64_tr_b16 v[96:97], v28 offset:10368
    v_mfma_f32_16x16x32_bf16 v[130:133], v[42:45], v[114:117], v[130:133]
    v_mfma_f32_16x16x32_bf16 v[134:137], v[42:45], v[118:121], v[134:137]
    ds_read_b64_tr_b16 v[98:99], v29 offset:9216
    ds_read_b64_tr_b16 v[100:101], v29 offset:10368
    v_mfma_f32_16x16x32_bf16 v[138:141], v[46:49], v[114:117], v[138:141]
    v_mfma_f32_16x16x32_bf16 v[142:145], v[46:49], v[118:121], v[142:145]
    ds_read_b64_tr_b16 v[102:103], v30 offset:9216
    ds_read_b64_tr_b16 v[104:105], v30 offset:10368
    v_mfma_f32_16x16x32_bf16 v[146:149], v[50:53], v[114:117], v[146:149]
    v_mfma_f32_16x16x32_bf16 v[150:153], v[50:53], v[118:121], v[150:153]
    ds_read_b64_tr_b16 v[106:107], v31 offset:9216
    ds_read_b64_tr_b16 v[108:109], v31 offset:10368
    v_mfma_f32_16x16x32_bf16 v[154:157], v[54:57], v[114:117], v[154:157]
    v_mfma_f32_16x16x32_bf16 v[158:161], v[54:57], v[118:121], v[158:161]
    ds_read_b64_tr_b16 v[110:111], v32 offset:9216
    ds_read_b64_tr_b16 v[112:113], v32 offset:10368
    v_mfma_f32_16x16x32_bf16 v[162:165], v[58:61], v[114:117], v[162:165]
    v_mfma_f32_16x16x32_bf16 v[166:169], v[58:61], v[118:121], v[166:169]
    v_mfma_f32_16x16x32_bf16 v[170:173], v[62:65], v[114:117], v[170:173]
    v_mfma_f32_16x16x32_bf16 v[174:177], v[62:65], v[118:121], v[174:177]
    v_mfma_f32_16x16x32_bf16 v[178:181], v[66:69], v[114:117], v[178:181]
    v_mfma_f32_16x16x32_bf16 v[182:185], v[66:69], v[118:121], v[182:185]
    v_mfma_f32_16x16x32_bf16 v[186:189], v[70:73], v[114:117], v[186:189]
    v_mfma_f32_16x16x32_bf16 v[190:193], v[70:73], v[118:121], v[190:193]
    v_mfma_f32_16x16x32_bf16 v[194:197], v[74:77], v[114:117], v[194:197]
    v_mfma_f32_16x16x32_bf16 v[198:201], v[74:77], v[118:121], v[198:201]
    s_waitcnt lgkmcnt(12)
    v_mfma_f32_16x16x32_bf16 a[16:19], a[28:31], v[78:81], a[16:19]
    s_branch L_pgqkv_kernel_3_s
.p2align 12
L_pgqkv_kernel_3:
    s_branch L_hopqkv_kernel_1
L_pgqkv_kernel_3_s:
    v_mfma_f32_16x16x32_bf16 a[20:23], a[28:31], v[82:85], a[20:23]
    v_mfma_f32_16x16x32_bf16 a[24:27], a[28:31], v[86:89], a[24:27]
    v_mfma_f32_16x16x32_bf16 a[0:3], a[28:31], v[122:125], a[0:3]
    v_mfma_f32_16x16x32_bf16 a[4:7], v[122:125], v[122:125], a[4:7]
    v_mfma_f32_16x16x32_bf16 a[8:11], a[28:31], v[126:129], a[8:11]
    v_mfma_f32_16x16x32_bf16 a[12:15], v[126:129], v[126:129], a[12:15]
    s_waitcnt lgkmcnt(0)
    v_mfma_f32_16x16x32_bf16 v[130:133], v[78:81], v[122:125], v[130:133]
    v_accvgpr_read_b32 v210, a16
    v_accvgpr_read_b32 v211, a20
    v_mfma_f32_16x16x32_bf16 v[134:137], v[78:81], v[126:129], v[134:137]
    v_accvgpr_read_b32 v212, a24
    ds_write2_b32 v236, v210, v210 offset0:0 offset1:144
    v_mfma_f32_16x16x32_bf16 v[138:141], v[82:85], v[122:125], v[138:141]
    ds_write2_b32 v236, v211, v211 offset0:16 offset1:160
    ds_write2_b32 v236, v212, v212 offset0:32 offset1:176
    v_mfma_f32_16x16x32_bf16 v[142:145], v[82:85], v[126:129], v[142:145]
    v_accvgpr_read_b32 v218, a4
    v_accvgpr_read_b32 v219, a5
    v_mfma_f32_16x16x32_bf16 v[146:149], v[86:89], v[122:125], v[146:149]
    v_accvgpr_read_b32 v220, a6
    v_accvgpr_read_b32 v221, a7
    v_mfma_f32_16x16x32_bf16 v[150:153], v[86:89], v[126:129], v[150:153]
    v_accvgpr_read_b32 v222, a12
    v_accvgpr_read_b32 v223, a13
    v_mfma_f32_16x16x32_bf16 v[154:157], v[90:93], v[122:125], v[154:157]
    v_accvgpr_read_b32 v224, a14
    v_accvgpr_read_b32 v225, a15
    v_mfma_f32_16x16x32_bf16 v[158:161], v[90:93], v[126:129], v[158:161]
    v_cndmask_b32 v218, v218, v219, s[36:37]
    v_cndmask_b32 v222, v222, v223, s[36:37]
    v_mfma_f32_16x16x32_bf16 v[162:165], v[94:97], v[122:125], v[162:165]
    v_cndmask_b32 v220, v220, v221, s[38:39]
    v_cndmask_b32 v224, v224, v225, s[38:39]
    v_mfma_f32_16x16x32_bf16 v[166:169], v[94:97], v[126:129], v[166:169]
    s_waitcnt lgkmcnt(0)
    s_barrier
    v_mfma_f32_16x16x32_bf16 v[170:173], v[98:101], v[122:125], v[170:173]
    v_cndmask_b32 v218, v218, v220, s[50:51]
    v_cndmask_b32 v222, v222, v224, s[50:51]
    v_mfma_f32_16x16x32_bf16 v[174:177], v[98:101], v[126:129], v[174:177]
    v_cndmask_b32 v218, 0, v218, vcc
    ds_read_b128 v[42:45], v237 offset:0
    v_mfma_f32_16x16x32_bf16 v[178:181], v[102:105], v[122:125], v[178:181]
    v_cndmask_b32 v222, 0, v222, vcc
    ds_read_b128 v[46:49], v237 offset:64
    v_mfma_f32_16x16x32_bf16 v[182:185], v[102:105], v[126:129], v[182:185]
    v_mov_b32 v219, v218
    ds_read_b128 v[50:53], v237 offset:128
    v_mfma_f32_16x16x32_bf16 v[186:189], v[106:109], v[122:125], v[186:189]
    v_mov_b32 v223, v222
    ds_read_b128 v[54:57], v237 offset:192
    v_mfma_f32_16x16x32_bf16 v[190:193], v[106:109], v[126:129], v[190:193]
    v_accvgpr_read_b32 v202, a0
    ds_read_b128 v[58:61], v237 offset:256
    v_mfma_f32_16x16x32_bf16 v[194:197], v[110:113], v[122:125], v[194:197]
    v_permlane32_swap_b32 v218, v219
    ds_read_b128 v[62:65], v237 offset:320
    v_mfma_f32_16x16x32_bf16 v[198:201], v[110:113], v[126:129], v[198:201]
    v_permlane32_swap_b32 v222, v223
    ds_read_b128 v[66:69], v237 offset:384
    v_add_f32 v218, v218, v219
    ds_read_b128 v[70:73], v237 offset:448
    v_add_f32 v222, v222, v223
    ds_read_b128 v[74:77], v237 offset:512
    v_mov_b32 v219, v218
    v_mov_b32 v223, v222
    v_accvgpr_read_b32 v203, a8
    v_permlane16_swap_b32 v218, v219
    v_permlane16_swap_b32 v222, v223
    v_add_f32 v218, v218, v219
    v_add_f32 v222, v222, v223
    v_mul_f32 v202, 0xbae38e39, v202
    v_mul_f32 v203, 0xbae38e39, v203
    v_mul_f32 v218, 0x3ae38e39, v218
    v_mul_f32 v222, 0x3ae38e39, v222
    v_fma_f32 v218, -v202, v202, v218
    v_fma_f32 v222, -v203, v203, v222
    v_max_f32 v218, 0, v218
    v_max_f32 v222, 0, v222
    v_add_f32 v218, 0x3727c5ac, v218
    v_add_f32 v222, 0x3727c5ac, v222
    v_rsq_f32 v18, v218
    v_rsq_f32 v19, v222
    v_mul_f32 v18, s53, v18
    v_mul_f32 v19, s53, v19
    v_mul_f32 v20, v202, v18
    v_mul_f32 v21, v203, v19
    s_waitcnt lgkmcnt(0)
    v_pk_mul_f32 v[216:217], v[42:43], v[20:21] op_sel_hi:[1,0]
    v_pk_mul_f32 v[218:219], v[44:45], v[20:21] op_sel_hi:[1,0]
    v_pk_fma_f32 v[130:131], v[130:131], v[18:19], v[216:217] op_sel_hi:[1,0,1]
    v_pk_fma_f32 v[132:133], v[132:133], v[18:19], v[218:219] op_sel_hi:[1,0,1]
    v_cvt_pk_bf16_f32 v220, v130, v131
    v_cvt_pk_bf16_f32 v221, v132, v133
    ds_write_b64 v6, v[220:221] offset:0
    v_pk_mul_f32 v[222:223], v[42:43], v[20:21] op_sel:[0,1] op_sel_hi:[1,1]
    v_pk_mul_f32 v[224:225], v[44:45], v[20:21] op_sel:[0,1] op_sel_hi:[1,1]
    v_pk_fma_f32 v[134:135], v[134:135], v[18:19], v[222:223] op_sel:[0,1,0] op_sel_hi:[1,1,1]
    v_pk_fma_f32 v[136:137], v[136:137], v[18:19], v[224:225] op_sel:[0,1,0] op_sel_hi:[1,1,1]
    v_cvt_pk_bf16_f32 v226, v134, v135
    v_cvt_pk_bf16_f32 v227, v136, v137
    ds_write_b64 v6, v[226:227] offset:4736
    v_pk_mul_f32 v[228:229], v[46:47], v[20:21] op_sel_hi:[1,0]
    v_pk_mul_f32 v[230:231], v[48:49], v[20:21] op_sel_hi:[1,0]
    v_pk_fma_f32 v[138:139], v[138:139], v[18:19], v[228:229] op_sel_hi:[1,0,1]
    v_pk_fma_f32 v[140:141], v[140:141], v[18:19], v[230:231] op_sel_hi:[1,0,1]
    v_cvt_pk_bf16_f32 v232, v138, v139
    v_cvt_pk_bf16_f32 v233, v140, v141
    ds_write_b64 v7, v[232:233] offset:0
    v_pk_mul_f32 v[216:217], v[46:47], v[20:21] op_sel:[0,1] op_sel_hi:[1,1]
    v_pk_mul_f32 v[218:219], v[48:49], v[20:21] op_sel:[0,1] op_sel_hi:[1,1]
    v_pk_fma_f32 v[142:143], v[142:143], v[18:19], v[216:217] op_sel:[0,1,0] op_sel_hi:[1,1,1]
    v_pk_fma_f32 v[144:145], v[144:145], v[18:19], v[218:219] op_sel:[0,1,0] op_sel_hi:[1,1,1]
    v_cvt_pk_bf16_f32 v220, v142, v143
    v_cvt_pk_bf16_f32 v221, v144, v145
    ds_write_b64 v7, v[220:221] offset:4736
    v_pk_mul_f32 v[222:223], v[50:51], v[20:21] op_sel_hi:[1,0]
    v_pk_mul_f32 v[224:225], v[52:53], v[20:21] op_sel_hi:[1,0]
    v_pk_fma_f32 v[146:147], v[146:147], v[18:19], v[222:223] op_sel_hi:[1,0,1]
    v_pk_fma_f32 v[148:149], v[148:149], v[18:19], v[224:225] op_sel_hi:[1,0,1]
    v_cvt_pk_bf16_f32 v226, v146, v147
    v_cvt_pk_bf16_f32 v227, v148, v149
    ds_write_b64 v8, v[226:227] offset:0
    v_pk_mul_f32 v[228:229], v[50:51], v[20:21] op_sel:[0,1] op_sel_hi:[1,1]
    v_pk_mul_f32 v[230:231], v[52:53], v[20:21] op_sel:[0,1] op_sel_hi:[1,1]
    v_pk_fma_f32 v[150:151], v[150:151], v[18:19], v[228:229] op_sel:[0,1,0] op_sel_hi:[1,1,1]
    v_pk_fma_f32 v[152:153], v[152:153], v[18:19], v[230:231] op_sel:[0,1,0] op_sel_hi:[1,1,1]
    v_cvt_pk_bf16_f32 v232, v150, v151
    v_cvt_pk_bf16_f32 v233, v152, v153
    ds_write_b64 v8, v[232:233] offset:4736
    v_pk_mul_f32 v[216:217], v[54:55], v[20:21] op_sel_hi:[1,0]
    v_pk_mul_f32 v[218:219], v[56:57], v[20:21] op_sel_hi:[1,0]
    v_pk_fma_f32 v[154:155], v[154:155], v[18:19], v[216:217] op_sel_hi:[1,0,1]
    v_pk_fma_f32 v[156:157], v[156:157], v[18:19], v[218:219] op_sel_hi:[1,0,1]
    v_cvt_pk_bf16_f32 v220, v154, v155
    v_cvt_pk_bf16_f32 v221, v156, v157
    ds_write_b64 v9, v[220:221] offset:0
    v_pk_mul_f32 v[222:223], v[54:55], v[20:21] op_sel:[0,1] op_sel_hi:[1,1]
    v_pk_mul_f32 v[224:225], v[56:57], v[20:21] op_sel:[0,1] op_sel_hi:[1,1]
    v_pk_fma_f32 v[158:159], v[158:159], v[18:19], v[222:223] op_sel:[0,1,0] op_sel_hi:[1,1,1]
    v_pk_fma_f32 v[160:161], v[160:161], v[18:19], v[224:225] op_sel:[0,1,0] op_sel_hi:[1,1,1]
    v_cvt_pk_bf16_f32 v226, v158, v159
    v_cvt_pk_bf16_f32 v227, v160, v161
    ds_write_b64 v9, v[226:227] offset:4736
    v_pk_mul_f32 v[228:229], v[58:59], v[20:21] op_sel_hi:[1,0]
    v_pk_mul_f32 v[230:231], v[60:61], v[20:21] op_sel_hi:[1,0]
    v_pk_fma_f32 v[162:163], v[162:163], v[18:19], v[228:229] op_sel_hi:[1,0,1]
    v_pk_fma_f32 v[164:165], v[164:165], v[18:19], v[230:231] op_sel_hi:[1,0,1]
    v_cvt_pk_bf16_f32 v232, v162, v163
    v_cvt_pk_bf16_f32 v233, v164, v165
    ds_write_b64 v10, v[232:233] offset:0
    v_pk_mul_f32 v[216:217], v[58:59], v[20:21] op_sel:[0,1] op_sel_hi:[1,1]
    v_pk_mul_f32 v[218:219], v[60:61], v[20:21] op_sel:[0,1] op_sel_hi:[1,1]
    v_pk_fma_f32 v[166:167], v[166:167], v[18:19], v[216:217] op_sel:[0,1,0] op_sel_hi:[1,1,1]
    v_pk_fma_f32 v[168:169], v[168:169], v[18:19], v[218:219] op_sel:[0,1,0] op_sel_hi:[1,1,1]
    v_cvt_pk_bf16_f32 v220, v166, v167
    v_cvt_pk_bf16_f32 v221, v168, v169
    ds_write_b64 v10, v[220:221] offset:4736
    v_pk_mul_f32 v[222:223], v[62:63], v[20:21] op_sel_hi:[1,0]
    v_pk_mul_f32 v[224:225], v[64:65], v[20:21] op_sel_hi:[1,0]
    v_pk_fma_f32 v[170:171], v[170:171], v[18:19], v[222:223] op_sel_hi:[1,0,1]
    v_pk_fma_f32 v[172:173], v[172:173], v[18:19], v[224:225] op_sel_hi:[1,0,1]
    v_cvt_pk_bf16_f32 v226, v170, v171
    v_cvt_pk_bf16_f32 v227, v172, v173
    ds_write_b64 v11, v[226:227] offset:0
    v_pk_mul_f32 v[228:229], v[62:63], v[20:21] op_sel:[0,1] op_sel_hi:[1,1]
    v_pk_mul_f32 v[230:231], v[64:65], v[20:21] op_sel:[0,1] op_sel_hi:[1,1]
    v_pk_fma_f32 v[174:175], v[174:175], v[18:19], v[228:229] op_sel:[0,1,0] op_sel_hi:[1,1,1]
    v_pk_fma_f32 v[176:177], v[176:177], v[18:19], v[230:231] op_sel:[0,1,0] op_sel_hi:[1,1,1]
    v_cvt_pk_bf16_f32 v232, v174, v175
    v_cvt_pk_bf16_f32 v233, v176, v177
    ds_write_b64 v11, v[232:233] offset:4736
    v_pk_mul_f32 v[216:217], v[66:67], v[20:21] op_sel_hi:[1,0]
    v_pk_mul_f32 v[218:219], v[68:69], v[20:21] op_sel_hi:[1,0]
    v_pk_fma_f32 v[178:179], v[178:179], v[18:19], v[216:217] op_sel_hi:[1,0,1]
    v_pk_fma_f32 v[180:181], v[180:181], v[18:19], v[218:219] op_sel_hi:[1,0,1]
    v_cvt_pk_bf16_f32 v220, v178, v179
    v_cvt_pk_bf16_f32 v221, v180, v181
    ds_write_b64 v12, v[220:221] offset:0
    v_pk_mul_f32 v[222:223], v[66:67], v[20:21] op_sel:[0,1] op_sel_hi:[1,1]
    v_pk_mul_f32 v[224:225], v[68:69], v[20:21] op_sel:[0,1] op_sel_hi:[1,1]
    v_pk_fma_f32 v[182:183], v[182:183], v[18:19], v[222:223] op_sel:[0,1,0] op_sel_hi:[1,1,1]
    v_pk_fma_f32 v[184:185], v[184:185], v[18:19], v[224:225] op_sel:[0,1,0] op_sel_hi:[1,1,1]
    v_cvt_pk_bf16_f32 v226, v182, v183
    v_cvt_pk_bf16_f32 v227, v184, v185
    ds_write_b64 v12, v[226:227] offset:4736
    v_pk_mul_f32 v[228:229], v[70:71], v[20:21] op_sel_hi:[1,0]
    v_pk_mul_f32 v[230:231], v[72:73], v[20:21] op_sel_hi:[1,0]
    v_pk_fma_f32 v[186:187], v[186:187], v[18:19], v[228:229] op_sel_hi:[1,0,1]
    v_pk_fma_f32 v[188:189], v[188:189], v[18:19], v[230:231] op_sel_hi:[1,0,1]
    v_cvt_pk_bf16_f32 v232, v186, v187
    v_cvt_pk_bf16_f32 v233, v188, v189
    ds_write_b64 v13, v[232:233] offset:0
    v_pk_mul_f32 v[216:217], v[70:71], v[20:21] op_sel:[0,1] op_sel_hi:[1,1]
    v_pk_mul_f32 v[218:219], v[72:73], v[20:21] op_sel:[0,1] op_sel_hi:[1,1]
    v_pk_fma_f32 v[190:191], v[190:191], v[18:19], v[216:217] op_sel:[0,1,0] op_sel_hi:[1,1,1]
    v_pk_fma_f32 v[192:193], v[192:193], v[18:19], v[218:219] op_sel:[0,1,0] op_sel_hi:[1,1,1]
    v_cvt_pk_bf16_f32 v220, v190, v191
    v_cvt_pk_bf16_f32 v221, v192, v193
    ds_write_b64 v13, v[220:221] offset:4736
    v_pk_mul_f32 v[222:223], v[74:75], v[20:21] op_sel_hi:[1,0]
    v_pk_mul_f32 v[224:225], v[76:77], v[20:21] op_sel_hi:[1,0]
    v_pk_fma_f32 v[194:195], v[194:195], v[18:19], v[222:223] op_sel_hi:[1,0,1]
    v_pk_fma_f32 v[196:197], v[196:197], v[18:19], v[224:225] op_sel_hi:[1,0,1]
    v_cvt_pk_bf16_f32 v226, v194, v195
    v_cvt_pk_bf16_f32 v227, v196, v197
    ds_write_b64 v14, v[226:227] offset:0
    v_pk_mul_f32 v[228:229], v[74:75], v[20:21] op_sel:[0,1] op_sel_hi:[1,1]
    v_pk_mul_f32 v[230:231], v[76:77], v[20:21] op_sel:[0,1] op_sel_hi:[1,1]
    v_pk_fma_f32 v[198:199], v[198:199], v[18:19], v[228:229] op_sel:[0,1,0] op_sel_hi:[1,1,1]
    v_pk_fma_f32 v[200:201], v[200:201], v[18:19], v[230:231] op_sel:[0,1,0] op_sel_hi:[1,1,1]
    v_cvt_pk_bf16_f32 v232, v198, v199
    v_cvt_pk_bf16_f32 v233, v200, v201
    ds_write_b64 v14, v[232:233] offset:4736
    ds_read2_b32 v[130:131], v238 offset0:0 offset1:1
    ds_read2_b32 v[132:133], v238 offset0:2 offset1:3
    ds_read_b32 v162, v239 offset:32
    ds_read2_b32 v[134:135], v238 offset0:9 offset1:10
    ds_read2_b32 v[136:137], v238 offset0:11 offset1:12
    ds_read2_b32 v[138:139], v238 offset0:18 offset1:19
    ds_read2_b32 v[140:141], v238 offset0:20 offset1:21
    ds_read_b32 v163, v239 offset:104
    ds_read2_b32 v[142:143], v238 offset0:27 offset1:28
    ds_read2_b32 v[144:145], v238 offset0:29 offset1:30
    ds_read2_b32 v[146:147], v238 offset0:36 offset1:37
    ds_read2_b32 v[148:149], v238 offset0:38 offset1:39
    ds_read_b32 v164, v239 offset:176
    ds_read2_b32 v[150:151], v238 offset0:45 offset1:46
    ds_read2_b32 v[152:153], v238 offset0:47 offset1:48
    ds_read2_b32 v[154:155], v238 offset0:54 offset1:55
    ds_read2_b32 v[156:157], v238 offset0:56 offset1:57
    ds_read_b32 v165, v239 offset:248
    ds_read2_b32 v[158:159], v238 offset0:63 offset1:64
    ds_read2_b32 v[160:161], v238 offset0:65 offset1:66
    s_waitcnt lgkmcnt(15)
    buffer_store_dwordx4 v[130:133], v4, s[32:35], s52 offen sc1
    s_waitcnt lgkmcnt(15)
    buffer_store_dword v162, v240, s[32:35], s52 offen offset:1024 sc1
    s_add_u32 s52, s52, 73728
    s_waitcnt lgkmcnt(15)
    buffer_store_dwordx4 v[134:137], v4, s[32:35], s52 offen sc1
    s_add_u32 s52, s52, 73728
    s_waitcnt lgkmcnt(13)
    buffer_store_dwordx4 v[138:141], v4, s[32:35], s52 offen sc1
    s_waitcnt lgkmcnt(12)
    buffer_store_dword v163, v240, s[32:35], s52 offen offset:1024 sc1
    s_add_u32 s52, s52, 73728
    s_waitcnt lgkmcnt(10)
    buffer_store_dwordx4 v[142:145], v4, s[32:35], s52 offen sc1
    s_add_u32 s52, s52, 73728
    s_waitcnt lgkmcnt(8)
    buffer_store_dwordx4 v[146:149], v4, s[32:35], s52 offen sc1
    s_waitcnt lgkmcnt(7)
    buffer_store_dword v164, v240, s[32:35], s52 offen offset:1024 sc1
    s_add_u32 s52, s52, 73728
    s_waitcnt lgkmcnt(5)
    buffer_store_dwordx4 v[150:153], v4, s[32:35], s52 offen sc1
    s_add_u32 s52, s52, 73728
    s_waitcnt lgkmcnt(3)
    buffer_store_dwordx4 v[154:157], v4, s[32:35], s52 offen sc1
    s_waitcnt lgkmcnt(2)
    buffer_store_dword v165, v240, s[32:35], s52 offen offset:1024 sc1
    s_add_u32 s52, s52, 73728
    s_waitcnt lgkmcnt(0)
    buffer_store_dwordx4 v[158:161], v4, s[32:35], s52 offen sc1
    s_endpgm
.p2align 12
L_pgqkv_kernel_4:
    s_branch L_hopqkv_kernel_1
L_pgqkv_kernel_4_s:
L_qkv_ori1:
    s_waitcnt vmcnt(14)
    s_waitcnt vmcnt(10)
    s_barrier
    ds_read_b128 v[114:117], v15 offset:0
    ds_read_b128 v[118:121], v15 offset:2048
    ds_read_b64_tr_b16 v[42:43], v24 offset:0
    ds_read_b64_tr_b16 v[44:45], v24 offset:1152
    ds_read_b64_tr_b16 v[46:47], v25 offset:0
    ds_read_b64_tr_b16 v[48:49], v25 offset:1152
    ds_read_b64_tr_b16 v[50:51], v26 offset:0
    ds_read_b64_tr_b16 v[52:53], v26 offset:1152
    ds_read_b64_tr_b16 v[54:55], v27 offset:0
    ds_read_b64_tr_b16 v[56:57], v27 offset:1152
    ds_read_b64_tr_b16 v[58:59], v28 offset:0
    ds_read_b64_tr_b16 v[60:61], v28 offset:1152
    ds_read_b64_tr_b16 v[62:63], v29 offset:0
    ds_read_b64_tr_b16 v[64:65], v29 offset:1152
    ds_read_b64_tr_b16 v[66:67], v30 offset:0
    ds_read_b64_tr_b16 v[68:69], v30 offset:1152
    ds_read_b64_tr_b16 v[70:71], v31 offset:0
    ds_read_b64_tr_b16 v[72:73], v31 offset:1152
    ds_read_b64_tr_b16 v[74:75], v32 offset:0
    ds_read_b64_tr_b16 v[76:77], v32 offset:1152
    s_waitcnt lgkmcnt(0)
    v_mfma_f32_16x16x32_bf16 v[130:133], v[114:117], v[42:45], 0
    ds_read_b128 v[122:125], v16 offset:0
    v_mfma_f32_16x16x32_bf16 v[134:137], v[118:121], v[42:45], 0
    ds_read_b128 v[126:129], v16 offset:2048
    v_mfma_f32_16x16x32_bf16 a[0:3], a[28:31], v[114:117], 0
    ds_read_b64_tr_b16 v[78:79], v24 offset:9216
    ds_read_b64_tr_b16 v[80:81], v24 offset:10368
    v_mfma_f32_16x16x32_bf16 v[138:141], v[114:117], v[46:49], 0
    ds_read_b64_tr_b16 v[82:83], v25 offset:9216
    ds_read_b64_tr_b16 v[84:85], v25 offset:10368
    v_mfma_f32_16x16x32_bf16 v[142:145], v[118:121], v[46:49], 0
    ds_read_b64_tr_b16 v[86:87], v26 offset:9216
    ds_read_b64_tr_b16 v[88:89], v26 offset:10368
    v_mfma_f32_16x16x32_bf16 v[146:149], v[114:117], v[50:53], 0
    ds_read_b64_tr_b16 v[90:91], v27 offset:9216
    ds_read_b64_tr_b16 v[92:93], v27 offset:10368
    v_mfma_f32_16x16x32_bf16 a[4:7], v[114:117], v[114:117], 0
    ds_read_b64_tr_b16 v[94:95], v28 offset:9216
    ds_read_b64_tr_b16 v[96:97], v28 offset:10368
    v_mfma_f32_16x16x32_bf16 v[150:153], v[118:121], v[50:53], 0
    v_mfma_f32_16x16x32_bf16 v[154:157], v[114:117], v[54:57], 0
    ds_read_b64_tr_b16 v[98:99], v29 offset:9216
    ds_read_b64_tr_b16 v[100:101], v29 offset:10368
    v_mfma_f32_16x16x32_bf16 v[158:161], v[118:121], v[54:57], 0
    s_add_u32 m0, s48, 8192
    s_nop 0
    buffer_load_dwordx4 v6, s[24:27], s50 offen lds
    v_mfma_f32_16x16x32_bf16 a[8:11], a[28:31], v[118:121], 0
    ds_read_b64_tr_b16 v[102:103], v30 offset:9216
    ds_read_b64_tr_b16 v[104:105], v30 offset:10368
    v_mfma_f32_16x16x32_bf16 v[162:165], v[114:117], v[58:61], 0
    s_add_u32 m0, s48, 9216
    s_nop 0
    buffer_load_dwordx4 v7, s[24:27], s50 offen lds
    v_mfma_f32_16x16x32_bf16 v[166:169], v[118:121], v[58:61], 0
    ds_read_b64_tr_b16 v[106:107], v31 offset:9216
    ds_read_b64_tr_b16 v[108:109], v31 offset:10368
    v_mfma_f32_16x16x32_bf16 v[170:173], v[114:117], v[62:65], 0
    s_add_u32 m0, s48, 10240
    s_nop 0
    buffer_load_dwordx4 v8, s[24:27], s50 offen lds
    v_mfma_f32_16x16x32_bf16 a[12:15], v[118:121], v[118:121], 0
    ds_read_b64_tr_b16 v[110:111], v32 offset:9216
    ds_read_b64_tr_b16 v[112:113], v32 offset:10368
    v_mfma_f32_16x16x32_bf16 v[174:177], v[118:121], v[62:65], 0
    s_add_u32 m0, s48, 11264
    s_nop 0
    buffer_load_dwordx4 v9, s[24:27], s50 offen lds
    s_add_u32 s50, s50, 128
    v_mfma_f32_16x16x32_bf16 v[178:181], v[114:117], v[66:69], 0
    s_add_u32 m0, s48, 12288
    s_nop 0
    buffer_load_dwordx4 v6, s[24:27], s50 offen lds
    v_mfma_f32_16x16x32_bf16 v[182:185], v[118:121], v[66:69], 0
    s_add_u32 m0, s48, 13312
    s_nop 0
    buffer_load_dwordx4 v7, s[24:27], s50 offen lds
    v_mfma_f32_16x16x32_bf16 a[16:19], a[28:31], v[42:45], 0
    s_add_u32 m0, s48, 14336
    s_nop 0
    buffer_load_dwordx4 v8, s[24:27], s50 offen lds
    v_mfma_f32_16x16x32_bf16 v[186:189], v[114:117], v[70:73], 0
    v_mfma_f32_16x16x32_bf16 v[190:193], v[118:121], v[70:73], 0
    s_add_u32 m0, s48, 15360
    s_nop 0
    buffer_load_dwordx4 v9, s[24:27], s50 offen lds
    s_add_u32 s50, s50, 128
    v_mfma_f32_16x16x32_bf16 v[194:197], v[114:117], v[74:77], 0
    v_mfma_f32_16x16x32_bf16 a[20:23], a[28:31], v[46:49], 0
    v_mfma_f32_16x16x32_bf16 v[198:201], v[118:121], v[74:77], 0
    v_mfma_f32_16x16x32_bf16 a[24:27], a[28:31], v[50:53], 0
    s_waitcnt vmcnt(13)
    s_waitcnt vmcnt(9)
    s_barrier
    s_waitcnt lgkmcnt(0)
    v_mfma_f32_16x16x32_bf16 v[130:133], v[122:125], v[78:81], v[130:133]
    ds_read_b128 v[114:117], v15 offset:4096
    v_mfma_f32_16x16x32_bf16 v[134:137], v[126:129], v[78:81], v[134:137]
    ds_read_b128 v[118:121], v15 offset:6144
    v_mfma_f32_16x16x32_bf16 a[0:3], a[28:31], v[122:125], a[0:3]
    ds_read_b64_tr_b16 v[42:43], v24 offset:18432
    ds_read_b64_tr_b16 v[44:45], v24 offset:19584
    v_mfma_f32_16x16x32_bf16 v[138:141], v[122:125], v[82:85], v[138:141]
    ds_read_b64_tr_b16 v[46:47], v25 offset:18432
    ds_read_b64_tr_b16 v[48:49], v25 offset:19584
    v_mfma_f32_16x16x32_bf16 v[142:145], v[126:129], v[82:85], v[142:145]
    ds_read_b64_tr_b16 v[50:51], v26 offset:18432
    ds_read_b64_tr_b16 v[52:53], v26 offset:19584
    v_mfma_f32_16x16x32_bf16 v[146:149], v[122:125], v[86:89], v[146:149]
    ds_read_b64_tr_b16 v[54:55], v27 offset:18432
    ds_read_b64_tr_b16 v[56:57], v27 offset:19584
    v_mfma_f32_16x16x32_bf16 a[4:7], v[122:125], v[122:125], a[4:7]
    ds_read_b64_tr_b16 v[58:59], v28 offset:18432
    ds_read_b64_tr_b16 v[60:61], v28 offset:19584
    v_mfma_f32_16x16x32_bf16 v[150:153], v[126:129], v[86:89], v[150:153]
    v_mfma_f32_16x16x32_bf16 v[154:157], v[122:125], v[90:93], v[154:157]
    ds_read_b64_tr_b16 v[62:63], v29 offset:18432
    ds_read_b64_tr_b16 v[64:65], v29 offset:19584
    v_mfma_f32_16x16x32_bf16 v[158:161], v[126:129], v[90:93], v[158:161]
    s_add_u32 m0, s49, 36864
    s_nop 0
    buffer_load_dwordx4 v10, s[28:31], s51 offen lds
    v_mfma_f32_16x16x32_bf16 a[8:11], a[28:31], v[126:129], a[8:11]
    ds_read_b64_tr_b16 v[66:67], v30 offset:18432
    ds_read_b64_tr_b16 v[68:69], v30 offset:19584
    v_mfma_f32_16x16x32_bf16 v[162:165], v[122:125], v[94:97], v[162:165]
    s_add_u32 m0, s49, 37888
    s_nop 0
    buffer_load_dwordx4 v11, s[28:31], s51 offen lds
    v_mfma_f32_16x16x32_bf16 v[166:169], v[126:129], v[94:97], v[166:169]
    ds_read_b64_tr_b16 v[70:71], v31 offset:18432
    ds_read_b64_tr_b16 v[72:73], v31 offset:19584
    v_mfma_f32_16x16x32_bf16 v[170:173], v[122:125], v[98:101], v[170:173]
    s_add_u32 m0, s49, 38912
    s_nop 0
    buffer_load_dwordx4 v12, s[28:31], s51 offen lds
    v_mfma_f32_16x16x32_bf16 a[12:15], v[126:129], v[126:129], a[12:15]
    ds_read_b64_tr_b16 v[74:75], v32 offset:18432
    ds_read_b64_tr_b16 v[76:77], v32 offset:19584
    v_mfma_f32_16x16x32_bf16 v[174:177], v[126:129], v[98:101], v[174:177]
    s_add_u32 m0, s49, 39936
    s_nop 0
    buffer_load_dwordx4 v13, s[28:31], s51 offen lds
    v_mfma_f32_16x16x32_bf16 v[178:181], v[122:125], v[102:105], v[178:181]
    s_add_u32 m0, s49, 40960
    s_mov_b32 exec_hi, 0
    buffer_load_dwordx4 v14, s[28:31], s51 offen lds
    s_mov_b32 exec_hi, -1
    s_add_u32 s51, s51, 221184
    v_mfma_f32_16x16x32_bf16 v[182:185], v[126:129], v[102:105], v[182:185]
    s_add_u32 m0, s49, 55296
    s_nop 0
    buffer_load_dwordx4 v10, s[28:31], s51 offen lds
    v_mfma_f32_16x16x32_bf16 a[16:19], a[28:31], v[78:81], a[16:19]
    s_add_u32 m0, s49, 56320
    s_nop 0
    buffer_load_dwordx4 v11, s[28:31], s51 offen lds
    v_mfma_f32_16x16x32_bf16 v[186:189], v[122:125], v[106:109], v[186:189]
    v_mfma_f32_16x16x32_bf16 v[190:193], v[126:129], v[106:109], v[190:193]
    s_add_u32 m0, s49, 57344
    s_nop 0
    buffer_load_dwordx4 v12, s[28:31], s51 offen lds
    v_mfma_f32_16x16x32_bf16 v[194:197], v[122:125], v[110:113], v[194:197]
    v_mfma_f32_16x16x32_bf16 a[20:23], a[28:31], v[82:85], a[20:23]
    s_add_u32 m0, s49, 58368
    s_nop 0
    buffer_load_dwordx4 v13, s[28:31], s51 offen lds
    v_mfma_f32_16x16x32_bf16 v[198:201], v[126:129], v[110:113], v[198:201]
    s_add_u32 m0, s49, 59392
    s_mov_b32 exec_hi, 0
    buffer_load_dwordx4 v14, s[28:31], s51 offen lds
    s_mov_b32 exec_hi, -1
    s_add_u32 s51, s51, 221184
    v_mfma_f32_16x16x32_bf16 a[24:27], a[28:31], v[86:89], a[24:27]
    s_waitcnt lgkmcnt(0)
    v_mfma_f32_16x16x32_bf16 v[130:133], v[114:117], v[42:45], v[130:133]
    ds_read_b128 v[122:125], v16 offset:4096
    v_mfma_f32_16x16x32_bf16 v[134:137], v[118:121], v[42:45], v[134:137]
    ds_read_b128 v[126:129], v16 offset:6144
    v_mfma_f32_16x16x32_bf16 a[0:3], a[28:31], v[114:117], a[0:3]
    ds_read_b64_tr_b16 v[78:79], v24 offset:27648
    ds_read_b64_tr_b16 v[80:81], v24 offset:28800
    v_mfma_f32_16x16x32_bf16 v[138:141], v[114:117], v[46:49], v[138:141]
    ds_read_b64_tr_b16 v[82:83], v25 offset:27648
    ds_read_b64_tr_b16 v[84:85], v25 offset:28800
    v_mfma_f32_16x16x32_bf16 v[142:145], v[118:121], v[46:49], v[142:145]
    ds_read_b64_tr_b16 v[86:87], v26 offset:27648
    ds_read_b64_tr_b16 v[88:89], v26 offset:28800
    v_mfma_f32_16x16x32_bf16 v[146:149], v[114:117], v[50:53], v[146:149]
    ds_read_b64_tr_b16 v[90:91], v27 offset:27648
    ds_read_b64_tr_b16 v[92:93], v27 offset:28800
    v_mfma_f32_16x16x32_bf16 a[4:7], v[114:117], v[114:117], a[4:7]
    ds_read_b64_tr_b16 v[94:95], v28 offset:27648
    ds_read_b64_tr_b16 v[96:97], v28 offset:28800
    v_mfma_f32_16x16x32_bf16 v[150:153], v[118:121], v[50:53], v[150:153]
    v_mfma_f32_16x16x32_bf16 v[154:157], v[114:117], v[54:57], v[154:157]
    ds_read_b64_tr_b16 v[98:99], v29 offset:27648
    ds_read_b64_tr_b16 v[100:101], v29 offset:28800
    v_mfma_f32_16x16x32_bf16 v[158:161], v[118:121], v[54:57], v[158:161]
    v_mfma_f32_16x16x32_bf16 a[8:11], a[28:31], v[118:121], a[8:11]
    ds_read_b64_tr_b16 v[102:103], v30 offset:27648
    ds_read_b64_tr_b16 v[104:105], v30 offset:28800
    v_mfma_f32_16x16x32_bf16 v[162:165], v[114:117], v[58:61], v[162:165]
    v_mfma_f32_16x16x32_bf16 v[166:169], v[118:121], v[58:61], v[166:169]
    ds_read_b64_tr_b16 v[106:107], v31 offset:27648
    ds_read_b64_tr_b16 v[108:109], v31 offset:28800
    v_mfma_f32_16x16x32_bf16 v[170:173], v[114:117], v[62:65], v[170:173]
    s_add_u32 m0, s48, 0
    s_nop 0
    buffer_load_dwordx4 v6, s[24:27], s50 offen lds
    v_mfma_f32_16x16x32_bf16 a[12:15], v[118:121], v[118:121], a[12:15]
    ds_read_b64_tr_b16 v[110:111], v32 offset:27648
    ds_read_b64_tr_b16 v[112:113], v32 offset:28800
    v_mfma_f32_16x16x32_bf16 v[174:177], v[118:121], v[62:65], v[174:177]
    v_mfma_f32_16x16x32_bf16 v[178:181], v[114:117], v[66:69], v[178:181]
    s_add_u32 m0, s48, 1024
    s_nop 0
    buffer_load_dwordx4 v7, s[24:27], s50 offen lds
    v_mfma_f32_16x16x32_bf16 v[182:185], v[118:121], v[66:69], v[182:185]
    v_mfma_f32_16x16x32_bf16 a[16:19], a[28:31], v[42:45], a[16:19]
    s_add_u32 m0, s48, 2048
    s_nop 0
    buffer_load_dwordx4 v8, s[24:27], s50 offen lds
    v_mfma_f32_16x16x32_bf16 v[186:189], v[114:117], v[70:73], v[186:189]
    v_mfma_f32_16x16x32_bf16 v[190:193], v[118:121], v[70:73], v[190:193]
    s_add_u32 m0, s48, 3072
    s_nop 0
    buffer_load_dwordx4 v9, s[24:27], s50 offen lds
    s_add_u32 s50, s50, 128
    v_mfma_f32_16x16x32_bf16 v[194:197], v[114:117], v[74:77], v[194:197]
    v_mfma_f32_16x16x32_bf16 a[20:23], a[28:31], v[46:49], a[20:23]
    v_mfma_f32_16x16x32_bf16 v[198:201], v[118:121], v[74:77], v[198:201]
    v_mfma_f32_16x16x32_bf16 a[24:27], a[28:31], v[50:53], a[24:27]
    s_waitcnt vmcnt(9)
    s_barrier
    s_waitcnt lgkmcnt(0)
    v_mfma_f32_16x16x32_bf16 v[130:133], v[122:125], v[78:81], v[130:133]
    ds_read_b128 v[114:117], v15 offset:8192
    v_mfma_f32_16x16x32_bf16 v[134:137], v[126:129], v[78:81], v[134:137]
    ds_read_b128 v[118:121], v15 offset:10240
    v_mfma_f32_16x16x32_bf16 a[0:3], a[28:31], v[122:125], a[0:3]
    ds_read_b64_tr_b16 v[42:43], v33 offset:0
    ds_read_b64_tr_b16 v[44:45], v33 offset:1152
    v_mfma_f32_16x16x32_bf16 v[138:141], v[122:125], v[82:85], v[138:141]
    ds_read_b64_tr_b16 v[46:47], v34 offset:0
    ds_read_b64_tr_b16 v[48:49], v34 offset:1152
    v_mfma_f32_16x16x32_bf16 v[142:145], v[126:129], v[82:85], v[142:145]
    ds_read_b64_tr_b16 v[50:51], v35 offset:0
    ds_read_b64_tr_b16 v[52:53], v35 offset:1152
    v_mfma_f32_16x16x32_bf16 v[146:149], v[122:125], v[86:89], v[146:149]
    ds_read_b64_tr_b16 v[54:55], v36 offset:0
    ds_read_b64_tr_b16 v[56:57], v36 offset:1152
    v_mfma_f32_16x16x32_bf16 a[4:7], v[122:125], v[122:125], a[4:7]
    ds_read_b64_tr_b16 v[58:59], v37 offset:0
    ds_read_b64_tr_b16 v[60:61], v37 offset:1152
    v_mfma_f32_16x16x32_bf16 v[150:153], v[126:129], v[86:89], v[150:153]
    v_mfma_f32_16x16x32_bf16 v[154:157], v[122:125], v[90:93], v[154:157]
    ds_read_b64_tr_b16 v[62:63], v38 offset:0
    ds_read_b64_tr_b16 v[64:65], v38 offset:1152
    v_mfma_f32_16x16x32_bf16 v[158:161], v[126:129], v[90:93], v[158:161]
    v_mfma_f32_16x16x32_bf16 a[8:11], a[28:31], v[126:129], a[8:11]
    ds_read_b64_tr_b16 v[66:67], v39 offset:0
    ds_read_b64_tr_b16 v[68:69], v39 offset:1152
    v_mfma_f32_16x16x32_bf16 v[162:165], v[122:125], v[94:97], v[162:165]
    v_mfma_f32_16x16x32_bf16 v[166:169], v[126:129], v[94:97], v[166:169]
    ds_read_b64_tr_b16 v[70:71], v40 offset:0
    ds_read_b64_tr_b16 v[72:73], v40 offset:1152
    v_mfma_f32_16x16x32_bf16 v[170:173], v[122:125], v[98:101], v[170:173]
    s_add_u32 m0, s49, 0
    s_nop 0
    buffer_load_dwordx4 v10, s[28:31], s51 offen lds
    v_mfma_f32_16x16x32_bf16 a[12:15], v[126:129], v[126:129], a[12:15]
    ds_read_b64_tr_b16 v[74:75], v41 offset:0
    ds_read_b64_tr_b16 v[76:77], v41 offset:1152
    v_mfma_f32_16x16x32_bf16 v[174:177], v[126:129], v[98:101], v[174:177]
    v_mfma_f32_16x16x32_bf16 v[178:181], v[122:125], v[102:105], v[178:181]
    s_add_u32 m0, s49, 1024
    s_nop 0
    buffer_load_dwordx4 v11, s[28:31], s51 offen lds
    v_mfma_f32_16x16x32_bf16 v[182:185], v[126:129], v[102:105], v[182:185]
    v_mfma_f32_16x16x32_bf16 a[16:19], a[28:31], v[78:81], a[16:19]
    s_add_u32 m0, s49, 2048
    s_nop 0
    buffer_load_dwordx4 v12, s[28:31], s51 offen lds
    v_mfma_f32_16x16x32_bf16 v[186:189], v[122:125], v[106:109], v[186:189]
    v_mfma_f32_16x16x32_bf16 v[190:193], v[126:129], v[106:109], v[190:193]
    s_add_u32 m0, s49, 3072
    s_nop 0
    buffer_load_dwordx4 v13, s[28:31], s51 offen lds
    v_mfma_f32_16x16x32_bf16 v[194:197], v[122:125], v[110:113], v[194:197]
    v_mfma_f32_16x16x32_bf16 a[20:23], a[28:31], v[82:85], a[20:23]
    s_add_u32 m0, s49, 4096
    s_mov_b32 exec_hi, 0
    buffer_load_dwordx4 v14, s[28:31], s51 offen lds
    s_mov_b32 exec_hi, -1
    s_add_u32 s51, s51, 221184
    v_mfma_f32_16x16x32_bf16 v[198:201], v[126:129], v[110:113], v[198:201]
    v_mfma_f32_16x16x32_bf16 a[24:27], a[28:31], v[86:89], a[24:27]
    s_waitcnt lgkmcnt(0)
    v_mfma_f32_16x16x32_bf16 v[130:133], v[114:117], v[42:45], v[130:133]
    ds_read_b128 v[122:125], v16 offset:8192
    v_mfma_f32_16x16x32_bf16 v[134:137], v[118:121], v[42:45], v[134:137]
    ds_read_b128 v[126:129], v16 offset:10240
    v_mfma_f32_16x16x32_bf16 a[0:3], a[28:31], v[114:117], a[0:3]
    ds_read_b64_tr_b16 v[78:79], v33 offset:9216
    ds_read_b64_tr_b16 v[80:81], v33 offset:10368
    v_mfma_f32_16x16x32_bf16 v[138:141], v[114:117], v[46:49], v[138:141]
    ds_read_b64_tr_b16 v[82:83], v34 offset:9216
    ds_read_b64_tr_b16 v[84:85], v34 offset:10368
    v_mfma_f32_16x16x32_bf16 v[142:145], v[118:121], v[46:49], v[142:145]
    ds_read_b64_tr_b16 v[86:87], v35 offset:9216
    ds_read_b64_tr_b16 v[88:89], v35 offset:10368
    v_mfma_f32_16x16x32_bf16 v[146:149], v[114:117], v[50:53], v[146:149]
    ds_read_b64_tr_b16 v[90:91], v36 offset:9216
    ds_read_b64_tr_b16 v[92:93], v36 offset:10368
    v_mfma_f32_16x16x32_bf16 a[4:7], v[114:117], v[114:117], a[4:7]
    ds_read_b64_tr_b16 v[94:95], v37 offset:9216
    ds_read_b64_tr_b16 v[96:97], v37 offset:10368
    v_mfma_f32_16x16x32_bf16 v[150:153], v[118:121], v[50:53], v[150:153]
    v_mfma_f32_16x16x32_bf16 v[154:157], v[114:117], v[54:57], v[154:157]
    ds_read_b64_tr_b16 v[98:99], v38 offset:9216
    ds_read_b64_tr_b16 v[100:101], v38 offset:10368
    v_mfma_f32_16x16x32_bf16 v[158:161], v[118:121], v[54:57], v[158:161]
    v_mfma_f32_16x16x32_bf16 a[8:11], a[28:31], v[118:121], a[8:11]
    ds_read_b64_tr_b16 v[102:103], v39 offset:9216
    ds_read_b64_tr_b16 v[104:105], v39 offset:10368
    v_mfma_f32_16x16x32_bf16 v[162:165], v[114:117], v[58:61], v[162:165]
    v_mfma_f32_16x16x32_bf16 v[166:169], v[118:121], v[58:61], v[166:169]
    ds_read_b64_tr_b16 v[106:107], v40 offset:9216
    ds_read_b64_tr_b16 v[108:109], v40 offset:10368
    v_mfma_f32_16x16x32_bf16 v[170:173], v[114:117], v[62:65], v[170:173]
    s_add_u32 m0, s48, 4096
    s_nop 0
    buffer_load_dwordx4 v6, s[24:27], s50 offen lds
    v_mfma_f32_16x16x32_bf16 a[12:15], v[118:121], v[118:121], a[12:15]
    ds_read_b64_tr_b16 v[110:111], v41 offset:9216
    ds_read_b64_tr_b16 v[112:113], v41 offset:10368
    v_mfma_f32_16x16x32_bf16 v[174:177], v[118:121], v[62:65], v[174:177]
    v_mfma_f32_16x16x32_bf16 v[178:181], v[114:117], v[66:69], v[178:181]
    s_add_u32 m0, s48, 5120
    s_nop 0
    buffer_load_dwordx4 v7, s[24:27], s50 offen lds
    v_mfma_f32_16x16x32_bf16 v[182:185], v[118:121], v[66:69], v[182:185]
    v_mfma_f32_16x16x32_bf16 a[16:19], a[28:31], v[42:45], a[16:19]
    s_add_u32 m0, s48, 6144
    s_nop 0
    buffer_load_dwordx4 v8, s[24:27], s50 offen lds
    v_mfma_f32_16x16x32_bf16 v[186:189], v[114:117], v[70:73], v[186:189]
    v_mfma_f32_16x16x32_bf16 v[190:193], v[118:121], v[70:73], v[190:193]
    s_add_u32 m0, s48, 7168
    s_nop 0
    buffer_load_dwordx4 v9, s[24:27], s50 offen lds
    s_add_u32 s50, s50, 128
    v_mfma_f32_16x16x32_bf16 v[194:197], v[114:117], v[74:77], v[194:197]
    v_mfma_f32_16x16x32_bf16 a[20:23], a[28:31], v[46:49], a[20:23]
    v_mfma_f32_16x16x32_bf16 v[198:201], v[118:121], v[74:77], v[198:201]
    v_mfma_f32_16x16x32_bf16 a[24:27], a[28:31], v[50:53], a[24:27]
    s_waitcnt vmcnt(13)
    s_barrier
    s_waitcnt lgkmcnt(0)
    v_mfma_f32_16x16x32_bf16 v[130:133], v[122:125], v[78:81], v[130:133]
    ds_read_b128 v[114:117], v15 offset:12288
    v_mfma_f32_16x16x32_bf16 v[134:137], v[126:129], v[78:81], v[134:137]
    ds_read_b128 v[118:121], v15 offset:14336
    v_mfma_f32_16x16x32_bf16 a[0:3], a[28:31], v[122:125], a[0:3]
    ds_read_b64_tr_b16 v[42:43], v33 offset:18432
    ds_read_b64_tr_b16 v[44:45], v33 offset:19584
    v_mfma_f32_16x16x32_bf16 v[138:141], v[122:125], v[82:85], v[138:141]
    ds_read_b64_tr_b16 v[46:47], v34 offset:18432
    ds_read_b64_tr_b16 v[48:49], v34 offset:19584
    v_mfma_f32_16x16x32_bf16 v[142:145], v[126:129], v[82:85], v[142:145]
    ds_read_b64_tr_b16 v[50:51], v35 offset:18432
    ds_read_b64_tr_b16 v[52:53], v35 offset:19584
    v_mfma_f32_16x16x32_bf16 v[146:149], v[122:125], v[86:89], v[146:149]
    ds_read_b64_tr_b16 v[54:55], v36 offset:18432
    ds_read_b64_tr_b16 v[56:57], v36 offset:19584
    v_mfma_f32_16x16x32_bf16 a[4:7], v[122:125], v[122:125], a[4:7]
    ds_read_b64_tr_b16 v[58:59], v37 offset:18432
    ds_read_b64_tr_b16 v[60:61], v37 offset:19584
    v_mfma_f32_16x16x32_bf16 v[150:153], v[126:129], v[86:89], v[150:153]
    v_mfma_f32_16x16x32_bf16 v[154:157], v[122:125], v[90:93], v[154:157]
    ds_read_b64_tr_b16 v[62:63], v38 offset:18432
    ds_read_b64_tr_b16 v[64:65], v38 offset:19584
    v_mfma_f32_16x16x32_bf16 v[158:161], v[126:129], v[90:93], v[158:161]
    v_mfma_f32_16x16x32_bf16 a[8:11], a[28:31], v[126:129], a[8:11]
    ds_read_b64_tr_b16 v[66:67], v39 offset:18432
    ds_read_b64_tr_b16 v[68:69], v39 offset:19584
    v_mfma_f32_16x16x32_bf16 v[162:165], v[122:125], v[94:97], v[162:165]
    v_mfma_f32_16x16x32_bf16 v[166:169], v[126:129], v[94:97], v[166:169]
    ds_read_b64_tr_b16 v[70:71], v40 offset:18432
    ds_read_b64_tr_b16 v[72:73], v40 offset:19584
    v_mfma_f32_16x16x32_bf16 v[170:173], v[122:125], v[98:101], v[170:173]
    s_add_u32 m0, s49, 18432
    s_nop 0
    buffer_load_dwordx4 v10, s[28:31], s51 offen lds
    v_mfma_f32_16x16x32_bf16 a[12:15], v[126:129], v[126:129], a[12:15]
    ds_read_b64_tr_b16 v[74:75], v41 offset:18432
    ds_read_b64_tr_b16 v[76:77], v41 offset:19584
    v_mfma_f32_16x16x32_bf16 v[174:177], v[126:129], v[98:101], v[174:177]
    v_mfma_f32_16x16x32_bf16 v[178:181], v[122:125], v[102:105], v[178:181]
    s_add_u32 m0, s49, 19456
    s_nop 0
    buffer_load_dwordx4 v11, s[28:31], s51 offen lds
    v_mfma_f32_16x16x32_bf16 v[182:185], v[126:129], v[102:105], v[182:185]
    v_mfma_f32_16x16x32_bf16 a[16:19], a[28:31], v[78:81], a[16:19]
    s_add_u32 m0, s49, 20480
    s_nop 0
    buffer_load_dwordx4 v12, s[28:31], s51 offen lds
    v_mfma_f32_16x16x32_bf16 v[186:189], v[122:125], v[106:109], v[186:189]
    v_mfma_f32_16x16x32_bf16 v[190:193], v[126:129], v[106:109], v[190:193]
    s_add_u32 m0, s49, 21504
    s_nop 0
    buffer_load_dwordx4 v13, s[28:31], s51 offen lds
    v_mfma_f32_16x16x32_bf16 v[194:197], v[122:125], v[110:113], v[194:197]
    v_mfma_f32_16x16x32_bf16 a[20:23], a[28:31], v[82:85], a[20:23]
    s_add_u32 m0, s49, 22528
    s_mov_b32 exec_hi, 0
    buffer_load_dwordx4 v14, s[28:31], s51 offen lds
    s_mov_b32 exec_hi, -1
    s_add_u32 s51, s51, 221184
    v_mfma_f32_16x16x32_bf16 v[198:201], v[126:129], v[110:113], v[198:201]
    v_mfma_f32_16x16x32_bf16 a[24:27], a[28:31], v[86:89], a[24:27]
    s_waitcnt lgkmcnt(0)
    v_mfma_f32_16x16x32_bf16 v[130:133], v[114:117], v[42:45], v[130:133]
    ds_read_b128 v[122:125], v16 offset:12288
    v_mfma_f32_16x16x32_bf16 v[134:137], v[118:121], v[42:45], v[134:137]
    ds_read_b128 v[126:129], v16 offset:14336
    v_mfma_f32_16x16x32_bf16 a[0:3], a[28:31], v[114:117], a[0:3]
    ds_read_b64_tr_b16 v[78:79], v33 offset:27648
    ds_read_b64_tr_b16 v[80:81], v33 offset:28800
    v_mfma_f32_16x16x32_bf16 v[138:141], v[114:117], v[46:49], v[138:141]
    ds_read_b64_tr_b16 v[82:83], v34 offset:27648
    ds_read_b64_tr_b16 v[84:85], v34 offset:28800
    v_mfma_f32_16x16x32_bf16 v[142:145], v[118:121], v[46:49], v[142:145]
    ds_read_b64_tr_b16 v[86:87], v35 offset:27648
    ds_read_b64_tr_b16 v[88:89], v35 offset:28800
    v_mfma_f32_16x16x32_bf16 v[146:149], v[114:117], v[50:53], v[146:149]
    ds_read_b64_tr_b16 v[90:91], v36 offset:27648
    ds_read_b64_tr_b16 v[92:93], v36 offset:28800
    v_mfma_f32_16x16x32_bf16 a[4:7], v[114:117], v[114:117], a[4:7]
    ds_read_b64_tr_b16 v[94:95], v37 offset:27648
    ds_read_b64_tr_b16 v[96:97], v37 offset:28800
    v_mfma_f32_16x16x32_bf16 v[150:153], v[118:121], v[50:53], v[150:153]
    v_mfma_f32_16x16x32_bf16 v[154:157], v[114:117], v[54:57], v[154:157]
    ds_read_b64_tr_b16 v[98:99], v38 offset:27648
    ds_read_b64_tr_b16 v[100:101], v38 offset:28800
    v_mfma_f32_16x16x32_bf16 v[158:161], v[118:121], v[54:57], v[158:161]
    v_mfma_f32_16x16x32_bf16 a[8:11], a[28:31], v[118:121], a[8:11]
    ds_read_b64_tr_b16 v[102:103], v39 offset:27648
    ds_read_b64_tr_b16 v[104:105], v39 offset:28800
    v_mfma_f32_16x16x32_bf16 v[162:165], v[114:117], v[58:61], v[162:165]
    v_mfma_f32_16x16x32_bf16 v[166:169], v[118:121], v[58:61], v[166:169]
    ds_read_b64_tr_b16 v[106:107], v40 offset:27648
    ds_read_b64_tr_b16 v[108:109], v40 offset:28800
    v_mfma_f32_16x16x32_bf16 v[170:173], v[114:117], v[62:65], v[170:173]
    s_add_u32 m0, s48, 8192
    s_nop 0
    buffer_load_dwordx4 v6, s[24:27], s50 offen lds
    v_mfma_f32_16x16x32_bf16 a[12:15], v[118:121], v[118:121], a[12:15]
    ds_read_b64_tr_b16 v[110:111], v41 offset:27648
    ds_read_b64_tr_b16 v[112:113], v41 offset:28800
    v_mfma_f32_16x16x32_bf16 v[174:177], v[118:121], v[62:65], v[174:177]
    v_mfma_f32_16x16x32_bf16 v[178:181], v[114:117], v[66:69], v[178:181]
    s_add_u32 m0, s48, 9216
    s_nop 0
    buffer_load_dwordx4 v7, s[24:27], s50 offen lds
    v_mfma_f32_16x16x32_bf16 v[182:185], v[118:121], v[66:69], v[182:185]
    v_mfma_f32_16x16x32_bf16 a[16:19], a[28:31], v[42:45], a[16:19]
    s_add_u32 m0, s48, 10240
    s_nop 0
    buffer_load_dwordx4 v8, s[24:27], s50 offen lds
    v_mfma_f32_16x16x32_bf16 v[186:189], v[114:117], v[70:73], v[186:189]
    v_mfma_f32_16x16x32_bf16 v[190:193], v[118:121], v[70:73], v[190:193]
    s_add_u32 m0, s48, 11264
    s_nop 0
    buffer_load_dwordx4 v9, s[24:27], s50 offen lds
    s_add_u32 s50, s50, 128
    v_mfma_f32_16x16x32_bf16 v[194:197], v[114:117], v[74:77], v[194:197]
    v_mfma_f32_16x16x32_bf16 a[20:23], a[28:31], v[46:49], a[20:23]
    v_mfma_f32_16x16x32_bf16 v[198:201], v[118:121], v[74:77], v[198:201]
    v_mfma_f32_16x16x32_bf16 a[24:27], a[28:31], v[50:53], a[24:27]
    s_waitcnt vmcnt(13)
    s_barrier
    s_waitcnt lgkmcnt(0)
    v_mfma_f32_16x16x32_bf16 v[130:133], v[122:125], v[78:81], v[130:133]
    ds_read_b128 v[114:117], v15 offset:0
    v_mfma_f32_16x16x32_bf16 v[134:137], v[126:129], v[78:81], v[134:137]
    ds_read_b128 v[118:121], v15 offset:2048
    v_mfma_f32_16x16x32_bf16 a[0:3], a[28:31], v[122:125], a[0:3]
    ds_read_b64_tr_b16 v[42:43], v24 offset:0
    ds_read_b64_tr_b16 v[44:45], v24 offset:1152
    v_mfma_f32_16x16x32_bf16 v[138:141], v[122:125], v[82:85], v[138:141]
    ds_read_b64_tr_b16 v[46:47], v25 offset:0
    ds_read_b64_tr_b16 v[48:49], v25 offset:1152
    v_mfma_f32_16x16x32_bf16 v[142:145], v[126:129], v[82:85], v[142:145]
    ds_read_b64_tr_b16 v[50:51], v26 offset:0
    ds_read_b64_tr_b16 v[52:53], v26 offset:1152
    v_mfma_f32_16x16x32_bf16 v[146:149], v[122:125], v[86:89], v[146:149]
    ds_read_b64_tr_b16 v[54:55], v27 offset:0
    ds_read_b64_tr_b16 v[56:57], v27 offset:1152
    v_mfma_f32_16x16x32_bf16 a[4:7], v[122:125], v[122:125], a[4:7]
    ds_read_b64_tr_b16 v[58:59], v28 offset:0
    ds_read_b64_tr_b16 v[60:61], v28 offset:1152
    v_mfma_f32_16x16x32_bf16 v[150:153], v[126:129], v[86:89], v[150:153]
    v_mfma_f32_16x16x32_bf16 v[154:157], v[122:125], v[90:93], v[154:157]
    ds_read_b64_tr_b16 v[62:63], v29 offset:0
    ds_read_b64_tr_b16 v[64:65], v29 offset:1152
    v_mfma_f32_16x16x32_bf16 v[158:161], v[126:129], v[90:93], v[158:161]
    v_mfma_f32_16x16x32_bf16 a[8:11], a[28:31], v[126:129], a[8:11]
    ds_read_b64_tr_b16 v[66:67], v30 offset:0
    ds_read_b64_tr_b16 v[68:69], v30 offset:1152
    v_mfma_f32_16x16x32_bf16 v[162:165], v[122:125], v[94:97], v[162:165]
    v_mfma_f32_16x16x32_bf16 v[166:169], v[126:129], v[94:97], v[166:169]
    ds_read_b64_tr_b16 v[70:71], v31 offset:0
    ds_read_b64_tr_b16 v[72:73], v31 offset:1152
    v_mfma_f32_16x16x32_bf16 v[170:173], v[122:125], v[98:101], v[170:173]
    s_add_u32 m0, s49, 36864
    s_nop 0
    buffer_load_dwordx4 v10, s[28:31], s51 offen lds
    v_mfma_f32_16x16x32_bf16 a[12:15], v[126:129], v[126:129], a[12:15]
    ds_read_b64_tr_b16 v[74:75], v32 offset:0
    ds_read_b64_tr_b16 v[76:77], v32 offset:1152
    v_mfma_f32_16x16x32_bf16 v[174:177], v[126:129], v[98:101], v[174:177]
    v_mfma_f32_16x16x32_bf16 v[178:181], v[122:125], v[102:105], v[178:181]
    s_add_u32 m0, s49, 37888
    s_nop 0
    buffer_load_dwordx4 v11, s[28:31], s51 offen lds
    v_mfma_f32_16x16x32_bf16 v[182:185], v[126:129], v[102:105], v[182:185]
    v_mfma_f32_16x16x32_bf16 a[16:19], a[28:31], v[78:81], a[16:19]
    s_add_u32 m0, s49, 38912
    s_nop 0
    buffer_load_dwordx4 v12, s[28:31], s51 offen lds
    v_mfma_f32_16x16x32_bf16 v[186:189], v[122:125], v[106:109], v[186:189]
    v_mfma_f32_16x16x32_bf16 v[190:193], v[126:129], v[106:109], v[190:193]
    s_add_u32 m0, s49, 39936
    s_nop 0
    buffer_load_dwordx4 v13, s[28:31], s51 offen lds
    v_mfma_f32_16x16x32_bf16 v[194:197], v[122:125], v[110:113], v[194:197]
    v_mfma_f32_16x16x32_bf16 a[20:23], a[28:31], v[82:85], a[20:23]
    s_add_u32 m0, s49, 40960
    s_mov_b32 exec_hi, 0
    buffer_load_dwordx4 v14, s[28:31], s51 offen lds
    s_mov_b32 exec_hi, -1
    s_branch L_pgqkv_kernel_5_s
.p2align 12
L_pgqkv_kernel_5:
    s_branch L_hopqkv_kernel_1
L_pgqkv_kernel_5_s:
    s_add_u32 s51, s51, 221184
    v_mfma_f32_16x16x32_bf16 v[198:201], v[126:129], v[110:113], v[198:201]
    v_mfma_f32_16x16x32_bf16 a[24:27], a[28:31], v[86:89], a[24:27]
    s_waitcnt lgkmcnt(0)
    v_mfma_f32_16x16x32_bf16 v[130:133], v[114:117], v[42:45], v[130:133]
    ds_read_b128 v[122:125], v16 offset:0
    v_mfma_f32_16x16x32_bf16 v[134:137], v[118:121], v[42:45], v[134:137]
    ds_read_b128 v[126:129], v16 offset:2048
    v_mfma_f32_16x16x32_bf16 a[0:3], a[28:31], v[114:117], a[0:3]
    ds_read_b64_tr_b16 v[78:79], v24 offset:9216
    ds_read_b64_tr_b16 v[80:81], v24 offset:10368
    v_mfma_f32_16x16x32_bf16 v[138:141], v[114:117], v[46:49], v[138:141]
    ds_read_b64_tr_b16 v[82:83], v25 offset:9216
    ds_read_b64_tr_b16 v[84:85], v25 offset:10368
    v_mfma_f32_16x16x32_bf16 v[142:145], v[118:121], v[46:49], v[142:145]
    ds_read_b64_tr_b16 v[86:87], v26 offset:9216
    ds_read_b64_tr_b16 v[88:89], v26 offset:10368
    v_mfma_f32_16x16x32_bf16 v[146:149], v[114:117], v[50:53], v[146:149]
    ds_read_b64_tr_b16 v[90:91], v27 offset:9216
    ds_read_b64_tr_b16 v[92:93], v27 offset:10368
    v_mfma_f32_16x16x32_bf16 a[4:7], v[114:117], v[114:117], a[4:7]
    ds_read_b64_tr_b16 v[94:95], v28 offset:9216
    ds_read_b64_tr_b16 v[96:97], v28 offset:10368
    v_mfma_f32_16x16x32_bf16 v[150:153], v[118:121], v[50:53], v[150:153]
    v_mfma_f32_16x16x32_bf16 v[154:157], v[114:117], v[54:57], v[154:157]
    ds_read_b64_tr_b16 v[98:99], v29 offset:9216
    ds_read_b64_tr_b16 v[100:101], v29 offset:10368
    v_mfma_f32_16x16x32_bf16 v[158:161], v[118:121], v[54:57], v[158:161]
    v_mfma_f32_16x16x32_bf16 a[8:11], a[28:31], v[118:121], a[8:11]
    ds_read_b64_tr_b16 v[102:103], v30 offset:9216
    ds_read_b64_tr_b16 v[104:105], v30 offset:10368
    v_mfma_f32_16x16x32_bf16 v[162:165], v[114:117], v[58:61], v[162:165]
    v_mfma_f32_16x16x32_bf16 v[166:169], v[118:121], v[58:61], v[166:169]
    ds_read_b64_tr_b16 v[106:107], v31 offset:9216
    ds_read_b64_tr_b16 v[108:109], v31 offset:10368
    v_mfma_f32_16x16x32_bf16 v[170:173], v[114:117], v[62:65], v[170:173]
    s_add_u32 m0, s48, 12288
    s_nop 0
    buffer_load_dwordx4 v6, s[24:27], s50 offen lds
    v_mfma_f32_16x16x32_bf16 a[12:15], v[118:121], v[118:121], a[12:15]
    ds_read_b64_tr_b16 v[110:111], v32 offset:9216
    ds_read_b64_tr_b16 v[112:113], v32 offset:10368
    v_mfma_f32_16x16x32_bf16 v[174:177], v[118:121], v[62:65], v[174:177]
    v_mfma_f32_16x16x32_bf16 v[178:181], v[114:117], v[66:69], v[178:181]
    s_add_u32 m0, s48, 13312
    s_nop 0
    buffer_load_dwordx4 v7, s[24:27], s50 offen lds
    v_mfma_f32_16x16x32_bf16 v[182:185], v[118:121], v[66:69], v[182:185]
    v_mfma_f32_16x16x32_bf16 a[16:19], a[28:31], v[42:45], a[16:19]
    s_add_u32 m0, s48, 14336
    s_nop 0
    buffer_load_dwordx4 v8, s[24:27], s50 offen lds
    v_mfma_f32_16x16x32_bf16 v[186:189], v[114:117], v[70:73], v[186:189]
    v_mfma_f32_16x16x32_bf16 v[190:193], v[118:121], v[70:73], v[190:193]
    s_add_u32 m0, s48, 15360
    s_nop 0
    buffer_load_dwordx4 v9, s[24:27], s50 offen lds
    s_add_u32 s50, s50, 128
    v_mfma_f32_16x16x32_bf16 v[194:197], v[114:117], v[74:77], v[194:197]
    v_mfma_f32_16x16x32_bf16 a[20:23], a[28:31], v[46:49], a[20:23]
    v_mfma_f32_16x16x32_bf16 v[198:201], v[118:121], v[74:77], v[198:201]
    v_mfma_f32_16x16x32_bf16 a[24:27], a[28:31], v[50:53], a[24:27]
    s_waitcnt vmcnt(13)
    s_barrier
    s_waitcnt lgkmcnt(0)
    v_mfma_f32_16x16x32_bf16 v[130:133], v[122:125], v[78:81], v[130:133]
    ds_read_b128 v[114:117], v15 offset:4096
    v_mfma_f32_16x16x32_bf16 v[134:137], v[126:129], v[78:81], v[134:137]
    ds_read_b128 v[118:121], v15 offset:6144
    v_mfma_f32_16x16x32_bf16 a[0:3], a[28:31], v[122:125], a[0:3]
    ds_read_b64_tr_b16 v[42:43], v24 offset:18432
    ds_read_b64_tr_b16 v[44:45], v24 offset:19584
    v_mfma_f32_16x16x32_bf16 v[138:141], v[122:125], v[82:85], v[138:141]
    ds_read_b64_tr_b16 v[46:47], v25 offset:18432
    ds_read_b64_tr_b16 v[48:49], v25 offset:19584
    v_mfma_f32_16x16x32_bf16 v[142:145], v[126:129], v[82:85], v[142:145]
    ds_read_b64_tr_b16 v[50:51], v26 offset:18432
    ds_read_b64_tr_b16 v[52:53], v26 offset:19584
    v_mfma_f32_16x16x32_bf16 v[146:149], v[122:125], v[86:89], v[146:149]
    ds_read_b64_tr_b16 v[54:55], v27 offset:18432
    ds_read_b64_tr_b16 v[56:57], v27 offset:19584
    v_mfma_f32_16x16x32_bf16 a[4:7], v[122:125], v[122:125], a[4:7]
    ds_read_b64_tr_b16 v[58:59], v28 offset:18432
    ds_read_b64_tr_b16 v[60:61], v28 offset:19584
    v_mfma_f32_16x16x32_bf16 v[150:153], v[126:129], v[86:89], v[150:153]
    v_mfma_f32_16x16x32_bf16 v[154:157], v[122:125], v[90:93], v[154:157]
    ds_read_b64_tr_b16 v[62:63], v29 offset:18432
    ds_read_b64_tr_b16 v[64:65], v29 offset:19584
    v_mfma_f32_16x16x32_bf16 v[158:161], v[126:129], v[90:93], v[158:161]
    v_mfma_f32_16x16x32_bf16 a[8:11], a[28:31], v[126:129], a[8:11]
    ds_read_b64_tr_b16 v[66:67], v30 offset:18432
    ds_read_b64_tr_b16 v[68:69], v30 offset:19584
    v_mfma_f32_16x16x32_bf16 v[162:165], v[122:125], v[94:97], v[162:165]
    v_mfma_f32_16x16x32_bf16 v[166:169], v[126:129], v[94:97], v[166:169]
    ds_read_b64_tr_b16 v[70:71], v31 offset:18432
    ds_read_b64_tr_b16 v[72:73], v31 offset:19584
    v_mfma_f32_16x16x32_bf16 v[170:173], v[122:125], v[98:101], v[170:173]
    s_add_u32 m0, s49, 55296
    s_nop 0
    buffer_load_dwordx4 v10, s[28:31], s51 offen lds
    v_mfma_f32_16x16x32_bf16 a[12:15], v[126:129], v[126:129], a[12:15]
    ds_read_b64_tr_b16 v[74:75], v32 offset:18432
    ds_read_b64_tr_b16 v[76:77], v32 offset:19584
    v_mfma_f32_16x16x32_bf16 v[174:177], v[126:129], v[98:101], v[174:177]
    v_mfma_f32_16x16x32_bf16 v[178:181], v[122:125], v[102:105], v[178:181]
    s_add_u32 m0, s49, 56320
    s_nop 0
    buffer_load_dwordx4 v11, s[28:31], s51 offen lds
    v_mfma_f32_16x16x32_bf16 v[182:185], v[126:129], v[102:105], v[182:185]
    v_mfma_f32_16x16x32_bf16 a[16:19], a[28:31], v[78:81], a[16:19]
    s_add_u32 m0, s49, 57344
    s_nop 0
    buffer_load_dwordx4 v12, s[28:31], s51 offen lds
    v_mfma_f32_16x16x32_bf16 v[186:189], v[122:125], v[106:109], v[186:189]
    v_mfma_f32_16x16x32_bf16 v[190:193], v[126:129], v[106:109], v[190:193]
    s_add_u32 m0, s49, 58368
    s_nop 0
    buffer_load_dwordx4 v13, s[28:31], s51 offen lds
    v_mfma_f32_16x16x32_bf16 v[194:197], v[122:125], v[110:113], v[194:197]
    v_mfma_f32_16x16x32_bf16 a[20:23], a[28:31], v[82:85], a[20:23]
    s_add_u32 m0, s49, 59392
    s_mov_b32 exec_hi, 0
    buffer_load_dwordx4 v14, s[28:31], s51 offen lds
    s_mov_b32 exec_hi, -1
    s_add_u32 s51, s51, 221184
    v_mfma_f32_16x16x32_bf16 v[198:201], v[126:129], v[110:113], v[198:201]
    v_mfma_f32_16x16x32_bf16 a[24:27], a[28:31], v[86:89], a[24:27]
    s_waitcnt lgkmcnt(0)
    v_mfma_f32_16x16x32_bf16 v[130:133], v[114:117], v[42:45], v[130:133]
    ds_read_b128 v[122:125], v16 offset:4096
    v_mfma_f32_16x16x32_bf16 v[134:137], v[118:121], v[42:45], v[134:137]
    ds_read_b128 v[126:129], v16 offset:6144
    v_mfma_f32_16x16x32_bf16 a[0:3], a[28:31], v[114:117], a[0:3]
    ds_read_b64_tr_b16 v[78:79], v24 offset:27648
    ds_read_b64_tr_b16 v[80:81], v24 offset:28800
    v_mfma_f32_16x16x32_bf16 v[138:141], v[114:117], v[46:49], v[138:141]
    ds_read_b64_tr_b16 v[82:83], v25 offset:27648
    ds_read_b64_tr_b16 v[84:85], v25 offset:28800
    v_mfma_f32_16x16x32_bf16 v[142:145], v[118:121], v[46:49], v[142:145]
    ds_read_b64_tr_b16 v[86:87], v26 offset:27648
    ds_read_b64_tr_b16 v[88:89], v26 offset:28800
    v_mfma_f32_16x16x32_bf16 v[146:149], v[114:117], v[50:53], v[146:149]
    ds_read_b64_tr_b16 v[90:91], v27 offset:27648
    ds_read_b64_tr_b16 v[92:93], v27 offset:28800
    v_mfma_f32_16x16x32_bf16 a[4:7], v[114:117], v[114:117], a[4:7]
    ds_read_b64_tr_b16 v[94:95], v28 offset:27648
    ds_read_b64_tr_b16 v[96:97], v28 offset:28800
    v_mfma_f32_16x16x32_bf16 v[150:153], v[118:121], v[50:53], v[150:153]
    v_mfma_f32_16x16x32_bf16 v[154:157], v[114:117], v[54:57], v[154:157]
    ds_read_b64_tr_b16 v[98:99], v29 offset:27648
    ds_read_b64_tr_b16 v[100:101], v29 offset:28800
    v_mfma_f32_16x16x32_bf16 v[158:161], v[118:121], v[54:57], v[158:161]
    v_mfma_f32_16x16x32_bf16 a[8:11], a[28:31], v[118:121], a[8:11]
    ds_read_b64_tr_b16 v[102:103], v30 offset:27648
    ds_read_b64_tr_b16 v[104:105], v30 offset:28800
    v_mfma_f32_16x16x32_bf16 v[162:165], v[114:117], v[58:61], v[162:165]
    v_mfma_f32_16x16x32_bf16 v[166:169], v[118:121], v[58:61], v[166:169]
    ds_read_b64_tr_b16 v[106:107], v31 offset:27648
    ds_read_b64_tr_b16 v[108:109], v31 offset:28800
    v_mfma_f32_16x16x32_bf16 v[170:173], v[114:117], v[62:65], v[170:173]
    s_add_u32 m0, s48, 0
    s_nop 0
    buffer_load_dwordx4 v6, s[24:27], s50 offen lds
    v_mfma_f32_16x16x32_bf16 a[12:15], v[118:121], v[118:121], a[12:15]
    ds_read_b64_tr_b16 v[110:111], v32 offset:27648
    ds_read_b64_tr_b16 v[112:113], v32 offset:28800
    v_mfma_f32_16x16x32_bf16 v[174:177], v[118:121], v[62:65], v[174:177]
    v_mfma_f32_16x16x32_bf16 v[178:181], v[114:117], v[66:69], v[178:181]
    s_add_u32 m0, s48, 1024
    s_nop 0
    buffer_load_dwordx4 v7, s[24:27], s50 offen lds
    v_mfma_f32_16x16x32_bf16 v[182:185], v[118:121], v[66:69], v[182:185]
    v_mfma_f32_16x16x32_bf16 a[16:19], a[28:31], v[42:45], a[16:19]
    s_add_u32 m0, s48, 2048
    s_nop 0
    buffer_load_dwordx4 v8, s[24:27], s50 offen lds
    v_mfma_f32_16x16x32_bf16 v[186:189], v[114:117], v[70:73], v[186:189]
    v_mfma_f32_16x16x32_bf16 v[190:193], v[118:121], v[70:73], v[190:193]
    s_add_u32 m0, s48, 3072
    s_nop 0
    buffer_load_dwordx4 v9, s[24:27], s50 offen lds
    s_add_u32 s50, s50, 128
    v_mfma_f32_16x16x32_bf16 v[194:197], v[114:117], v[74:77], v[194:197]
    v_mfma_f32_16x16x32_bf16 a[20:23], a[28:31], v[46:49], a[20:23]
    v_mfma_f32_16x16x32_bf16 v[198:201], v[118:121], v[74:77], v[198:201]
    v_mfma_f32_16x16x32_bf16 a[24:27], a[28:31], v[50:53], a[24:27]
    s_waitcnt vmcnt(13)
    s_barrier
    s_waitcnt lgkmcnt(0)
    v_mfma_f32_16x16x32_bf16 v[130:133], v[122:125], v[78:81], v[130:133]
    ds_read_b128 v[114:117], v15 offset:8192
    v_mfma_f32_16x16x32_bf16 v[134:137], v[126:129], v[78:81], v[134:137]
    ds_read_b128 v[118:121], v15 offset:10240
    v_mfma_f32_16x16x32_bf16 a[0:3], a[28:31], v[122:125], a[0:3]
    ds_read_b64_tr_b16 v[42:43], v33 offset:0
    ds_read_b64_tr_b16 v[44:45], v33 offset:1152
    v_mfma_f32_16x16x32_bf16 v[138:141], v[122:125], v[82:85], v[138:141]
    ds_read_b64_tr_b16 v[46:47], v34 offset:0
    ds_read_b64_tr_b16 v[48:49], v34 offset:1152
    v_mfma_f32_16x16x32_bf16 v[142:145], v[126:129], v[82:85], v[142:145]
    ds_read_b64_tr_b16 v[50:51], v35 offset:0
    ds_read_b64_tr_b16 v[52:53], v35 offset:1152
    v_mfma_f32_16x16x32_bf16 v[146:149], v[122:125], v[86:89], v[146:149]
    ds_read_b64_tr_b16 v[54:55], v36 offset:0
    ds_read_b64_tr_b16 v[56:57], v36 offset:1152
    v_mfma_f32_16x16x32_bf16 a[4:7], v[122:125], v[122:125], a[4:7]
    ds_read_b64_tr_b16 v[58:59], v37 offset:0
    ds_read_b64_tr_b16 v[60:61], v37 offset:1152
    v_mfma_f32_16x16x32_bf16 v[150:153], v[126:129], v[86:89], v[150:153]
    v_mfma_f32_16x16x32_bf16 v[154:157], v[122:125], v[90:93], v[154:157]
    ds_read_b64_tr_b16 v[62:63], v38 offset:0
    ds_read_b64_tr_b16 v[64:65], v38 offset:1152
    v_mfma_f32_16x16x32_bf16 v[158:161], v[126:129], v[90:93], v[158:161]
    v_mfma_f32_16x16x32_bf16 a[8:11], a[28:31], v[126:129], a[8:11]
    ds_read_b64_tr_b16 v[66:67], v39 offset:0
    ds_read_b64_tr_b16 v[68:69], v39 offset:1152
    v_mfma_f32_16x16x32_bf16 v[162:165], v[122:125], v[94:97], v[162:165]
    v_mfma_f32_16x16x32_bf16 v[166:169], v[126:129], v[94:97], v[166:169]
    ds_read_b64_tr_b16 v[70:71], v40 offset:0
    ds_read_b64_tr_b16 v[72:73], v40 offset:1152
    v_mfma_f32_16x16x32_bf16 v[170:173], v[122:125], v[98:101], v[170:173]
    s_add_u32 m0, s49, 0
    s_nop 0
    buffer_load_dwordx4 v10, s[28:31], s51 offen lds
    v_mfma_f32_16x16x32_bf16 a[12:15], v[126:129], v[126:129], a[12:15]
    ds_read_b64_tr_b16 v[74:75], v41 offset:0
    ds_read_b64_tr_b16 v[76:77], v41 offset:1152
    v_mfma_f32_16x16x32_bf16 v[174:177], v[126:129], v[98:101], v[174:177]
    v_mfma_f32_16x16x32_bf16 v[178:181], v[122:125], v[102:105], v[178:181]
    s_add_u32 m0, s49, 1024
    s_nop 0
    buffer_load_dwordx4 v11, s[28:31], s51 offen lds
    v_mfma_f32_16x16x32_bf16 v[182:185], v[126:129], v[102:105], v[182:185]
    v_mfma_f32_16x16x32_bf16 a[16:19], a[28:31], v[78:81], a[16:19]
    s_add_u32 m0, s49, 2048
    s_nop 0
    buffer_load_dwordx4 v12, s[28:31], s51 offen lds
    v_mfma_f32_16x16x32_bf16 v[186:189], v[122:125], v[106:109], v[186:189]
    v_mfma_f32_16x16x32_bf16 v[190:193], v[126:129], v[106:109], v[190:193]
    s_add_u32 m0, s49, 3072
    s_nop 0
    buffer_load_dwordx4 v13, s[28:31], s51 offen lds
    v_mfma_f32_16x16x32_bf16 v[194:197], v[122:125], v[110:113], v[194:197]
    v_mfma_f32_16x16x32_bf16 a[20:23], a[28:31], v[82:85], a[20:23]
    s_add_u32 m0, s49, 4096
    s_mov_b32 exec_hi, 0
    buffer_load_dwordx4 v14, s[28:31], s51 offen lds
    s_mov_b32 exec_hi, -1
    s_add_u32 s51, s51, 221184
    v_mfma_f32_16x16x32_bf16 v[198:201], v[126:129], v[110:113], v[198:201]
    v_mfma_f32_16x16x32_bf16 a[24:27], a[28:31], v[86:89], a[24:27]
    s_waitcnt lgkmcnt(0)
    v_mfma_f32_16x16x32_bf16 v[130:133], v[114:117], v[42:45], v[130:133]
    ds_read_b128 v[122:125], v16 offset:8192
    v_mfma_f32_16x16x32_bf16 v[134:137], v[118:121], v[42:45], v[134:137]
    ds_read_b128 v[126:129], v16 offset:10240
    v_mfma_f32_16x16x32_bf16 a[0:3], a[28:31], v[114:117], a[0:3]
    ds_read_b64_tr_b16 v[78:79], v33 offset:9216
    ds_read_b64_tr_b16 v[80:81], v33 offset:10368
    v_mfma_f32_16x16x32_bf16 v[138:141], v[114:117], v[46:49], v[138:141]
    ds_read_b64_tr_b16 v[82:83], v34 offset:9216
    ds_read_b64_tr_b16 v[84:85], v34 offset:10368
    v_mfma_f32_16x16x32_bf16 v[142:145], v[118:121], v[46:49], v[142:145]
    ds_read_b64_tr_b16 v[86:87], v35 offset:9216
    ds_read_b64_tr_b16 v[88:89], v35 offset:10368
    v_mfma_f32_16x16x32_bf16 v[146:149], v[114:117], v[50:53], v[146:149]
    ds_read_b64_tr_b16 v[90:91], v36 offset:9216
    ds_read_b64_tr_b16 v[92:93], v36 offset:10368
    v_mfma_f32_16x16x32_bf16 a[4:7], v[114:117], v[114:117], a[4:7]
    ds_read_b64_tr_b16 v[94:95], v37 offset:9216
    ds_read_b64_tr_b16 v[96:97], v37 offset:10368
    v_mfma_f32_16x16x32_bf16 v[150:153], v[118:121], v[50:53], v[150:153]
    v_mfma_f32_16x16x32_bf16 v[154:157], v[114:117], v[54:57], v[154:157]
    ds_read_b64_tr_b16 v[98:99], v38 offset:9216
    ds_read_b64_tr_b16 v[100:101], v38 offset:10368
    v_mfma_f32_16x16x32_bf16 v[158:161], v[118:121], v[54:57], v[158:161]
    v_mfma_f32_16x16x32_bf16 a[8:11], a[28:31], v[118:121], a[8:11]
    ds_read_b64_tr_b16 v[102:103], v39 offset:9216
    ds_read_b64_tr_b16 v[104:105], v39 offset:10368
    v_mfma_f32_16x16x32_bf16 v[162:165], v[114:117], v[58:61], v[162:165]
    v_mfma_f32_16x16x32_bf16 v[166:169], v[118:121], v[58:61], v[166:169]
    ds_read_b64_tr_b16 v[106:107], v40 offset:9216
    ds_read_b64_tr_b16 v[108:109], v40 offset:10368
    v_mfma_f32_16x16x32_bf16 v[170:173], v[114:117], v[62:65], v[170:173]
    s_lshl_b32 s44, s2, 2
    s_add_u32 s44, s44, s40
    s_cmp_lt_u32 s44, 648
    s_cselect_b32 s36, s12, s8
    v_mfma_f32_16x16x32_bf16 a[12:15], v[118:121], v[118:121], a[12:15]
    ds_read_b64_tr_b16 v[110:111], v41 offset:9216
    ds_read_b64_tr_b16 v[112:113], v41 offset:10368
    v_mfma_f32_16x16x32_bf16 v[174:177], v[118:121], v[62:65], v[174:177]
    v_mfma_f32_16x16x32_bf16 v[178:181], v[114:117], v[66:69], v[178:181]
    s_cselect_b32 s37, s13, s9
    s_mov_b32 s38, 663552
    s_cselect_b32 s38, 5308416, s38
    s_cselect_b32 s45, 0, 648
    v_mfma_f32_16x16x32_bf16 v[182:185], v[118:121], v[66:69], v[182:185]
    v_mfma_f32_16x16x32_bf16 a[16:19], a[28:31], v[42:45], a[16:19]
    s_mov_b32 s39, 0x20000
    s_sub_u32 s44, s44, s45
    s_lshl_b32 s44, s44, 13
    v_mfma_f32_16x16x32_bf16 v[186:189], v[114:117], v[70:73], v[186:189]
    v_mfma_f32_16x16x32_bf16 v[190:193], v[118:121], v[70:73], v[190:193]
    v_lshl_add_u32 v252, v1, 7, s44
    v_mfma_f32_16x16x32_bf16 v[194:197], v[114:117], v[74:77], v[194:197]
    v_mfma_f32_16x16x32_bf16 a[20:23], a[28:31], v[46:49], a[20:23]
    buffer_load_dword v252, v252, s[36:39], 0 offen
    v_mfma_f32_16x16x32_bf16 v[198:201], v[118:121], v[74:77], v[198:201]
    v_mfma_f32_16x16x32_bf16 a[24:27], a[28:31], v[50:53], a[24:27]
    s_waitcnt vmcnt(10)
    s_barrier
    s_waitcnt lgkmcnt(0)
    v_mfma_f32_16x16x32_bf16 v[130:133], v[122:125], v[78:81], v[130:133]
    ds_read_b128 v[114:117], v15 offset:12288
    s_lshl_b32 s44, s40, 7
    v_mfma_f32_16x16x32_bf16 v[134:137], v[126:129], v[78:81], v[134:137]
    ds_read_b128 v[118:121], v15 offset:14336
    s_add_u32 s44, s44, 139264
    v_mfma_f32_16x16x32_bf16 a[0:3], a[28:31], v[122:125], a[0:3]
    ds_read_b64_tr_b16 v[42:43], v33 offset:18432
    ds_read_b64_tr_b16 v[44:45], v33 offset:19584
    v_mfma_f32_16x16x32_bf16 v[138:141], v[122:125], v[82:85], v[138:141]
    ds_read_b64_tr_b16 v[46:47], v34 offset:18432
    ds_read_b64_tr_b16 v[48:49], v34 offset:19584
    v_mfma_f32_16x16x32_bf16 v[142:145], v[126:129], v[82:85], v[142:145]
    ds_read_b64_tr_b16 v[50:51], v35 offset:18432
    ds_read_b64_tr_b16 v[52:53], v35 offset:19584
    v_mfma_f32_16x16x32_bf16 v[146:149], v[122:125], v[86:89], v[146:149]
    ds_read_b64_tr_b16 v[54:55], v36 offset:18432
    ds_read_b64_tr_b16 v[56:57], v36 offset:19584
    v_mfma_f32_16x16x32_bf16 a[4:7], v[122:125], v[122:125], a[4:7]
    ds_read_b64_tr_b16 v[58:59], v37 offset:18432
    ds_read_b64_tr_b16 v[60:61], v37 offset:19584
    v_mfma_f32_16x16x32_bf16 v[150:153], v[126:129], v[86:89], v[150:153]
    v_lshlrev_b32 v236, 2, v2
    v_lshlrev_b32 v237, 4, v3
    v_mfma_f32_16x16x32_bf16 v[154:157], v[122:125], v[90:93], v[154:157]
    ds_read_b64_tr_b16 v[62:63], v38 offset:18432
    ds_read_b64_tr_b16 v[64:65], v38 offset:19584
    v_mfma_f32_16x16x32_bf16 v[158:161], v[126:129], v[90:93], v[158:161]
    v_add_u32 v236, s44, v236
    v_add_u32 v237, s44, v237
    v_mfma_f32_16x16x32_bf16 a[8:11], a[28:31], v[126:129], a[8:11]
    ds_read_b64_tr_b16 v[66:67], v39 offset:18432
    ds_read_b64_tr_b16 v[68:69], v39 offset:19584
    v_mfma_f32_16x16x32_bf16 v[162:165], v[122:125], v[94:97], v[162:165]
    s_sub_u32 s44, s42, 8
    s_mul_i32 s52, s44, 589824
    v_mfma_f32_16x16x32_bf16 v[166:169], v[126:129], v[94:97], v[166:169]
    ds_read_b64_tr_b16 v[70:71], v40 offset:18432
    ds_read_b64_tr_b16 v[72:73], v40 offset:19584
    v_mfma_f32_16x16x32_bf16 v[170:173], v[122:125], v[98:101], v[170:173]
    s_add_u32 s52, s52, 4718592
    s_lshl_b32 s44, s41, 2
    v_mfma_f32_16x16x32_bf16 a[12:15], v[126:129], v[126:129], a[12:15]
    ds_read_b64_tr_b16 v[74:75], v41 offset:18432
    ds_read_b64_tr_b16 v[76:77], v41 offset:19584
    v_mfma_f32_16x16x32_bf16 v[174:177], v[126:129], v[98:101], v[174:177]
    s_add_u32 s44, s44, s40
    s_mul_i32 s44, s44, 1152
    v_mfma_f32_16x16x32_bf16 v[178:181], v[122:125], v[102:105], v[178:181]
    s_add_u32 s52, s52, s44
    s_mov_b32 s53, 72576
    v_mfma_f32_16x16x32_bf16 v[182:185], v[126:129], v[102:105], v[182:185]
    s_movk_i32 s44, 864
    v_and_b32 v241, 1, v3
    v_mfma_f32_16x16x32_bf16 a[16:19], a[28:31], v[78:81], a[16:19]
    v_mul_u32_u24 v241, 288, v241
    v_lshrrev_b32 v242, 1, v3
    v_mfma_f32_16x16x32_bf16 v[186:189], v[122:125], v[106:109], v[186:189]
    v_lshl_add_u32 v241, v242, 3, v241
    v_add_u32 v241, s48, v241
    v_mfma_f32_16x16x32_bf16 v[190:193], v[126:129], v[106:109], v[190:193]
    v_add_u32 v238, s48, v4
    v_lshl_add_u32 v242, s54, 4, v2
    v_mfma_f32_16x16x32_bf16 v[194:197], v[122:125], v[110:113], v[194:197]
    v_mul_u32_u24 v243, 57, v242
    v_lshrrev_b32 v243, 10, v243
    v_mfma_f32_16x16x32_bf16 a[20:23], a[28:31], v[82:85], a[20:23]
    v_lshl_add_u32 v242, v242, 4, v241
    v_mad_u32_u24 v6, v243, s44, v242
    v_mfma_f32_16x16x32_bf16 v[198:201], v[126:129], v[110:113], v[198:201]
    v_lshl_add_u32 v242, s55, 4, v2
    v_mul_u32_u24 v243, 57, v242
    v_mfma_f32_16x16x32_bf16 a[24:27], a[28:31], v[86:89], a[24:27]
    v_lshrrev_b32 v243, 10, v243
    v_lshl_add_u32 v242, v242, 4, v241
    s_waitcnt lgkmcnt(0)
    v_mfma_f32_16x16x32_bf16 v[130:133], v[114:117], v[42:45], v[130:133]
    ds_read_b128 v[122:125], v16 offset:12288
    v_mad_u32_u24 v7, v243, s44, v242
    v_mfma_f32_16x16x32_bf16 v[134:137], v[118:121], v[42:45], v[134:137]
    ds_read_b128 v[126:129], v16 offset:14336
    v_lshl_add_u32 v242, s56, 4, v2
    v_mfma_f32_16x16x32_bf16 a[0:3], a[28:31], v[114:117], a[0:3]
    ds_read_b64_tr_b16 v[78:79], v33 offset:27648
    ds_read_b64_tr_b16 v[80:81], v33 offset:28800
    v_mfma_f32_16x16x32_bf16 v[138:141], v[114:117], v[46:49], v[138:141]
    ds_read_b64_tr_b16 v[82:83], v34 offset:27648
    ds_read_b64_tr_b16 v[84:85], v34 offset:28800
    v_mfma_f32_16x16x32_bf16 v[142:145], v[118:121], v[46:49], v[142:145]
    ds_read_b64_tr_b16 v[86:87], v35 offset:27648
    ds_read_b64_tr_b16 v[88:89], v35 offset:28800
    v_mfma_f32_16x16x32_bf16 v[146:149], v[114:117], v[50:53], v[146:149]
    ds_read_b64_tr_b16 v[90:91], v36 offset:27648
    ds_read_b64_tr_b16 v[92:93], v36 offset:28800
    v_mfma_f32_16x16x32_bf16 a[4:7], v[114:117], v[114:117], a[4:7]
    ds_read_b64_tr_b16 v[94:95], v37 offset:27648
    ds_read_b64_tr_b16 v[96:97], v37 offset:28800
    v_mfma_f32_16x16x32_bf16 v[150:153], v[118:121], v[50:53], v[150:153]
    v_mul_u32_u24 v243, 57, v242
    v_lshrrev_b32 v243, 10, v243
    v_mfma_f32_16x16x32_bf16 v[154:157], v[114:117], v[54:57], v[154:157]
    ds_read_b64_tr_b16 v[98:99], v38 offset:27648
    ds_read_b64_tr_b16 v[100:101], v38 offset:28800
    v_mfma_f32_16x16x32_bf16 v[158:161], v[118:121], v[54:57], v[158:161]
    v_lshl_add_u32 v242, v242, 4, v241
    v_mad_u32_u24 v8, v243, s44, v242
    v_mfma_f32_16x16x32_bf16 a[8:11], a[28:31], v[118:121], a[8:11]
    ds_read_b64_tr_b16 v[102:103], v39 offset:27648
    ds_read_b64_tr_b16 v[104:105], v39 offset:28800
    v_mfma_f32_16x16x32_bf16 v[162:165], v[114:117], v[58:61], v[162:165]
    v_lshl_add_u32 v242, s57, 4, v2
    v_mul_u32_u24 v243, 57, v242
    v_mfma_f32_16x16x32_bf16 v[166:169], v[118:121], v[58:61], v[166:169]
    ds_read_b64_tr_b16 v[106:107], v40 offset:27648
    ds_read_b64_tr_b16 v[108:109], v40 offset:28800
    v_mfma_f32_16x16x32_bf16 v[170:173], v[114:117], v[62:65], v[170:173]
    v_lshrrev_b32 v243, 10, v243
    v_lshl_add_u32 v242, v242, 4, v241
    v_mfma_f32_16x16x32_bf16 a[12:15], v[118:121], v[118:121], a[12:15]
    ds_read_b64_tr_b16 v[110:111], v41 offset:27648
    ds_read_b64_tr_b16 v[112:113], v41 offset:28800
    v_mfma_f32_16x16x32_bf16 v[174:177], v[118:121], v[62:65], v[174:177]
    v_mad_u32_u24 v9, v243, s44, v242
    v_lshl_add_u32 v242, s58, 4, v2
    v_mfma_f32_16x16x32_bf16 v[178:181], v[114:117], v[66:69], v[178:181]
    v_mul_u32_u24 v243, 57, v242
    v_lshrrev_b32 v243, 10, v243
    v_mfma_f32_16x16x32_bf16 v[182:185], v[118:121], v[66:69], v[182:185]
    v_lshl_add_u32 v242, v242, 4, v241
    v_mad_u32_u24 v10, v243, s44, v242
    v_mfma_f32_16x16x32_bf16 a[16:19], a[28:31], v[42:45], a[16:19]
    v_lshl_add_u32 v242, s59, 4, v2
    v_mul_u32_u24 v243, 57, v242
    v_mfma_f32_16x16x32_bf16 v[186:189], v[114:117], v[70:73], v[186:189]
    v_lshrrev_b32 v243, 10, v243
    v_lshl_add_u32 v242, v242, 4, v241
    v_mfma_f32_16x16x32_bf16 v[190:193], v[118:121], v[70:73], v[190:193]
    v_mad_u32_u24 v11, v243, s44, v242
    v_lshl_add_u32 v242, s60, 4, v2
    v_mfma_f32_16x16x32_bf16 v[194:197], v[114:117], v[74:77], v[194:197]
    v_mul_u32_u24 v243, 57, v242
    v_lshrrev_b32 v243, 10, v243
    v_mfma_f32_16x16x32_bf16 a[20:23], a[28:31], v[46:49], a[20:23]
    v_lshl_add_u32 v242, v242, 4, v241
    v_mad_u32_u24 v12, v243, s44, v242
    v_mfma_f32_16x16x32_bf16 v[198:201], v[118:121], v[74:77], v[198:201]
    v_lshl_add_u32 v242, s61, 4, v2
    v_mul_u32_u24 v243, 57, v242
    v_mfma_f32_16x16x32_bf16 a[24:27], a[28:31], v[50:53], a[24:27]
    v_lshrrev_b32 v243, 10, v243
    v_lshl_add_u32 v242, v242, 4, v241
    s_waitcnt vmcnt(1)
    s_barrier
    s_waitcnt lgkmcnt(0)
    v_mfma_f32_16x16x32_bf16 v[130:133], v[122:125], v[78:81], v[130:133]
    ds_read_b128 v[114:117], v15 offset:0
    v_mad_u32_u24 v13, v243, s44, v242
    v_mfma_f32_16x16x32_bf16 v[134:137], v[126:129], v[78:81], v[134:137]
    ds_read_b128 v[118:121], v15 offset:2048
    v_lshl_add_u32 v242, s62, 4, v2
    v_mfma_f32_16x16x32_bf16 a[0:3], a[28:31], v[122:125], a[0:3]
    ds_read_b64_tr_b16 v[42:43], v24 offset:0
    ds_read_b64_tr_b16 v[44:45], v24 offset:1152
    v_mfma_f32_16x16x32_bf16 v[138:141], v[122:125], v[82:85], v[138:141]
    ds_read_b64_tr_b16 v[46:47], v25 offset:0
    ds_read_b64_tr_b16 v[48:49], v25 offset:1152
    v_mfma_f32_16x16x32_bf16 v[142:145], v[126:129], v[82:85], v[142:145]
    ds_read_b64_tr_b16 v[50:51], v26 offset:0
    ds_read_b64_tr_b16 v[52:53], v26 offset:1152
    v_mfma_f32_16x16x32_bf16 v[146:149], v[122:125], v[86:89], v[146:149]
    ds_read_b64_tr_b16 v[54:55], v27 offset:0
    ds_read_b64_tr_b16 v[56:57], v27 offset:1152
    v_mfma_f32_16x16x32_bf16 a[4:7], v[122:125], v[122:125], a[4:7]
    ds_read_b64_tr_b16 v[58:59], v28 offset:0
    ds_read_b64_tr_b16 v[60:61], v28 offset:1152
    v_mfma_f32_16x16x32_bf16 v[150:153], v[126:129], v[86:89], v[150:153]
    v_mul_u32_u24 v243, 57, v242
    v_lshrrev_b32 v243, 10, v243
    v_mfma_f32_16x16x32_bf16 v[154:157], v[122:125], v[90:93], v[154:157]
    ds_read_b64_tr_b16 v[62:63], v29 offset:0
    ds_read_b64_tr_b16 v[64:65], v29 offset:1152
    v_mfma_f32_16x16x32_bf16 v[158:161], v[126:129], v[90:93], v[158:161]
    v_lshl_add_u32 v242, v242, 4, v241
    v_mad_u32_u24 v14, v243, s44, v242
    v_mfma_f32_16x16x32_bf16 a[8:11], a[28:31], v[126:129], a[8:11]
    ds_read_b64_tr_b16 v[66:67], v30 offset:0
    ds_read_b64_tr_b16 v[68:69], v30 offset:1152
    v_mfma_f32_16x16x32_bf16 v[162:165], v[122:125], v[94:97], v[162:165]
    v_and_b32 v241, 3, v2
    v_lshrrev_b32 v242, 2, v2
    v_mfma_f32_16x16x32_bf16 v[166:169], v[126:129], v[94:97], v[166:169]
    ds_read_b64_tr_b16 v[70:71], v31 offset:0
    ds_read_b64_tr_b16 v[72:73], v31 offset:1152
    v_mfma_f32_16x16x32_bf16 v[170:173], v[122:125], v[98:101], v[170:173]
    v_cmp_eq_u32 s[36:37], 1, v241
    v_cmp_eq_u32 s[38:39], 3, v241
    v_mfma_f32_16x16x32_bf16 a[12:15], v[126:129], v[126:129], a[12:15]
    ds_read_b64_tr_b16 v[74:75], v32 offset:0
    ds_read_b64_tr_b16 v[76:77], v32 offset:1152
    v_mfma_f32_16x16x32_bf16 v[174:177], v[126:129], v[98:101], v[174:177]
    v_cmp_le_u32 s[50:51], 2, v241
    v_cmp_eq_u32 vcc, v242, v3
    v_mfma_f32_16x16x32_bf16 v[178:181], v[122:125], v[102:105], v[178:181]
    v_mfma_f32_16x16x32_bf16 v[182:185], v[126:129], v[102:105], v[182:185]
    v_mfma_f32_16x16x32_bf16 a[16:19], a[28:31], v[78:81], a[16:19]
    v_mfma_f32_16x16x32_bf16 v[186:189], v[122:125], v[106:109], v[186:189]
    v_mfma_f32_16x16x32_bf16 v[190:193], v[126:129], v[106:109], v[190:193]
    v_mfma_f32_16x16x32_bf16 v[194:197], v[122:125], v[110:113], v[194:197]
    v_mfma_f32_16x16x32_bf16 a[20:23], a[28:31], v[82:85], a[20:23]
    v_mfma_f32_16x16x32_bf16 v[198:201], v[126:129], v[110:113], v[198:201]
    v_mfma_f32_16x16x32_bf16 a[24:27], a[28:31], v[86:89], a[24:27]
    s_waitcnt lgkmcnt(0)
    v_mfma_f32_16x16x32_bf16 a[16:19], a[28:31], v[42:45], a[16:19]
    ds_read_b128 v[122:125], v16 offset:0
    v_mfma_f32_16x16x32_bf16 a[20:23], a[28:31], v[46:49], a[20:23]
    ds_read_b128 v[126:129], v16 offset:2048
    v_mfma_f32_16x16x32_bf16 a[24:27], a[28:31], v[50:53], a[24:27]
    ds_read_b64_tr_b16 v[78:79], v24 offset:9216
    ds_read_b64_tr_b16 v[80:81], v24 offset:10368
    v_mfma_f32_16x16x32_bf16 a[0:3], a[28:31], v[114:117], a[0:3]
    ds_read_b64_tr_b16 v[82:83], v25 offset:9216
    ds_read_b64_tr_b16 v[84:85], v25 offset:10368
    v_mfma_f32_16x16x32_bf16 a[4:7], v[114:117], v[114:117], a[4:7]
    ds_read_b64_tr_b16 v[86:87], v26 offset:9216
    ds_read_b64_tr_b16 v[88:89], v26 offset:10368
    v_mfma_f32_16x16x32_bf16 a[8:11], a[28:31], v[118:121], a[8:11]
    ds_read_b64_tr_b16 v[90:91], v27 offset:9216
    ds_read_b64_tr_b16 v[92:93], v27 offset:10368
    v_mfma_f32_16x16x32_bf16 a[12:15], v[118:121], v[118:121], a[12:15]
    ds_read_b64_tr_b16 v[94:95], v28 offset:9216
    ds_read_b64_tr_b16 v[96:97], v28 offset:10368
    v_mfma_f32_16x16x32_bf16 v[130:133], v[114:117], v[42:45], v[130:133]
    v_mfma_f32_16x16x32_bf16 v[134:137], v[118:121], v[42:45], v[134:137]
    ds_read_b64_tr_b16 v[98:99], v29 offset:9216
    ds_read_b64_tr_b16 v[100:101], v29 offset:10368
    v_mfma_f32_16x16x32_bf16 v[138:141], v[114:117], v[46:49], v[138:141]
    v_mfma_f32_16x16x32_bf16 v[142:145], v[118:121], v[46:49], v[142:145]
    ds_read_b64_tr_b16 v[102:103], v30 offset:9216
    s_branch L_pgqkv_kernel_6_s
.p2align 12
L_pgqkv_kernel_6:
    s_branch L_hopqkv_kernel_1
L_pgqkv_kernel_6_s:
    ds_read_b64_tr_b16 v[104:105], v30 offset:10368
    v_mfma_f32_16x16x32_bf16 v[146:149], v[114:117], v[50:53], v[146:149]
    v_mfma_f32_16x16x32_bf16 v[150:153], v[118:121], v[50:53], v[150:153]
    ds_read_b64_tr_b16 v[106:107], v31 offset:9216
    ds_read_b64_tr_b16 v[108:109], v31 offset:10368
    v_mfma_f32_16x16x32_bf16 v[154:157], v[114:117], v[54:57], v[154:157]
    v_mfma_f32_16x16x32_bf16 v[158:161], v[118:121], v[54:57], v[158:161]
    ds_read_b64_tr_b16 v[110:111], v32 offset:9216
    ds_read_b64_tr_b16 v[112:113], v32 offset:10368
    v_mfma_f32_16x16x32_bf16 v[162:165], v[114:117], v[58:61], v[162:165]
    v_mfma_f32_16x16x32_bf16 v[166:169], v[118:121], v[58:61], v[166:169]
    v_mfma_f32_16x16x32_bf16 v[170:173], v[114:117], v[62:65], v[170:173]
    v_mfma_f32_16x16x32_bf16 v[174:177], v[118:121], v[62:65], v[174:177]
    v_mfma_f32_16x16x32_bf16 v[178:181], v[114:117], v[66:69], v[178:181]
    v_mfma_f32_16x16x32_bf16 v[182:185], v[118:121], v[66:69], v[182:185]
    v_mfma_f32_16x16x32_bf16 v[186:189], v[114:117], v[70:73], v[186:189]
    v_mfma_f32_16x16x32_bf16 v[190:193], v[118:121], v[70:73], v[190:193]
    v_mfma_f32_16x16x32_bf16 v[194:197], v[114:117], v[74:77], v[194:197]
    v_mfma_f32_16x16x32_bf16 v[198:201], v[118:121], v[74:77], v[198:201]
    s_waitcnt lgkmcnt(12)
    v_mfma_f32_16x16x32_bf16 a[16:19], a[28:31], v[78:81], a[16:19]
    v_mfma_f32_16x16x32_bf16 a[20:23], a[28:31], v[82:85], a[20:23]
    v_mfma_f32_16x16x32_bf16 a[24:27], a[28:31], v[86:89], a[24:27]
    v_mfma_f32_16x16x32_bf16 a[0:3], a[28:31], v[122:125], a[0:3]
    v_mfma_f32_16x16x32_bf16 a[4:7], v[122:125], v[122:125], a[4:7]
    v_mfma_f32_16x16x32_bf16 a[8:11], a[28:31], v[126:129], a[8:11]
    v_mfma_f32_16x16x32_bf16 a[12:15], v[126:129], v[126:129], a[12:15]
    s_waitcnt lgkmcnt(0)
    v_mfma_f32_16x16x32_bf16 v[130:133], v[122:125], v[78:81], v[130:133]
    v_accvgpr_read_b32 v210, a16
    v_accvgpr_read_b32 v211, a20
    v_mfma_f32_16x16x32_bf16 v[134:137], v[126:129], v[78:81], v[134:137]
    v_accvgpr_read_b32 v212, a24
    ds_write2_b32 v236, v210, v210 offset0:0 offset1:144
    v_mfma_f32_16x16x32_bf16 v[138:141], v[122:125], v[82:85], v[138:141]
    ds_write2_b32 v236, v211, v211 offset0:16 offset1:160
    ds_write2_b32 v236, v212, v212 offset0:32 offset1:176
    v_mfma_f32_16x16x32_bf16 v[142:145], v[126:129], v[82:85], v[142:145]
    v_accvgpr_read_b32 v218, a4
    v_accvgpr_read_b32 v219, a5
    v_mfma_f32_16x16x32_bf16 v[146:149], v[122:125], v[86:89], v[146:149]
    v_accvgpr_read_b32 v220, a6
    v_accvgpr_read_b32 v221, a7
    v_mfma_f32_16x16x32_bf16 v[150:153], v[126:129], v[86:89], v[150:153]
    v_accvgpr_read_b32 v222, a12
    v_accvgpr_read_b32 v223, a13
    v_mfma_f32_16x16x32_bf16 v[154:157], v[122:125], v[90:93], v[154:157]
    v_accvgpr_read_b32 v224, a14
    v_accvgpr_read_b32 v225, a15
    v_mfma_f32_16x16x32_bf16 v[158:161], v[126:129], v[90:93], v[158:161]
    v_cndmask_b32 v218, v218, v219, s[36:37]
    v_cndmask_b32 v222, v222, v223, s[36:37]
    v_mfma_f32_16x16x32_bf16 v[162:165], v[122:125], v[94:97], v[162:165]
    v_cndmask_b32 v220, v220, v221, s[38:39]
    v_cndmask_b32 v224, v224, v225, s[38:39]
    v_mfma_f32_16x16x32_bf16 v[166:169], v[126:129], v[94:97], v[166:169]
    s_waitcnt lgkmcnt(0)
    s_barrier
    v_mfma_f32_16x16x32_bf16 v[170:173], v[122:125], v[98:101], v[170:173]
    v_cndmask_b32 v218, v218, v220, s[50:51]
    v_cndmask_b32 v222, v222, v224, s[50:51]
    v_mfma_f32_16x16x32_bf16 v[174:177], v[126:129], v[98:101], v[174:177]
    v_cndmask_b32 v218, 0, v218, vcc
    ds_read_b32 v42, v236 offset:0
    v_mfma_f32_16x16x32_bf16 v[178:181], v[122:125], v[102:105], v[178:181]
    v_cndmask_b32 v222, 0, v222, vcc
    ds_read_b32 v43, v236 offset:64
    v_mfma_f32_16x16x32_bf16 v[182:185], v[126:129], v[102:105], v[182:185]
    v_mov_b32 v219, v218
    ds_read_b32 v44, v236 offset:128
    v_mfma_f32_16x16x32_bf16 v[186:189], v[122:125], v[106:109], v[186:189]
    v_mov_b32 v223, v222
    ds_read_b32 v45, v236 offset:192
    v_mfma_f32_16x16x32_bf16 v[190:193], v[126:129], v[106:109], v[190:193]
    v_accvgpr_read_b32 v202, a0
    ds_read_b32 v46, v236 offset:256
    v_mfma_f32_16x16x32_bf16 v[194:197], v[122:125], v[110:113], v[194:197]
    v_permlane32_swap_b32 v218, v219
    ds_read_b32 v47, v236 offset:320
    v_mfma_f32_16x16x32_bf16 v[198:201], v[126:129], v[110:113], v[198:201]
    v_permlane32_swap_b32 v222, v223
    ds_read_b32 v48, v236 offset:384
    v_add_f32 v218, v218, v219
    ds_read_b32 v49, v236 offset:448
    v_add_f32 v222, v222, v223
    ds_read_b32 v50, v236 offset:512
    v_mov_b32 v219, v218
    v_mov_b32 v223, v222
    v_accvgpr_read_b32 v203, a8
    v_permlane16_swap_b32 v218, v219
    v_permlane16_swap_b32 v222, v223
    v_add_f32 v218, v218, v219
    v_add_f32 v222, v222, v223
    v_mul_f32 v202, 0xbae38e39, v202
    v_mul_f32 v203, 0xbae38e39, v203
    v_mul_f32 v218, 0x3ae38e39, v218
    v_mul_f32 v222, 0x3ae38e39, v222
    v_fma_f32 v218, -v202, v202, v218
    v_fma_f32 v222, -v203, v203, v222
    v_max_f32 v218, 0, v218
    v_max_f32 v222, 0, v222
    v_add_f32 v218, 0x3727c5ac, v218
    v_add_f32 v222, 0x3727c5ac, v222
    v_rsq_f32 v18, v218
    v_rsq_f32 v19, v222
    v_mul_f32 v20, v202, v18
    v_mul_f32 v21, v203, v19
    ds_write2_b32 v22, v18, v20 offset0:0 offset1:32
    ds_write2_b32 v22, v19, v21 offset0:16 offset1:48
    ds_read_b128 v[58:61], v23 offset:0
    ds_read_b128 v[66:69], v23 offset:128
    ds_read_b128 v[62:65], v23 offset:64
    ds_read_b128 v[70:73], v23 offset:192
    s_waitcnt lgkmcnt(0)
    v_pk_mul_f32 v[216:217], v[66:67], v[42:43] op_sel_hi:[1,0]
    v_pk_mul_f32 v[218:219], v[68:69], v[42:43] op_sel_hi:[1,0]
    v_pk_fma_f32 v[130:131], v[130:131], v[58:59], v[216:217]
    v_pk_fma_f32 v[132:133], v[132:133], v[60:61], v[218:219]
    v_cvt_pk_bf16_f32 v220, v130, v131
    v_cvt_pk_bf16_f32 v221, v132, v133
    ds_write_b64 v6, v[220:221] offset:0
    v_pk_mul_f32 v[222:223], v[70:71], v[42:43] op_sel_hi:[1,0]
    v_pk_mul_f32 v[224:225], v[72:73], v[42:43] op_sel_hi:[1,0]
    v_pk_fma_f32 v[134:135], v[134:135], v[62:63], v[222:223]
    v_pk_fma_f32 v[136:137], v[136:137], v[64:65], v[224:225]
    v_cvt_pk_bf16_f32 v226, v134, v135
    v_cvt_pk_bf16_f32 v227, v136, v137
    ds_write_b64 v6, v[226:227] offset:576
    v_pk_mul_f32 v[228:229], v[66:67], v[42:43] op_sel:[0,1] op_sel_hi:[1,1]
    v_pk_mul_f32 v[230:231], v[68:69], v[42:43] op_sel:[0,1] op_sel_hi:[1,1]
    v_pk_fma_f32 v[138:139], v[138:139], v[58:59], v[228:229]
    v_pk_fma_f32 v[140:141], v[140:141], v[60:61], v[230:231]
    v_cvt_pk_bf16_f32 v232, v138, v139
    v_cvt_pk_bf16_f32 v233, v140, v141
    ds_write_b64 v7, v[232:233] offset:0
    v_pk_mul_f32 v[216:217], v[70:71], v[42:43] op_sel:[0,1] op_sel_hi:[1,1]
    v_pk_mul_f32 v[218:219], v[72:73], v[42:43] op_sel:[0,1] op_sel_hi:[1,1]
    v_pk_fma_f32 v[142:143], v[142:143], v[62:63], v[216:217]
    v_pk_fma_f32 v[144:145], v[144:145], v[64:65], v[218:219]
    v_cvt_pk_bf16_f32 v220, v142, v143
    v_cvt_pk_bf16_f32 v221, v144, v145
    ds_write_b64 v7, v[220:221] offset:576
    v_pk_mul_f32 v[222:223], v[66:67], v[44:45] op_sel_hi:[1,0]
    v_pk_mul_f32 v[224:225], v[68:69], v[44:45] op_sel_hi:[1,0]
    v_pk_fma_f32 v[146:147], v[146:147], v[58:59], v[222:223]
    v_pk_fma_f32 v[148:149], v[148:149], v[60:61], v[224:225]
    v_cvt_pk_bf16_f32 v226, v146, v147
    v_cvt_pk_bf16_f32 v227, v148, v149
    ds_write_b64 v8, v[226:227] offset:0
    v_pk_mul_f32 v[228:229], v[70:71], v[44:45] op_sel_hi:[1,0]
    v_pk_mul_f32 v[230:231], v[72:73], v[44:45] op_sel_hi:[1,0]
    v_pk_fma_f32 v[150:151], v[150:151], v[62:63], v[228:229]
    v_pk_fma_f32 v[152:153], v[152:153], v[64:65], v[230:231]
    v_cvt_pk_bf16_f32 v232, v150, v151
    v_cvt_pk_bf16_f32 v233, v152, v153
    ds_write_b64 v8, v[232:233] offset:576
    v_pk_mul_f32 v[216:217], v[66:67], v[44:45] op_sel:[0,1] op_sel_hi:[1,1]
    v_pk_mul_f32 v[218:219], v[68:69], v[44:45] op_sel:[0,1] op_sel_hi:[1,1]
    v_pk_fma_f32 v[154:155], v[154:155], v[58:59], v[216:217]
    v_pk_fma_f32 v[156:157], v[156:157], v[60:61], v[218:219]
    v_cvt_pk_bf16_f32 v220, v154, v155
    v_cvt_pk_bf16_f32 v221, v156, v157
    ds_write_b64 v9, v[220:221] offset:0
    v_pk_mul_f32 v[222:223], v[70:71], v[44:45] op_sel:[0,1] op_sel_hi:[1,1]
    v_pk_mul_f32 v[224:225], v[72:73], v[44:45] op_sel:[0,1] op_sel_hi:[1,1]
    v_pk_fma_f32 v[158:159], v[158:159], v[62:63], v[222:223]
    v_pk_fma_f32 v[160:161], v[160:161], v[64:65], v[224:225]
    v_cvt_pk_bf16_f32 v226, v158, v159
    v_cvt_pk_bf16_f32 v227, v160, v161
    ds_write_b64 v9, v[226:227] offset:576
    v_pk_mul_f32 v[228:229], v[66:67], v[46:47] op_sel_hi:[1,0]
    v_pk_mul_f32 v[230:231], v[68:69], v[46:47] op_sel_hi:[1,0]
    v_pk_fma_f32 v[162:163], v[162:163], v[58:59], v[228:229]
    v_pk_fma_f32 v[164:165], v[164:165], v[60:61], v[230:231]
    v_cvt_pk_bf16_f32 v232, v162, v163
    v_cvt_pk_bf16_f32 v233, v164, v165
    ds_write_b64 v10, v[232:233] offset:0
    v_pk_mul_f32 v[216:217], v[70:71], v[46:47] op_sel_hi:[1,0]
    v_pk_mul_f32 v[218:219], v[72:73], v[46:47] op_sel_hi:[1,0]
    v_pk_fma_f32 v[166:167], v[166:167], v[62:63], v[216:217]
    v_pk_fma_f32 v[168:169], v[168:169], v[64:65], v[218:219]
    v_cvt_pk_bf16_f32 v220, v166, v167
    v_cvt_pk_bf16_f32 v221, v168, v169
    ds_write_b64 v10, v[220:221] offset:576
    v_pk_mul_f32 v[222:223], v[66:67], v[46:47] op_sel:[0,1] op_sel_hi:[1,1]
    v_pk_mul_f32 v[224:225], v[68:69], v[46:47] op_sel:[0,1] op_sel_hi:[1,1]
    v_pk_fma_f32 v[170:171], v[170:171], v[58:59], v[222:223]
    v_pk_fma_f32 v[172:173], v[172:173], v[60:61], v[224:225]
    v_cvt_pk_bf16_f32 v226, v170, v171
    v_cvt_pk_bf16_f32 v227, v172, v173
    ds_write_b64 v11, v[226:227] offset:0
    v_pk_mul_f32 v[228:229], v[70:71], v[46:47] op_sel:[0,1] op_sel_hi:[1,1]
    v_pk_mul_f32 v[230:231], v[72:73], v[46:47] op_sel:[0,1] op_sel_hi:[1,1]
    v_pk_fma_f32 v[174:175], v[174:175], v[62:63], v[228:229]
    v_pk_fma_f32 v[176:177], v[176:177], v[64:65], v[230:231]
    v_cvt_pk_bf16_f32 v232, v174, v175
    v_cvt_pk_bf16_f32 v233, v176, v177
    ds_write_b64 v11, v[232:233] offset:576
    v_pk_mul_f32 v[216:217], v[66:67], v[48:49] op_sel_hi:[1,0]
    v_pk_mul_f32 v[218:219], v[68:69], v[48:49] op_sel_hi:[1,0]
    v_pk_fma_f32 v[178:179], v[178:179], v[58:59], v[216:217]
    v_pk_fma_f32 v[180:181], v[180:181], v[60:61], v[218:219]
    v_cvt_pk_bf16_f32 v220, v178, v179
    v_cvt_pk_bf16_f32 v221, v180, v181
    ds_write_b64 v12, v[220:221] offset:0
    v_pk_mul_f32 v[222:223], v[70:71], v[48:49] op_sel_hi:[1,0]
    v_pk_mul_f32 v[224:225], v[72:73], v[48:49] op_sel_hi:[1,0]
    v_pk_fma_f32 v[182:183], v[182:183], v[62:63], v[222:223]
    v_pk_fma_f32 v[184:185], v[184:185], v[64:65], v[224:225]
    v_cvt_pk_bf16_f32 v226, v182, v183
    v_cvt_pk_bf16_f32 v227, v184, v185
    ds_write_b64 v12, v[226:227] offset:576
    v_pk_mul_f32 v[228:229], v[66:67], v[48:49] op_sel:[0,1] op_sel_hi:[1,1]
    v_pk_mul_f32 v[230:231], v[68:69], v[48:49] op_sel:[0,1] op_sel_hi:[1,1]
    v_pk_fma_f32 v[186:187], v[186:187], v[58:59], v[228:229]
    v_pk_fma_f32 v[188:189], v[188:189], v[60:61], v[230:231]
    v_cvt_pk_bf16_f32 v232, v186, v187
    v_cvt_pk_bf16_f32 v233, v188, v189
    ds_write_b64 v13, v[232:233] offset:0
    v_pk_mul_f32 v[216:217], v[70:71], v[48:49] op_sel:[0,1] op_sel_hi:[1,1]
    v_pk_mul_f32 v[218:219], v[72:73], v[48:49] op_sel:[0,1] op_sel_hi:[1,1]
    v_pk_fma_f32 v[190:191], v[190:191], v[62:63], v[216:217]
    v_pk_fma_f32 v[192:193], v[192:193], v[64:65], v[218:219]
    v_cvt_pk_bf16_f32 v220, v190, v191
    v_cvt_pk_bf16_f32 v221, v192, v193
    ds_write_b64 v13, v[220:221] offset:576
    v_pk_mul_f32 v[222:223], v[66:67], v[50:51] op_sel_hi:[1,0]
    v_pk_mul_f32 v[224:225], v[68:69], v[50:51] op_sel_hi:[1,0]
    v_pk_fma_f32 v[194:195], v[194:195], v[58:59], v[222:223]
    v_pk_fma_f32 v[196:197], v[196:197], v[60:61], v[224:225]
    v_cvt_pk_bf16_f32 v226, v194, v195
    v_cvt_pk_bf16_f32 v227, v196, v197
    ds_write_b64 v14, v[226:227] offset:0
    v_pk_mul_f32 v[228:229], v[70:71], v[50:51] op_sel_hi:[1,0]
    v_pk_mul_f32 v[230:231], v[72:73], v[50:51] op_sel_hi:[1,0]
    v_pk_fma_f32 v[198:199], v[198:199], v[62:63], v[228:229]
    v_pk_fma_f32 v[200:201], v[200:201], v[64:65], v[230:231]
    v_cvt_pk_bf16_f32 v232, v198, v199
    v_cvt_pk_bf16_f32 v233, v200, v201
    ds_write_b64 v14, v[232:233] offset:576
    ds_read_b128 v[130:133], v238 offset:0
    ds_read_b128 v[134:137], v238 offset:1024
    ds_read_b128 v[138:141], v238 offset:2048
    ds_read_b128 v[142:145], v238 offset:3072
    ds_read_b128 v[146:149], v238 offset:4096
    ds_read_b128 v[150:153], v238 offset:5120
    ds_read_b128 v[154:157], v238 offset:6144
    ds_read_b128 v[158:161], v238 offset:7168
    ds_read_b128 v[162:165], v238 offset:8192
    v_add_u32 v217, 0, v1
    v_mul_u32_u24 v218, 911, v217
    v_lshrrev_b32 v218, 16, v218
    v_mul_u32_u24 v218, s53, v218
    v_lshl_add_u32 v170, v217, 4, v218
    v_add_u32 v217, 64, v1
    v_mul_u32_u24 v218, 911, v217
    v_lshrrev_b32 v218, 16, v218
    v_mul_u32_u24 v218, s53, v218
    v_lshl_add_u32 v171, v217, 4, v218
    v_add_u32 v217, 128, v1
    v_mul_u32_u24 v218, 911, v217
    v_lshrrev_b32 v218, 16, v218
    v_mul_u32_u24 v218, s53, v218
    v_lshl_add_u32 v172, v217, 4, v218
    s_waitcnt lgkmcnt(8)
    buffer_store_dwordx4 v[130:133], v170, s[32:35], s52 offen sc1
    v_add_u32 v217, 192, v1
    v_mul_u32_u24 v218, 911, v217
    v_lshrrev_b32 v218, 16, v218
    v_mul_u32_u24 v218, s53, v218
    v_lshl_add_u32 v173, v217, 4, v218
    s_waitcnt lgkmcnt(7)
    buffer_store_dwordx4 v[134:137], v171, s[32:35], s52 offen sc1
    v_add_u32 v217, 256, v1
    v_mul_u32_u24 v218, 911, v217
    v_lshrrev_b32 v218, 16, v218
    v_mul_u32_u24 v218, s53, v218
    v_lshl_add_u32 v174, v217, 4, v218
    s_waitcnt lgkmcnt(6)
    buffer_store_dwordx4 v[138:141], v172, s[32:35], s52 offen sc1
    v_add_u32 v217, 320, v1
    v_mul_u32_u24 v218, 911, v217
    v_lshrrev_b32 v218, 16, v218
    v_mul_u32_u24 v218, s53, v218
    v_lshl_add_u32 v175, v217, 4, v218
    s_waitcnt lgkmcnt(5)
    buffer_store_dwordx4 v[142:145], v173, s[32:35], s52 offen sc1
    v_add_u32 v217, 384, v1
    v_mul_u32_u24 v218, 911, v217
    v_lshrrev_b32 v218, 16, v218
    v_mul_u32_u24 v218, s53, v218
    v_lshl_add_u32 v176, v217, 4, v218
    s_waitcnt lgkmcnt(4)
    buffer_store_dwordx4 v[146:149], v174, s[32:35], s52 offen sc1
    v_add_u32 v217, 448, v1
    v_mul_u32_u24 v218, 911, v217
    v_lshrrev_b32 v218, 16, v218
    v_mul_u32_u24 v218, s53, v218
    v_lshl_add_u32 v177, v217, 4, v218
    s_waitcnt lgkmcnt(3)
    buffer_store_dwordx4 v[150:153], v175, s[32:35], s52 offen sc1
    v_add_u32 v217, 512, v1
    v_mul_u32_u24 v218, 911, v217
    v_lshrrev_b32 v218, 16, v218
    v_mul_u32_u24 v218, s53, v218
    v_lshl_add_u32 v178, v217, 4, v218
    s_waitcnt lgkmcnt(2)
    buffer_store_dwordx4 v[154:157], v176, s[32:35], s52 offen sc1
    s_waitcnt lgkmcnt(1)
    buffer_store_dwordx4 v[158:161], v177, s[32:35], s52 offen sc1
    s_waitcnt lgkmcnt(0)
    buffer_store_dwordx4 v[162:165], v178, s[32:35], s52 offen sc1
    s_endpgm
L_qkv_tab:
    s_mov_b32 s48, 3641
    s_mov_b32 s49, 144
    s_mov_b32 s51, 9216
    s_cmp_ge_u32 s42, 9
    s_cselect_b32 s48, 7282, s48
    s_cselect_b32 s49, 72, s49
    s_cselect_b32 s50, 64, 1000
    s_cselect_b32 s51, 4096, s51
    s_cselect_b32 s52, 9, 0
    s_mov_b32 s53, 331776
    s_cmp_ge_u32 s42, 18
    s_cselect_b32 s52, 18, s52
    s_cselect_b32 s53, 82944, s53
    s_sub_u32 s52, s42, s52
    v_bfe_u32 v40, v1, 4, 1
    v_lshrrev_b32 v42, 5, v1
    v_and_b32 v43, 15, v1
    v_lshl_add_u32 v42, v42, 4, v43
    s_lshl_b32 s54, s52, 6
    v_add_u32 v42, s54, v42
    v_lshlrev_b32 v43, 8, v40
    v_mov_b32 v46, 128
    v_mov_b32 v47, 4096
    s_and_b32 s55, s49, 0xe0
    v_add_u32 v41, 0, v42
    v_lshrrev_b32 v40, 3, v41
    v_mul_u32_u24 v40, s48, v40
    v_lshrrev_b32 v40, 16, v40
    v_mul_u32_u24 v44, s49, v40
    v_sub_u32 v44, v41, v44
    v_lshrrev_b32 v45, 4, v40
    v_and_b32 v40, 15, v40
    v_xor_b32 v45, 1, v45
    v_mul_lo_u32 v40, v40, s53
    v_mul_u32_u24 v45, 165888, v45
    v_add_u32 v40, v40, v45
    v_cmp_gt_u32 vcc, s55, v44
    v_and_b32 v45, 0xe3, v44
    v_bfe_u32 v41, v44, 2, 1
    v_lshl_or_b32 v45, v41, 4, v45
    v_bfe_u32 v41, v44, 3, 2
    v_lshl_or_b32 v45, v41, 2, v45
    v_cndmask_b32 v44, v44, v45, vcc
    v_cmp_le_u32 vcc, s50, v44
    v_lshrrev_b32 v45, 4, v44
    v_lshl_add_u32 v40, v45, 10, v40
    v_and_b32 v44, 15, v44
    v_lshl_add_u32 v40, v44, 4, v40
    v_mov_b32 v45, s51
    v_cndmask_b32 v38, v45, v46, vcc
    v_cndmask_b32 v44, 0, v47, vcc
    v_add3_u32 v36, v40, v43, v44
    v_add_u32 v41, 32, v42
    v_lshrrev_b32 v40, 3, v41
    v_mul_u32_u24 v40, s48, v40
    v_lshrrev_b32 v40, 16, v40
    v_mul_u32_u24 v44, s49, v40
    v_sub_u32 v44, v41, v44
    v_lshrrev_b32 v45, 4, v40
    v_and_b32 v40, 15, v40
    v_xor_b32 v45, 1, v45
    v_mul_lo_u32 v40, v40, s53
    v_mul_u32_u24 v45, 165888, v45
    v_add_u32 v40, v40, v45
    v_cmp_gt_u32 vcc, s55, v44
    v_and_b32 v45, 0xe3, v44
    v_bfe_u32 v41, v44, 2, 1
    v_lshl_or_b32 v45, v41, 4, v45
    v_bfe_u32 v41, v44, 3, 2
    v_lshl_or_b32 v45, v41, 2, v45
    v_cndmask_b32 v44, v44, v45, vcc
    v_cmp_le_u32 vcc, s50, v44
    v_lshrrev_b32 v45, 4, v44
    v_lshl_add_u32 v40, v45, 10, v40
    v_and_b32 v44, 15, v44
    v_lshl_add_u32 v40, v44, 4, v40
    v_mov_b32 v45, s51
    v_cndmask_b32 v39, v45, v46, vcc
    v_cndmask_b32 v44, 0, v47, vcc
    v_add3_u32 v37, v40, v43, v44
    s_add_u32 s28, s22, 26738688
    s_addc_u32 s29, s23, 0
    s_mov_b32 s30, 27648
    s_mov_b32 s31, 0x20000
    v_lshlrev_b32 v40, 4, v1
    s_lshl_b32 s54, s42, 10
    buffer_store_dwordx4 v[36:39], v40, s[28:31], s54 offen sc1
    s_endpgm
.p2align 12
.globl attn_kernel
.p2align 8
.type attn_kernel,@function
attn_kernel:
    s_cmp_ge_u32 s2, 256
    s_cbranch_scc1 L_end_attn_kernel
    s_load_dwordx16 s[4:19], s[0:1], 0
    s_load_dwordx2 s[20:21], s[0:1], 64
    s_load_dwordx2 s[22:23], s[0:1], 80
    v_and_b32 v1, 63, v0
    v_lshrrev_b32 v112, 6, v0
    v_lshlrev_b32 v2, 4, v1
    v_readfirstlane_b32 s40, v112
    s_and_b32 s41, s2, 7
    s_lshl_b32 s41, s41, 2
    s_lshr_b32 s44, s2, 3
    s_and_b32 s44, s44, 3
    s_add_u32 s41, s41, s44
    s_lshr_b32 s42, s2, 5
    s_mul_i32 s46, s41, 73728
    s_mul_i32 s47, s41, 73728
    s_and_b32 s3, s40, 3
    s_lshl_b32 s3, s3, 1
    s_lshr_b32 s49, s40, 2
    s_add_u32 s3, s3, s49
    s_lshl_b32 s44, s42, 3
    s_mul_i32 s44, s44, 1152
    s_add_u32 s48, s44, s46
    s_add_u32 s46, s46, 2359296
    s_add_u32 s47, s47, 4718592
    v_and_b32 v112, 31, v1
    v_lshlrev_b32 v112, 2, v112
    v_lshrrev_b32 v113, 5, v1
    v_mul_u32_u24 v3, 1152, v113
    v_add_u32 v3, v3, v112
    v_add_u32 v3, 1024, v3
    s_lshl_b32 s52, s40, 11
    s_add_u32 s53, s52, 1024
    s_mul_i32 s58, s40, 2304
    s_add_u32 s58, s58, s46
    s_add_u32 s59, s58, 1152
    s_lshl_b32 s54, s40, 8
    s_add_u32 s54, s54, 65536
    s_mov_b32 s60, s58
    s_lshl_b32 s44, s40, 10
    s_add_u32 s55, s44, 73728
    s_add_u32 s61, s44, s47
    s_add_u32 s56, s55, 8192
    s_add_u32 s62, s61, 8192
    s_cmp_lt_u32 s40, 2
    s_cselect_b32 s44, 8192, 0
    s_add_u32 s57, s56, s44
    s_add_u32 s63, s62, s44
    s_waitcnt lgkmcnt(0)
    s_add_u32 s24, s22, 0
    s_addc_u32 s25, s23, 0
    s_mov_b32 s26, 11796480
    s_mov_b32 s27, 0x20000
    s_mov_b32 m0, s52
    s_add_u32 s52, s52, 16384
    buffer_load_dwordx4 v2, s[24:27], s58 offen lds
    s_add_u32 s58, s58, 18432
    s_mov_b32 m0, s54
    s_add_u32 s54, s54, 2048
    buffer_load_dword v3, s[24:27], s60 offen lds
    s_add_u32 s60, s60, 18432
    s_lshl_b32 s44, s40, 10
    s_add_u32 m0, s44, 151552
    s_add_u32 s44, s44, s48
    buffer_load_dwordx4 v2, s[24:27], s44 offen lds
    s_mov_b32 m0, s55
    s_add_u32 s55, s55, 18432
    buffer_load_dwordx4 v2, s[24:27], s61 offen lds
    s_add_u32 s61, s61, 18432
    s_mov_b32 m0, s53
    s_add_u32 s53, s53, 16384
    buffer_load_dwordx4 v2, s[24:27], s59 offen lds
    s_add_u32 s59, s59, 18432
    s_mov_b32 m0, s56
    s_add_u32 s56, s56, 18432
    buffer_load_dwordx4 v2, s[24:27], s62 offen lds
    s_add_u32 s62, s62, 18432
    s_cmp_ge_u32 s40, 2
    s_cbranch_scc1 L_ld5_1
    s_mov_b32 m0, s57
    s_add_u32 s57, s57, 18432
    buffer_load_dwordx4 v2, s[24:27], s63 offen lds
    s_add_u32 s63, s63, 18432
L_ld5_1:
    s_cmp_lg_u32 s40, 2
    s_cbranch_scc1 L_ldq
    s_mov_b32 m0, 159744
    s_add_u32 s44, s48, 8192
    buffer_load_dwordx4 v2, s[24:27], s44 offen lds
L_ldq:
    s_mov_b32 s32, s14
    s_mov_b32 s33, s15
    s_mov_b32 s34, 8388608
    s_mov_b32 s35, 0x20000
    v_lshrrev_b32 v112, 3, v1
    v_and_b32 v113, 7, v1
    v_and_b32 v114, 4, v112
    v_add_u32 v114, v114, v112
    v_lshlrev_b32 v114, 12, v114
    v_lshl_add_u32 v114, v113, 4, v114
    s_lshr_b32 s44, s2, 2
    s_lshl_b32 s44, s44, 17
    s_and_b32 s45, s2, 1
    s_lshl_b32 s45, s45, 14
    s_add_u32 s44, s44, s45
    s_and_b32 s45, s2, 2
    s_lshl_b32 s45, s45, 15
    s_add_u32 s44, s44, s45
    s_lshl_b32 s45, s40, 9
    s_add_u32 s44, s44, s45
    v_mov_b32 v137, v114
    s_mov_b32 s51, s44
    s_add_u32 s36, s22, 62914560
    s_addc_u32 s37, s23, 0
    s_mov_b32 s38, 8388608
    s_mov_b32 s39, 0x20000
    v_lshrrev_b32 v114, 2, v113
    v_lshlrev_b32 v114, 11, v114
    v_and_b32 v113, 3, v113
    v_lshl_add_u32 v114, v113, 8, v114
    v_lshl_add_u32 v136, v112, 4, v114
    s_lshr_b32 s50, s2, 2
    s_lshl_b32 s50, s50, 17
    s_bfe_u32 s44, s2, 0x10001
    s_lshl_b32 s44, s44, 10
    s_add_u32 s50, s50, s44
    s_and_b32 s44, s2, 1
    s_lshl_b32 s44, s44, 7
    s_add_u32 s50, s50, s44
    s_lshl_b32 s44, s40, 14
    s_add_u32 s50, s50, s44
    v_mov_b32 v114, 0x3f803f80
    v_bfe_i32 v115, v0, 1, 1
    v_bfi_b32 v114, v115, 0, v114
    v_mov_b32 v115, v114
    v_lshlrev_b32 v116, 3, v0
    v_add_u32 v116, 147456, v116
    ds_write_b64 v116, v[114:115]
    v_mov_b32 v13, 0
    v_mov_b32 v25, 0
    v_mov_b32 v27, 0
    v_mov_b32 v96, 0
    v_mov_b32 v97, 0
    v_mov_b32 v98, 0
    v_mov_b32 v99, 0
    v_mov_b32 v100, 0
    v_mov_b32 v101, 0
    v_mov_b32 v102, 0
    v_mov_b32 v103, 0
    v_mov_b32 v104, 0
    v_mov_b32 v105, 0
    v_mov_b32 v106, 0
    v_mov_b32 v107, 0
    v_mov_b32 v108, 0
    v_mov_b32 v109, 0
    v_mov_b32 v110, 0
    v_mov_b32 v111, 0
    v_mov_b32 v93, 0
    v_mov_b32 v196, 0
    v_mov_b32 v197, 0
    v_mov_b32 v198, 0
    v_mov_b32 v199, 0
    v_mov_b32 v200, 0
    v_mov_b32 v201, 0
    v_mov_b32 v202, 0
    v_mov_b32 v203, 0
    v_mov_b32 v204, 0
    v_mov_b32 v205, 0
    v_mov_b32 v206, 0
    v_mov_b32 v207, 0
    v_mov_b32 v208, 0
    v_mov_b32 v209, 0
    v_mov_b32 v210, 0
    v_mov_b32 v211, 0
    v_mov_b32 v4, v2
    v_and_b32 v112, 31, v1
    v_lshlrev_b32 v5, 2, v112
    v_add_u32 v5, 65536, v5
    v_lshrrev_b32 v113, 5, v1
    v_mul_u32_u24 v113, 288, v113
    v_lshl_add_u32 v113, v112, 4, v113
    v_add_u32 v113, 73728, v113
    v_cmp_gt_u32 vcc, 18, v112
    v_mov_b32 v114, 147456
    v_cmp_eq_u32 s[44:45], 18, v112
    v_mov_b32 v115, 147472
    s_nop 0
    v_cndmask_b32 v114, v115, v114, s[44:45]
    v_mov_b32 v115, 2304
    v_cndmask_b32 v6, v114, v113, vcc
    v_cndmask_b32 v7, 0, v115, vcc
    v_mov_b32 v44, v4
    v_mov_b32 v45, v5
    v_mov_b32 v46, v6
    s_lshl_b32 s44, s49, 10
    s_lshl_b32 s45, s49, 7
    v_lshrrev_b32 v112, 1, v7
    v_add_u32 v4, s44, v4
    v_add_u32 v5, s45, v5
    v_mad_u32_u24 v6, v112, s49, v6
    v_lshlrev_b32 v47, 1, v7
    s_mul_i32 s44, s3, 1152
    s_xor_b32 s45, s3, 1
    s_mul_i32 s45, s45, 1152
    s_add_u32 s44, s44, 151552
    s_add_u32 s45, s45, 151552
    v_lshlrev_b32 v112, 2, v1
    v_cmp_gt_u32 vcc, 32, v1
    v_mov_b32 v113, 146448
    v_add_u32 v8, s44, v2
    v_add_u32 v88, s45, v2
    v_add_u32 v12, s44, v112
    v_add_u32 v92, s45, v112
    v_cndmask_b32 v12, v113, v12, vcc
    v_cndmask_b32 v92, v113, v92, vcc
    s_lshl_b32 s49, s42, 4
    s_lshl_b32 s43, s3, 1
    s_add_u32 s49, s49, s43
    s_mul_i32 s49, s49, 18432
    s_lshl_b32 s43, s41, 9
    s_add_u32 s43, s43, s49
    s_lshr_b32 s44, s41, 2
    s_lshl_b32 s44, s44, 8
    s_add_u32 s49, s49, s44
    s_and_b32 s44, s41, 3
    s_lshl_b32 s44, s44, 2
    s_add_u32 s49, s49, s44
    s_add_u32 s49, s49, 16384
    v_bfe_u32 v192, v1, 4, 1
    v_mul_u32_u24 v192, 18432, v192
    v_and_b32 v115, 3, v1
    v_lshl_add_u32 v192, v115, 4, v192
    v_and_b32 v115, 40, v1
    v_lshl_add_u32 v192, v115, 3, v192
    v_and_b32 v115, 4, v1
    v_lshl_add_u32 v192, v115, 5, v192
    s_cmp_eq_u32 s40, 6
    s_cbranch_scc1 L_pgattn_kernel_1
    s_cmp_eq_u32 s40, 7
    s_cbranch_scc1 L_pgattn_kernel_2
L_hopattn_kernel_0:
    v_mov_b32 v80, 0
    v_mov_b32 v28, 0
    v_mov_b32 v81, 0
    v_mov_b32 v29, 0
    v_mov_b32 v82, 0
    v_mov_b32 v30, 0
    v_mov_b32 v83, 0
    v_mov_b32 v31, 0
    v_mov_b32 v84, 0
    v_mov_b32 v32, 0
    v_mov_b32 v85, 0
    v_mov_b32 v33, 0
    v_mov_b32 v86, 0
    v_mov_b32 v34, 0
    v_mov_b32 v87, 0
    v_mov_b32 v35, 0
    v_mov_b32 v180, 0
    v_mov_b32 v212, 0
    v_mov_b32 v213, 0
    v_mov_b32 v214, 0
    v_mov_b32 v215, 0
    s_and_b32 s92, s40, 3
    s_mul_i32 s92, s92, 3072
    s_lshr_b32 s44, s40, 2
    s_mul_i32 s44, s44, 73728
    s_add_u32 s92, s92, s44
    v_lshrrev_b32 v216, 5, v1
    v_bfe_u32 v217, v1, 4, 1
    v_bfe_u32 v218, v1, 3, 1
    v_and_b32 v219, 0x70, v2
    v_bfe_u32 v113, v1, 2, 2
    v_lshl_add_u32 v113, v217, 3, v113
    v_lshlrev_b32 v113, 7, v113
    v_lshl_add_u32 v113, v216, 5, v113
    v_and_b32 v115, 3, v1
    v_lshl_add_u32 v113, v115, 3, v113
    v_add_u32 v183, s92, v113
    v_and_b32 v112, 15, v1
    v_cmp_eq_u32 vcc, v112, v216
    v_mov_b32 v112, 0x3f803f80
    s_nop 0
    v_cndmask_b32 v176, 0, v112, vcc
    v_cndmask_b32 v177, 0, v112, vcc
    v_cndmask_b32 v178, 0, v112, vcc
    v_cndmask_b32 v179, 0, v112, vcc
    v_mov_b32 v168, 0
    v_mov_b32 v169, 0
    v_mov_b32 v170, 0
    v_mov_b32 v171, 0
    v_mov_b32 v172, 0
    v_mov_b32 v173, 0
    v_mov_b32 v174, 0
    v_mov_b32 v175, 0
    s_waitcnt vmcnt(0) lgkmcnt(0)
    s_barrier
    ds_read_b128 v[16:19], v4 offset:0
    ds_read_b32 v24, v5 offset:0
    ds_read_b128 v[8:11], v8
    ds_read_b32 v12, v12 offset:1024
    ds_read_b128 v[88:91], v88
    ds_read_b32 v92, v92 offset:1024
    s_getpc_b64 s[28:29]
Lpc_attn_kernel_1:
    s_sub_u32 s28, s28, Lpc_attn_kernel_1-L_text_begin
    s_subb_u32 s29, s29, 0
    s_mov_b32 s30, L_text_end-L_text_begin
    s_mov_b32 s31, 0x20000
    s_lshr_b32 s44, s2, 3
    s_mul_i32 s44, s44, 8
    s_add_u32 s44, s44, s40
    s_and_b32 s44, s44, 15
    s_lshl_b32 s44, s44, 13
    v_lshlrev_b32 v186, 7, v1
    buffer_load_dword v187, v186, s[28:31], s44 offen
    s_add_u32 s28, s22, 16777216
    s_addc_u32 s29, s23, 0
    s_mov_b32 s30, 2359296
    s_mov_b32 s31, 0x20000
    s_waitcnt lgkmcnt(2)
    v_mfma_f32_32x32x16_bf16 v[48:63], v[16:19], v[8:11], 0
    v_mfma_f32_32x32x8bf16_1k v[48:63], v[24:25], v[12:13], v[48:63]
    s_waitcnt lgkmcnt(0)
    s_nop 7
    s_nop 1
    s_setprio 3
    v_mfma_f32_32x32x16_bf16 v[196:211], v[28:31], v[80:83], v[196:211]
    v_exp_f32 v48, v48
    v_exp_f32 v49, v49
    v_exp_f32 v50, v50
    v_exp_f32 v51, v51
    s_mov_b32 m0, s52
    s_add_u32 s52, s52, 16384
    buffer_load_dwordx4 v2, s[24:27], s58 offen lds
    s_add_u32 s58, s58, 18432
    v_mfma_f32_32x32x16_bf16 v[196:211], v[32:35], v[84:87], v[196:211]
    v_exp_f32 v52, v52
    v_exp_f32 v53, v53
    v_exp_f32 v54, v54
    v_exp_f32 v55, v55
    ds_read_b128 v[28:31], v6 offset:0
    ds_read_b128 v[32:35], v6 offset:576
    v_mfma_f32_32x32x16_bf16 v[64:79], v[16:19], v[88:91], 0
    v_exp_f32 v56, v56
    v_exp_f32 v57, v57
    v_exp_f32 v58, v58
    v_exp_f32 v59, v59
    s_mov_b32 m0, s54
    s_add_u32 s54, s54, 2048
    buffer_load_dword v3, s[24:27], s60 offen lds
    s_add_u32 s60, s60, 18432
    v_mfma_f32_32x32x8bf16_1k v[64:79], v[24:25], v[92:93], v[64:79]
    ds_read_b128 v[16:19], v4 offset:2048
    ds_read_b32 v24, v5 offset:256
    v_exp_f32 v60, v60
    v_exp_f32 v61, v61
    v_exp_f32 v62, v62
    v_exp_f32 v63, v63
    v_cvt_pk_bf16_f32 v80, v48, v49
    v_cvt_pk_bf16_f32 v81, v50, v51
    v_cvt_pk_bf16_f32 v82, v52, v53
    v_cvt_pk_bf16_f32 v83, v54, v55
    v_cvt_pk_bf16_f32 v84, v56, v57
    v_cvt_pk_bf16_f32 v85, v58, v59
    v_cvt_pk_bf16_f32 v86, v60, v61
    v_cvt_pk_bf16_f32 v87, v62, v63
    s_waitcnt lgkmcnt(2)
    v_mfma_f32_32x32x16_bf16 v[96:111], v[28:31], v[80:83], v[96:111]
    v_exp_f32 v64, v64
    v_exp_f32 v65, v65
    v_exp_f32 v66, v66
    v_exp_f32 v67, v67
    s_mov_b32 m0, s55
    s_add_u32 s55, s55, 18432
    buffer_load_dwordx4 v2, s[24:27], s61 offen lds
    s_add_u32 s61, s61, 18432
    v_mfma_f32_32x32x16_bf16 v[96:111], v[32:35], v[84:87], v[96:111]
    v_exp_f32 v68, v68
    v_exp_f32 v69, v69
    v_exp_f32 v70, v70
    v_exp_f32 v71, v71
    s_waitcnt lgkmcnt(0)
    v_mfma_f32_32x32x16_bf16 v[48:63], v[16:19], v[8:11], 0
    v_exp_f32 v72, v72
    v_exp_f32 v73, v73
    v_exp_f32 v74, v74
    v_exp_f32 v75, v75
    s_mov_b32 m0, s53
    s_add_u32 s53, s53, 16384
    buffer_load_dwordx4 v2, s[24:27], s59 offen lds
    s_add_u32 s59, s59, 18432
    v_mfma_f32_32x32x8bf16_1k v[48:63], v[24:25], v[12:13], v[48:63]
    v_exp_f32 v76, v76
    v_exp_f32 v77, v77
    v_exp_f32 v78, v78
    v_exp_f32 v79, v79
    v_cvt_pk_bf16_f32 v80, v64, v65
    v_cvt_pk_bf16_f32 v81, v66, v67
    v_cvt_pk_bf16_f32 v82, v68, v69
    v_cvt_pk_bf16_f32 v83, v70, v71
    v_cvt_pk_bf16_f32 v84, v72, v73
    v_cvt_pk_bf16_f32 v85, v74, v75
    v_cvt_pk_bf16_f32 v86, v76, v77
    v_cvt_pk_bf16_f32 v87, v78, v79
    v_mfma_f32_32x32x16_bf16 v[196:211], v[28:31], v[80:83], v[196:211]
    v_exp_f32 v48, v48
    v_exp_f32 v49, v49
    v_exp_f32 v50, v50
    v_exp_f32 v51, v51
    s_mov_b32 m0, s56
    s_add_u32 s56, s56, 18432
    buffer_load_dwordx4 v2, s[24:27], s62 offen lds
    s_add_u32 s62, s62, 18432
    v_mfma_f32_32x32x16_bf16 v[196:211], v[32:35], v[84:87], v[196:211]
    v_exp_f32 v52, v52
    v_exp_f32 v53, v53
    v_exp_f32 v54, v54
    v_exp_f32 v55, v55
    ds_read_b128 v[28:31], v6 offset:2304
    ds_read_b128 v[32:35], v6 offset:2880
    v_mfma_f32_32x32x16_bf16 v[64:79], v[16:19], v[88:91], 0
    v_exp_f32 v56, v56
    v_exp_f32 v57, v57
    v_exp_f32 v58, v58
    v_exp_f32 v59, v59
    s_cmp_ge_u32 s40, 2
    s_cbranch_scc1 L_ld5_2
    s_mov_b32 m0, s57
    s_add_u32 s57, s57, 18432
    buffer_load_dwordx4 v2, s[24:27], s63 offen lds
    s_add_u32 s63, s63, 18432
L_ld5_2:
    v_mfma_f32_32x32x8bf16_1k v[64:79], v[24:25], v[92:93], v[64:79]
    ds_read_b128 v[16:19], v4 offset:4096
    ds_read_b32 v24, v5 offset:512
    v_exp_f32 v60, v60
    v_exp_f32 v61, v61
    v_exp_f32 v62, v62
    v_exp_f32 v63, v63
    v_cvt_pk_bf16_f32 v80, v48, v49
    v_cvt_pk_bf16_f32 v81, v50, v51
    v_cvt_pk_bf16_f32 v82, v52, v53
    v_cvt_pk_bf16_f32 v83, v54, v55
    v_cvt_pk_bf16_f32 v84, v56, v57
    v_cvt_pk_bf16_f32 v85, v58, v59
    v_cvt_pk_bf16_f32 v86, v60, v61
    v_cvt_pk_bf16_f32 v87, v62, v63
    s_waitcnt lgkmcnt(2)
    v_mfma_f32_32x32x16_bf16 v[96:111], v[28:31], v[80:83], v[96:111]
    v_exp_f32 v64, v64
    v_exp_f32 v65, v65
    v_exp_f32 v66, v66
    v_exp_f32 v67, v67
    s_mov_b32 m0, s52
    s_add_u32 s52, s52, 16384
    buffer_load_dwordx4 v2, s[24:27], s58 offen lds
    s_add_u32 s58, s58, 18432
    v_mfma_f32_32x32x16_bf16 v[96:111], v[32:35], v[84:87], v[96:111]
    v_exp_f32 v68, v68
    v_exp_f32 v69, v69
    v_exp_f32 v70, v70
    v_add_u32 v6, v47, v6
    v_exp_f32 v71, v71
    s_waitcnt lgkmcnt(0)
    v_mfma_f32_32x32x16_bf16 v[48:63], v[16:19], v[8:11], 0
    v_exp_f32 v72, v72
    v_exp_f32 v73, v73
    v_exp_f32 v74, v74
    v_exp_f32 v75, v75
    s_mov_b32 m0, s54
    s_add_u32 s54, s54, 2048
    buffer_load_dword v3, s[24:27], s60 offen lds
    s_add_u32 s60, s60, 18432
    v_mfma_f32_32x32x8bf16_1k v[48:63], v[24:25], v[12:13], v[48:63]
    v_exp_f32 v76, v76
    v_exp_f32 v77, v77
    v_exp_f32 v78, v78
    v_exp_f32 v79, v79
    v_cvt_pk_bf16_f32 v80, v64, v65
    v_cvt_pk_bf16_f32 v81, v66, v67
    v_cvt_pk_bf16_f32 v82, v68, v69
    v_cvt_pk_bf16_f32 v83, v70, v71
    v_cvt_pk_bf16_f32 v84, v72, v73
    v_cvt_pk_bf16_f32 v85, v74, v75
    v_cvt_pk_bf16_f32 v86, v76, v77
    v_cvt_pk_bf16_f32 v87, v78, v79
    v_mfma_f32_32x32x16_bf16 v[196:211], v[28:31], v[80:83], v[196:211]
    v_exp_f32 v48, v48
    v_exp_f32 v49, v49
    v_exp_f32 v50, v50
    v_exp_f32 v51, v51
    s_mov_b32 m0, s55
    s_add_u32 s55, s55, 18432
    buffer_load_dwordx4 v2, s[24:27], s61 offen lds
    s_add_u32 s61, s61, 18432
    v_mfma_f32_32x32x16_bf16 v[196:211], v[32:35], v[84:87], v[196:211]
    v_exp_f32 v52, v52
    v_exp_f32 v53, v53
    v_exp_f32 v54, v54
    v_exp_f32 v55, v55
    ds_read_b128 v[28:31], v6 offset:0
    ds_read_b128 v[32:35], v6 offset:576
    v_mfma_f32_32x32x16_bf16 v[64:79], v[16:19], v[88:91], 0
    v_exp_f32 v56, v56
    v_exp_f32 v57, v57
    v_exp_f32 v58, v58
    v_exp_f32 v59, v59
    s_mov_b32 m0, s53
    s_add_u32 s53, s53, 16384
    buffer_load_dwordx4 v2, s[24:27], s59 offen lds
    s_add_u32 s59, s59, 18432
    v_mfma_f32_32x32x8bf16_1k v[64:79], v[24:25], v[92:93], v[64:79]
    ds_read_b128 v[16:19], v4 offset:6144
    ds_read_b32 v24, v5 offset:768
    v_exp_f32 v60, v60
    v_exp_f32 v61, v61
    v_exp_f32 v62, v62
    v_exp_f32 v63, v63
    v_cvt_pk_bf16_f32 v80, v48, v49
    v_cvt_pk_bf16_f32 v81, v50, v51
    v_cvt_pk_bf16_f32 v82, v52, v53
    v_cvt_pk_bf16_f32 v83, v54, v55
    v_cvt_pk_bf16_f32 v84, v56, v57
    v_cvt_pk_bf16_f32 v85, v58, v59
    v_cvt_pk_bf16_f32 v86, v60, v61
    v_cvt_pk_bf16_f32 v87, v62, v63
    s_waitcnt lgkmcnt(2)
    v_mfma_f32_32x32x16_bf16 v[96:111], v[28:31], v[80:83], v[96:111]
    v_exp_f32 v64, v64
    v_exp_f32 v65, v65
    v_exp_f32 v66, v66
    v_exp_f32 v67, v67
    s_mov_b32 m0, s56
    s_add_u32 s56, s56, 18432
    buffer_load_dwordx4 v2, s[24:27], s62 offen lds
    s_add_u32 s62, s62, 18432
    v_mfma_f32_32x32x16_bf16 v[96:111], v[32:35], v[84:87], v[96:111]
    v_exp_f32 v68, v68
    v_exp_f32 v69, v69
    v_exp_f32 v70, v70
    v_exp_f32 v71, v71
    s_waitcnt lgkmcnt(0)
    v_mfma_f32_32x32x16_bf16 v[48:63], v[16:19], v[8:11], 0
    v_exp_f32 v72, v72
    v_exp_f32 v73, v73
    v_exp_f32 v74, v74
    v_exp_f32 v75, v75
    s_cmp_ge_u32 s40, 2
    s_cbranch_scc1 L_ld5_3
    s_mov_b32 m0, s57
    s_add_u32 s57, s57, 18432
    buffer_load_dwordx4 v2, s[24:27], s63 offen lds
    s_add_u32 s63, s63, 18432
L_ld5_3:
    v_mfma_f32_32x32x8bf16_1k v[48:63], v[24:25], v[12:13], v[48:63]
    v_exp_f32 v76, v76
    v_exp_f32 v77, v77
    v_exp_f32 v78, v78
    v_exp_f32 v79, v79
    v_cvt_pk_bf16_f32 v80, v64, v65
    v_cvt_pk_bf16_f32 v81, v66, v67
    v_cvt_pk_bf16_f32 v82, v68, v69
    v_cvt_pk_bf16_f32 v83, v70, v71
    v_cvt_pk_bf16_f32 v84, v72, v73
    v_cvt_pk_bf16_f32 v85, v74, v75
    v_cvt_pk_bf16_f32 v86, v76, v77
    v_cvt_pk_bf16_f32 v87, v78, v79
    s_setprio 2
    v_mfma_f32_32x32x16_bf16 v[196:211], v[28:31], v[80:83], v[196:211]
    v_exp_f32 v48, v48
    v_exp_f32 v49, v49
    v_exp_f32 v50, v50
    v_exp_f32 v51, v51
    s_mov_b32 m0, s52
    s_add_u32 s52, s52, 16384
    buffer_load_dwordx4 v2, s[24:27], s58 offen lds
    s_add_u32 s58, s58, 18432
    v_mfma_f32_32x32x16_bf16 v[196:211], v[32:35], v[84:87], v[196:211]
    v_exp_f32 v52, v52
    v_exp_f32 v53, v53
    v_exp_f32 v54, v54
    v_exp_f32 v55, v55
    ds_read_b128 v[28:31], v6 offset:2304
    ds_read_b128 v[32:35], v6 offset:2880
    v_mfma_f32_32x32x16_bf16 v[64:79], v[16:19], v[88:91], 0
    v_exp_f32 v56, v56
    v_exp_f32 v57, v57
    v_exp_f32 v58, v58
    v_exp_f32 v59, v59
    s_mov_b32 m0, s54
    s_add_u32 s54, s54, 2048
    buffer_load_dword v3, s[24:27], s60 offen lds
    s_add_u32 s60, s60, 18432
    v_mfma_f32_32x32x8bf16_1k v[64:79], v[24:25], v[92:93], v[64:79]
    ds_read_b128 v[16:19], v4 offset:8192
    ds_read_b32 v24, v5 offset:1024
    v_exp_f32 v60, v60
    v_exp_f32 v61, v61
    v_exp_f32 v62, v62
    v_exp_f32 v63, v63
    v_cvt_pk_bf16_f32 v80, v48, v49
    v_cvt_pk_bf16_f32 v81, v50, v51
    v_cvt_pk_bf16_f32 v82, v52, v53
    v_cvt_pk_bf16_f32 v83, v54, v55
    v_cvt_pk_bf16_f32 v84, v56, v57
    v_cvt_pk_bf16_f32 v85, v58, v59
    v_cvt_pk_bf16_f32 v86, v60, v61
    v_cvt_pk_bf16_f32 v87, v62, v63
    s_waitcnt lgkmcnt(2)
    v_mfma_f32_32x32x16_bf16 v[96:111], v[28:31], v[80:83], v[96:111]
    v_exp_f32 v64, v64
    v_exp_f32 v65, v65
    v_exp_f32 v66, v66
    v_exp_f32 v67, v67
    s_mov_b32 m0, s55
    s_add_u32 s55, s55, 18432
    buffer_load_dwordx4 v2, s[24:27], s61 offen lds
    s_add_u32 s61, s61, 18432
    v_mfma_f32_32x32x16_bf16 v[96:111], v[32:35], v[84:87], v[96:111]
    v_exp_f32 v68, v68
    v_exp_f32 v69, v69
    v_exp_f32 v70, v70
    v_add_u32 v6, v47, v6
    v_exp_f32 v71, v71
    s_waitcnt lgkmcnt(0)
    v_mfma_f32_32x32x16_bf16 v[48:63], v[16:19], v[8:11], 0
    v_exp_f32 v72, v72
    v_exp_f32 v73, v73
    v_exp_f32 v74, v74
    v_exp_f32 v75, v75
    s_mov_b32 m0, s53
    s_add_u32 s53, s53, 16384
    buffer_load_dwordx4 v2, s[24:27], s59 offen lds
    s_add_u32 s59, s59, 18432
    v_mfma_f32_32x32x8bf16_1k v[48:63], v[24:25], v[12:13], v[48:63]
    v_exp_f32 v76, v76
    v_exp_f32 v77, v77
    v_exp_f32 v78, v78
    v_exp_f32 v79, v79
    v_cvt_pk_bf16_f32 v80, v64, v65
    v_cvt_pk_bf16_f32 v81, v66, v67
    v_cvt_pk_bf16_f32 v82, v68, v69
    v_cvt_pk_bf16_f32 v83, v70, v71
    v_cvt_pk_bf16_f32 v84, v72, v73
    v_cvt_pk_bf16_f32 v85, v74, v75
    v_cvt_pk_bf16_f32 v86, v76, v77
    v_cvt_pk_bf16_f32 v87, v78, v79
    v_mfma_f32_32x32x16_bf16 v[196:211], v[28:31], v[80:83], v[196:211]
    v_exp_f32 v48, v48
    v_exp_f32 v49, v49
    v_exp_f32 v50, v50
    v_exp_f32 v51, v51
    s_mov_b32 m0, s56
    s_add_u32 s56, s56, 18432
    buffer_load_dwordx4 v2, s[24:27], s62 offen lds
    s_add_u32 s62, s62, 18432
    v_mfma_f32_32x32x16_bf16 v[196:211], v[32:35], v[84:87], v[196:211]
    v_exp_f32 v52, v52
    v_exp_f32 v53, v53
    v_exp_f32 v54, v54
    v_exp_f32 v55, v55
    ds_read_b128 v[28:31], v6 offset:0
    ds_read_b128 v[32:35], v6 offset:576
    v_mfma_f32_32x32x16_bf16 v[64:79], v[16:19], v[88:91], 0
    v_exp_f32 v56, v56
    v_exp_f32 v57, v57
    v_exp_f32 v58, v58
    v_exp_f32 v59, v59
    s_cmp_ge_u32 s40, 2
    s_cbranch_scc1 L_ld5_4
    s_mov_b32 m0, s57
    s_add_u32 s57, s57, 18432
    buffer_load_dwordx4 v2, s[24:27], s63 offen lds
    s_add_u32 s63, s63, 18432
L_ld5_4:
    v_mfma_f32_32x32x8bf16_1k v[64:79], v[24:25], v[92:93], v[64:79]
    ds_read_b128 v[16:19], v4 offset:10240
    ds_read_b32 v24, v5 offset:1280
    v_exp_f32 v60, v60
    v_exp_f32 v61, v61
    v_exp_f32 v62, v62
    v_exp_f32 v63, v63
    v_cvt_pk_bf16_f32 v80, v48, v49
    v_cvt_pk_bf16_f32 v81, v50, v51
    v_cvt_pk_bf16_f32 v82, v52, v53
    v_cvt_pk_bf16_f32 v83, v54, v55
    v_cvt_pk_bf16_f32 v84, v56, v57
    v_cvt_pk_bf16_f32 v85, v58, v59
    v_cvt_pk_bf16_f32 v86, v60, v61
    v_cvt_pk_bf16_f32 v87, v62, v63
    s_setprio 1
    s_waitcnt lgkmcnt(2)
    v_mfma_f32_32x32x16_bf16 v[96:111], v[28:31], v[80:83], v[96:111]
    v_exp_f32 v64, v64
    v_exp_f32 v65, v65
    v_exp_f32 v66, v66
    v_exp_f32 v67, v67
    v_mov_b32 v144, -1
    v_mov_b32 v145, -1
    v_mov_b32 v146, -1
    v_mov_b32 v147, -1
    s_lshl_b32 s44, s2, 3
    s_add_u32 s44, s44, s40
    s_mul_i32 s44, s44, 2304
    s_add_u32 s44, s44, 7077888
    buffer_store_dwordx4 v[144:147], v2, s[24:27], s44 offen offset:0 sc1
    buffer_store_dwordx4 v[144:147], v2, s[24:27], s44 offen offset:1024 sc1
    s_mov_b64 exec, 0xffff
    buffer_store_dwordx4 v[144:147], v2, s[24:27], s44 offen offset:2048 sc1
    s_mov_b64 exec, -1
    v_mfma_f32_32x32x16_bf16 v[96:111], v[32:35], v[84:87], v[96:111]
    v_exp_f32 v68, v68
    v_exp_f32 v69, v69
    v_exp_f32 v70, v70
    v_exp_f32 v71, v71
    s_waitcnt lgkmcnt(0)
    v_mfma_f32_32x32x16_bf16 v[48:63], v[16:19], v[8:11], 0
    v_exp_f32 v72, v72
    v_exp_f32 v73, v73
    v_exp_f32 v74, v74
    v_exp_f32 v75, v75
    v_mfma_f32_32x32x8bf16_1k v[48:63], v[24:25], v[12:13], v[48:63]
    v_exp_f32 v76, v76
    v_exp_f32 v77, v77
    v_exp_f32 v78, v78
    v_exp_f32 v79, v79
    v_cvt_pk_bf16_f32 v80, v64, v65
    v_cvt_pk_bf16_f32 v81, v66, v67
    v_cvt_pk_bf16_f32 v82, v68, v69
    s_branch L_pgattn_kernel_1_s
.p2align 12
L_pgattn_kernel_1:
    s_branch L_hopattn_kernel_0
L_pgattn_kernel_1_s:
    v_cvt_pk_bf16_f32 v83, v70, v71
    v_cvt_pk_bf16_f32 v84, v72, v73
    v_cvt_pk_bf16_f32 v85, v74, v75
    v_cvt_pk_bf16_f32 v86, v76, v77
    v_cvt_pk_bf16_f32 v87, v78, v79
    v_mfma_f32_32x32x16_bf16 v[196:211], v[28:31], v[80:83], v[196:211]
    v_exp_f32 v48, v48
    v_exp_f32 v49, v49
    v_exp_f32 v50, v50
    v_exp_f32 v51, v51
    v_mfma_f32_32x32x16_bf16 v[196:211], v[32:35], v[84:87], v[196:211]
    v_exp_f32 v52, v52
    v_exp_f32 v53, v53
    v_exp_f32 v54, v54
    v_exp_f32 v55, v55
    ds_read_b128 v[28:31], v6 offset:2304
    ds_read_b128 v[32:35], v6 offset:2880
    v_mfma_f32_32x32x16_bf16 v[64:79], v[16:19], v[88:91], 0
    v_exp_f32 v56, v56
    v_exp_f32 v57, v57
    v_exp_f32 v58, v58
    v_exp_f32 v59, v59
    v_mfma_f32_32x32x8bf16_1k v[64:79], v[24:25], v[92:93], v[64:79]
    ds_read_b128 v[16:19], v4 offset:12288
    ds_read_b32 v24, v5 offset:1536
    v_exp_f32 v60, v60
    v_exp_f32 v61, v61
    v_exp_f32 v62, v62
    v_exp_f32 v63, v63
    v_cvt_pk_bf16_f32 v80, v48, v49
    v_cvt_pk_bf16_f32 v81, v50, v51
    v_cvt_pk_bf16_f32 v82, v52, v53
    v_cvt_pk_bf16_f32 v83, v54, v55
    v_cvt_pk_bf16_f32 v84, v56, v57
    v_cvt_pk_bf16_f32 v85, v58, v59
    v_cvt_pk_bf16_f32 v86, v60, v61
    v_cvt_pk_bf16_f32 v87, v62, v63
    s_setprio 0
    s_waitcnt lgkmcnt(2)
    v_mfma_f32_32x32x16_bf16 v[96:111], v[28:31], v[80:83], v[96:111]
    v_exp_f32 v64, v64
    v_exp_f32 v65, v65
    v_exp_f32 v66, v66
    v_exp_f32 v67, v67
    v_mfma_f32_32x32x16_bf16 v[96:111], v[32:35], v[84:87], v[96:111]
    v_exp_f32 v68, v68
    v_exp_f32 v69, v69
    v_exp_f32 v70, v70
    v_add_u32 v6, v47, v6
    v_exp_f32 v71, v71
    s_waitcnt lgkmcnt(0)
    v_mfma_f32_32x32x16_bf16 v[48:63], v[16:19], v[8:11], 0
    v_exp_f32 v72, v72
    v_exp_f32 v73, v73
    v_exp_f32 v74, v74
    v_exp_f32 v75, v75
    v_mfma_f32_32x32x8bf16_1k v[48:63], v[24:25], v[12:13], v[48:63]
    v_exp_f32 v76, v76
    v_exp_f32 v77, v77
    v_exp_f32 v78, v78
    v_exp_f32 v79, v79
    v_cvt_pk_bf16_f32 v80, v64, v65
    v_cvt_pk_bf16_f32 v81, v66, v67
    v_cvt_pk_bf16_f32 v82, v68, v69
    v_cvt_pk_bf16_f32 v83, v70, v71
    v_cvt_pk_bf16_f32 v84, v72, v73
    v_cvt_pk_bf16_f32 v85, v74, v75
    v_cvt_pk_bf16_f32 v86, v76, v77
    v_cvt_pk_bf16_f32 v87, v78, v79
    s_waitcnt vmcnt(0)
    s_barrier
    s_mov_b32 s93, 0
    s_mov_b32 s94, 0
    s_mov_b32 s85, 0
    s_mov_b32 s86, 0
    s_mov_b32 s90, 0
    s_mov_b32 s91, 0
    s_mov_b32 s101, 0
    s_lshr_b32 s44, s2, 1
    s_bitcmp1_b32 s2, 0
    s_cselect_b32 s45, 3, 6
    s_mul_i32 s84, s44, s45
    s_cselect_b32 s44, 768, 0
    s_add_u32 s84, s84, s40
    s_add_u32 s84, s84, s44
    s_cmp_ge_u32 s40, s45
    s_cselect_b32 s84, 2000, s84
    s_cmp_ge_u32 s84, 648
    s_cselect_b32 s52, s18, s12
    s_cselect_b32 s53, s19, s13
    s_mov_b32 s54, 5308416
    s_cselect_b32 s54, 2654208, s54
    s_mov_b32 s55, 0x20000
    s_cmp_ge_u32 s84, 972
    s_cselect_b32 s52, s8, s52
    s_cselect_b32 s53, s9, s53
    s_cselect_b32 s54, 663552, s54
    s_add_u32 s56, s22, 26214400
    s_addc_u32 s57, s23, 0
    s_mov_b32 s58, 47185920
    s_mov_b32 s59, 0x20000
    s_cmp_ge_u32 s84, 1053
    s_cbranch_scc1 L_wj_skip1
    s_mov_b32 s88, 4
    s_mov_b32 s89, 2
    s_mov_b32 s90, 16
    s_mov_b32 s91, 8
    s_cmp_ge_u32 s84, 648
    s_cbranch_scc1 L_wj_b
    s_mul_i32 s85, s84, 911
    s_lshr_b32 s85, s85, 16
    s_mul_i32 s86, s85, 72
    s_sub_u32 s86, s84, s86
    s_mov_b32 s87, 9216
    s_mul_i32 s93, s85, 589824
    s_mul_i32 s96, s86, 7282
    s_lshr_b32 s96, s96, 16
    s_mul_i32 s97, s96, 9
    s_sub_u32 s97, s86, s97
    s_cmp_ge_u32 s96, 4
    s_cselect_b32 s94, 5474304, 0
    s_sub_u32 s94, 26214400, s94
    s_mul_i32 s96, s96, 1327104
    s_add_u32 s94, s94, s96
    s_mov_b32 s100, 18432
    s_branch L_wj_go
L_wj_b:
    s_mov_b32 s87, 1152
    s_mov_b32 s100, 9216
    s_cmp_ge_u32 s84, 972
    s_cbranch_scc1 L_wj_c
    s_sub_u32 s86, s84, 648
    s_mul_i32 s85, s86, 7282
    s_lshr_b32 s85, s85, 16
    s_mul_i32 s93, s85, 9
    s_sub_u32 s86, s86, s93
    s_and_b32 s93, s85, 3
    s_mul_i32 s93, s93, 36
    s_lshr_b32 s94, s85, 3
    s_lshl_b32 s94, s94, 1
    s_add_u32 s93, s93, s94
    s_bfe_u32 s94, s85, 0x10002
    s_mul_i32 s94, s94, 18
    s_add_u32 s93, s93, s94
    s_mul_i32 s93, s93, 18432
    s_cmp_ge_u32 s85, 32
    s_cselect_b32 s90, 144, 16
    s_cselect_b32 s101, 0, 145408
    s_mov_b32 s94, 32339968
    s_add_u32 s97, s86, 9
    s_branch L_wj_go
L_wj_c:
    s_sub_u32 s86, s84, 972
    s_mul_i32 s85, s86, 7282
    s_lshr_b32 s85, s85, 16
    s_mul_i32 s93, s85, 9
    s_sub_u32 s86, s86, s93
    s_mul_i32 s93, s85, 82944
    s_mov_b32 s94, 35485696
    s_add_u32 s97, s86, 18
    s_mov_b32 s88, 8
    s_mov_b32 s90, 18
    s_mov_b32 s91, 4
    s_cmp_lt_u32 s85, 8
    s_cbranch_scc1 L_wj_go
    s_mov_b32 s88, 36
    s_mov_b32 s89, 18
    s_mov_b32 s90, 144
    s_mov_b32 s91, 72
    s_mov_b32 s93, 18432
L_wj_go:
    s_lshl_b32 s97, s97, 10
    s_add_u32 s97, s97, 524288
    buffer_load_dwordx4 v[212:215], v2, s[56:59], s97 offen
    s_lshl_b32 s44, s86, 7
    s_add_u32 s93, s93, s44
    s_sub_u32 s90, s90, s91
    s_mul_i32 s90, s90, s87
    s_mul_i32 s91, s91, s87
    v_mad_u32_u24 v112, v216, s88, v218
    v_mad_u32_u24 v112, v217, s89, v112
    v_mad_u32_u24 v180, v112, s87, v219
    s_mul_i32 s44, s85, s100
    s_add_u32 s94, s94, s44
L_wj_skip1:
    s_setprio 3
    v_mfma_f32_32x32x16_bf16 v[196:211], v[28:31], v[80:83], v[196:211]
    v_exp_f32 v48, v48
    v_exp_f32 v49, v49
    v_exp_f32 v50, v50
    v_exp_f32 v51, v51
    buffer_load_dwordx4 v[120:123], v137, s[32:35], s51 offen offset:0
    v_mfma_f32_32x32x16_bf16 v[196:211], v[32:35], v[84:87], v[196:211]
    v_exp_f32 v52, v52
    v_exp_f32 v53, v53
    v_exp_f32 v54, v54
    v_exp_f32 v55, v55
    ds_read_b128 v[28:31], v6 offset:0
    ds_read_b128 v[32:35], v6 offset:576
    v_mfma_f32_32x32x16_bf16 v[64:79], v[16:19], v[88:91], 0
    v_exp_f32 v56, v56
    v_exp_f32 v57, v57
    v_exp_f32 v58, v58
    v_exp_f32 v59, v59
    v_mfma_f32_32x32x8bf16_1k v[64:79], v[24:25], v[92:93], v[64:79]
    ds_read_b128 v[16:19], v4 offset:14336
    ds_read_b32 v24, v5 offset:1792
    v_exp_f32 v60, v60
    v_exp_f32 v61, v61
    v_exp_f32 v62, v62
    v_exp_f32 v63, v63
    v_cvt_pk_bf16_f32 v80, v48, v49
    v_cvt_pk_bf16_f32 v81, v50, v51
    v_cvt_pk_bf16_f32 v82, v52, v53
    v_cvt_pk_bf16_f32 v83, v54, v55
    v_cvt_pk_bf16_f32 v84, v56, v57
    v_cvt_pk_bf16_f32 v85, v58, v59
    v_cvt_pk_bf16_f32 v86, v60, v61
    v_cvt_pk_bf16_f32 v87, v62, v63
    s_waitcnt lgkmcnt(2)
    v_mfma_f32_32x32x16_bf16 v[96:111], v[28:31], v[80:83], v[96:111]
    v_exp_f32 v64, v64
    v_exp_f32 v65, v65
    v_exp_f32 v66, v66
    v_exp_f32 v67, v67
    buffer_load_dwordx4 v[124:127], v137, s[32:35], s51 offen offset:128
    v_mfma_f32_32x32x16_bf16 v[96:111], v[32:35], v[84:87], v[96:111]
    v_exp_f32 v68, v68
    v_exp_f32 v69, v69
    v_exp_f32 v70, v70
    v_exp_f32 v71, v71
    s_waitcnt lgkmcnt(0)
    v_mfma_f32_32x32x16_bf16 v[48:63], v[16:19], v[8:11], 0
    v_exp_f32 v72, v72
    v_exp_f32 v73, v73
    v_exp_f32 v74, v74
    v_exp_f32 v75, v75
    v_mfma_f32_32x32x8bf16_1k v[48:63], v[24:25], v[12:13], v[48:63]
    v_exp_f32 v76, v76
    v_exp_f32 v77, v77
    v_exp_f32 v78, v78
    v_exp_f32 v79, v79
    v_cvt_pk_bf16_f32 v80, v64, v65
    v_cvt_pk_bf16_f32 v81, v66, v67
    v_cvt_pk_bf16_f32 v82, v68, v69
    v_cvt_pk_bf16_f32 v83, v70, v71
    v_cvt_pk_bf16_f32 v84, v72, v73
    v_cvt_pk_bf16_f32 v85, v74, v75
    v_cvt_pk_bf16_f32 v86, v76, v77
    v_cvt_pk_bf16_f32 v87, v78, v79
    v_mfma_f32_32x32x16_bf16 v[196:211], v[28:31], v[80:83], v[196:211]
    v_exp_f32 v48, v48
    v_exp_f32 v49, v49
    v_exp_f32 v50, v50
    v_exp_f32 v51, v51
    buffer_load_dwordx4 v[128:131], v137, s[32:35], s51 offen offset:256
    v_mfma_f32_32x32x16_bf16 v[196:211], v[32:35], v[84:87], v[196:211]
    v_exp_f32 v52, v52
    v_exp_f32 v53, v53
    v_exp_f32 v54, v54
    v_exp_f32 v55, v55
    ds_read_b128 v[28:31], v6 offset:2304
    ds_read_b128 v[32:35], v6 offset:2880
    v_mfma_f32_32x32x16_bf16 v[64:79], v[16:19], v[88:91], 0
    v_exp_f32 v56, v56
    v_exp_f32 v57, v57
    v_exp_f32 v58, v58
    v_exp_f32 v59, v59
    v_mfma_f32_32x32x8bf16_1k v[64:79], v[24:25], v[92:93], v[64:79]
    ds_read_b128 v[16:19], v4 offset:16384
    ds_read_b32 v24, v5 offset:2048
    v_exp_f32 v60, v60
    v_exp_f32 v61, v61
    v_exp_f32 v62, v62
    v_exp_f32 v63, v63
    v_cvt_pk_bf16_f32 v80, v48, v49
    v_cvt_pk_bf16_f32 v81, v50, v51
    v_cvt_pk_bf16_f32 v82, v52, v53
    v_cvt_pk_bf16_f32 v83, v54, v55
    v_cvt_pk_bf16_f32 v84, v56, v57
    v_cvt_pk_bf16_f32 v85, v58, v59
    v_cvt_pk_bf16_f32 v86, v60, v61
    v_cvt_pk_bf16_f32 v87, v62, v63
    s_waitcnt lgkmcnt(2)
    v_mfma_f32_32x32x16_bf16 v[96:111], v[28:31], v[80:83], v[96:111]
    v_exp_f32 v64, v64
    v_exp_f32 v65, v65
    v_exp_f32 v66, v66
    v_exp_f32 v67, v67
    buffer_load_dwordx4 v[132:135], v137, s[32:35], s51 offen offset:384
    v_mfma_f32_32x32x16_bf16 v[96:111], v[32:35], v[84:87], v[96:111]
    v_exp_f32 v68, v68
    v_exp_f32 v69, v69
    v_exp_f32 v70, v70
    v_add_u32 v6, v47, v6
    v_exp_f32 v71, v71
    s_waitcnt lgkmcnt(0)
    v_mfma_f32_32x32x16_bf16 v[48:63], v[16:19], v[8:11], 0
    v_exp_f32 v72, v72
    v_exp_f32 v73, v73
    v_exp_f32 v74, v74
    v_exp_f32 v75, v75
    v_mfma_f32_32x32x8bf16_1k v[48:63], v[24:25], v[12:13], v[48:63]
    v_exp_f32 v76, v76
    v_exp_f32 v77, v77
    v_exp_f32 v78, v78
    v_exp_f32 v79, v79
    v_cvt_pk_bf16_f32 v80, v64, v65
    v_cvt_pk_bf16_f32 v81, v66, v67
    v_cvt_pk_bf16_f32 v82, v68, v69
    v_cvt_pk_bf16_f32 v83, v70, v71
    v_cvt_pk_bf16_f32 v84, v72, v73
    v_cvt_pk_bf16_f32 v85, v74, v75
    v_cvt_pk_bf16_f32 v86, v76, v77
    v_cvt_pk_bf16_f32 v87, v78, v79
    v_mfma_f32_32x32x16_bf16 v[196:211], v[28:31], v[80:83], v[196:211]
    v_exp_f32 v48, v48
    v_exp_f32 v49, v49
    v_exp_f32 v50, v50
    v_exp_f32 v51, v51
    s_cmp_ge_u32 s84, 1053
    s_cbranch_scc1 L_wj_da
    s_add_u32 m0, s92, 0
    s_nop 0
    buffer_load_dwordx4 v180, s[52:55], s93 offen lds
    s_add_u32 s93, s93, s91
L_wj_da:
    v_mfma_f32_32x32x16_bf16 v[196:211], v[32:35], v[84:87], v[196:211]
    v_exp_f32 v52, v52
    v_exp_f32 v53, v53
    v_exp_f32 v54, v54
    v_exp_f32 v55, v55
    ds_read_b128 v[28:31], v6 offset:0
    ds_read_b128 v[32:35], v6 offset:576
    v_mfma_f32_32x32x16_bf16 v[64:79], v[16:19], v[88:91], 0
    v_exp_f32 v56, v56
    v_exp_f32 v57, v57
    v_exp_f32 v58, v58
    v_exp_f32 v59, v59
    v_mfma_f32_32x32x8bf16_1k v[64:79], v[24:25], v[92:93], v[64:79]
    ds_read_b128 v[16:19], v4 offset:18432
    ds_read_b32 v24, v5 offset:2304
    v_exp_f32 v60, v60
    v_exp_f32 v61, v61
    v_exp_f32 v62, v62
    v_exp_f32 v63, v63
    v_cvt_pk_bf16_f32 v80, v48, v49
    v_cvt_pk_bf16_f32 v81, v50, v51
    v_cvt_pk_bf16_f32 v82, v52, v53
    v_cvt_pk_bf16_f32 v83, v54, v55
    v_cvt_pk_bf16_f32 v84, v56, v57
    v_cvt_pk_bf16_f32 v85, v58, v59
    v_cvt_pk_bf16_f32 v86, v60, v61
    v_cvt_pk_bf16_f32 v87, v62, v63
    s_waitcnt lgkmcnt(2)
    v_mfma_f32_32x32x16_bf16 v[96:111], v[28:31], v[80:83], v[96:111]
    v_exp_f32 v64, v64
    v_exp_f32 v65, v65
    v_exp_f32 v66, v66
    v_exp_f32 v67, v67
    s_cmp_ge_u32 s84, 1053
    s_cbranch_scc1 L_wj_db
    s_add_u32 m0, s92, 1024
    s_nop 0
    buffer_load_dwordx4 v180, s[52:55], s93 offen lds
    s_add_u32 s93, s93, s90
    s_xor_b32 s90, s90, s101
L_wj_db:
    v_mfma_f32_32x32x16_bf16 v[96:111], v[32:35], v[84:87], v[96:111]
    v_exp_f32 v68, v68
    v_exp_f32 v69, v69
    v_exp_f32 v70, v70
    v_exp_f32 v71, v71
    s_waitcnt lgkmcnt(0)
    v_mfma_f32_32x32x16_bf16 v[48:63], v[16:19], v[8:11], 0
    v_exp_f32 v72, v72
    v_exp_f32 v73, v73
    v_exp_f32 v74, v74
    v_exp_f32 v75, v75
    v_mfma_f32_32x32x8bf16_1k v[48:63], v[24:25], v[12:13], v[48:63]
    v_exp_f32 v76, v76
    v_exp_f32 v77, v77
    v_exp_f32 v78, v78
    v_exp_f32 v79, v79
    v_cvt_pk_bf16_f32 v80, v64, v65
    v_cvt_pk_bf16_f32 v81, v66, v67
    v_cvt_pk_bf16_f32 v82, v68, v69
    v_cvt_pk_bf16_f32 v83, v70, v71
    v_cvt_pk_bf16_f32 v84, v72, v73
    v_cvt_pk_bf16_f32 v85, v74, v75
    v_cvt_pk_bf16_f32 v86, v76, v77
    v_cvt_pk_bf16_f32 v87, v78, v79
    v_mfma_f32_32x32x16_bf16 v[196:211], v[28:31], v[80:83], v[196:211]
    v_exp_f32 v48, v48
    v_exp_f32 v49, v49
    v_exp_f32 v50, v50
    v_exp_f32 v51, v51
    v_mfma_f32_32x32x16_bf16 v[196:211], v[32:35], v[84:87], v[196:211]
    v_exp_f32 v52, v52
    v_exp_f32 v53, v53
    v_exp_f32 v54, v54
    v_exp_f32 v55, v55
    ds_read_b128 v[28:31], v6 offset:2304
    ds_read_b128 v[32:35], v6 offset:2880
    v_mfma_f32_32x32x16_bf16 v[64:79], v[16:19], v[88:91], 0
    v_exp_f32 v56, v56
    v_exp_f32 v57, v57
    v_exp_f32 v58, v58
    v_exp_f32 v59, v59
    v_mfma_f32_32x32x8bf16_1k v[64:79], v[24:25], v[92:93], v[64:79]
    ds_read_b128 v[16:19], v4 offset:20480
    ds_read_b32 v24, v5 offset:2560
    v_exp_f32 v60, v60
    v_exp_f32 v61, v61
    v_exp_f32 v62, v62
    v_exp_f32 v63, v63
    v_cvt_pk_bf16_f32 v80, v48, v49
    v_cvt_pk_bf16_f32 v81, v50, v51
    v_cvt_pk_bf16_f32 v82, v52, v53
    v_cvt_pk_bf16_f32 v83, v54, v55
    v_cvt_pk_bf16_f32 v84, v56, v57
    v_cvt_pk_bf16_f32 v85, v58, v59
    v_cvt_pk_bf16_f32 v86, v60, v61
    v_cvt_pk_bf16_f32 v87, v62, v63
    s_waitcnt lgkmcnt(2)
    v_mfma_f32_32x32x16_bf16 v[96:111], v[28:31], v[80:83], v[96:111]
    v_exp_f32 v64, v64
    v_exp_f32 v65, v65
    v_exp_f32 v66, v66
    v_exp_f32 v67, v67
    v_mfma_f32_32x32x16_bf16 v[96:111], v[32:35], v[84:87], v[96:111]
    v_exp_f32 v68, v68
    v_exp_f32 v69, v69
    v_exp_f32 v70, v70
    v_add_u32 v6, v47, v6
    v_exp_f32 v71, v71
    s_waitcnt lgkmcnt(0)
    v_mfma_f32_32x32x16_bf16 v[48:63], v[16:19], v[8:11], 0
    v_exp_f32 v72, v72
    v_exp_f32 v73, v73
    v_exp_f32 v74, v74
    v_exp_f32 v75, v75
    v_mfma_f32_32x32x8bf16_1k v[48:63], v[24:25], v[12:13], v[48:63]
    v_exp_f32 v76, v76
    v_exp_f32 v77, v77
    v_exp_f32 v78, v78
    v_exp_f32 v79, v79
    v_cvt_pk_bf16_f32 v80, v64, v65
    v_cvt_pk_bf16_f32 v81, v66, v67
    v_cvt_pk_bf16_f32 v82, v68, v69
    v_cvt_pk_bf16_f32 v83, v70, v71
    v_cvt_pk_bf16_f32 v84, v72, v73
    v_cvt_pk_bf16_f32 v85, v74, v75
    v_cvt_pk_bf16_f32 v86, v76, v77
    v_cvt_pk_bf16_f32 v87, v78, v79
    v_mfma_f32_32x32x16_bf16 v[196:211], v[28:31], v[80:83], v[196:211]
    v_exp_f32 v48, v48
    v_exp_f32 v49, v49
    v_exp_f32 v50, v50
    v_exp_f32 v51, v51
    v_mfma_f32_32x32x16_bf16 v[196:211], v[32:35], v[84:87], v[196:211]
    v_exp_f32 v52, v52
    v_exp_f32 v53, v53
    v_exp_f32 v54, v54
    v_exp_f32 v55, v55
    ds_read_b128 v[28:31], v6 offset:0
    ds_read_b128 v[32:35], v6 offset:576
    v_mfma_f32_32x32x16_bf16 v[64:79], v[16:19], v[88:91], 0
    v_exp_f32 v56, v56
    v_exp_f32 v57, v57
    v_exp_f32 v58, v58
    v_exp_f32 v59, v59
    v_mfma_f32_32x32x8bf16_1k v[64:79], v[24:25], v[92:93], v[64:79]
    ds_read_b128 v[16:19], v4 offset:22528
    ds_read_b32 v24, v5 offset:2816
    v_exp_f32 v60, v60
    v_exp_f32 v61, v61
    v_exp_f32 v62, v62
    v_exp_f32 v63, v63
    v_cvt_pk_bf16_f32 v80, v48, v49
    v_cvt_pk_bf16_f32 v81, v50, v51
    v_cvt_pk_bf16_f32 v82, v52, v53
    v_cvt_pk_bf16_f32 v83, v54, v55
    v_cvt_pk_bf16_f32 v84, v56, v57
    v_cvt_pk_bf16_f32 v85, v58, v59
    v_cvt_pk_bf16_f32 v86, v60, v61
    v_cvt_pk_bf16_f32 v87, v62, v63
    s_waitcnt lgkmcnt(2)
    v_mfma_f32_32x32x16_bf16 v[96:111], v[28:31], v[80:83], v[96:111]
    v_exp_f32 v64, v64
    v_exp_f32 v65, v65
    v_exp_f32 v66, v66
    v_exp_f32 v67, v67
    v_mfma_f32_32x32x16_bf16 v[96:111], v[32:35], v[84:87], v[96:111]
    v_exp_f32 v68, v68
    v_exp_f32 v69, v69
    v_exp_f32 v70, v70
    v_exp_f32 v71, v71
    s_waitcnt lgkmcnt(0)
    v_mfma_f32_32x32x16_bf16 v[48:63], v[16:19], v[8:11], 0
    v_exp_f32 v72, v72
    v_exp_f32 v73, v73
    v_exp_f32 v74, v74
    v_exp_f32 v75, v75
    v_mfma_f32_32x32x8bf16_1k v[48:63], v[24:25], v[12:13], v[48:63]
    v_exp_f32 v76, v76
    v_exp_f32 v77, v77
    v_exp_f32 v78, v78
    v_exp_f32 v79, v79
    v_cvt_pk_bf16_f32 v80, v64, v65
    v_cvt_pk_bf16_f32 v81, v66, v67
    v_cvt_pk_bf16_f32 v82, v68, v69
    v_cvt_pk_bf16_f32 v83, v70, v71
    v_cvt_pk_bf16_f32 v84, v72, v73
    v_cvt_pk_bf16_f32 v85, v74, v75
    v_cvt_pk_bf16_f32 v86, v76, v77
    v_cvt_pk_bf16_f32 v87, v78, v79
    v_mfma_f32_32x32x16_bf16 v[196:211], v[28:31], v[80:83], v[196:211]
    v_exp_f32 v48, v48
    v_exp_f32 v49, v49
    v_exp_f32 v50, v50
    v_exp_f32 v51, v51
    v_mfma_f32_32x32x16_bf16 v[196:211], v[32:35], v[84:87], v[196:211]
    v_exp_f32 v52, v52
    v_exp_f32 v53, v53
    v_exp_f32 v54, v54
    v_exp_f32 v55, v55
    ds_read_b128 v[28:31], v6 offset:2304
    ds_read_b128 v[32:35], v6 offset:2880
    v_mfma_f32_32x32x16_bf16 v[64:79], v[16:19], v[88:91], 0
    v_exp_f32 v56, v56
    v_exp_f32 v57, v57
    v_exp_f32 v58, v58
    v_exp_f32 v59, v59
    v_mfma_f32_32x32x8bf16_1k v[64:79], v[24:25], v[92:93], v[64:79]
    ds_read_b128 v[16:19], v4 offset:24576
    ds_read_b32 v24, v5 offset:3072
    v_exp_f32 v60, v60
    v_exp_f32 v61, v61
    v_exp_f32 v62, v62
    v_exp_f32 v63, v63
    v_cvt_pk_bf16_f32 v80, v48, v49
    v_cvt_pk_bf16_f32 v81, v50, v51
    v_cvt_pk_bf16_f32 v82, v52, v53
    v_cvt_pk_bf16_f32 v83, v54, v55
    v_cvt_pk_bf16_f32 v84, v56, v57
    v_cvt_pk_bf16_f32 v85, v58, v59
    v_cvt_pk_bf16_f32 v86, v60, v61
    v_cvt_pk_bf16_f32 v87, v62, v63
    s_waitcnt lgkmcnt(2)
    v_mfma_f32_32x32x16_bf16 v[96:111], v[28:31], v[80:83], v[96:111]
    v_exp_f32 v64, v64
    v_exp_f32 v65, v65
    v_exp_f32 v66, v66
    v_exp_f32 v67, v67
    v_mfma_f32_32x32x16_bf16 v[96:111], v[32:35], v[84:87], v[96:111]
    v_exp_f32 v68, v68
    v_exp_f32 v69, v69
    v_exp_f32 v70, v70
    v_add_u32 v6, v47, v6
    v_exp_f32 v71, v71
    s_waitcnt lgkmcnt(0)
    v_mfma_f32_32x32x16_bf16 v[48:63], v[16:19], v[8:11], 0
    v_exp_f32 v72, v72
    v_exp_f32 v73, v73
    v_exp_f32 v74, v74
    v_exp_f32 v75, v75
    v_mfma_f32_32x32x8bf16_1k v[48:63], v[24:25], v[12:13], v[48:63]
    v_exp_f32 v76, v76
    v_exp_f32 v77, v77
    v_exp_f32 v78, v78
    v_exp_f32 v79, v79
    v_cvt_pk_bf16_f32 v80, v64, v65
    v_cvt_pk_bf16_f32 v81, v66, v67
    v_cvt_pk_bf16_f32 v82, v68, v69
    v_cvt_pk_bf16_f32 v83, v70, v71
    v_cvt_pk_bf16_f32 v84, v72, v73
    v_cvt_pk_bf16_f32 v85, v74, v75
    v_cvt_pk_bf16_f32 v86, v76, v77
    v_cvt_pk_bf16_f32 v87, v78, v79
    v_mfma_f32_32x32x16_bf16 v[196:211], v[28:31], v[80:83], v[196:211]
    v_exp_f32 v48, v48
    v_exp_f32 v49, v49
    v_exp_f32 v50, v50
    v_exp_f32 v51, v51
    v_mfma_f32_32x32x16_bf16 v[196:211], v[32:35], v[84:87], v[196:211]
    v_exp_f32 v52, v52
    v_exp_f32 v53, v53
    v_exp_f32 v54, v54
    v_exp_f32 v55, v55
    ds_read_b128 v[28:31], v6 offset:0
    ds_read_b128 v[32:35], v6 offset:576
    v_mfma_f32_32x32x16_bf16 v[64:79], v[16:19], v[88:91], 0
    v_exp_f32 v56, v56
    v_exp_f32 v57, v57
    v_exp_f32 v58, v58
    v_exp_f32 v59, v59
    v_mfma_f32_32x32x8bf16_1k v[64:79], v[24:25], v[92:93], v[64:79]
    ds_read_b128 v[16:19], v4 offset:26624
    ds_read_b32 v24, v5 offset:3328
    v_exp_f32 v60, v60
    v_exp_f32 v61, v61
    v_exp_f32 v62, v62
    v_exp_f32 v63, v63
    v_cvt_pk_bf16_f32 v80, v48, v49
    v_cvt_pk_bf16_f32 v81, v50, v51
    v_cvt_pk_bf16_f32 v82, v52, v53
    v_cvt_pk_bf16_f32 v83, v54, v55
    v_cvt_pk_bf16_f32 v84, v56, v57
    v_cvt_pk_bf16_f32 v85, v58, v59
    v_cvt_pk_bf16_f32 v86, v60, v61
    v_cvt_pk_bf16_f32 v87, v62, v63
    s_waitcnt lgkmcnt(2)
    v_mfma_f32_32x32x16_bf16 v[96:111], v[28:31], v[80:83], v[96:111]
    v_exp_f32 v64, v64
    v_exp_f32 v65, v65
    v_exp_f32 v66, v66
    v_exp_f32 v67, v67
    v_mfma_f32_32x32x16_bf16 v[96:111], v[32:35], v[84:87], v[96:111]
    v_exp_f32 v68, v68
    v_exp_f32 v69, v69
    v_exp_f32 v70, v70
    v_add_u32 v4, 26624, v4
    v_add_u32 v5, 3328, v5
    v_add_u32 v6, v7, v6
    v_exp_f32 v71, v71
    s_waitcnt lgkmcnt(0)
    v_mfma_f32_32x32x16_bf16 v[48:63], v[16:19], v[8:11], 0
    v_exp_f32 v72, v72
    v_exp_f32 v73, v73
    v_exp_f32 v74, v74
    v_exp_f32 v75, v75
    v_mfma_f32_32x32x8bf16_1k v[48:63], v[24:25], v[12:13], v[48:63]
    v_exp_f32 v76, v76
    v_exp_f32 v77, v77
    v_exp_f32 v78, v78
    v_exp_f32 v79, v79
    v_cvt_pk_bf16_f32 v80, v64, v65
    v_cvt_pk_bf16_f32 v81, v66, v67
    v_cvt_pk_bf16_f32 v82, v68, v69
    v_cvt_pk_bf16_f32 v83, v70, v71
    v_cvt_pk_bf16_f32 v84, v72, v73
    v_cvt_pk_bf16_f32 v85, v74, v75
    v_cvt_pk_bf16_f32 v86, v76, v77
    v_cvt_pk_bf16_f32 v87, v78, v79
    s_mov_b32 s48, 4
    s_waitcnt vmcnt(0)
L_att3:
    v_mfma_f32_32x32x16_bf16 v[196:211], v[28:31], v[80:83], v[196:211]
    v_exp_f32 v48, v48
    v_exp_f32 v49, v49
    v_exp_f32 v50, v50
    v_exp_f32 v51, v51
    s_cmp_ge_u32 s84, 1053
    s_cbranch_scc1 L_wj_tx
    s_waitcnt vmcnt(2)
    ds_read_b64_tr_b16 v[160:161], v183 offset:0
    ds_read_b64_tr_b16 v[162:163], v183 offset:512
    ds_read_b64_tr_b16 v[164:165], v183 offset:64
    ds_read_b64_tr_b16 v[166:167], v183 offset:576
L_wj_tx:
    v_mfma_f32_32x32x16_bf16 v[196:211], v[32:35], v[84:87], v[196:211]
    v_exp_f32 v52, v52
    v_exp_f32 v53, v53
    v_exp_f32 v54, v54
    v_exp_f32 v55, v55
    ds_read_b128 v[28:31], v6 offset:0
    ds_read_b128 v[32:35], v6 offset:576
    v_mfma_f32_32x32x16_bf16 v[64:79], v[16:19], v[88:91], 0
    v_exp_f32 v56, v56
    v_exp_f32 v57, v57
    v_exp_f32 v58, v58
    v_exp_f32 v59, v59
    v_mfma_f32_32x32x8bf16_1k v[64:79], v[24:25], v[92:93], v[64:79]
    ds_read_b128 v[16:19], v4 offset:2048
    ds_read_b32 v24, v5 offset:256
    v_exp_f32 v60, v60
    v_exp_f32 v61, v61
    v_exp_f32 v62, v62
    v_exp_f32 v63, v63
    v_cvt_pk_bf16_f32 v80, v48, v49
    v_cvt_pk_bf16_f32 v81, v50, v51
    v_cvt_pk_bf16_f32 v82, v52, v53
    v_cvt_pk_bf16_f32 v83, v54, v55
    v_cvt_pk_bf16_f32 v84, v56, v57
    v_cvt_pk_bf16_f32 v85, v58, v59
    v_cvt_pk_bf16_f32 v86, v60, v61
    v_cvt_pk_bf16_f32 v87, v62, v63
    s_waitcnt lgkmcnt(2)
    v_mfma_f32_32x32x16_bf16 v[96:111], v[28:31], v[80:83], v[96:111]
    v_exp_f32 v64, v64
    v_exp_f32 v65, v65
    v_exp_f32 v66, v66
    v_exp_f32 v67, v67
    s_cmp_ge_u32 s84, 1053
    s_cbranch_scc1 L_wj_sx
    s_cmp_eq_u32 s48, 1
    s_cbranch_scc1 L_wj_ox
    s_mov_b32 m0, s92
    s_nop 0
    buffer_load_dwordx4 v180, s[52:55], s93 offen lds
    s_add_u32 s93, s93, s91
    s_add_u32 m0, s92, 1024
    s_nop 0
    buffer_load_dwordx4 v180, s[52:55], s93 offen lds
    s_add_u32 s93, s93, s90
    s_xor_b32 s90, s90, s101
L_wj_ox:
    v_mfma_f32_16x16x32_bf16 v[168:171], v[176:179], v[160:163], v[168:171]
    buffer_store_dwordx4 v[160:163], v212, s[56:59], s94 offen sc1
    v_mfma_f32_16x16x32_bf16 v[172:175], v[176:179], v[164:167], v[172:175]
    buffer_store_dwordx4 v[164:167], v213, s[56:59], s94 offen sc1
    s_bitcmp1_b32 s48, 0
    s_cselect_b32 s44, 1024, 0
    s_cselect_b32 s45, 1, 0
    s_sub_u32 s94, s94, s44
    s_branch L_pgattn_kernel_2_s
.p2align 12
L_pgattn_kernel_2:
    s_branch L_hopattn_kernel_0
L_pgattn_kernel_2_s:
    s_add_u32 s94, s94, 512
    v_mad_u32_u24 v212, v214, s45, v212
    v_mad_u32_u24 v213, v215, s45, v213
L_wj_sx:
    v_mfma_f32_32x32x16_bf16 v[96:111], v[32:35], v[84:87], v[96:111]
    v_exp_f32 v68, v68
    v_exp_f32 v69, v69
    v_exp_f32 v70, v70
    v_exp_f32 v71, v71
    s_waitcnt lgkmcnt(0)
    v_mfma_f32_32x32x16_bf16 v[48:63], v[16:19], v[8:11], 0
    v_exp_f32 v72, v72
    v_exp_f32 v73, v73
    v_exp_f32 v74, v74
    v_exp_f32 v75, v75
    v_mfma_f32_32x32x8bf16_1k v[48:63], v[24:25], v[12:13], v[48:63]
    v_exp_f32 v76, v76
    v_exp_f32 v77, v77
    v_exp_f32 v78, v78
    v_exp_f32 v79, v79
    v_cvt_pk_bf16_f32 v80, v64, v65
    v_cvt_pk_bf16_f32 v81, v66, v67
    v_cvt_pk_bf16_f32 v82, v68, v69
    v_cvt_pk_bf16_f32 v83, v70, v71
    v_cvt_pk_bf16_f32 v84, v72, v73
    v_cvt_pk_bf16_f32 v85, v74, v75
    v_cvt_pk_bf16_f32 v86, v76, v77
    v_cvt_pk_bf16_f32 v87, v78, v79
    v_mfma_f32_32x32x16_bf16 v[196:211], v[28:31], v[80:83], v[196:211]
    v_exp_f32 v48, v48
    v_exp_f32 v49, v49
    v_exp_f32 v50, v50
    v_exp_f32 v51, v51
    v_mfma_f32_32x32x16_bf16 v[196:211], v[32:35], v[84:87], v[196:211]
    v_exp_f32 v52, v52
    v_exp_f32 v53, v53
    v_exp_f32 v54, v54
    v_exp_f32 v55, v55
    ds_read_b128 v[28:31], v6 offset:2304
    ds_read_b128 v[32:35], v6 offset:2880
    v_mfma_f32_32x32x16_bf16 v[64:79], v[16:19], v[88:91], 0
    v_exp_f32 v56, v56
    v_exp_f32 v57, v57
    v_exp_f32 v58, v58
    v_exp_f32 v59, v59
    v_mfma_f32_32x32x8bf16_1k v[64:79], v[24:25], v[92:93], v[64:79]
    ds_read_b128 v[16:19], v4 offset:4096
    ds_read_b32 v24, v5 offset:512
    v_exp_f32 v60, v60
    v_exp_f32 v61, v61
    v_exp_f32 v62, v62
    v_exp_f32 v63, v63
    v_cvt_pk_bf16_f32 v80, v48, v49
    v_cvt_pk_bf16_f32 v81, v50, v51
    v_cvt_pk_bf16_f32 v82, v52, v53
    v_cvt_pk_bf16_f32 v83, v54, v55
    v_cvt_pk_bf16_f32 v84, v56, v57
    v_cvt_pk_bf16_f32 v85, v58, v59
    v_cvt_pk_bf16_f32 v86, v60, v61
    v_cvt_pk_bf16_f32 v87, v62, v63
    s_waitcnt lgkmcnt(2)
    v_mfma_f32_32x32x16_bf16 v[96:111], v[28:31], v[80:83], v[96:111]
    v_exp_f32 v64, v64
    v_exp_f32 v65, v65
    v_exp_f32 v66, v66
    v_exp_f32 v67, v67
    v_mfma_f32_32x32x16_bf16 v[96:111], v[32:35], v[84:87], v[96:111]
    v_exp_f32 v68, v68
    v_exp_f32 v69, v69
    v_exp_f32 v70, v70
    v_add_u32 v6, v47, v6
    v_exp_f32 v71, v71
    s_waitcnt lgkmcnt(0)
    v_mfma_f32_32x32x16_bf16 v[48:63], v[16:19], v[8:11], 0
    v_exp_f32 v72, v72
    v_exp_f32 v73, v73
    v_exp_f32 v74, v74
    v_exp_f32 v75, v75
    v_mfma_f32_32x32x8bf16_1k v[48:63], v[24:25], v[12:13], v[48:63]
    v_exp_f32 v76, v76
    v_exp_f32 v77, v77
    v_exp_f32 v78, v78
    v_exp_f32 v79, v79
    v_cvt_pk_bf16_f32 v80, v64, v65
    v_cvt_pk_bf16_f32 v81, v66, v67
    v_cvt_pk_bf16_f32 v82, v68, v69
    v_cvt_pk_bf16_f32 v83, v70, v71
    v_cvt_pk_bf16_f32 v84, v72, v73
    v_cvt_pk_bf16_f32 v85, v74, v75
    v_cvt_pk_bf16_f32 v86, v76, v77
    v_cvt_pk_bf16_f32 v87, v78, v79
    v_mfma_f32_32x32x16_bf16 v[196:211], v[28:31], v[80:83], v[196:211]
    v_exp_f32 v48, v48
    v_exp_f32 v49, v49
    v_exp_f32 v50, v50
    v_exp_f32 v51, v51
    v_mfma_f32_32x32x16_bf16 v[196:211], v[32:35], v[84:87], v[196:211]
    v_exp_f32 v52, v52
    v_exp_f32 v53, v53
    v_exp_f32 v54, v54
    v_exp_f32 v55, v55
    ds_read_b128 v[28:31], v6 offset:0
    ds_read_b128 v[32:35], v6 offset:576
    v_mfma_f32_32x32x16_bf16 v[64:79], v[16:19], v[88:91], 0
    v_exp_f32 v56, v56
    v_exp_f32 v57, v57
    v_exp_f32 v58, v58
    v_exp_f32 v59, v59
    v_mfma_f32_32x32x8bf16_1k v[64:79], v[24:25], v[92:93], v[64:79]
    ds_read_b128 v[16:19], v4 offset:6144
    ds_read_b32 v24, v5 offset:768
    v_exp_f32 v60, v60
    v_exp_f32 v61, v61
    v_exp_f32 v62, v62
    v_exp_f32 v63, v63
    v_cvt_pk_bf16_f32 v80, v48, v49
    v_cvt_pk_bf16_f32 v81, v50, v51
    v_cvt_pk_bf16_f32 v82, v52, v53
    v_cvt_pk_bf16_f32 v83, v54, v55
    v_cvt_pk_bf16_f32 v84, v56, v57
    v_cvt_pk_bf16_f32 v85, v58, v59
    v_cvt_pk_bf16_f32 v86, v60, v61
    v_cvt_pk_bf16_f32 v87, v62, v63
    s_waitcnt lgkmcnt(2)
    v_mfma_f32_32x32x16_bf16 v[96:111], v[28:31], v[80:83], v[96:111]
    v_exp_f32 v64, v64
    v_exp_f32 v65, v65
    v_exp_f32 v66, v66
    v_exp_f32 v67, v67
    v_mfma_f32_32x32x16_bf16 v[96:111], v[32:35], v[84:87], v[96:111]
    v_exp_f32 v68, v68
    v_exp_f32 v69, v69
    v_exp_f32 v70, v70
    v_add_u32 v4, 6144, v4
    v_add_u32 v5, 768, v5
    v_add_u32 v6, v7, v6
    v_exp_f32 v71, v71
    s_waitcnt lgkmcnt(0)
    v_mfma_f32_32x32x16_bf16 v[48:63], v[16:19], v[8:11], 0
    v_exp_f32 v72, v72
    v_exp_f32 v73, v73
    v_exp_f32 v74, v74
    v_exp_f32 v75, v75
    v_mfma_f32_32x32x8bf16_1k v[48:63], v[24:25], v[12:13], v[48:63]
    v_exp_f32 v76, v76
    v_exp_f32 v77, v77
    v_exp_f32 v78, v78
    v_exp_f32 v79, v79
    v_cvt_pk_bf16_f32 v80, v64, v65
    v_cvt_pk_bf16_f32 v81, v66, v67
    v_cvt_pk_bf16_f32 v82, v68, v69
    v_cvt_pk_bf16_f32 v83, v70, v71
    v_cvt_pk_bf16_f32 v84, v72, v73
    v_cvt_pk_bf16_f32 v85, v74, v75
    v_cvt_pk_bf16_f32 v86, v76, v77
    v_cvt_pk_bf16_f32 v87, v78, v79
    s_cmp_lg_u32 s48, 1
    s_cbranch_scc1 L_att_p3
    s_setprio 2
L_att_p3:
    s_sub_u32 s48, s48, 1
    s_cmp_lg_u32 s48, 0
    s_cbranch_scc1 L_att3
    v_mfma_f32_32x32x16_bf16 v[196:211], v[28:31], v[80:83], v[196:211]
    v_exp_f32 v48, v48
    v_exp_f32 v49, v49
    v_exp_f32 v50, v50
    v_exp_f32 v51, v51
    buffer_store_dwordx4 v[120:123], v136, s[36:39], s50 offen sc1
    s_add_u32 s50, s50, 4096
    v_mfma_f32_32x32x16_bf16 v[196:211], v[32:35], v[84:87], v[196:211]
    v_exp_f32 v52, v52
    v_exp_f32 v53, v53
    v_exp_f32 v54, v54
    v_exp_f32 v55, v55
    ds_read_b128 v[28:31], v6 offset:0
    ds_read_b128 v[32:35], v6 offset:576
    v_mfma_f32_32x32x16_bf16 v[64:79], v[16:19], v[88:91], 0
    v_exp_f32 v56, v56
    v_exp_f32 v57, v57
    v_exp_f32 v58, v58
    v_exp_f32 v59, v59
    v_mfma_f32_32x32x8bf16_1k v[64:79], v[24:25], v[92:93], v[64:79]
    ds_read_b128 v[16:19], v4 offset:2048
    ds_read_b32 v24, v5 offset:256
    v_exp_f32 v60, v60
    v_exp_f32 v61, v61
    v_exp_f32 v62, v62
    v_exp_f32 v63, v63
    v_cvt_pk_bf16_f32 v80, v48, v49
    v_cvt_pk_bf16_f32 v81, v50, v51
    v_cvt_pk_bf16_f32 v82, v52, v53
    v_cvt_pk_bf16_f32 v83, v54, v55
    v_cvt_pk_bf16_f32 v84, v56, v57
    v_cvt_pk_bf16_f32 v85, v58, v59
    v_cvt_pk_bf16_f32 v86, v60, v61
    v_cvt_pk_bf16_f32 v87, v62, v63
    s_waitcnt lgkmcnt(2)
    v_mfma_f32_32x32x16_bf16 v[96:111], v[28:31], v[80:83], v[96:111]
    v_exp_f32 v64, v64
    v_exp_f32 v65, v65
    v_exp_f32 v66, v66
    v_exp_f32 v67, v67
    buffer_store_dwordx4 v[124:127], v136, s[36:39], s50 offen sc1
    s_add_u32 s50, s50, 4096
    v_mfma_f32_32x32x16_bf16 v[96:111], v[32:35], v[84:87], v[96:111]
    v_exp_f32 v68, v68
    v_exp_f32 v69, v69
    v_exp_f32 v70, v70
    v_exp_f32 v71, v71
    s_waitcnt lgkmcnt(0)
    v_mfma_f32_32x32x16_bf16 v[48:63], v[16:19], v[8:11], 0
    v_exp_f32 v72, v72
    v_exp_f32 v73, v73
    v_exp_f32 v74, v74
    v_exp_f32 v75, v75
    v_mfma_f32_32x32x8bf16_1k v[48:63], v[24:25], v[12:13], v[48:63]
    v_exp_f32 v76, v76
    v_exp_f32 v77, v77
    v_exp_f32 v78, v78
    v_exp_f32 v79, v79
    v_cvt_pk_bf16_f32 v80, v64, v65
    v_cvt_pk_bf16_f32 v81, v66, v67
    v_cvt_pk_bf16_f32 v82, v68, v69
    v_cvt_pk_bf16_f32 v83, v70, v71
    v_cvt_pk_bf16_f32 v84, v72, v73
    v_cvt_pk_bf16_f32 v85, v74, v75
    v_cvt_pk_bf16_f32 v86, v76, v77
    v_cvt_pk_bf16_f32 v87, v78, v79
    v_mfma_f32_32x32x16_bf16 v[196:211], v[28:31], v[80:83], v[196:211]
    v_exp_f32 v48, v48
    v_exp_f32 v49, v49
    v_exp_f32 v50, v50
    v_exp_f32 v51, v51
    buffer_store_dwordx4 v[128:131], v136, s[36:39], s50 offen sc1
    s_add_u32 s50, s50, 4096
    v_mfma_f32_32x32x16_bf16 v[196:211], v[32:35], v[84:87], v[196:211]
    v_exp_f32 v52, v52
    v_exp_f32 v53, v53
    v_exp_f32 v54, v54
    v_exp_f32 v55, v55
    ds_read_b128 v[28:31], v6 offset:2304
    ds_read_b128 v[32:35], v6 offset:2880
    v_mfma_f32_32x32x16_bf16 v[64:79], v[16:19], v[88:91], 0
    v_exp_f32 v56, v56
    v_exp_f32 v57, v57
    v_exp_f32 v58, v58
    v_exp_f32 v59, v59
    v_mfma_f32_32x32x8bf16_1k v[64:79], v[24:25], v[92:93], v[64:79]
    ds_read_b128 v[16:19], v4 offset:4096
    ds_read_b32 v24, v5 offset:512
    v_exp_f32 v60, v60
    v_exp_f32 v61, v61
    v_exp_f32 v62, v62
    v_exp_f32 v63, v63
    v_cvt_pk_bf16_f32 v80, v48, v49
    v_cvt_pk_bf16_f32 v81, v50, v51
    v_cvt_pk_bf16_f32 v82, v52, v53
    v_cvt_pk_bf16_f32 v83, v54, v55
    v_cvt_pk_bf16_f32 v84, v56, v57
    v_cvt_pk_bf16_f32 v85, v58, v59
    v_cvt_pk_bf16_f32 v86, v60, v61
    v_cvt_pk_bf16_f32 v87, v62, v63
    s_waitcnt lgkmcnt(2)
    v_mfma_f32_32x32x16_bf16 v[96:111], v[28:31], v[80:83], v[96:111]
    v_exp_f32 v64, v64
    v_exp_f32 v65, v65
    v_exp_f32 v66, v66
    v_exp_f32 v67, v67
    buffer_store_dwordx4 v[132:135], v136, s[36:39], s50 offen sc1
    v_mfma_f32_32x32x16_bf16 v[96:111], v[32:35], v[84:87], v[96:111]
    v_exp_f32 v68, v68
    v_exp_f32 v69, v69
    v_exp_f32 v70, v70
    v_add_u32 v6, v47, v6
    v_exp_f32 v71, v71
    s_waitcnt lgkmcnt(0)
    v_mfma_f32_32x32x16_bf16 v[48:63], v[16:19], v[8:11], 0
    v_exp_f32 v72, v72
    v_exp_f32 v73, v73
    v_exp_f32 v74, v74
    v_exp_f32 v75, v75
    v_mfma_f32_32x32x8bf16_1k v[48:63], v[24:25], v[12:13], v[48:63]
    v_exp_f32 v76, v76
    v_exp_f32 v77, v77
    v_exp_f32 v78, v78
    v_exp_f32 v79, v79
    v_cvt_pk_bf16_f32 v80, v64, v65
    v_cvt_pk_bf16_f32 v81, v66, v67
    v_cvt_pk_bf16_f32 v82, v68, v69
    v_cvt_pk_bf16_f32 v83, v70, v71
    v_cvt_pk_bf16_f32 v84, v72, v73
    v_cvt_pk_bf16_f32 v85, v74, v75
    v_cvt_pk_bf16_f32 v86, v76, v77
    v_cvt_pk_bf16_f32 v87, v78, v79
    v_mfma_f32_32x32x16_bf16 v[196:211], v[28:31], v[80:83], v[196:211]
    v_exp_f32 v48, v48
    v_exp_f32 v49, v49
    v_exp_f32 v50, v50
    v_exp_f32 v51, v51
    s_cmp_lt_u32 s40, 5
    s_cbranch_scc1 L_wj_ns
    v_mov_b32 v160, -1.0
    v_mov_b32 v161, -1.0
    v_mov_b32 v162, -1.0
    v_mov_b32 v163, -1.0
    s_lshl_b32 s44, s2, 10
    s_cmp_eq_u32 s40, 6
    s_cselect_b32 s45, 46137344, 0
    s_add_u32 s44, s44, s45
    s_cmp_eq_u32 s40, 5
    s_cselect_b32 s45, 46399488, 0
    s_add_u32 s44, s44, s45
    buffer_store_dwordx4 v[160:163], v2, s[56:59], s44 offen sc1
L_wj_ns:
    s_add_u32 s52, s22, 16252928
    s_addc_u32 s53, s23, 0
    s_mov_b32 s54, 165888
    s_mov_b32 s55, 0x20000
    v_lshlrev_b32 v184, 2, v1
    s_cmp_ge_u32 s84, 648
    s_cbranch_scc1 L_wj_skip2
    s_mul_i32 s44, s85, 18432
    s_lshl_b32 s45, s86, 8
    s_add_u32 s44, s44, s45
    s_mov_b64 exec, 0xffff
    buffer_store_dword v168, v184, s[52:55], s44 offen
    buffer_store_dword v169, v184, s[52:55], s44 offen offset:64
    buffer_store_dword v172, v184, s[52:55], s44 offen offset:128
    buffer_store_dword v173, v184, s[52:55], s44 offen offset:192
    s_mov_b64 exec, -1
L_wj_skip2:
    v_mfma_f32_32x32x16_bf16 v[196:211], v[32:35], v[84:87], v[196:211]
    v_exp_f32 v52, v52
    v_exp_f32 v53, v53
    v_exp_f32 v54, v54
    v_exp_f32 v55, v55
    ds_read_b128 v[28:31], v6 offset:0
    ds_read_b128 v[32:35], v6 offset:576
    v_mfma_f32_32x32x16_bf16 v[64:79], v[16:19], v[88:91], 0
    v_exp_f32 v56, v56
    v_exp_f32 v57, v57
    v_exp_f32 v58, v58
    v_exp_f32 v59, v59
    v_mfma_f32_32x32x8bf16_1k v[64:79], v[24:25], v[92:93], v[64:79]
    ds_read_b128 v[16:19], v4 offset:6144
    ds_read_b32 v24, v5 offset:768
    v_exp_f32 v60, v60
    v_exp_f32 v61, v61
    v_exp_f32 v62, v62
    v_exp_f32 v63, v63
    v_cvt_pk_bf16_f32 v80, v48, v49
    v_cvt_pk_bf16_f32 v81, v50, v51
    v_cvt_pk_bf16_f32 v82, v52, v53
    v_cvt_pk_bf16_f32 v83, v54, v55
    v_cvt_pk_bf16_f32 v84, v56, v57
    v_cvt_pk_bf16_f32 v85, v58, v59
    v_cvt_pk_bf16_f32 v86, v60, v61
    v_cvt_pk_bf16_f32 v87, v62, v63
    s_waitcnt lgkmcnt(2)
    v_mfma_f32_32x32x16_bf16 v[96:111], v[28:31], v[80:83], v[96:111]
    v_exp_f32 v64, v64
    v_exp_f32 v65, v65
    v_exp_f32 v66, v66
    v_exp_f32 v67, v67
    v_mfma_f32_32x32x16_bf16 v[96:111], v[32:35], v[84:87], v[96:111]
    v_exp_f32 v68, v68
    v_exp_f32 v69, v69
    v_exp_f32 v70, v70
    v_exp_f32 v71, v71
    s_waitcnt lgkmcnt(0)
    v_mfma_f32_32x32x16_bf16 v[48:63], v[16:19], v[8:11], 0
    v_exp_f32 v72, v72
    v_exp_f32 v73, v73
    v_exp_f32 v74, v74
    v_exp_f32 v75, v75
    v_mfma_f32_32x32x8bf16_1k v[48:63], v[24:25], v[12:13], v[48:63]
    v_exp_f32 v76, v76
    v_exp_f32 v77, v77
    v_exp_f32 v78, v78
    v_exp_f32 v79, v79
    v_cvt_pk_bf16_f32 v80, v64, v65
    v_cvt_pk_bf16_f32 v81, v66, v67
    v_cvt_pk_bf16_f32 v82, v68, v69
    v_cvt_pk_bf16_f32 v83, v70, v71
    v_cvt_pk_bf16_f32 v84, v72, v73
    v_cvt_pk_bf16_f32 v85, v74, v75
    v_cvt_pk_bf16_f32 v86, v76, v77
    v_cvt_pk_bf16_f32 v87, v78, v79
    s_add_u32 s32, s22, 26214400
    s_addc_u32 s33, s23, 0
    s_mov_b32 s34, 36700160
    s_mov_b32 s35, 0x20000
    s_lshr_b32 s44, s2, 3
    s_mul_i32 s44, s44, 8
    s_add_u32 s44, s44, s40
    v_lshlrev_b32 v186, 7, v1
    s_sub_u32 s45, s44, 0
    s_cmp_ge_u32 s45, 81
    s_cbranch_scc1 Lt_attn_kernel_2
    s_lshl_b32 s45, s45, 13
    s_add_u32 s45, s45, 35651584
    buffer_load_dword v187, v186, s[32:35], s45 offen
Lt_attn_kernel_2:
    s_sub_u32 s45, s44, 81
    s_cmp_ge_u32 s45, 162
    s_cbranch_scc1 Lt_attn_kernel_3
    s_lshl_b32 s45, s45, 13
    s_and_b32 s46, s2, 3
    s_mul_i32 s46, s46, 1327104
    s_add_u32 s45, s45, s46
    s_add_u32 s45, s45, 26214400
    buffer_load_dword v188, v186, s[32:35], s45 offen
Lt_attn_kernel_3:
    s_setprio 2
    v_mfma_f32_32x32x16_bf16 v[196:211], v[28:31], v[80:83], v[196:211]
    v_exp_f32 v48, v48
    v_exp_f32 v49, v49
    v_exp_f32 v50, v50
    v_exp_f32 v51, v51
    v_mfma_f32_32x32x16_bf16 v[196:211], v[32:35], v[84:87], v[196:211]
    v_exp_f32 v52, v52
    v_exp_f32 v53, v53
    v_exp_f32 v54, v54
    v_exp_f32 v55, v55
    ds_read_b128 v[28:31], v6 offset:2304
    ds_read_b128 v[32:35], v6 offset:2880
    v_mfma_f32_32x32x16_bf16 v[64:79], v[16:19], v[88:91], 0
    v_exp_f32 v56, v56
    v_exp_f32 v57, v57
    v_exp_f32 v58, v58
    v_exp_f32 v59, v59
    v_mfma_f32_32x32x8bf16_1k v[64:79], v[24:25], v[92:93], v[64:79]
    ds_read_b128 v[16:19], v4 offset:8192
    ds_read_b32 v24, v5 offset:1024
    v_exp_f32 v60, v60
    v_exp_f32 v61, v61
    v_exp_f32 v62, v62
    v_exp_f32 v63, v63
    v_cvt_pk_bf16_f32 v80, v48, v49
    v_cvt_pk_bf16_f32 v81, v50, v51
    v_cvt_pk_bf16_f32 v82, v52, v53
    v_cvt_pk_bf16_f32 v83, v54, v55
    v_cvt_pk_bf16_f32 v84, v56, v57
    v_cvt_pk_bf16_f32 v85, v58, v59
    v_cvt_pk_bf16_f32 v86, v60, v61
    v_cvt_pk_bf16_f32 v87, v62, v63
    s_waitcnt lgkmcnt(2)
    v_mfma_f32_32x32x16_bf16 v[96:111], v[28:31], v[80:83], v[96:111]
    v_exp_f32 v64, v64
    v_exp_f32 v65, v65
    v_exp_f32 v66, v66
    v_exp_f32 v67, v67
    v_mfma_f32_32x32x16_bf16 v[96:111], v[32:35], v[84:87], v[96:111]
    v_exp_f32 v68, v68
    v_exp_f32 v69, v69
    v_exp_f32 v70, v70
    v_add_u32 v6, v47, v6
    v_exp_f32 v71, v71
    s_waitcnt lgkmcnt(0)
    v_mfma_f32_32x32x16_bf16 v[48:63], v[16:19], v[8:11], 0
    v_exp_f32 v72, v72
    v_exp_f32 v73, v73
    v_exp_f32 v74, v74
    v_exp_f32 v75, v75
    v_mfma_f32_32x32x8bf16_1k v[48:63], v[24:25], v[12:13], v[48:63]
    v_exp_f32 v76, v76
    v_exp_f32 v77, v77
    v_exp_f32 v78, v78
    v_exp_f32 v79, v79
    v_cvt_pk_bf16_f32 v80, v64, v65
    v_cvt_pk_bf16_f32 v81, v66, v67
    v_cvt_pk_bf16_f32 v82, v68, v69
    v_cvt_pk_bf16_f32 v83, v70, v71
    v_cvt_pk_bf16_f32 v84, v72, v73
    v_cvt_pk_bf16_f32 v85, v74, v75
    v_cvt_pk_bf16_f32 v86, v76, v77
    v_cvt_pk_bf16_f32 v87, v78, v79
    v_mfma_f32_32x32x16_bf16 v[196:211], v[28:31], v[80:83], v[196:211]
    v_exp_f32 v48, v48
    v_exp_f32 v49, v49
    v_exp_f32 v50, v50
    v_exp_f32 v51, v51
    v_mfma_f32_32x32x16_bf16 v[196:211], v[32:35], v[84:87], v[196:211]
    v_exp_f32 v52, v52
    v_exp_f32 v53, v53
    v_exp_f32 v54, v54
    v_exp_f32 v55, v55
    ds_read_b128 v[28:31], v6 offset:0
    ds_read_b128 v[32:35], v6 offset:576
    v_mfma_f32_32x32x16_bf16 v[64:79], v[16:19], v[88:91], 0
    v_exp_f32 v56, v56
    v_exp_f32 v57, v57
    v_exp_f32 v58, v58
    v_exp_f32 v59, v59
    v_mfma_f32_32x32x8bf16_1k v[64:79], v[24:25], v[92:93], v[64:79]
    ds_read_b128 v[16:19], v4 offset:10240
    ds_read_b32 v24, v5 offset:1280
    v_exp_f32 v60, v60
    v_exp_f32 v61, v61
    v_exp_f32 v62, v62
    v_exp_f32 v63, v63
    v_cvt_pk_bf16_f32 v80, v48, v49
    v_cvt_pk_bf16_f32 v81, v50, v51
    v_cvt_pk_bf16_f32 v82, v52, v53
    v_cvt_pk_bf16_f32 v83, v54, v55
    v_cvt_pk_bf16_f32 v84, v56, v57
    v_cvt_pk_bf16_f32 v85, v58, v59
    v_cvt_pk_bf16_f32 v86, v60, v61
    v_cvt_pk_bf16_f32 v87, v62, v63
    s_waitcnt lgkmcnt(2)
    v_mfma_f32_32x32x16_bf16 v[96:111], v[28:31], v[80:83], v[96:111]
    v_exp_f32 v64, v64
    v_exp_f32 v65, v65
    v_exp_f32 v66, v66
    v_exp_f32 v67, v67
    v_mfma_f32_32x32x16_bf16 v[96:111], v[32:35], v[84:87], v[96:111]
    v_exp_f32 v68, v68
    v_exp_f32 v69, v69
    v_exp_f32 v70, v70
    v_exp_f32 v71, v71
    s_waitcnt lgkmcnt(0)
    v_mfma_f32_32x32x16_bf16 v[48:63], v[16:19], v[8:11], 0
    v_exp_f32 v72, v72
    v_exp_f32 v73, v73
    v_exp_f32 v74, v74
    v_exp_f32 v75, v75
    v_mfma_f32_32x32x8bf16_1k v[48:63], v[24:25], v[12:13], v[48:63]
    v_exp_f32 v76, v76
    v_exp_f32 v77, v77
    v_exp_f32 v78, v78
    v_exp_f32 v79, v79
    v_cvt_pk_bf16_f32 v80, v64, v65
    v_cvt_pk_bf16_f32 v81, v66, v67
    v_cvt_pk_bf16_f32 v82, v68, v69
    v_cvt_pk_bf16_f32 v83, v70, v71
    v_cvt_pk_bf16_f32 v84, v72, v73
    v_cvt_pk_bf16_f32 v85, v74, v75
    v_cvt_pk_bf16_f32 v86, v76, v77
    v_cvt_pk_bf16_f32 v87, v78, v79
    s_setprio 1
    v_mfma_f32_32x32x16_bf16 v[196:211], v[28:31], v[80:83], v[196:211]
    v_exp_f32 v48, v48
    v_exp_f32 v49, v49
    v_exp_f32 v50, v50
    v_exp_f32 v51, v51
    v_mfma_f32_32x32x16_bf16 v[196:211], v[32:35], v[84:87], v[196:211]
    v_exp_f32 v52, v52
    v_exp_f32 v53, v53
    v_exp_f32 v54, v54
    v_exp_f32 v55, v55
    ds_read_b128 v[28:31], v6 offset:2304
    ds_read_b128 v[32:35], v6 offset:2880
    v_mfma_f32_32x32x16_bf16 v[64:79], v[16:19], v[88:91], 0
    v_exp_f32 v56, v56
    v_exp_f32 v57, v57
    v_exp_f32 v58, v58
    v_exp_f32 v59, v59
    v_mfma_f32_32x32x8bf16_1k v[64:79], v[24:25], v[92:93], v[64:79]
    ds_read_b128 v[16:19], v4 offset:12288
    ds_read_b32 v24, v5 offset:1536
    v_exp_f32 v60, v60
    v_exp_f32 v61, v61
    v_exp_f32 v62, v62
    v_exp_f32 v63, v63
    v_cvt_pk_bf16_f32 v80, v48, v49
    v_cvt_pk_bf16_f32 v81, v50, v51
    v_cvt_pk_bf16_f32 v82, v52, v53
    v_cvt_pk_bf16_f32 v83, v54, v55
    v_cvt_pk_bf16_f32 v84, v56, v57
    v_cvt_pk_bf16_f32 v85, v58, v59
    v_cvt_pk_bf16_f32 v86, v60, v61
    v_cvt_pk_bf16_f32 v87, v62, v63
    s_waitcnt lgkmcnt(2)
    v_mfma_f32_32x32x16_bf16 v[96:111], v[28:31], v[80:83], v[96:111]
    v_exp_f32 v64, v64
    v_exp_f32 v65, v65
    v_exp_f32 v66, v66
    v_exp_f32 v67, v67
    v_mfma_f32_32x32x16_bf16 v[96:111], v[32:35], v[84:87], v[96:111]
    v_exp_f32 v68, v68
    v_exp_f32 v69, v69
    v_exp_f32 v70, v70
    v_add_u32 v6, v47, v6
    v_exp_f32 v71, v71
    s_waitcnt lgkmcnt(0)
    v_mfma_f32_32x32x16_bf16 v[48:63], v[16:19], v[8:11], 0
    v_exp_f32 v72, v72
    v_exp_f32 v73, v73
    v_exp_f32 v74, v74
    v_exp_f32 v75, v75
    v_mfma_f32_32x32x8bf16_1k v[48:63], v[24:25], v[12:13], v[48:63]
    v_exp_f32 v76, v76
    v_exp_f32 v77, v77
    v_exp_f32 v78, v78
    v_exp_f32 v79, v79
    v_cvt_pk_bf16_f32 v80, v64, v65
    v_cvt_pk_bf16_f32 v81, v66, v67
    v_cvt_pk_bf16_f32 v82, v68, v69
    v_cvt_pk_bf16_f32 v83, v70, v71
    v_cvt_pk_bf16_f32 v84, v72, v73
    v_cvt_pk_bf16_f32 v85, v74, v75
    v_cvt_pk_bf16_f32 v86, v76, v77
    v_cvt_pk_bf16_f32 v87, v78, v79
    v_mfma_f32_32x32x16_bf16 v[196:211], v[28:31], v[80:83], v[196:211]
    v_exp_f32 v48, v48
    v_exp_f32 v49, v49
    v_exp_f32 v50, v50
    v_exp_f32 v51, v51
    v_mfma_f32_32x32x16_bf16 v[196:211], v[32:35], v[84:87], v[196:211]
    v_exp_f32 v52, v52
    v_exp_f32 v53, v53
    v_exp_f32 v54, v54
    v_exp_f32 v55, v55
    ds_read_b128 v[28:31], v6 offset:0
    ds_read_b128 v[32:35], v6 offset:576
    v_mfma_f32_32x32x16_bf16 v[64:79], v[16:19], v[88:91], 0
    v_exp_f32 v56, v56
    v_exp_f32 v57, v57
    v_exp_f32 v58, v58
    v_exp_f32 v59, v59
    v_mfma_f32_32x32x8bf16_1k v[64:79], v[24:25], v[92:93], v[64:79]
    ds_read_b128 v[16:19], v4 offset:14336
    ds_read_b32 v24, v5 offset:1792
    v_exp_f32 v60, v60
    v_exp_f32 v61, v61
    v_exp_f32 v62, v62
    v_exp_f32 v63, v63
    v_cvt_pk_bf16_f32 v80, v48, v49
    v_cvt_pk_bf16_f32 v81, v50, v51
    v_cvt_pk_bf16_f32 v82, v52, v53
    v_cvt_pk_bf16_f32 v83, v54, v55
    v_cvt_pk_bf16_f32 v84, v56, v57
    v_cvt_pk_bf16_f32 v85, v58, v59
    v_cvt_pk_bf16_f32 v86, v60, v61
    v_cvt_pk_bf16_f32 v87, v62, v63
    s_waitcnt lgkmcnt(2)
    v_mfma_f32_32x32x16_bf16 v[96:111], v[28:31], v[80:83], v[96:111]
    v_exp_f32 v64, v64
    v_exp_f32 v65, v65
    v_exp_f32 v66, v66
    v_exp_f32 v67, v67
    s_setprio 0
    v_mfma_f32_32x32x16_bf16 v[96:111], v[32:35], v[84:87], v[96:111]
    v_exp_f32 v68, v68
    v_exp_f32 v69, v69
    v_exp_f32 v70, v70
    v_exp_f32 v71, v71
    s_waitcnt lgkmcnt(0)
    v_mfma_f32_32x32x16_bf16 v[48:63], v[16:19], v[8:11], 0
    v_exp_f32 v72, v72
    v_exp_f32 v73, v73
    v_exp_f32 v74, v74
    v_exp_f32 v75, v75
    v_mfma_f32_32x32x8bf16_1k v[48:63], v[24:25], v[12:13], v[48:63]
    v_exp_f32 v76, v76
    v_exp_f32 v77, v77
    v_exp_f32 v78, v78
    v_exp_f32 v79, v79
    v_cvt_pk_bf16_f32 v80, v64, v65
    v_cvt_pk_bf16_f32 v81, v66, v67
    v_cvt_pk_bf16_f32 v82, v68, v69
    v_cvt_pk_bf16_f32 v83, v70, v71
    v_cvt_pk_bf16_f32 v84, v72, v73
    v_cvt_pk_bf16_f32 v85, v74, v75
    v_cvt_pk_bf16_f32 v86, v76, v77
    v_cvt_pk_bf16_f32 v87, v78, v79
    s_nop 0
    v_mfma_f32_32x32x16_bf16 v[196:211], v[28:31], v[80:83], v[196:211]
    v_mfma_f32_32x32x16_bf16 v[196:211], v[32:35], v[84:87], v[196:211]
    s_lshr_b32 s46, s40, 2
    s_and_b32 s44, s40, 3
    s_mul_i32 s44, s44, 3072
    s_mul_i32 s45, s46, 73728
    s_add_u32 s45, s45, s44
    s_xor_b32 s46, s46, 1
    s_mul_i32 s46, s46, 73728
    s_add_u32 s44, s44, s46
    v_add_u32 v112, s45, v2
    v_add_u32 v113, s44, v2
    s_nop 7
    s_nop 1
    ds_write_b128 v112, v[196:199]
    ds_write_b128 v112, v[200:203] offset:1024
    ds_write_b96 v112, v[204:206] offset:2048
    s_waitcnt lgkmcnt(0)
    s_barrier
    ds_read_b96 v[204:206], v113 offset:2048
    ds_read_b128 v[196:199], v113
    ds_read_b128 v[200:203], v113 offset:1024
    s_waitcnt lgkmcnt(2)
    v_add_f32 v106, v106, v206
    v_mov_b32 v112, v106
    v_mov_b32 v113, v106
    s_mov_b32 s44, 0x21800000
    s_mov_b32 s45, 0x5d800000
    v_permlane32_swap_b32 v112, v113
    s_nop 1
    v_cmp_le_f32 vcc, s44, v112
    v_cmp_ge_f32 s[46:47], s45, v112
    s_and_b64 vcc, vcc, s[46:47]
    s_cmp_eq_u64 vcc, exec
    s_cbranch_scc0 L_att_fb
    s_waitcnt lgkmcnt(0)
    v_pk_add_f32 v[96:97], v[96:97], v[196:197]
    v_pk_add_f32 v[98:99], v[98:99], v[198:199]
    v_pk_add_f32 v[100:101], v[100:101], v[200:201]
    v_pk_add_f32 v[102:103], v[102:103], v[202:203]
    v_pk_add_f32 v[104:105], v[104:105], v[204:205]
    s_mov_b32 s48, 1
L_att_epi:
    v_rcp_f32 v112, v112
    s_nop 0
    v_mul_f32 v96, v96, v112
    v_mul_f32 v97, v97, v112
    v_mul_f32 v98, v98, v112
    v_mul_f32 v99, v99, v112
    v_mul_f32 v100, v100, v112
    v_mul_f32 v101, v101, v112
    v_mul_f32 v102, v102, v112
    v_mul_f32 v103, v103, v112
    v_mul_f32 v104, v104, v112
    v_mul_f32 v105, v105, v112
    v_cvt_pk_bf16_f32 v80, v96, v97
    v_cvt_pk_bf16_f32 v81, v98, v99
    v_cvt_pk_bf16_f32 v82, v100, v101
    v_cvt_pk_bf16_f32 v83, v102, v103
    v_cvt_pk_bf16_f32 v84, v104, v105
    buffer_store_dwordx4 v[80:83], v192, s[28:31], s43 offen sc1
    s_mov_b32 exec_hi, 0
    buffer_store_dword v84, v192, s[28:31], s49 offen sc1
    s_cmp_eq_u32 s48, 0
    s_cbranch_scc1 L_att_nb
    s_barrier
L_att_nb:
    s_endpgm
L_att_fb:
    s_waitcnt lgkmcnt(0)
    s_barrier
    s_mul_i32 s46, s41, 73728
    s_add_u32 s47, s46, 4718592
    s_add_u32 s46, s46, 2359296
    s_mov_b32 m0, 0
    s_nop 0
    buffer_load_dwordx4 v2, s[24:27], s46 offen lds
    s_add_u32 s46, s46, 1152
    s_mov_b32 m0, 1024
    s_nop 0
    buffer_load_dwordx4 v2, s[24:27], s46 offen lds
    s_add_u32 s46, s46, 1152
    s_mov_b32 m0, 2048
    s_nop 0
    buffer_load_dwordx4 v2, s[24:27], s46 offen lds
    s_add_u32 s46, s46, 1152
    s_mov_b32 m0, 3072
    s_nop 0
    buffer_load_dwordx4 v2, s[24:27], s46 offen lds
    s_add_u32 s46, s46, 1152
    s_mov_b32 m0, 4096
    s_nop 0
    buffer_load_dwordx4 v2, s[24:27], s46 offen lds
    s_add_u32 s46, s46, 1152
    s_mov_b32 m0, 5120
    s_nop 0
    buffer_load_dwordx4 v2, s[24:27], s46 offen lds
    s_add_u32 s46, s46, 1152
    s_mov_b32 m0, 6144
    s_nop 0
    buffer_load_dwordx4 v2, s[24:27], s46 offen lds
    s_add_u32 s46, s46, 1152
    s_mov_b32 m0, 7168
    s_nop 0
    buffer_load_dwordx4 v2, s[24:27], s46 offen lds
    s_add_u32 s46, s46, 1152
    s_mov_b32 m0, 8192
    s_nop 0
    buffer_load_dwordx4 v2, s[24:27], s46 offen lds
    s_add_u32 s46, s46, 1152
    s_mov_b32 m0, 9216
    s_nop 0
    buffer_load_dwordx4 v2, s[24:27], s46 offen lds
    s_add_u32 s46, s46, 1152
    s_mov_b32 m0, 10240
    s_nop 0
    buffer_load_dwordx4 v2, s[24:27], s46 offen lds
    s_add_u32 s46, s46, 1152
    s_mov_b32 m0, 11264
    s_nop 0
    buffer_load_dwordx4 v2, s[24:27], s46 offen lds
    s_add_u32 s46, s46, 1152
    s_mov_b32 m0, 73728
    s_nop 0
    buffer_load_dwordx4 v2, s[24:27], s47 offen lds
    s_add_u32 s47, s47, 1024
    s_mov_b32 m0, 74752
    s_nop 0
    buffer_load_dwordx4 v2, s[24:27], s47 offen lds
    s_add_u32 s47, s47, 1024
    s_mov_b32 m0, 75776
    s_nop 0
    buffer_load_dwordx4 v2, s[24:27], s47 offen lds
    s_add_u32 s47, s47, 1024
    s_mov_b32 m0, 76800
    s_nop 0
    buffer_load_dwordx4 v2, s[24:27], s47 offen lds
    s_add_u32 s47, s47, 1024
    s_mov_b32 m0, 77824
    s_nop 0
    buffer_load_dwordx4 v2, s[24:27], s47 offen lds
    s_add_u32 s47, s47, 1024
    s_mov_b32 m0, 78848
    s_nop 0
    buffer_load_dwordx4 v2, s[24:27], s47 offen lds
    s_add_u32 s47, s47, 1024
    s_mov_b32 m0, 79872
    s_nop 0
    buffer_load_dwordx4 v2, s[24:27], s47 offen lds
    s_add_u32 s47, s47, 1024
    s_mov_b32 m0, 80896
    s_nop 0
    buffer_load_dwordx4 v2, s[24:27], s47 offen lds
    s_add_u32 s47, s47, 1024
    s_mov_b32 m0, 81920
    s_nop 0
    buffer_load_dwordx4 v2, s[24:27], s47 offen lds
    s_add_u32 s47, s47, 1024
    s_mov_b32 m0, 82944
    s_nop 0
    buffer_load_dwordx4 v2, s[24:27], s47 offen lds
    s_add_u32 s47, s47, 1024
    s_mov_b32 m0, 83968
    s_nop 0
    buffer_load_dwordx4 v2, s[24:27], s47 offen lds
    s_add_u32 s47, s47, 1024
    s_mov_b32 m0, 84992
    s_nop 0
    buffer_load_dwordx4 v2, s[24:27], s47 offen lds
    s_add_u32 s47, s47, 1024
    s_waitcnt vmcnt(0)
    v_mov_b32 v4, v44
    v_mov_b32 v5, v45
    v_mov_b32 v140, 0xff800000
    s_mov_b32 s48, 64
L_att_fb1:
    ds_read_b128 v[16:19], v4 offset:0
    ds_read_b32 v24, v5 offset:0
    v_add_u32 v4, 1024, v4
    v_add_u32 v5, 128, v5
    s_waitcnt lgkmcnt(0)
    v_mfma_f32_32x32x16_bf16 v[48:63], v[16:19], v[8:11], 0
    v_mfma_f32_32x32x8bf16_1k v[48:63], v[24:25], v[12:13], v[48:63]
    s_nop 15
    v_max3_f32 v140, v48, v49, v140
    v_max3_f32 v140, v50, v51, v140
    v_max3_f32 v140, v52, v53, v140
    v_max3_f32 v140, v54, v55, v140
    v_max3_f32 v140, v56, v57, v140
    v_max3_f32 v140, v58, v59, v140
    v_max3_f32 v140, v60, v61, v140
    v_max3_f32 v140, v62, v63, v140
    s_sub_u32 s48, s48, 1
    s_cmp_lg_u32 s48, 0
    s_cbranch_scc1 L_att_fb1
    v_mov_b32 v112, v140
    v_mov_b32 v113, v140
    s_nop 1
    v_permlane32_swap_b32 v112, v113
    s_nop 1
    v_max_f32 v112, v112, v113
    v_mov_b32 v4, v44
    v_mov_b32 v5, v45
    v_mov_b32 v6, v46
    v_sub_f32 v140, 0, v112
    v_sub_f32 v141, 0, v112
    v_sub_f32 v142, 0, v112
    v_sub_f32 v143, 0, v112
    v_sub_f32 v144, 0, v112
    v_sub_f32 v145, 0, v112
    v_sub_f32 v146, 0, v112
    v_sub_f32 v147, 0, v112
    v_sub_f32 v148, 0, v112
    v_sub_f32 v149, 0, v112
    v_sub_f32 v150, 0, v112
    v_sub_f32 v151, 0, v112
    v_sub_f32 v152, 0, v112
    v_sub_f32 v153, 0, v112
    v_sub_f32 v154, 0, v112
    v_sub_f32 v155, 0, v112
    v_mov_b32 v96, 0
    v_mov_b32 v97, 0
    v_mov_b32 v98, 0
    v_mov_b32 v99, 0
    v_mov_b32 v100, 0
    v_mov_b32 v101, 0
    v_mov_b32 v102, 0
    v_mov_b32 v103, 0
    v_mov_b32 v104, 0
    v_mov_b32 v105, 0
    v_mov_b32 v106, 0
    v_mov_b32 v107, 0
    v_mov_b32 v108, 0
    v_mov_b32 v109, 0
    v_mov_b32 v110, 0
    v_mov_b32 v111, 0
    s_mov_b32 s48, 32
    ds_read_b128 v[16:19], v4 offset:0
    ds_read_b32 v24, v5 offset:0
    ds_read_b128 v[20:23], v4 offset:1024
    ds_read_b32 v26, v5 offset:128
    v_mov_b32 v80, 0
    v_mov_b32 v36, 0
    v_mov_b32 v81, 0
    v_mov_b32 v37, 0
    v_mov_b32 v82, 0
    v_mov_b32 v38, 0
    v_mov_b32 v83, 0
    v_mov_b32 v39, 0
    v_mov_b32 v84, 0
    v_mov_b32 v40, 0
    v_mov_b32 v85, 0
    v_mov_b32 v41, 0
    v_mov_b32 v86, 0
    v_mov_b32 v42, 0
    v_mov_b32 v87, 0
    v_mov_b32 v43, 0
    s_waitcnt lgkmcnt(2)
    v_mfma_f32_32x32x16_bf16 v[48:63], v[16:19], v[8:11], v[140:155]
    v_mfma_f32_32x32x8bf16_1k v[48:63], v[24:25], v[12:13], v[48:63]
    ds_read_b128 v[28:31], v6 offset:0
    ds_read_b128 v[32:35], v6 offset:576
    ds_read_b128 v[16:19], v4 offset:2048
    ds_read_b32 v24, v5 offset:256
    s_nop 7
L_att_fb2:
    s_waitcnt lgkmcnt(4)
    v_mfma_f32_32x32x16_bf16 v[96:111], v[36:39], v[80:83], v[96:111]
    v_exp_f32 v48, v48
    v_exp_f32 v49, v49
    v_exp_f32 v50, v50
    v_exp_f32 v51, v51
    v_mfma_f32_32x32x16_bf16 v[96:111], v[40:43], v[84:87], v[96:111]
    v_exp_f32 v52, v52
    v_exp_f32 v53, v53
    v_exp_f32 v54, v54
    v_exp_f32 v55, v55
    ds_read_b128 v[36:39], v6 offset:1152
    ds_read_b128 v[40:43], v6 offset:1728
    v_mfma_f32_32x32x16_bf16 v[64:79], v[20:23], v[8:11], v[140:155]
    v_exp_f32 v56, v56
    v_exp_f32 v57, v57
    v_exp_f32 v58, v58
    v_exp_f32 v59, v59
    v_mfma_f32_32x32x8bf16_1k v[64:79], v[26:27], v[12:13], v[64:79]
    ds_read_b128 v[20:23], v4 offset:3072
    ds_read_b32 v26, v5 offset:384
    v_exp_f32 v60, v60
    v_exp_f32 v61, v61
    v_exp_f32 v62, v62
    v_exp_f32 v63, v63
    v_cvt_pk_bf16_f32 v80, v48, v49
    v_cvt_pk_bf16_f32 v81, v50, v51
    v_cvt_pk_bf16_f32 v82, v52, v53
    v_cvt_pk_bf16_f32 v83, v54, v55
    v_cvt_pk_bf16_f32 v84, v56, v57
    v_cvt_pk_bf16_f32 v85, v58, v59
    v_cvt_pk_bf16_f32 v86, v60, v61
    v_cvt_pk_bf16_f32 v87, v62, v63
    s_waitcnt lgkmcnt(4)
    v_mfma_f32_32x32x16_bf16 v[96:111], v[28:31], v[80:83], v[96:111]
    v_exp_f32 v64, v64
    v_exp_f32 v65, v65
    v_exp_f32 v66, v66
    v_exp_f32 v67, v67
    v_mfma_f32_32x32x16_bf16 v[96:111], v[32:35], v[84:87], v[96:111]
    v_exp_f32 v68, v68
    v_exp_f32 v69, v69
    v_exp_f32 v70, v70
    v_exp_f32 v71, v71
    ds_read_b128 v[28:31], v6 offset:2304
    ds_read_b128 v[32:35], v6 offset:2880
    v_mfma_f32_32x32x16_bf16 v[48:63], v[16:19], v[8:11], v[140:155]
    v_exp_f32 v72, v72
    v_exp_f32 v73, v73
    v_exp_f32 v74, v74
    v_exp_f32 v75, v75
    v_mfma_f32_32x32x8bf16_1k v[48:63], v[24:25], v[12:13], v[48:63]
    ds_read_b128 v[16:19], v4 offset:4096
    ds_read_b32 v24, v5 offset:512
    v_exp_f32 v76, v76
    v_exp_f32 v77, v77
    v_exp_f32 v78, v78
    v_exp_f32 v79, v79
    v_cvt_pk_bf16_f32 v80, v64, v65
    v_cvt_pk_bf16_f32 v81, v66, v67
    v_cvt_pk_bf16_f32 v82, v68, v69
    v_cvt_pk_bf16_f32 v83, v70, v71
    v_cvt_pk_bf16_f32 v84, v72, v73
    v_cvt_pk_bf16_f32 v85, v74, v75
    v_cvt_pk_bf16_f32 v86, v76, v77
    v_cvt_pk_bf16_f32 v87, v78, v79
    v_add_u32 v4, 2048, v4
    v_add_u32 v5, 256, v5
    v_add_u32 v6, v7, v6
    s_sub_u32 s48, s48, 1
    s_cmp_lg_u32 s48, 0
    s_cbranch_scc1 L_att_fb2
    s_waitcnt lgkmcnt(0)
    v_mfma_f32_32x32x16_bf16 v[96:111], v[36:39], v[80:83], v[96:111]
    v_mfma_f32_32x32x16_bf16 v[96:111], v[40:43], v[84:87], v[96:111]
    s_nop 15
    v_mov_b32 v112, v106
    v_mov_b32 v113, v106
    s_nop 1
    v_permlane32_swap_b32 v112, v113
    s_nop 1
    s_branch L_att_epi
L_end_attn_kernel:
    s_endpgm
.p2align 12
.globl post_kernel
.p2align 8
.type post_kernel,@function
post_kernel:
    s_cmp_ge_u32 s2, 256
    s_cbranch_scc1 L_end_post_kernel
    s_load_dwordx16 s[4:19], s[0:1], 0
    s_load_dwordx2 s[20:21], s[0:1], 64
    s_load_dwordx2 s[22:23], s[0:1], 80
    v_and_b32 v1, 63, v0
    v_lshrrev_b32 v252, 6, v0
    v_and_b32 v2, 15, v0
    v_readfirstlane_b32 s40, v252
    v_lshlrev_b32 v4, 4, v1
    v_add_u32 v5, 4096, v4
    v_add_u32 v6, 8192, v4
    s_and_b32 s44, s2, 7
    s_lshr_b32 s45, s2, 3
    s_and_b32 s36, s45, 7
    s_lshr_b32 s46, s45, 3
    s_lshl_b32 s37, s44, 2
    s_add_u32 s37, s37, s46
    s_mul_i32 s38, s36, 82944
    s_add_u32 s38, s38, 61865984
    s_mul_i32 s39, s37, 73728
    s_add_u32 s39, s39, 16777216
    s_and_b32 s42, s44, 3
    s_lshl_b32 s42, s42, 2
    s_and_b32 s46, s45, 3
    s_add_u32 s42, s42, s46
    s_lshr_b32 s41, s44, 2
    s_lshl_b32 s41, s41, 3
    s_lshr_b32 s46, s45, 2
    s_add_u32 s41, s41, s46
    s_cmp_eq_u32 s40, 0
    s_cbranch_scc1 L_pgpost_kernel_1
    s_cmp_eq_u32 s40, 1
    s_cbranch_scc1 L_pgpost_kernel_2
    s_cmp_eq_u32 s40, 2
    s_cbranch_scc1 L_pgpost_kernel_3
    s_cmp_eq_u32 s40, 3
    s_cbranch_scc1 L_pgpost_kernel_4
L_hoppost_kernel_2:
    s_add_u32 s44, s40, 0
    s_and_b32 s44, s44, 3
    s_mul_i32 s45, s44, 18432
    v_add_u32 v7, s45, v4
    s_add_u32 s44, s40, 1
    s_and_b32 s44, s44, 3
    s_mul_i32 s45, s44, 18432
    v_add_u32 v8, s45, v4
    s_mul_i32 s44, s44, 15360
    s_add_u32 s44, s44, 92160
    v_add_u32 v11, s44, v4
    s_add_u32 s44, s40, 2
    s_and_b32 s44, s44, 3
    s_mul_i32 s45, s44, 18432
    v_add_u32 v9, s45, v4
    s_mul_i32 s44, s44, 15360
    s_add_u32 s44, s44, 97280
    v_add_u32 v14, s44, v4
    s_add_u32 s44, s40, 3
    s_and_b32 s44, s44, 3
    s_mul_i32 s45, s44, 18432
    v_add_u32 v10, s45, v4
    s_mul_i32 s44, s44, 15360
    s_add_u32 s44, s44, 102400
    v_add_u32 v15, s44, v4
    s_waitcnt lgkmcnt(0)
    s_add_u32 s32, s22, 0
    s_addc_u32 s33, s23, 0
    s_mov_b32 s34, 73400320
    s_mov_b32 s35, 0x20000
    s_add_u32 s54, s39, 16384
    s_add_u32 s55, s38, 73728
    s_lshl_b32 s44, s40, 10
    s_add_u32 s56, s55, s44
    s_add_u32 s57, s44, 73728
    s_mul_i32 s44, s40, 9216
    s_add_u32 s38, s38, s44
    s_lshl_b32 s44, s40, 11
    s_add_u32 s39, s39, s44
    buffer_load_dwordx4 v[28:31], v7, s[32:35], s39 offen offset:0
    buffer_load_dwordx4 v[32:35], v8, s[32:35], s39 offen offset:0
    buffer_load_dwordx4 v[36:39], v9, s[32:35], s39 offen offset:0
    buffer_load_dwordx4 v[40:43], v10, s[32:35], s39 offen offset:0
    buffer_load_dwordx4 a[0:3], v4, s[32:35], s38 offen offset:0
    buffer_load_dwordx4 a[4:7], v4, s[32:35], s38 offen offset:1024
    buffer_load_dwordx4 a[8:11], v4, s[32:35], s38 offen offset:2048
    buffer_load_dwordx4 a[12:15], v4, s[32:35], s38 offen offset:3072
    buffer_load_dwordx4 a[32:35], v6, s[32:35], s38 offen offset:0
    buffer_load_dwordx4 v[44:47], v7, s[32:35], s39 offen offset:1024
    buffer_load_dwordx4 v[48:51], v8, s[32:35], s39 offen offset:1024
    buffer_load_dwordx4 v[52:55], v9, s[32:35], s39 offen offset:1024
    s_mov_b32 s24, s4
    s_mov_b32 s25, s5
    s_mov_b32 s26, 2359296
    s_mov_b32 s27, 0x20000
    v_lshrrev_b32 v3, 4, v1
    v_and_b32 v252, 4, v2
    v_add_u32 v252, v252, v2
    v_lshrrev_b32 v253, 3, v2
    v_mad_i32_i24 v252, v253, -4, v252
    v_mul_u32_u24 v12, 1152, v252
    v_lshl_add_u32 v27, v3, 3, v12
    v_lshl_add_u32 v12, v3, 4, v12
    v_lshrrev_b32 v252, 1, v3
    v_lshlrev_b32 v252, 8, v252
    v_lshl_add_u32 v252, v2, 4, v252
    v_and_b32 v253, 1, v3
    v_lshl_add_u32 v13, v253, 3, v252
    s_lshl_b32 s44, s37, 2
    s_add_u32 s44, s44, s40
    s_mul_i32 s6, s44, 18432
    s_mul_i32 s45, s36, 144
    s_add_u32 s6, s6, s45
    s_mul_i32 s7, s44, 18432
    s_mul_i32 s45, s36, 2304
    s_add_u32 s7, s7, s45
    s_add_u32 s7, s7, 9437184
    s_lshl_b32 s10, s44, 10
    s_lshr_b32 s45, s36, 1
    s_lshl_b32 s45, s45, 8
    s_add_u32 s10, s10, s45
    s_and_b32 s45, s36, 1
    s_lshl_b32 s45, s45, 3
    s_add_u32 s10, s10, s45
    s_add_u32 s10, s10, 72482816
    s_lshl_b32 s43, s41, 7
    s_lshl_b32 s44, s40, 5
    s_add_u32 s43, s43, s44
    s_mul_i32 s49, s42, 331776
    s_lshl_b32 s48, s40, 12
    s_add_u32 s49, s49, 52428800
    s_add_u32 s49, s49, s48
    s_lshl_b32 s12, s40, 10
    s_add_u32 s12, s12, 16384
    s_sub_u32 s13, s12, s48
    v_min_u32 v124, 143, v0
    v_cmp_gt_u32 vcc, 72, v124
    v_subrev_u32 v142, 72, v124
    v_mov_b32 v125, 9216
    v_cndmask_b32 v142, v142, v124, vcc
    v_cndmask_b32 v125, 0, v125, vcc
    v_lshl_add_u32 v142, v142, 3, v125
    v_lshlrev_b32 v143, 3, v124
    v_add_u32 v143, 153600, v143
    s_mul_i32 s50, s42, 576
    s_add_u32 s50, s50, 16252928
    v_add_u32 v252, 73728, v4
    s_cmp_eq_u32 s40, 0
    s_cbranch_scc1 L_pgpost_kernel_9
    s_cmp_eq_u32 s40, 1
    s_cbranch_scc1 L_pgpost_kernel_10
    s_cmp_eq_u32 s40, 2
    s_cbranch_scc1 L_pgpost_kernel_11
L_hoppost_kernel_0:
    s_waitcnt vmcnt(7)
    v_mfma_f32_16x16x32_bf16 v[156:159], a[0:3], v[28:31], 0
    buffer_load_dwordx4 v[56:59], v10, s[32:35], s39 offen offset:1024
    s_add_u32 s39, s39, 8192
    buffer_load_dwordx4 a[16:19], v5, s[32:35], s38 offen offset:0
    v_mfma_f32_16x16x32_bf16 v[160:163], a[0:3], v[32:35], 0
    buffer_load_dwordx4 a[20:23], v5, s[32:35], s38 offen offset:1024
    v_mfma_f32_16x16x32_bf16 v[164:167], a[0:3], v[36:39], 0
    buffer_load_dwordx4 a[24:27], v5, s[32:35], s38 offen offset:2048
    v_mfma_f32_16x16x32_bf16 v[168:171], a[0:3], v[40:43], 0
    buffer_load_dwordx4 a[28:31], v5, s[32:35], s38 offen offset:3072
    s_add_u32 s38, s38, 36864
    s_mov_b32 m0, s57
    s_nop 0
    buffer_load_dwordx4 v4, s[32:35], s56 offen lds
    s_waitcnt vmcnt(12)
    v_mfma_f32_16x16x32_bf16 v[172:175], a[4:7], v[28:31], 0
    s_add_u32 m0, s57, 4096
    s_nop 0
    buffer_load_dwordx4 v5, s[32:35], s56 offen lds
    v_mfma_f32_16x16x32_bf16 v[176:179], a[4:7], v[32:35], 0
    v_mfma_f32_16x16x32_bf16 v[180:183], a[4:7], v[36:39], 0
    v_mfma_f32_16x16x32_bf16 v[184:187], a[4:7], v[40:43], 0
    s_waitcnt vmcnt(12)
    v_mfma_f32_16x16x32_bf16 v[188:191], a[8:11], v[28:31], 0
    s_mov_b32 m0, 81920
    s_nop 0
    buffer_load_dwordx4 v6, s[32:35], s55 offen lds
    v_mfma_f32_16x16x32_bf16 v[192:195], a[8:11], v[32:35], 0
    v_mfma_f32_16x16x32_bf16 v[196:199], a[8:11], v[36:39], 0
    v_mfma_f32_16x16x32_bf16 v[200:203], a[8:11], v[40:43], 0
    s_waitcnt vmcnt(12)
    v_mfma_f32_16x16x32_bf16 v[204:207], a[12:15], v[28:31], 0
    buffer_load_dwordx4 v[92:95], v7, s[32:35], s54 offen offset:0
    v_mfma_f32_16x16x32_bf16 v[208:211], a[12:15], v[32:35], 0
    v_mfma_f32_16x16x32_bf16 v[212:215], a[12:15], v[36:39], 0
    v_mfma_f32_16x16x32_bf16 v[216:219], a[12:15], v[40:43], 0
    s_waitcnt vmcnt(12)
    v_mfma_f32_16x16x32_bf16 v[220:223], a[32:35], v[28:31], 0
    buffer_load_dwordx4 v[108:111], v7, s[32:35], s54 offen offset:1024
    v_mfma_f32_16x16x32_bf16 v[224:227], a[32:35], v[32:35], 0
    v_mfma_f32_16x16x32_bf16 v[228:231], a[32:35], v[36:39], 0
    v_mfma_f32_16x16x32_bf16 v[232:235], a[32:35], v[40:43], 0
    s_waitcnt vmcnt(9)
    v_mfma_f32_16x16x32_bf16 v[236:239], a[32:35], v[44:47], 0
    buffer_load_dwordx4 v[60:63], v7, s[32:35], s39 offen offset:0
    v_mfma_f32_16x16x32_bf16 v[240:243], a[32:35], v[48:51], 0
    buffer_load_dwordx4 v[64:67], v8, s[32:35], s39 offen offset:0
    v_mfma_f32_16x16x32_bf16 v[244:247], a[32:35], v[52:55], 0
    v_mfma_f32_16x16x32_bf16 v[248:251], a[32:35], v[56:59], 0
    buffer_load_dwordx4 v[68:71], v9, s[32:35], s39 offen offset:0
    buffer_load_dwordx4 v[72:75], v10, s[32:35], s39 offen offset:0
    s_waitcnt vmcnt(12)
    v_mfma_f32_16x16x32_bf16 v[156:159], a[16:19], v[44:47], v[156:159]
    buffer_load_dwordx4 a[36:39], v4, s[32:35], s38 offen offset:0
    v_mfma_f32_16x16x32_bf16 v[160:163], a[16:19], v[48:51], v[160:163]
    v_mfma_f32_16x16x32_bf16 v[164:167], a[16:19], v[52:55], v[164:167]
    v_mfma_f32_16x16x32_bf16 v[168:171], a[16:19], v[56:59], v[168:171]
    s_waitcnt vmcnt(12)
    v_mfma_f32_16x16x32_bf16 v[172:175], a[20:23], v[44:47], v[172:175]
    buffer_load_dwordx4 a[40:43], v4, s[32:35], s38 offen offset:1024
    v_mfma_f32_16x16x32_bf16 v[176:179], a[20:23], v[48:51], v[176:179]
    v_mfma_f32_16x16x32_bf16 v[180:183], a[20:23], v[52:55], v[180:183]
    v_mfma_f32_16x16x32_bf16 v[184:187], a[20:23], v[56:59], v[184:187]
    s_waitcnt vmcnt(12)
    v_mfma_f32_16x16x32_bf16 v[188:191], a[24:27], v[44:47], v[188:191]
    buffer_load_dwordx4 a[44:47], v4, s[32:35], s38 offen offset:2048
    v_mfma_f32_16x16x32_bf16 v[192:195], a[24:27], v[48:51], v[192:195]
    v_mfma_f32_16x16x32_bf16 v[196:199], a[24:27], v[52:55], v[196:199]
    v_mfma_f32_16x16x32_bf16 v[200:203], a[24:27], v[56:59], v[200:203]
    s_waitcnt vmcnt(12)
    v_mfma_f32_16x16x32_bf16 v[204:207], a[28:31], v[44:47], v[204:207]
    buffer_load_dwordx4 a[48:51], v4, s[32:35], s38 offen offset:3072
    v_mfma_f32_16x16x32_bf16 v[208:211], a[28:31], v[48:51], v[208:211]
    v_mfma_f32_16x16x32_bf16 v[212:215], a[28:31], v[52:55], v[212:215]
    v_mfma_f32_16x16x32_bf16 v[216:219], a[28:31], v[56:59], v[216:219]
    buffer_load_dwordx4 a[68:71], v6, s[32:35], s38 offen offset:0
    buffer_load_dwordx4 v[76:79], v7, s[32:35], s39 offen offset:1024
    buffer_load_dwordx4 v[80:83], v8, s[32:35], s39 offen offset:1024
    buffer_load_dwordx4 v[84:87], v9, s[32:35], s39 offen offset:1024
    s_waitcnt vmcnt(14)
    s_barrier
    ds_read_b128 a[72:75], v252 offset:0
    ds_read_b128 a[76:79], v252 offset:1024
    ds_read_b128 a[80:83], v252 offset:2048
    ds_read_b128 a[84:87], v252 offset:3072
    ds_read_b128 a[88:91], v252 offset:4096
    ds_read_b128 a[92:95], v252 offset:5120
    ds_read_b128 a[96:99], v252 offset:6144
    ds_read_b128 a[100:103], v252 offset:7168
    ds_read_b128 a[104:107], v252 offset:8192
    buffer_load_dwordx4 v[88:91], v10, s[32:35], s39 offen offset:1024
    s_add_u32 s39, s39, 8192
    buffer_load_dwordx4 a[52:55], v5, s[32:35], s38 offen offset:0
    buffer_load_dwordx4 a[56:59], v5, s[32:35], s38 offen offset:1024
    s_waitcnt vmcnt(15)
    s_waitcnt lgkmcnt(8)
    v_mfma_f32_16x16x32_bf16 v[156:159], a[72:75], v[92:95], v[156:159]
    s_waitcnt lgkmcnt(7)
    v_mfma_f32_16x16x32_bf16 v[172:175], a[76:79], v[92:95], v[172:175]
    s_waitcnt lgkmcnt(6)
    v_mfma_f32_16x16x32_bf16 v[188:191], a[80:83], v[92:95], v[188:191]
    s_waitcnt lgkmcnt(5)
    v_mfma_f32_16x16x32_bf16 v[204:207], a[84:87], v[92:95], v[204:207]
    s_waitcnt lgkmcnt(4)
    v_mfma_f32_16x16x32_bf16 v[156:159], a[88:91], v[108:111], v[156:159]
    s_waitcnt lgkmcnt(3)
    v_mfma_f32_16x16x32_bf16 v[172:175], a[92:95], v[108:111], v[172:175]
    s_waitcnt lgkmcnt(2)
    v_mfma_f32_16x16x32_bf16 v[188:191], a[96:99], v[108:111], v[188:191]
    s_waitcnt lgkmcnt(1)
    v_mfma_f32_16x16x32_bf16 v[204:207], a[100:103], v[108:111], v[204:207]
    s_waitcnt lgkmcnt(0)
    v_mfma_f32_16x16x32_bf16 v[220:223], a[104:107], v[92:95], v[220:223]
    s_waitcnt lgkmcnt(0)
    v_mfma_f32_16x16x32_bf16 v[236:239], a[104:107], v[108:111], v[236:239]
    s_waitcnt vmcnt(6)
    v_mfma_f32_16x16x32_bf16 v[220:223], a[68:71], v[60:63], v[220:223]
    buffer_load_dwordx4 a[60:63], v5, s[32:35], s38 offen offset:2048
    v_mfma_f32_16x16x32_bf16 v[224:227], a[68:71], v[64:67], v[224:227]
    v_mfma_f32_16x16x32_bf16 v[228:231], a[68:71], v[68:71], v[228:231]
    v_mfma_f32_16x16x32_bf16 v[232:235], a[68:71], v[72:75], v[232:235]
    s_waitcnt vmcnt(3)
    v_mfma_f32_16x16x32_bf16 v[236:239], a[68:71], v[76:79], v[236:239]
    buffer_load_dwordx4 a[64:67], v5, s[32:35], s38 offen offset:3072
    s_add_u32 s38, s38, 36864
    v_mfma_f32_16x16x32_bf16 v[240:243], a[68:71], v[80:83], v[240:243]
    v_mfma_f32_16x16x32_bf16 v[244:247], a[68:71], v[84:87], v[244:247]
    v_mfma_f32_16x16x32_bf16 v[248:251], a[68:71], v[88:91], v[248:251]
    v_mfma_f32_16x16x32_bf16 v[156:159], a[36:39], v[60:63], v[156:159]
    buffer_load_dwordx4 v[16:19], v12, s[24:27], s6 offen offset:0
    v_mfma_f32_16x16x32_bf16 v[160:163], a[36:39], v[64:67], v[160:163]
    v_mfma_f32_16x16x32_bf16 v[164:167], a[36:39], v[68:71], v[164:167]
    v_mfma_f32_16x16x32_bf16 v[168:171], a[36:39], v[72:75], v[168:171]
    s_mov_b32 exec_hi, 0
    ds_write_b128 v11, v[224:227] offset:4096
    ds_write_b128 v14, v[228:231] offset:4096
    ds_write_b128 v15, v[232:235] offset:4096
    s_mov_b32 exec_hi, -1
    s_waitcnt vmcnt(4)
    v_mfma_f32_16x16x32_bf16 v[156:159], a[52:55], v[76:79], v[156:159]
    buffer_load_dwordx4 v[20:23], v12, s[24:27], s6 offen offset:64
    v_mfma_f32_16x16x32_bf16 v[160:163], a[52:55], v[80:83], v[160:163]
    v_mfma_f32_16x16x32_bf16 v[164:167], a[52:55], v[84:87], v[164:167]
    v_mfma_f32_16x16x32_bf16 v[168:171], a[52:55], v[88:91], v[168:171]
    s_mov_b32 exec_lo, 0
    ds_write_b128 v11, v[240:243] offset:4096
    ds_write_b128 v14, v[244:247] offset:4096
    ds_write_b128 v15, v[248:251] offset:4096
    v_mov_b32 v220, v236
    v_mov_b32 v221, v237
    v_mov_b32 v222, v238
    v_mov_b32 v223, v239
    s_mov_b32 exec_lo, -1
    v_mfma_f32_16x16x32_bf16 v[172:175], a[40:43], v[60:63], v[172:175]
    buffer_load_dwordx2 v[24:25], v27, s[24:27], s6 offen offset:128
    v_mfma_f32_16x16x32_bf16 v[176:179], a[40:43], v[64:67], v[176:179]
    v_mfma_f32_16x16x32_bf16 v[180:183], a[40:43], v[68:71], v[180:183]
    v_mfma_f32_16x16x32_bf16 v[184:187], a[40:43], v[72:75], v[184:187]
    s_nop 1
    ds_write_b128 v11, v[160:163] offset:0
    ds_write_b128 v14, v[164:167] offset:0
    ds_write_b128 v15, v[168:171] offset:0
    s_waitcnt vmcnt(5)
    v_mfma_f32_16x16x32_bf16 v[172:175], a[56:59], v[76:79], v[172:175]
    buffer_load_dwordx2 v[124:125], v142, s[32:35], s50 offen
    s_add_u32 s50, s50, 18432
    v_mfma_f32_16x16x32_bf16 v[176:179], a[56:59], v[80:83], v[176:179]
    v_mfma_f32_16x16x32_bf16 v[180:183], a[56:59], v[84:87], v[180:183]
    v_mfma_f32_16x16x32_bf16 v[184:187], a[56:59], v[88:91], v[184:187]
    v_mfma_f32_16x16x32_bf16 v[188:191], a[44:47], v[60:63], v[188:191]
    buffer_load_dwordx2 v[126:127], v142, s[32:35], s50 offen
    s_add_u32 s50, s50, 18432
    v_mfma_f32_16x16x32_bf16 v[192:195], a[44:47], v[64:67], v[192:195]
    v_mfma_f32_16x16x32_bf16 v[196:199], a[44:47], v[68:71], v[196:199]
    v_mfma_f32_16x16x32_bf16 v[200:203], a[44:47], v[72:75], v[200:203]
    s_nop 1
    ds_write_b128 v11, v[176:179] offset:1024
    ds_write_b128 v14, v[180:183] offset:1024
    ds_write_b128 v15, v[184:187] offset:1024
    s_waitcnt vmcnt(6)
    v_mfma_f32_16x16x32_bf16 v[188:191], a[60:63], v[76:79], v[188:191]
    buffer_load_dwordx2 v[128:129], v142, s[32:35], s50 offen
    s_add_u32 s50, s50, 18432
    v_mfma_f32_16x16x32_bf16 v[192:195], a[60:63], v[80:83], v[192:195]
    v_mfma_f32_16x16x32_bf16 v[196:199], a[60:63], v[84:87], v[196:199]
    v_mfma_f32_16x16x32_bf16 v[200:203], a[60:63], v[88:91], v[200:203]
    v_mfma_f32_16x16x32_bf16 v[204:207], a[48:51], v[60:63], v[204:207]
    buffer_load_dwordx2 v[130:131], v142, s[32:35], s50 offen
    s_add_u32 s50, s50, 18432
    v_mfma_f32_16x16x32_bf16 v[208:211], a[48:51], v[64:67], v[208:211]
    v_mfma_f32_16x16x32_bf16 v[212:215], a[48:51], v[68:71], v[212:215]
    v_mfma_f32_16x16x32_bf16 v[216:219], a[48:51], v[72:75], v[216:219]
    s_nop 1
    ds_write_b128 v11, v[192:195] offset:2048
    ds_write_b128 v14, v[196:199] offset:2048
    ds_write_b128 v15, v[200:203] offset:2048
    s_waitcnt vmcnt(7)
    v_mfma_f32_16x16x32_bf16 v[204:207], a[64:67], v[76:79], v[204:207]
    buffer_load_dwordx2 v[132:133], v142, s[32:35], s50 offen
    s_add_u32 s50, s50, 18432
    v_mfma_f32_16x16x32_bf16 v[208:211], a[64:67], v[80:83], v[208:211]
    v_mfma_f32_16x16x32_bf16 v[212:215], a[64:67], v[84:87], v[212:215]
    v_mfma_f32_16x16x32_bf16 v[216:219], a[64:67], v[88:91], v[216:219]
    s_nop 7
    ds_write_b128 v11, v[208:211] offset:3072
    ds_write_b128 v14, v[212:215] offset:3072
    ds_write_b128 v15, v[216:219] offset:3072
    buffer_load_dwordx2 v[134:135], v142, s[32:35], s50 offen
    s_add_u32 s50, s50, 18432
    buffer_load_dwordx2 v[136:137], v142, s[32:35], s50 offen
    s_add_u32 s50, s50, 18432
    s_mul_i32 s44, s40, 15360
    s_add_u32 s44, s44, 92160
    v_add_u32 v252, s44, v4
    s_waitcnt lgkmcnt(0)
    s_barrier
    ds_read_b128 v[28:31], v252 offset:0
    ds_read_b128 v[32:35], v252 offset:5120
    ds_read_b128 v[36:39], v252 offset:10240
    ds_read_b128 v[40:43], v252 offset:1024
    ds_read_b128 v[44:47], v252 offset:6144
    ds_read_b128 v[48:51], v252 offset:11264
    ds_read_b128 v[52:55], v252 offset:2048
    ds_read_b128 v[56:59], v252 offset:7168
    ds_read_b128 v[60:63], v252 offset:12288
    ds_read_b128 v[64:67], v252 offset:3072
    ds_read_b128 v[68:71], v252 offset:8192
    ds_read_b128 v[72:75], v252 offset:13312
    ds_read_b128 v[76:79], v252 offset:4096
    ds_read_b128 v[80:83], v252 offset:9216
    ds_read_b128 v[84:87], v252 offset:14336
    buffer_load_dwordx2 v[138:139], v142, s[32:35], s50 offen
    s_add_u32 s50, s50, 18432
    buffer_load_dwordx2 v[140:141], v142, s[32:35], s50 offen
    s_add_u32 s50, s50, 18432
    s_add_u32 m0, s48, 0
    s_add_u32 s14, s49, s13
    buffer_load_dwordx4 v4, s[32:35], s49 offen offset:0 lds
    buffer_load_dwordx4 v4, s[32:35], s49 offen offset:1024 lds
    s_waitcnt vmcnt(11)
    buffer_load_dwordx4 v4, s[32:35], s49 offen offset:2048 lds
    s_waitcnt lgkmcnt(12)
    v_lshlrev_b32 v92, 16, v16
    v_and_b32 v93, 0xffff0000, v16
    v_lshlrev_b32 v94, 16, v17
    v_and_b32 v95, 0xffff0000, v17
    v_pk_add_f32 v[156:157], v[156:157], v[28:29]
    v_pk_add_f32 v[158:159], v[158:159], v[30:31]
    v_pk_add_f32 v[32:33], v[32:33], v[36:37]
    v_pk_add_f32 v[34:35], v[34:35], v[38:39]
    v_pk_add_f32 v[156:157], v[156:157], v[32:33]
    v_pk_add_f32 v[158:159], v[158:159], v[34:35]
    v_pk_add_f32 v[156:157], v[156:157], v[92:93]
    v_pk_add_f32 v[158:159], v[158:159], v[94:95]
    v_cvt_pk_bf16_f32 v16, v156, v157
    v_cvt_pk_bf16_f32 v17, v158, v159
    v_min_u32 v16, -2, v16
    v_pk_add_f32 v[100:101], v[156:157], v[158:159]
    v_pk_mul_f32 v[102:103], v[156:157], v[156:157]
    v_pk_fma_f32 v[102:103], v[158:159], v[158:159], v[102:103]
    buffer_load_dwordx4 v4, s[32:35], s49 offen offset:3072 lds
    s_add_u32 m0, s12, 0
    s_add_u32 s49, s49, 20480
    s_waitcnt lgkmcnt(9)
    v_lshlrev_b32 v96, 16, v18
    v_and_b32 v97, 0xffff0000, v18
    v_lshlrev_b32 v98, 16, v19
    v_and_b32 v99, 0xffff0000, v19
    v_pk_add_f32 v[172:173], v[172:173], v[40:41]
    v_pk_add_f32 v[174:175], v[174:175], v[42:43]
    v_pk_add_f32 v[44:45], v[44:45], v[48:49]
    v_pk_add_f32 v[46:47], v[46:47], v[50:51]
    v_pk_add_f32 v[172:173], v[172:173], v[44:45]
    v_pk_add_f32 v[174:175], v[174:175], v[46:47]
    v_pk_add_f32 v[172:173], v[172:173], v[96:97]
    v_pk_add_f32 v[174:175], v[174:175], v[98:99]
    v_cvt_pk_bf16_f32 v18, v172, v173
    v_cvt_pk_bf16_f32 v19, v174, v175
    buffer_store_dwordx4 v[16:19], v4, s[32:35], s7 offen offset:0 sc1
    v_pk_add_f32 v[100:101], v[100:101], v[172:173]
    v_pk_add_f32 v[100:101], v[100:101], v[174:175]
    v_pk_fma_f32 v[102:103], v[172:173], v[172:173], v[102:103]
    v_pk_fma_f32 v[102:103], v[174:175], v[174:175], v[102:103]
    buffer_load_dwordx4 v4, s[32:35], s14 offen offset:0 lds
    s_waitcnt lgkmcnt(6)
    v_lshlrev_b32 v92, 16, v20
    v_and_b32 v93, 0xffff0000, v20
    v_lshlrev_b32 v94, 16, v21
    v_and_b32 v95, 0xffff0000, v21
    v_pk_add_f32 v[188:189], v[188:189], v[52:53]
    v_pk_add_f32 v[190:191], v[190:191], v[54:55]
    v_pk_add_f32 v[56:57], v[56:57], v[60:61]
    v_pk_add_f32 v[58:59], v[58:59], v[62:63]
    v_pk_add_f32 v[188:189], v[188:189], v[56:57]
    v_pk_add_f32 v[190:191], v[190:191], v[58:59]
    v_pk_add_f32 v[188:189], v[188:189], v[92:93]
    v_pk_add_f32 v[190:191], v[190:191], v[94:95]
    v_cvt_pk_bf16_f32 v20, v188, v189
    v_cvt_pk_bf16_f32 v21, v190, v191
    v_min_u32 v20, -2, v20
    v_pk_add_f32 v[100:101], v[100:101], v[188:189]
    v_pk_add_f32 v[100:101], v[100:101], v[190:191]
    v_pk_fma_f32 v[102:103], v[188:189], v[188:189], v[102:103]
    v_pk_fma_f32 v[102:103], v[190:191], v[190:191], v[102:103]
    s_add_u32 m0, s48, 20480
    s_nop 0
    buffer_load_dwordx4 v4, s[32:35], s49 offen offset:0 lds
    s_waitcnt lgkmcnt(3)
    v_lshlrev_b32 v96, 16, v22
    v_and_b32 v97, 0xffff0000, v22
    v_lshlrev_b32 v98, 16, v23
    v_and_b32 v99, 0xffff0000, v23
    v_pk_add_f32 v[204:205], v[204:205], v[64:65]
    v_pk_add_f32 v[206:207], v[206:207], v[66:67]
    v_pk_add_f32 v[68:69], v[68:69], v[72:73]
    v_pk_add_f32 v[70:71], v[70:71], v[74:75]
    v_pk_add_f32 v[204:205], v[204:205], v[68:69]
    v_pk_add_f32 v[206:207], v[206:207], v[70:71]
    v_pk_add_f32 v[204:205], v[204:205], v[96:97]
    v_pk_add_f32 v[206:207], v[206:207], v[98:99]
    v_cvt_pk_bf16_f32 v22, v204, v205
    v_cvt_pk_bf16_f32 v23, v206, v207
    buffer_store_dwordx4 v[20:23], v4, s[32:35], s7 offen offset:1024 sc1
    v_pk_add_f32 v[100:101], v[100:101], v[204:205]
    v_pk_add_f32 v[100:101], v[100:101], v[206:207]
    v_pk_fma_f32 v[102:103], v[204:205], v[204:205], v[102:103]
    v_pk_fma_f32 v[102:103], v[206:207], v[206:207], v[102:103]
    buffer_load_dwordx4 v4, s[32:35], s49 offen offset:1024 lds
    s_waitcnt lgkmcnt(0)
    v_lshlrev_b32 v92, 16, v24
    v_and_b32 v93, 0xffff0000, v24
    v_lshlrev_b32 v94, 16, v25
    v_and_b32 v95, 0xffff0000, v25
    v_pk_add_f32 v[220:221], v[220:221], v[76:77]
    v_pk_add_f32 v[222:223], v[222:223], v[78:79]
    v_pk_add_f32 v[80:81], v[80:81], v[84:85]
    v_pk_add_f32 v[82:83], v[82:83], v[86:87]
    v_pk_add_f32 v[220:221], v[220:221], v[80:81]
    v_pk_add_f32 v[222:223], v[222:223], v[82:83]
    v_mov_b32 v76, v220
    v_mov_b32 v77, v221
    v_mov_b32 v78, v222
    v_mov_b32 v79, v223
    v_permlane32_swap_b32 v220, v76
    v_permlane32_swap_b32 v221, v77
    v_permlane32_swap_b32 v222, v78
    v_permlane32_swap_b32 v223, v79
    s_mov_b32 exec_hi, 0
    v_pk_add_f32 v[220:221], v[220:221], v[76:77]
    v_pk_add_f32 v[222:223], v[222:223], v[78:79]
    v_pk_add_f32 v[220:221], v[220:221], v[92:93]
    v_pk_add_f32 v[222:223], v[222:223], v[94:95]
    v_cvt_pk_bf16_f32 v24, v220, v221
    v_cvt_pk_bf16_f32 v25, v222, v223
    v_min_u32 v24, -2, v24
    buffer_store_dwordx2 v[24:25], v13, s[32:35], s7 offen offset:2048 sc1
    v_pk_add_f32 v[100:101], v[100:101], v[220:221]
    v_pk_add_f32 v[100:101], v[100:101], v[222:223]
    v_pk_fma_f32 v[102:103], v[220:221], v[220:221], v[102:103]
    v_pk_fma_f32 v[102:103], v[222:223], v[222:223], v[102:103]
    s_mov_b32 exec_hi, -1
    buffer_load_dwordx4 v4, s[32:35], s49 offen offset:2048 lds
    buffer_load_dwordx4 v4, s[32:35], s49 offen offset:3072 lds
    s_add_u32 s49, s49, 16384
    v_add_f32 v100, v100, v101
    v_add_f32 v102, v102, v103
    v_mov_b32 v101, v100
    v_mov_b32 v103, v102
    s_nop 1
    v_permlane32_swap_b32 v100, v101
    v_permlane32_swap_b32 v102, v103
    v_add_f32 v100, v100, v101
    v_add_f32 v102, v102, v103
    v_mov_b32 v101, v100
    v_mov_b32 v103, v102
    s_nop 1
    v_permlane16_swap_b32 v100, v101
    v_permlane16_swap_b32 v102, v103
    v_add_f32 v100, v100, v101
    v_add_f32 v101, v102, v103
    s_mov_b64 exec, 0xffff
    buffer_store_dwordx2 v[100:101], v4, s[32:35], s10 offen sc1
    s_mov_b64 exec, -1
    v_add_u32 v5, 18432, v4
    s_mul_i32 s44, s40, 9216
    s_add_u32 s44, s44, 36864
    v_add_u32 v6, s44, v4
    v_lshrrev_b32 v8, 5, v1
    v_lshl_add_u32 v6, v8, 9, v6
    v_mov_b32 v8, v4
    v_add_u32 v9, 55296, v4
    v_add_u32 v10, 110592, v4
    s_lshr_b32 s50, s43, 4
    s_lshl_b32 s11, s50, 10
    s_add_u32 s11, s11, 72482816
    s_mul_i32 s50, s50, 18432
    s_add_u32 s50, s50, 9437184
    s_mul_i32 s54, s42, 36864
    s_lshl_b32 s44, s41, 2
    s_add_u32 s44, s44, s40
    s_lshl_b32 s18, s44, 17
    s_add_u32 s18, s18, 62914560
    s_lshl_b32 s51, s41, 13
    s_add_u32 s51, s51, s18
    s_add_u32 s15, s54, 0
    s_add_u32 s15, s15, s48
    s_add_u32 s19, s41, s42
    s_and_b32 s19, s19, 3
    s_lshl_b32 s19, s19, 2
    s_or_b32 s19, s19, 0x40000
    s_bfe_u32 s59, 52428, s19
    s_lshl_b32 s53, s42, 11
    s_add_u32 s53, s53, 72351744
    s_lshl_b32 s52, s41, 7
    s_add_u32 s52, s52, s53
    s_lshl_b32 s8, s40, 15
    s_add_u32 s52, s52, s8
    s_lshl_b32 s8, s44, 10
    s_lshl_b32 s45, s42, 6
    s_add_u32 s8, s8, s45
    s_add_u32 s8, s8, 72613888
    s_lshl_b32 s9, s37, 11
    s_add_u32 s9, s9, 72613888
    s_lshl_b32 s62, s44, 12
    s_add_u32 s62, s62, 26214400
    s_bfe_u32 s45, s42, 0x10001
    s_lshl_b32 s45, s45, 10
    s_add_u32 s63, s62, s45
    s_lshr_b32 s45, s42, 2
    s_lshl_b32 s45, s45, 8
    s_add_u32 s63, s63, s45
    s_and_b32 s45, s42, 1
    s_lshl_b32 s45, s45, 3
    s_add_u32 s63, s63, s45
    s_mul_i32 s44, s44, 9216
    s_add_u32 s54, s54, s44
    s_mul_i32 s44, s41, 552960
    s_add_u32 s54, s54, s44
    s_add_u32 s54, s54, 0
    s_mov_b32 s60, 1.0
    s_mov_b32 s61, 1.0
    s_lshl_b32 s44, s40, 9
    s_add_u32 s44, s44, 155648
    v_lshlrev_b32 v18, 2, v2
    v_add_u32 v232, 153600, v18
    v_and_b32 v235, 48, v18
    v_add_u32 v235, v235, v232
    v_add_u32 v18, s44, v18
    v_lshlrev_b32 v19, 4, v3
    v_add_u32 v233, 154176, v19
    v_add_u32 v236, v233, v19
    v_add_u32 v19, s44, v19
    v_lshlrev_b32 v7, 2, v1
    s_lshr_b32 s56, s43, 4
    s_mul_i32 s56, s56, 73728
    s_add_u32 s56, s56, 36700160
    s_lshl_b32 s44, s42, 9
    s_add_u32 s58, s56, s44
    s_lshr_b32 s44, s42, 2
    s_lshl_b32 s44, s44, 11
    s_add_u32 s56, s56, s44
    s_and_b32 s44, s42, 1
    s_lshl_b32 s44, s44, 10
    s_add_u32 s56, s56, s44
    s_and_b32 s44, s42, 2
    s_lshl_b32 s44, s44, 12
    s_add_u32 s56, s56, s44
    s_lshl_b32 s44, s40, 8
    s_add_u32 s9, s9, s44
    s_add_u32 m0, s48, 36864
    s_add_u32 s14, s49, s13
    buffer_load_dwordx4 v4, s[32:35], s49 offen offset:0 lds
    buffer_load_dwordx4 v4, s[32:35], s49 offen offset:1024 lds
    buffer_load_dwordx4 v4, s[32:35], s49 offen offset:2048 lds
    buffer_load_dwordx4 v4, s[32:35], s49 offen offset:3072 lds
    s_add_u32 m0, s12, 36864
    s_add_u32 s49, s49, 20480
    buffer_load_dwordx4 v4, s[32:35], s14 offen offset:0 lds
    s_add_u32 m0, s48, 57344
    s_nop 0
    buffer_load_dwordx4 v4, s[32:35], s49 offen offset:0 lds
    buffer_load_dwordx4 v4, s[32:35], s49 offen offset:1024 lds
    buffer_load_dwordx4 v4, s[32:35], s49 offen offset:2048 lds
    s_branch L_pgpost_kernel_1_s
.p2align 12
L_pgpost_kernel_1:
    s_branch L_pgpost_kernel_5
L_pgpost_kernel_1_s:
    buffer_load_dwordx4 v4, s[32:35], s49 offen offset:3072 lds
    s_add_u32 s49, s49, 16384
    s_waitcnt vmcnt(22)
    v_pk_add_f32 v[124:125], v[124:125], v[126:127]
    v_pk_add_f32 v[124:125], v[124:125], v[128:129]
    v_pk_add_f32 v[124:125], v[124:125], v[130:131]
    v_pk_add_f32 v[124:125], v[124:125], v[132:133]
    v_pk_add_f32 v[124:125], v[124:125], v[134:135]
    v_pk_add_f32 v[124:125], v[124:125], v[136:137]
    v_pk_add_f32 v[124:125], v[124:125], v[138:139]
    v_pk_add_f32 v[124:125], v[124:125], v[140:141]
    ds_write_b64 v143, v[124:125]
    s_waitcnt lgkmcnt(0)
    s_barrier
    ds_read_b32 v180, v235 offset:0
    ds_read_b32 v181, v235 offset:16
    ds_read_b32 v182, v235 offset:128
    ds_read_b32 v183, v235 offset:144
    ds_read_b32 v184, v235 offset:256
    ds_read_b32 v185, v235 offset:272
    ds_read_b32 v186, v235 offset:384
    ds_read_b32 v187, v235 offset:400
    ds_read_b32 v188, v232 offset:512
    ds_read_b128 v[92:95], v236 offset:0
    ds_read_b128 v[100:103], v236 offset:16
    ds_read_b128 v[108:111], v236 offset:128
    ds_read_b128 v[116:119], v236 offset:144
    ds_read_b128 v[124:127], v236 offset:256
    ds_read_b128 v[132:135], v236 offset:272
    ds_read_b128 v[140:143], v236 offset:384
    ds_read_b128 v[148:151], v236 offset:400
    ds_read_b128 v[156:159], v233 offset:512
    buffer_load_dwordx4 a[0:3], v4, s[32:35], s50 offen offset:0
    buffer_load_dwordx4 a[4:7], v5, s[32:35], s50 offen offset:0
    buffer_load_dwordx4 a[8:11], v4, s[32:35], s50 offen offset:1024
    buffer_load_dwordx4 a[12:15], v5, s[32:35], s50 offen offset:1024
    s_add_u32 s50, s50, 2048
    buffer_load_dwordx4 a[16:19], v4, s[32:35], s50 offen offset:0
    buffer_load_dwordx4 a[20:23], v5, s[32:35], s50 offen offset:0
    buffer_load_dwordx4 a[24:27], v4, s[32:35], s50 offen offset:1024
    buffer_load_dwordx4 a[28:31], v5, s[32:35], s50 offen offset:1024
    s_add_u32 s50, s50, 2048
    buffer_load_dwordx4 a[32:35], v4, s[32:35], s50 offen offset:0
    buffer_load_dwordx4 a[36:39], v5, s[32:35], s50 offen offset:0
    buffer_load_dwordx4 a[40:43], v4, s[32:35], s50 offen offset:1024
    buffer_load_dwordx4 a[44:47], v5, s[32:35], s50 offen offset:1024
    s_add_u32 s50, s50, 2048
    buffer_load_dwordx4 a[48:51], v4, s[32:35], s50 offen offset:0
    buffer_load_dwordx4 a[52:55], v5, s[32:35], s50 offen offset:0
    buffer_load_dwordx4 a[56:59], v4, s[32:35], s50 offen offset:1024
    buffer_load_dwordx4 a[60:63], v5, s[32:35], s50 offen offset:1024
    s_add_u32 s50, s50, 2048
    v_mov_b32 v216, 0
    v_mov_b32 v217, 0
    v_mov_b32 v218, 0
    v_mov_b32 v219, 0
    v_mov_b32 v220, 0
    v_mov_b32 v221, 0
    v_mov_b32 v222, 0
    v_mov_b32 v223, 0
    v_mov_b32 v224, 0
    v_mov_b32 v225, 0
    v_mov_b32 v226, 0
    v_mov_b32 v227, 0
    v_mov_b32 v228, 0
    v_mov_b32 v229, 0
    v_mov_b32 v230, 0
    v_mov_b32 v231, 0
    s_waitcnt vmcnt(32)
    s_waitcnt vmcnt(12)
    s_barrier
    ds_read_b128 a[144:147], v8 offset:0
    ds_read_b128 a[148:151], v8 offset:1024
    ds_read_b128 a[152:155], v8 offset:2048
    ds_read_b128 a[156:159], v8 offset:3072
    ds_read_b128 a[160:163], v8 offset:4096
    ds_read_b128 a[164:167], v8 offset:5120
    ds_read_b128 a[168:171], v8 offset:6144
    ds_read_b128 a[172:175], v8 offset:7168
    ds_read_b128 a[176:179], v8 offset:8192
    v_accvgpr_read_b32 v244, a0
    v_accvgpr_read_b32 v245, a4
    v_accvgpr_read_b32 v246, a8
    v_accvgpr_read_b32 v247, a12
    v_max3_u32 v244, v244, v245, v246
    v_max_u32 v244, v244, v247
    v_cmp_eq_u32 vcc, -1, v244
    s_cbranch_vccnz L_hf0
L_hb0:
    s_waitcnt lgkmcnt(0)
    v_mfma_f32_16x16x32_bf16 v[20:23], a[0:3], a[144:147], 0
    ds_read_b128 a[180:183], v8 offset:9216
    v_mfma_f32_16x16x32_bf16 v[24:27], a[4:7], a[144:147], 0
    ds_read_b128 a[184:187], v8 offset:10240
    v_mfma_f32_16x16x32_bf16 v[28:31], a[0:3], a[148:151], 0
    ds_read_b128 a[188:191], v8 offset:11264
    v_mfma_f32_16x16x32_bf16 v[32:35], a[4:7], a[148:151], 0
    ds_read_b128 a[192:195], v8 offset:12288
    v_mfma_f32_16x16x32_bf16 v[36:39], a[0:3], a[152:155], 0
    ds_read_b128 a[196:199], v8 offset:13312
    v_mfma_f32_16x16x32_bf16 v[40:43], a[4:7], a[152:155], 0
    ds_read_b128 a[200:203], v8 offset:14336
    v_mfma_f32_16x16x32_bf16 v[44:47], a[0:3], a[156:159], 0
    ds_read_b128 a[204:207], v8 offset:15360
    v_mfma_f32_16x16x32_bf16 v[48:51], a[4:7], a[156:159], 0
    ds_read_b128 a[208:211], v8 offset:16384
    v_mfma_f32_16x16x32_bf16 v[52:55], a[0:3], a[160:163], 0
    ds_read_b128 a[212:215], v8 offset:17408
    v_mfma_f32_16x16x32_bf16 v[56:59], a[4:7], a[160:163], 0
    s_add_u32 m0, s48, 73728
    s_add_u32 s14, s49, s13
    buffer_load_dwordx4 v4, s[32:35], s49 offen offset:0 lds
    v_mfma_f32_16x16x32_bf16 v[60:63], a[0:3], a[164:167], 0
    v_mfma_f32_16x16x32_bf16 v[64:67], a[4:7], a[164:167], 0
    buffer_load_dwordx4 v4, s[32:35], s49 offen offset:1024 lds
    v_mfma_f32_16x16x32_bf16 v[68:71], a[0:3], a[168:171], 0
    v_mfma_f32_16x16x32_bf16 v[72:75], a[4:7], a[168:171], 0
    buffer_load_dwordx4 v4, s[32:35], s49 offen offset:2048 lds
    v_mfma_f32_16x16x32_bf16 v[76:79], a[0:3], a[172:175], 0
    v_mfma_f32_16x16x32_bf16 v[80:83], a[4:7], a[172:175], 0
    buffer_load_dwordx4 v4, s[32:35], s49 offen offset:3072 lds
    s_add_u32 m0, s12, 73728
    s_add_u32 s49, s49, 20480
    v_mfma_f32_16x16x32_bf16 v[84:87], a[0:3], a[176:179], 0
    v_mfma_f32_16x16x32_bf16 v[88:91], a[4:7], a[176:179], 0
    buffer_load_dwordx4 v4, s[32:35], s14 offen offset:0 lds
    s_waitcnt vmcnt(13)
    s_barrier
    s_waitcnt lgkmcnt(0)
    v_mfma_f32_16x16x32_bf16 v[20:23], a[8:11], a[180:183], v[20:23]
    ds_read_b128 a[144:147], v8 offset:18432
    v_accvgpr_read_b32 v244, a16
    v_mfma_f32_16x16x32_bf16 v[24:27], a[12:15], a[180:183], v[24:27]
    ds_read_b128 a[148:151], v8 offset:19456
    buffer_load_dwordx4 a[64:67], v4, s[32:35], s50 offen offset:0
    v_mfma_f32_16x16x32_bf16 v[28:31], a[8:11], a[184:187], v[28:31]
    ds_read_b128 a[152:155], v8 offset:20480
    v_accvgpr_read_b32 v245, a20
    v_mfma_f32_16x16x32_bf16 v[32:35], a[12:15], a[184:187], v[32:35]
    ds_read_b128 a[156:159], v8 offset:21504
    buffer_load_dwordx4 a[68:71], v5, s[32:35], s50 offen offset:0
    v_mfma_f32_16x16x32_bf16 v[36:39], a[8:11], a[188:191], v[36:39]
    ds_read_b128 a[160:163], v8 offset:22528
    v_accvgpr_read_b32 v246, a24
    v_mfma_f32_16x16x32_bf16 v[40:43], a[12:15], a[188:191], v[40:43]
    ds_read_b128 a[164:167], v8 offset:23552
    buffer_load_dwordx4 a[72:75], v4, s[32:35], s50 offen offset:1024
    v_mfma_f32_16x16x32_bf16 v[44:47], a[8:11], a[192:195], v[44:47]
    ds_read_b128 a[168:171], v8 offset:24576
    v_accvgpr_read_b32 v247, a28
    v_mfma_f32_16x16x32_bf16 v[48:51], a[12:15], a[192:195], v[48:51]
    ds_read_b128 a[172:175], v8 offset:25600
    buffer_load_dwordx4 a[76:79], v5, s[32:35], s50 offen offset:1024
    s_add_u32 s50, s50, 2048
    v_mfma_f32_16x16x32_bf16 v[52:55], a[8:11], a[196:199], v[52:55]
    ds_read_b128 a[176:179], v8 offset:26624
    v_max3_u32 v244, v244, v245, v246
    v_mfma_f32_16x16x32_bf16 v[56:59], a[12:15], a[196:199], v[56:59]
    buffer_load_dwordx4 a[80:83], v4, s[32:35], s50 offen offset:0
    v_mfma_f32_16x16x32_bf16 v[60:63], a[8:11], a[200:203], v[60:63]
    v_max_u32 v244, v244, v247
    v_cmp_eq_u32 vcc, -1, v244
    v_mfma_f32_16x16x32_bf16 v[64:67], a[12:15], a[200:203], v[64:67]
    buffer_load_dwordx4 a[84:87], v5, s[32:35], s50 offen offset:0
    v_mfma_f32_16x16x32_bf16 v[68:71], a[8:11], a[204:207], v[68:71]
    v_mfma_f32_16x16x32_bf16 v[72:75], a[12:15], a[204:207], v[72:75]
    buffer_load_dwordx4 a[88:91], v4, s[32:35], s50 offen offset:1024
    v_mfma_f32_16x16x32_bf16 v[76:79], a[8:11], a[208:211], v[76:79]
    v_mfma_f32_16x16x32_bf16 v[80:83], a[12:15], a[208:211], v[80:83]
    buffer_load_dwordx4 a[92:95], v5, s[32:35], s50 offen offset:1024
    s_add_u32 s50, s50, 2048
    v_mfma_f32_16x16x32_bf16 v[84:87], a[8:11], a[212:215], v[84:87]
    v_mfma_f32_16x16x32_bf16 v[88:91], a[12:15], a[212:215], v[88:91]
    s_cbranch_vccnz L_hf1
L_hb1:
    s_waitcnt lgkmcnt(0)
    v_mfma_f32_16x16x32_bf16 v[20:23], a[16:19], a[144:147], v[20:23]
    ds_read_b128 a[180:183], v8 offset:27648
    v_mfma_f32_16x16x32_bf16 v[24:27], a[20:23], a[144:147], v[24:27]
    ds_read_b128 a[184:187], v8 offset:28672
    v_mfma_f32_16x16x32_bf16 v[28:31], a[16:19], a[148:151], v[28:31]
    ds_read_b128 a[188:191], v8 offset:29696
    v_mfma_f32_16x16x32_bf16 v[32:35], a[20:23], a[148:151], v[32:35]
    ds_read_b128 a[192:195], v8 offset:30720
    v_mfma_f32_16x16x32_bf16 v[36:39], a[16:19], a[152:155], v[36:39]
    ds_read_b128 a[196:199], v8 offset:31744
    v_mfma_f32_16x16x32_bf16 v[40:43], a[20:23], a[152:155], v[40:43]
    ds_read_b128 a[200:203], v8 offset:32768
    v_mfma_f32_16x16x32_bf16 v[44:47], a[16:19], a[156:159], v[44:47]
    ds_read_b128 a[204:207], v8 offset:33792
    v_mfma_f32_16x16x32_bf16 v[48:51], a[20:23], a[156:159], v[48:51]
    ds_read_b128 a[208:211], v8 offset:34816
    v_mfma_f32_16x16x32_bf16 v[52:55], a[16:19], a[160:163], v[52:55]
    ds_read_b128 a[212:215], v8 offset:35840
    v_mfma_f32_16x16x32_bf16 v[56:59], a[20:23], a[160:163], v[56:59]
    s_add_u32 m0, s48, 94208
    s_nop 0
    buffer_load_dwordx4 v4, s[32:35], s49 offen offset:0 lds
    v_mfma_f32_16x16x32_bf16 v[60:63], a[16:19], a[164:167], v[60:63]
    v_mfma_f32_16x16x32_bf16 v[64:67], a[20:23], a[164:167], v[64:67]
    buffer_load_dwordx4 v4, s[32:35], s49 offen offset:1024 lds
    v_mfma_f32_16x16x32_bf16 v[68:71], a[16:19], a[168:171], v[68:71]
    v_mfma_f32_16x16x32_bf16 v[72:75], a[20:23], a[168:171], v[72:75]
    buffer_load_dwordx4 v4, s[32:35], s49 offen offset:2048 lds
    v_mfma_f32_16x16x32_bf16 v[76:79], a[16:19], a[172:175], v[76:79]
    v_mfma_f32_16x16x32_bf16 v[80:83], a[20:23], a[172:175], v[80:83]
    buffer_load_dwordx4 v4, s[32:35], s49 offen offset:3072 lds
    s_add_u32 s49, s49, 16384
    v_mfma_f32_16x16x32_bf16 v[84:87], a[16:19], a[176:179], v[84:87]
    v_mfma_f32_16x16x32_bf16 v[88:91], a[20:23], a[176:179], v[88:91]
    s_waitcnt vmcnt(21)
    s_barrier
    s_waitcnt lgkmcnt(0)
    v_mfma_f32_16x16x32_bf16 v[20:23], a[24:27], a[180:183], v[20:23]
    ds_read_b128 a[144:147], v8 offset:36864
    v_accvgpr_read_b32 v244, a32
    v_mfma_f32_16x16x32_bf16 v[24:27], a[28:31], a[180:183], v[24:27]
    ds_read_b128 a[148:151], v8 offset:37888
    buffer_load_dwordx4 a[96:99], v4, s[32:35], s50 offen offset:0
    v_mfma_f32_16x16x32_bf16 v[28:31], a[24:27], a[184:187], v[28:31]
    ds_read_b128 a[152:155], v8 offset:38912
    v_accvgpr_read_b32 v245, a36
    v_mfma_f32_16x16x32_bf16 v[32:35], a[28:31], a[184:187], v[32:35]
    ds_read_b128 a[156:159], v8 offset:39936
    buffer_load_dwordx4 a[100:103], v5, s[32:35], s50 offen offset:0
    v_mfma_f32_16x16x32_bf16 v[36:39], a[24:27], a[188:191], v[36:39]
    ds_read_b128 a[160:163], v8 offset:40960
    v_accvgpr_read_b32 v246, a40
    v_mfma_f32_16x16x32_bf16 v[40:43], a[28:31], a[188:191], v[40:43]
    ds_read_b128 a[164:167], v8 offset:41984
    buffer_load_dwordx4 a[104:107], v4, s[32:35], s50 offen offset:1024
    v_mfma_f32_16x16x32_bf16 v[44:47], a[24:27], a[192:195], v[44:47]
    ds_read_b128 a[168:171], v8 offset:43008
    v_accvgpr_read_b32 v247, a44
    v_mfma_f32_16x16x32_bf16 v[48:51], a[28:31], a[192:195], v[48:51]
    ds_read_b128 a[172:175], v8 offset:44032
    buffer_load_dwordx4 a[108:111], v5, s[32:35], s50 offen offset:1024
    s_add_u32 s50, s50, 2048
    v_mfma_f32_16x16x32_bf16 v[52:55], a[24:27], a[196:199], v[52:55]
    ds_read_b128 a[176:179], v8 offset:45056
    v_max3_u32 v244, v244, v245, v246
    v_mfma_f32_16x16x32_bf16 v[56:59], a[28:31], a[196:199], v[56:59]
    buffer_load_dwordx4 v[198:201], v4, s[32:35], s11 offen offset:0 sc1
    v_mfma_f32_16x16x32_bf16 v[60:63], a[24:27], a[200:203], v[60:63]
    v_max_u32 v244, v244, v247
    v_cmp_eq_u32 vcc, -1, v244
    v_mfma_f32_16x16x32_bf16 v[64:67], a[28:31], a[200:203], v[64:67]
    buffer_load_dwordx4 v[204:207], v4, s[32:35], s11 offen offset:1024 sc1
    v_mfma_f32_16x16x32_bf16 v[68:71], a[24:27], a[204:207], v[68:71]
    v_mfma_f32_16x16x32_bf16 v[72:75], a[28:31], a[204:207], v[72:75]
    v_mfma_f32_16x16x32_bf16 v[76:79], a[24:27], a[208:211], v[76:79]
    v_mfma_f32_16x16x32_bf16 v[80:83], a[28:31], a[208:211], v[80:83]
    v_mfma_f32_16x16x32_bf16 v[84:87], a[24:27], a[212:215], v[84:87]
    v_mfma_f32_16x16x32_bf16 v[88:91], a[28:31], a[212:215], v[88:91]
    s_cbranch_vccnz L_hf2
L_hb2:
    s_waitcnt lgkmcnt(0)
    v_mfma_f32_16x16x32_bf16 v[20:23], a[32:35], a[144:147], v[20:23]
    ds_read_b128 a[180:183], v8 offset:46080
    v_mfma_f32_16x16x32_bf16 v[24:27], a[36:39], a[144:147], v[24:27]
    ds_read_b128 a[184:187], v8 offset:47104
    v_mfma_f32_16x16x32_bf16 v[28:31], a[32:35], a[148:151], v[28:31]
    ds_read_b128 a[188:191], v8 offset:48128
    v_mfma_f32_16x16x32_bf16 v[32:35], a[36:39], a[148:151], v[32:35]
    ds_read_b128 a[192:195], v8 offset:49152
    v_mfma_f32_16x16x32_bf16 v[36:39], a[32:35], a[152:155], v[36:39]
    ds_read_b128 a[196:199], v8 offset:50176
    v_mfma_f32_16x16x32_bf16 v[40:43], a[36:39], a[152:155], v[40:43]
    ds_read_b128 a[200:203], v8 offset:51200
    v_mfma_f32_16x16x32_bf16 v[44:47], a[32:35], a[156:159], v[44:47]
    ds_read_b128 a[204:207], v8 offset:52224
    v_mfma_f32_16x16x32_bf16 v[48:51], a[36:39], a[156:159], v[48:51]
    ds_read_b128 a[208:211], v8 offset:53248
    v_mfma_f32_16x16x32_bf16 v[52:55], a[32:35], a[160:163], v[52:55]
    ds_read_b128 a[212:215], v8 offset:54272
    v_mfma_f32_16x16x32_bf16 v[56:59], a[36:39], a[160:163], v[56:59]
    s_add_u32 m0, s48, 110592
    s_add_u32 s14, s49, s13
    buffer_load_dwordx4 v4, s[32:35], s49 offen offset:0 lds
    v_mfma_f32_16x16x32_bf16 v[60:63], a[32:35], a[164:167], v[60:63]
    v_mfma_f32_16x16x32_bf16 v[64:67], a[36:39], a[164:167], v[64:67]
    buffer_load_dwordx4 v4, s[32:35], s49 offen offset:1024 lds
    v_mfma_f32_16x16x32_bf16 v[68:71], a[32:35], a[168:171], v[68:71]
    v_mfma_f32_16x16x32_bf16 v[72:75], a[36:39], a[168:171], v[72:75]
    buffer_load_dwordx4 v4, s[32:35], s49 offen offset:2048 lds
    v_mfma_f32_16x16x32_bf16 v[76:79], a[32:35], a[172:175], v[76:79]
    v_mfma_f32_16x16x32_bf16 v[80:83], a[36:39], a[172:175], v[80:83]
    buffer_load_dwordx4 v4, s[32:35], s49 offen offset:3072 lds
    s_add_u32 m0, s12, 110592
    s_add_u32 s49, s49, 20480
    v_mfma_f32_16x16x32_bf16 v[84:87], a[32:35], a[176:179], v[84:87]
    v_mfma_f32_16x16x32_bf16 v[88:91], a[36:39], a[176:179], v[88:91]
    buffer_load_dwordx4 v4, s[32:35], s14 offen offset:0 lds
    s_waitcnt vmcnt(28)
    s_barrier
    s_waitcnt lgkmcnt(0)
    v_mfma_f32_16x16x32_bf16 v[20:23], a[40:43], a[180:183], v[20:23]
    ds_read_b128 a[144:147], v9 offset:0
    v_accvgpr_read_b32 v244, a48
    v_mfma_f32_16x16x32_bf16 v[24:27], a[44:47], a[180:183], v[24:27]
    ds_read_b128 a[148:151], v9 offset:1024
    v_accvgpr_read_b32 v245, a52
    v_mfma_f32_16x16x32_bf16 v[28:31], a[40:43], a[184:187], v[28:31]
    ds_read_b128 a[152:155], v9 offset:2048
    v_accvgpr_read_b32 v246, a56
    v_mfma_f32_16x16x32_bf16 v[32:35], a[44:47], a[184:187], v[32:35]
    ds_read_b128 a[156:159], v9 offset:3072
    v_accvgpr_read_b32 v247, a60
    v_mfma_f32_16x16x32_bf16 v[36:39], a[40:43], a[188:191], v[36:39]
    ds_read_b128 a[160:163], v9 offset:4096
    v_max3_u32 v244, v244, v245, v246
    v_mfma_f32_16x16x32_bf16 v[40:43], a[44:47], a[188:191], v[40:43]
    ds_read_b128 a[164:167], v9 offset:5120
    v_max_u32 v244, v244, v247
    v_mfma_f32_16x16x32_bf16 v[44:47], a[40:43], a[192:195], v[44:47]
    ds_read_b128 a[168:171], v9 offset:6144
    v_cmp_eq_u32 vcc, -1, v244
    v_mfma_f32_16x16x32_bf16 v[48:51], a[44:47], a[192:195], v[48:51]
    ds_read_b128 a[172:175], v9 offset:7168
    v_mfma_f32_16x16x32_bf16 v[52:55], a[40:43], a[196:199], v[52:55]
    ds_read_b128 a[176:179], v9 offset:8192
    v_mfma_f32_16x16x32_bf16 v[56:59], a[44:47], a[196:199], v[56:59]
    buffer_load_dwordx4 a[112:115], v4, s[32:35], s50 offen offset:0
    v_mfma_f32_16x16x32_bf16 v[60:63], a[40:43], a[200:203], v[60:63]
    v_mfma_f32_16x16x32_bf16 v[64:67], a[44:47], a[200:203], v[64:67]
    buffer_load_dwordx4 a[116:119], v5, s[32:35], s50 offen offset:0
    v_mfma_f32_16x16x32_bf16 v[68:71], a[40:43], a[204:207], v[68:71]
    v_mfma_f32_16x16x32_bf16 v[72:75], a[44:47], a[204:207], v[72:75]
    buffer_load_dwordx4 a[120:123], v4, s[32:35], s50 offen offset:1024
    v_mfma_f32_16x16x32_bf16 v[76:79], a[40:43], a[208:211], v[76:79]
    v_mfma_f32_16x16x32_bf16 v[80:83], a[44:47], a[208:211], v[80:83]
    buffer_load_dwordx4 a[124:127], v5, s[32:35], s50 offen offset:1024
    s_add_u32 s50, s50, 2048
    v_mfma_f32_16x16x32_bf16 v[84:87], a[40:43], a[212:215], v[84:87]
    v_mfma_f32_16x16x32_bf16 v[88:91], a[44:47], a[212:215], v[88:91]
    s_cbranch_vccnz L_hf3
L_hb3:
    s_waitcnt vmcnt(9)
    v_min3_f32 v234, v199, v201, v205
    v_min_f32 v234, v234, v207
    v_cmp_gt_f32 vcc, 0, v234
    s_cbranch_vccnz L_hsf
L_hsb:
    s_waitcnt lgkmcnt(0)
    v_mfma_f32_16x16x32_bf16 v[20:23], a[48:51], a[144:147], v[20:23]
    ds_read_b128 a[180:183], v9 offset:9216
    v_add_f32 v198, v198, v200
    v_mfma_f32_16x16x32_bf16 v[24:27], a[52:55], a[144:147], v[24:27]
    ds_read_b128 a[184:187], v9 offset:10240
    v_add_f32 v199, v199, v201
    v_mfma_f32_16x16x32_bf16 v[28:31], a[48:51], a[148:151], v[28:31]
    ds_read_b128 a[188:191], v9 offset:11264
    v_add_f32 v204, v204, v206
    v_mfma_f32_16x16x32_bf16 v[32:35], a[52:55], a[148:151], v[32:35]
    ds_read_b128 a[192:195], v9 offset:12288
    v_add_f32 v205, v205, v207
    v_mfma_f32_16x16x32_bf16 v[36:39], a[48:51], a[152:155], v[36:39]
    ds_read_b128 a[196:199], v9 offset:13312
    v_mov_b32 v240, v198
    v_mfma_f32_16x16x32_bf16 v[40:43], a[52:55], a[152:155], v[40:43]
    ds_read_b128 a[200:203], v9 offset:14336
    v_mov_b32 v241, v199
    v_mfma_f32_16x16x32_bf16 v[44:47], a[48:51], a[156:159], v[44:47]
    ds_read_b128 a[204:207], v9 offset:15360
    v_mov_b32 v242, v204
    v_mfma_f32_16x16x32_bf16 v[48:51], a[52:55], a[156:159], v[48:51]
    ds_read_b128 a[208:211], v9 offset:16384
    v_mov_b32 v243, v205
    v_mfma_f32_16x16x32_bf16 v[52:55], a[48:51], a[160:163], v[52:55]
    ds_read_b128 a[212:215], v9 offset:17408
    v_mfma_f32_16x16x32_bf16 v[56:59], a[52:55], a[160:163], v[56:59]
    s_add_u32 m0, s48, 131072
    s_nop 0
    buffer_load_dwordx4 v4, s[32:35], s49 offen offset:0 lds
    v_mfma_f32_16x16x32_bf16 v[60:63], a[48:51], a[164:167], v[60:63]
    v_permlane32_swap_b32 v198, v240
    v_mfma_f32_16x16x32_bf16 v[64:67], a[52:55], a[164:167], v[64:67]
    buffer_load_dwordx4 v4, s[32:35], s49 offen offset:1024 lds
    v_mfma_f32_16x16x32_bf16 v[68:71], a[48:51], a[168:171], v[68:71]
    v_permlane32_swap_b32 v199, v241
    v_mfma_f32_16x16x32_bf16 v[72:75], a[52:55], a[168:171], v[72:75]
    buffer_load_dwordx4 v4, s[32:35], s49 offen offset:2048 lds
    v_mfma_f32_16x16x32_bf16 v[76:79], a[48:51], a[172:175], v[76:79]
    v_permlane32_swap_b32 v204, v242
    v_mfma_f32_16x16x32_bf16 v[80:83], a[52:55], a[172:175], v[80:83]
    buffer_load_dwordx4 v4, s[32:35], s49 offen offset:3072 lds
    s_add_u32 s49, s49, 16384
    v_mfma_f32_16x16x32_bf16 v[84:87], a[48:51], a[176:179], v[84:87]
    v_permlane32_swap_b32 v205, v243
    v_mfma_f32_16x16x32_bf16 v[88:91], a[52:55], a[176:179], v[88:91]
    s_barrier
    s_waitcnt lgkmcnt(0)
    v_mfma_f32_16x16x32_bf16 v[20:23], a[56:59], a[180:183], v[20:23]
    ds_read_b128 a[144:147], v9 offset:18432
    v_accvgpr_read_b32 v244, a64
    v_mfma_f32_16x16x32_bf16 v[24:27], a[60:63], a[180:183], v[24:27]
    ds_read_b128 a[148:151], v9 offset:19456
    v_accvgpr_read_b32 v245, a68
    v_mfma_f32_16x16x32_bf16 v[28:31], a[56:59], a[184:187], v[28:31]
    ds_read_b128 a[152:155], v9 offset:20480
    v_accvgpr_read_b32 v246, a72
    v_mfma_f32_16x16x32_bf16 v[32:35], a[60:63], a[184:187], v[32:35]
    ds_read_b128 a[156:159], v9 offset:21504
    v_accvgpr_read_b32 v247, a76
    v_mfma_f32_16x16x32_bf16 v[36:39], a[56:59], a[188:191], v[36:39]
    ds_read_b128 a[160:163], v9 offset:22528
    v_max3_u32 v244, v244, v245, v246
    v_mfma_f32_16x16x32_bf16 v[40:43], a[60:63], a[188:191], v[40:43]
    ds_read_b128 a[164:167], v9 offset:23552
    v_max_u32 v244, v244, v247
    v_mfma_f32_16x16x32_bf16 v[44:47], a[56:59], a[192:195], v[44:47]
    ds_read_b128 a[168:171], v9 offset:24576
    v_cmp_eq_u32 vcc, -1, v244
    v_mfma_f32_16x16x32_bf16 v[48:51], a[60:63], a[192:195], v[48:51]
    ds_read_b128 a[172:175], v9 offset:25600
    v_add_f32 v198, v198, v240
    v_mfma_f32_16x16x32_bf16 v[52:55], a[56:59], a[196:199], v[52:55]
    ds_read_b128 a[176:179], v9 offset:26624
    v_add_f32 v199, v199, v241
    v_mfma_f32_16x16x32_bf16 v[56:59], a[60:63], a[196:199], v[56:59]
    buffer_load_dwordx4 a[128:131], v4, s[32:35], s50 offen offset:0
    v_mfma_f32_16x16x32_bf16 v[60:63], a[56:59], a[200:203], v[60:63]
    v_add_f32 v204, v204, v242
    v_add_f32 v205, v205, v243
    v_mfma_f32_16x16x32_bf16 v[64:67], a[60:63], a[200:203], v[64:67]
    buffer_load_dwordx4 a[132:135], v5, s[32:35], s50 offen offset:0
    v_mfma_f32_16x16x32_bf16 v[68:71], a[56:59], a[204:207], v[68:71]
    v_mov_b32 v240, v198
    v_mov_b32 v241, v199
    v_mfma_f32_16x16x32_bf16 v[72:75], a[60:63], a[204:207], v[72:75]
    buffer_load_dwordx4 a[136:139], v4, s[32:35], s50 offen offset:1024
    v_mfma_f32_16x16x32_bf16 v[76:79], a[56:59], a[208:211], v[76:79]
    v_mov_b32 v242, v204
    v_mov_b32 v243, v205
    v_mfma_f32_16x16x32_bf16 v[80:83], a[60:63], a[208:211], v[80:83]
    buffer_load_dwordx4 a[140:143], v5, s[32:35], s50 offen offset:1024
    s_add_u32 s50, s50, 2048
    v_mfma_f32_16x16x32_bf16 v[84:87], a[56:59], a[212:215], v[84:87]
    v_permlane16_swap_b32 v198, v240
    v_mfma_f32_16x16x32_bf16 v[88:91], a[60:63], a[212:215], v[88:91]
    v_permlane16_swap_b32 v199, v241
    s_cbranch_vccnz L_hf4
L_hb4:
    s_waitcnt lgkmcnt(0)
    v_mfma_f32_16x16x32_bf16 v[20:23], a[64:67], a[144:147], v[20:23]
    ds_read_b128 a[180:183], v9 offset:27648
    v_mfma_f32_16x16x32_bf16 v[24:27], a[68:71], a[144:147], v[24:27]
    ds_read_b128 a[184:187], v9 offset:28672
    v_mfma_f32_16x16x32_bf16 v[28:31], a[64:67], a[148:151], v[28:31]
    ds_read_b128 a[188:191], v9 offset:29696
    v_mfma_f32_16x16x32_bf16 v[32:35], a[68:71], a[148:151], v[32:35]
    ds_read_b128 a[192:195], v9 offset:30720
    v_mfma_f32_16x16x32_bf16 v[36:39], a[64:67], a[152:155], v[36:39]
    ds_read_b128 a[196:199], v9 offset:31744
    v_mfma_f32_16x16x32_bf16 v[40:43], a[68:71], a[152:155], v[40:43]
    ds_read_b128 a[200:203], v9 offset:32768
    v_mfma_f32_16x16x32_bf16 v[44:47], a[64:67], a[156:159], v[44:47]
    ds_read_b128 a[204:207], v9 offset:33792
    v_mfma_f32_16x16x32_bf16 v[48:51], a[68:71], a[156:159], v[48:51]
    ds_read_b128 a[208:211], v9 offset:34816
    v_mfma_f32_16x16x32_bf16 v[52:55], a[64:67], a[160:163], v[52:55]
    ds_read_b128 a[212:215], v9 offset:35840
    v_mfma_f32_16x16x32_bf16 v[56:59], a[68:71], a[160:163], v[56:59]
    s_add_u32 m0, s48, 0
    s_add_u32 s14, s49, s13
    buffer_load_dwordx4 v4, s[32:35], s49 offen offset:0 lds
    v_mfma_f32_16x16x32_bf16 v[60:63], a[64:67], a[164:167], v[60:63]
    v_permlane16_swap_b32 v204, v242
    v_mfma_f32_16x16x32_bf16 v[64:67], a[68:71], a[164:167], v[64:67]
    buffer_load_dwordx4 v4, s[32:35], s49 offen offset:1024 lds
    v_mfma_f32_16x16x32_bf16 v[68:71], a[64:67], a[168:171], v[68:71]
    v_permlane16_swap_b32 v205, v243
    v_mfma_f32_16x16x32_bf16 v[72:75], a[68:71], a[168:171], v[72:75]
    buffer_load_dwordx4 v4, s[32:35], s49 offen offset:2048 lds
    v_mfma_f32_16x16x32_bf16 v[76:79], a[64:67], a[172:175], v[76:79]
    v_add_f32 v198, v198, v240
    v_add_f32 v199, v199, v241
    v_mfma_f32_16x16x32_bf16 v[80:83], a[68:71], a[172:175], v[80:83]
    buffer_load_dwordx4 v4, s[32:35], s49 offen offset:3072 lds
    s_add_u32 m0, s12, 0
    s_add_u32 s49, s49, 20480
    v_mfma_f32_16x16x32_bf16 v[84:87], a[64:67], a[176:179], v[84:87]
    v_add_f32 v204, v204, v242
    v_add_f32 v205, v205, v243
    v_mfma_f32_16x16x32_bf16 v[88:91], a[68:71], a[176:179], v[88:91]
    buffer_load_dwordx4 v4, s[32:35], s14 offen offset:0 lds
    s_barrier
    s_waitcnt lgkmcnt(0)
    v_mfma_f32_16x16x32_bf16 v[20:23], a[72:75], a[180:183], v[20:23]
    ds_read_b128 a[144:147], v9 offset:36864
    v_accvgpr_read_b32 v244, a80
    v_mfma_f32_16x16x32_bf16 v[24:27], a[76:79], a[180:183], v[24:27]
    ds_read_b128 a[148:151], v9 offset:37888
    v_accvgpr_read_b32 v245, a84
    v_mfma_f32_16x16x32_bf16 v[28:31], a[72:75], a[184:187], v[28:31]
    ds_read_b128 a[152:155], v9 offset:38912
    v_accvgpr_read_b32 v246, a88
    v_mfma_f32_16x16x32_bf16 v[32:35], a[76:79], a[184:187], v[32:35]
    ds_read_b128 a[156:159], v9 offset:39936
    v_accvgpr_read_b32 v247, a92
    v_mfma_f32_16x16x32_bf16 v[36:39], a[72:75], a[188:191], v[36:39]
    ds_read_b128 a[160:163], v9 offset:40960
    v_max3_u32 v244, v244, v245, v246
    v_mfma_f32_16x16x32_bf16 v[40:43], a[76:79], a[188:191], v[40:43]
    ds_read_b128 a[164:167], v9 offset:41984
    v_max_u32 v244, v244, v247
    v_mfma_f32_16x16x32_bf16 v[44:47], a[72:75], a[192:195], v[44:47]
    ds_read_b128 a[168:171], v9 offset:43008
    v_cmp_eq_u32 vcc, -1, v244
    v_mfma_f32_16x16x32_bf16 v[48:51], a[76:79], a[192:195], v[48:51]
    ds_read_b128 a[172:175], v9 offset:44032
    v_mul_f32 v16, 0xbae38e39, v198
    v_mfma_f32_16x16x32_bf16 v[52:55], a[72:75], a[196:199], v[52:55]
    ds_read_b128 a[176:179], v9 offset:45056
    v_mul_f32 v199, 0x3ae38e39, v199
    v_mfma_f32_16x16x32_bf16 v[56:59], a[76:79], a[196:199], v[56:59]
    v_fma_f32 v199, -v16, v16, v199
    v_max_f32 v199, 0, v199
    v_mfma_f32_16x16x32_bf16 v[60:63], a[72:75], a[200:203], v[60:63]
    v_add_f32 v199, 0x3727c5ac, v199
    v_mfma_f32_16x16x32_bf16 v[64:67], a[76:79], a[200:203], v[64:67]
    v_rsq_f32 v14, v199
    v_mfma_f32_16x16x32_bf16 v[68:71], a[72:75], a[204:207], v[68:71]
    v_mul_f32 v11, 0x3727c5ac, v199
    v_mul_f32 v200, v14, v14
    v_mfma_f32_16x16x32_bf16 v[72:75], a[76:79], a[204:207], v[72:75]
    v_mul_f32 v201, 0xc0135761, v14
    v_mul_f32 v200, v200, v14
    v_mfma_f32_16x16x32_bf16 v[76:79], a[72:75], a[208:211], v[76:79]
    v_mul_f32 v200, 0xbdd2d3e8, v200
    ds_write_b32 v18, v16 offset:0
    v_mfma_f32_16x16x32_bf16 v[80:83], a[76:79], a[208:211], v[80:83]
    ds_write_b32 v18, v201 offset:128
    ds_write_b32 v18, v200 offset:256
    v_mfma_f32_16x16x32_bf16 v[84:87], a[72:75], a[212:215], v[84:87]
    v_mul_f32 v17, 0xbae38e39, v204
    v_mfma_f32_16x16x32_bf16 v[88:91], a[76:79], a[212:215], v[88:91]
    s_cbranch_vccnz L_hf5
L_hb5:
    s_waitcnt lgkmcnt(0)
    v_mfma_f32_16x16x32_bf16 v[20:23], a[80:83], a[144:147], v[20:23]
    ds_read_b128 a[180:183], v9 offset:46080
    v_mul_f32 v205, 0x3ae38e39, v205
    v_mfma_f32_16x16x32_bf16 v[24:27], a[84:87], a[144:147], v[24:27]
    ds_read_b128 a[184:187], v9 offset:47104
    v_fma_f32 v205, -v17, v17, v205
    v_mfma_f32_16x16x32_bf16 v[28:31], a[80:83], a[148:151], v[28:31]
    ds_read_b128 a[188:191], v9 offset:48128
    v_max_f32 v205, 0, v205
    v_mfma_f32_16x16x32_bf16 v[32:35], a[84:87], a[148:151], v[32:35]
    ds_read_b128 a[192:195], v9 offset:49152
    v_add_f32 v205, 0x3727c5ac, v205
    v_mfma_f32_16x16x32_bf16 v[36:39], a[80:83], a[152:155], v[36:39]
    ds_read_b128 a[196:199], v9 offset:50176
    v_mfma_f32_16x16x32_bf16 v[40:43], a[84:87], a[152:155], v[40:43]
    ds_read_b128 a[200:203], v9 offset:51200
    v_mfma_f32_16x16x32_bf16 v[44:47], a[80:83], a[156:159], v[44:47]
    ds_read_b128 a[204:207], v9 offset:52224
    v_mfma_f32_16x16x32_bf16 v[48:51], a[84:87], a[156:159], v[48:51]
    ds_read_b128 a[208:211], v9 offset:53248
    v_mfma_f32_16x16x32_bf16 v[52:55], a[80:83], a[160:163], v[52:55]
    ds_read_b128 a[212:215], v9 offset:54272
    v_mfma_f32_16x16x32_bf16 v[56:59], a[84:87], a[160:163], v[56:59]
    s_add_u32 m0, s48, 20480
    s_nop 0
    buffer_load_dwordx4 v4, s[32:35], s49 offen offset:0 lds
    v_mfma_f32_16x16x32_bf16 v[60:63], a[80:83], a[164:167], v[60:63]
    v_rsq_f32 v15, v205
    v_mfma_f32_16x16x32_bf16 v[64:67], a[84:87], a[164:167], v[64:67]
    buffer_load_dwordx4 v4, s[32:35], s49 offen offset:1024 lds
    s_branch L_pgpost_kernel_2_s
.p2align 12
L_pgpost_kernel_2:
    s_branch L_pgpost_kernel_6
L_pgpost_kernel_2_s:
    v_mfma_f32_16x16x32_bf16 v[68:71], a[80:83], a[168:171], v[68:71]
    v_mul_f32 v12, 0x3727c5ac, v205
    v_mul_f32 v206, v15, v15
    v_mfma_f32_16x16x32_bf16 v[72:75], a[84:87], a[168:171], v[72:75]
    buffer_load_dwordx4 v4, s[32:35], s49 offen offset:2048 lds
    v_mfma_f32_16x16x32_bf16 v[76:79], a[80:83], a[172:175], v[76:79]
    v_mul_f32 v207, 0xc0135761, v15
    v_mul_f32 v206, v206, v15
    v_mfma_f32_16x16x32_bf16 v[80:83], a[84:87], a[172:175], v[80:83]
    buffer_load_dwordx4 v4, s[32:35], s49 offen offset:3072 lds
    s_add_u32 s49, s49, 16384
    v_mfma_f32_16x16x32_bf16 v[84:87], a[80:83], a[176:179], v[84:87]
    v_mul_f32 v206, 0xbdd2d3e8, v206
    ds_write_b32 v18, v17 offset:64
    v_mfma_f32_16x16x32_bf16 v[88:91], a[84:87], a[176:179], v[88:91]
    ds_write_b32 v18, v207 offset:192
    ds_write_b32 v18, v206 offset:320
    s_waitcnt vmcnt(21)
    s_barrier
    s_waitcnt lgkmcnt(0)
    v_mfma_f32_16x16x32_bf16 v[20:23], a[88:91], a[180:183], v[20:23]
    ds_read_b128 a[144:147], v10 offset:0
    v_accvgpr_read_b32 v244, a96
    v_mfma_f32_16x16x32_bf16 v[24:27], a[92:95], a[180:183], v[24:27]
    ds_read_b128 a[148:151], v10 offset:1024
    v_accvgpr_read_b32 v245, a100
    v_mfma_f32_16x16x32_bf16 v[28:31], a[88:91], a[184:187], v[28:31]
    ds_read_b128 a[152:155], v10 offset:2048
    v_accvgpr_read_b32 v246, a104
    v_mfma_f32_16x16x32_bf16 v[32:35], a[92:95], a[184:187], v[32:35]
    ds_read_b128 a[156:159], v10 offset:3072
    v_accvgpr_read_b32 v247, a108
    v_mfma_f32_16x16x32_bf16 v[36:39], a[88:91], a[188:191], v[36:39]
    ds_read_b128 a[160:163], v10 offset:4096
    v_max3_u32 v244, v244, v245, v246
    v_mfma_f32_16x16x32_bf16 v[40:43], a[92:95], a[188:191], v[40:43]
    ds_read_b128 a[164:167], v10 offset:5120
    v_max_u32 v244, v244, v247
    v_mfma_f32_16x16x32_bf16 v[44:47], a[88:91], a[192:195], v[44:47]
    ds_read_b128 a[168:171], v10 offset:6144
    v_cmp_eq_u32 vcc, -1, v244
    v_mfma_f32_16x16x32_bf16 v[48:51], a[92:95], a[192:195], v[48:51]
    ds_read_b128 a[172:175], v10 offset:7168
    ds_read_b128 v[208:211], v19 offset:0
    v_mfma_f32_16x16x32_bf16 v[52:55], a[88:91], a[196:199], v[52:55]
    ds_read_b128 a[176:179], v10 offset:8192
    ds_read_b128 v[212:215], v19 offset:64
    v_mfma_f32_16x16x32_bf16 v[56:59], a[92:95], a[196:199], v[56:59]
    ds_read_b128 v[164:167], v19 offset:128
    ds_read_b128 v[168:171], v19 offset:192
    v_mfma_f32_16x16x32_bf16 v[60:63], a[88:91], a[200:203], v[60:63]
    ds_read_b128 v[172:175], v19 offset:256
    ds_read_b128 v[176:179], v19 offset:320
    v_mfma_f32_16x16x32_bf16 v[64:67], a[92:95], a[200:203], v[64:67]
    v_mul_f32 v96, v92, v17
    v_mul_f32 v97, v93, v17
    v_mfma_f32_16x16x32_bf16 v[68:71], a[88:91], a[204:207], v[68:71]
    v_mul_f32 v98, v94, v17
    v_mul_f32 v99, v95, v17
    v_mfma_f32_16x16x32_bf16 v[72:75], a[92:95], a[204:207], v[72:75]
    v_mul_f32 v92, v92, v16
    v_mul_f32 v93, v93, v16
    v_mfma_f32_16x16x32_bf16 v[76:79], a[88:91], a[208:211], v[76:79]
    v_mul_f32 v94, v94, v16
    v_mul_f32 v95, v95, v16
    v_mfma_f32_16x16x32_bf16 v[80:83], a[92:95], a[208:211], v[80:83]
    v_mul_f32 v104, v100, v17
    v_mul_f32 v105, v101, v17
    v_mfma_f32_16x16x32_bf16 v[84:87], a[88:91], a[212:215], v[84:87]
    v_mfma_f32_16x16x32_bf16 v[88:91], a[92:95], a[212:215], v[88:91]
    s_cbranch_vccnz L_hf6
L_hb6:
    s_waitcnt lgkmcnt(0)
    v_mfma_f32_16x16x32_bf16 v[20:23], a[96:99], a[144:147], v[20:23]
    ds_read_b128 a[180:183], v10 offset:9216
    v_mul_f32 v106, v102, v17
    v_mfma_f32_16x16x32_bf16 v[24:27], a[100:103], a[144:147], v[24:27]
    ds_read_b128 a[184:187], v10 offset:10240
    v_mul_f32 v107, v103, v17
    v_mfma_f32_16x16x32_bf16 v[28:31], a[96:99], a[148:151], v[28:31]
    ds_read_b128 a[188:191], v10 offset:11264
    v_mul_f32 v100, v100, v16
    v_mfma_f32_16x16x32_bf16 v[32:35], a[100:103], a[148:151], v[32:35]
    ds_read_b128 a[192:195], v10 offset:12288
    v_mul_f32 v101, v101, v16
    v_mfma_f32_16x16x32_bf16 v[36:39], a[96:99], a[152:155], v[36:39]
    ds_read_b128 a[196:199], v10 offset:13312
    v_mul_f32 v102, v102, v16
    v_mfma_f32_16x16x32_bf16 v[40:43], a[100:103], a[152:155], v[40:43]
    ds_read_b128 a[200:203], v10 offset:14336
    v_mul_f32 v103, v103, v16
    v_mfma_f32_16x16x32_bf16 v[44:47], a[96:99], a[156:159], v[44:47]
    ds_read_b128 a[204:207], v10 offset:15360
    v_mul_f32 v112, v108, v17
    v_mfma_f32_16x16x32_bf16 v[48:51], a[100:103], a[156:159], v[48:51]
    ds_read_b128 a[208:211], v10 offset:16384
    v_mul_f32 v113, v109, v17
    v_mfma_f32_16x16x32_bf16 v[52:55], a[96:99], a[160:163], v[52:55]
    ds_read_b128 a[212:215], v10 offset:17408
    v_mul_f32 v114, v110, v17
    v_mfma_f32_16x16x32_bf16 v[56:59], a[100:103], a[160:163], v[56:59]
    s_add_u32 m0, s48, 36864
    s_add_u32 s14, s49, s13
    buffer_load_dwordx4 v4, s[32:35], s49 offen offset:0 lds
    v_mfma_f32_16x16x32_bf16 v[60:63], a[96:99], a[164:167], v[60:63]
    v_mul_f32 v115, v111, v17
    v_mul_f32 v108, v108, v16
    v_mfma_f32_16x16x32_bf16 v[64:67], a[100:103], a[164:167], v[64:67]
    buffer_load_dwordx4 v4, s[32:35], s49 offen offset:1024 lds
    v_mfma_f32_16x16x32_bf16 v[68:71], a[96:99], a[168:171], v[68:71]
    v_mul_f32 v109, v109, v16
    v_mul_f32 v110, v110, v16
    v_mfma_f32_16x16x32_bf16 v[72:75], a[100:103], a[168:171], v[72:75]
    buffer_load_dwordx4 v4, s[32:35], s49 offen offset:2048 lds
    v_mfma_f32_16x16x32_bf16 v[76:79], a[96:99], a[172:175], v[76:79]
    v_mul_f32 v111, v111, v16
    v_mul_f32 v120, v116, v17
    v_mfma_f32_16x16x32_bf16 v[80:83], a[100:103], a[172:175], v[80:83]
    buffer_load_dwordx4 v4, s[32:35], s49 offen offset:3072 lds
    s_add_u32 m0, s12, 36864
    s_add_u32 s49, s49, 20480
    v_mfma_f32_16x16x32_bf16 v[84:87], a[96:99], a[176:179], v[84:87]
    v_mul_f32 v121, v117, v17
    v_mfma_f32_16x16x32_bf16 v[88:91], a[100:103], a[176:179], v[88:91]
    buffer_load_dwordx4 v4, s[32:35], s14 offen offset:0 lds
    s_waitcnt vmcnt(18)
    s_barrier
    s_waitcnt lgkmcnt(0)
    v_mfma_f32_16x16x32_bf16 v[20:23], a[104:107], a[180:183], v[20:23]
    ds_read_b128 a[144:147], v10 offset:18432
    v_accvgpr_read_b32 v244, a112
    v_mfma_f32_16x16x32_bf16 v[24:27], a[108:111], a[180:183], v[24:27]
    ds_read_b128 a[148:151], v10 offset:19456
    v_accvgpr_read_b32 v245, a116
    v_mfma_f32_16x16x32_bf16 v[28:31], a[104:107], a[184:187], v[28:31]
    ds_read_b128 a[152:155], v10 offset:20480
    v_accvgpr_read_b32 v246, a120
    v_mfma_f32_16x16x32_bf16 v[32:35], a[108:111], a[184:187], v[32:35]
    ds_read_b128 a[156:159], v10 offset:21504
    v_accvgpr_read_b32 v247, a124
    v_mfma_f32_16x16x32_bf16 v[36:39], a[104:107], a[188:191], v[36:39]
    ds_read_b128 a[160:163], v10 offset:22528
    v_max3_u32 v244, v244, v245, v246
    v_mfma_f32_16x16x32_bf16 v[40:43], a[108:111], a[188:191], v[40:43]
    ds_read_b128 a[164:167], v10 offset:23552
    v_max_u32 v244, v244, v247
    v_mfma_f32_16x16x32_bf16 v[44:47], a[104:107], a[192:195], v[44:47]
    ds_read_b128 a[168:171], v10 offset:24576
    v_cmp_eq_u32 vcc, -1, v244
    v_mfma_f32_16x16x32_bf16 v[48:51], a[108:111], a[192:195], v[48:51]
    ds_read_b128 a[172:175], v10 offset:25600
    v_mul_f32 v122, v118, v17
    v_mfma_f32_16x16x32_bf16 v[52:55], a[104:107], a[196:199], v[52:55]
    ds_read_b128 a[176:179], v10 offset:26624
    v_mul_f32 v123, v119, v17
    v_mfma_f32_16x16x32_bf16 v[56:59], a[108:111], a[196:199], v[56:59]
    v_mul_f32 v116, v116, v16
    v_mul_f32 v117, v117, v16
    v_mfma_f32_16x16x32_bf16 v[60:63], a[104:107], a[200:203], v[60:63]
    v_mul_f32 v118, v118, v16
    v_mul_f32 v119, v119, v16
    v_mfma_f32_16x16x32_bf16 v[64:67], a[108:111], a[200:203], v[64:67]
    v_mul_f32 v128, v124, v17
    v_mul_f32 v129, v125, v17
    v_mfma_f32_16x16x32_bf16 v[68:71], a[104:107], a[204:207], v[68:71]
    v_mul_f32 v130, v126, v17
    v_mul_f32 v131, v127, v17
    v_mfma_f32_16x16x32_bf16 v[72:75], a[108:111], a[204:207], v[72:75]
    v_mul_f32 v124, v124, v16
    v_mul_f32 v125, v125, v16
    v_mfma_f32_16x16x32_bf16 v[76:79], a[104:107], a[208:211], v[76:79]
    v_mul_f32 v126, v126, v16
    v_mul_f32 v127, v127, v16
    v_mfma_f32_16x16x32_bf16 v[80:83], a[108:111], a[208:211], v[80:83]
    v_mul_f32 v136, v132, v17
    v_mul_f32 v137, v133, v17
    v_mfma_f32_16x16x32_bf16 v[84:87], a[104:107], a[212:215], v[84:87]
    v_mfma_f32_16x16x32_bf16 v[88:91], a[108:111], a[212:215], v[88:91]
    s_cbranch_vccnz L_hf7
L_hb7:
    s_waitcnt lgkmcnt(0)
    v_mfma_f32_16x16x32_bf16 v[20:23], a[112:115], a[144:147], v[20:23]
    ds_read_b128 a[180:183], v10 offset:27648
    v_mul_f32 v138, v134, v17
    v_mfma_f32_16x16x32_bf16 v[24:27], a[116:119], a[144:147], v[24:27]
    ds_read_b128 a[184:187], v10 offset:28672
    v_mul_f32 v139, v135, v17
    v_mfma_f32_16x16x32_bf16 v[28:31], a[112:115], a[148:151], v[28:31]
    ds_read_b128 a[188:191], v10 offset:29696
    v_mul_f32 v132, v132, v16
    v_mfma_f32_16x16x32_bf16 v[32:35], a[116:119], a[148:151], v[32:35]
    ds_read_b128 a[192:195], v10 offset:30720
    v_mul_f32 v133, v133, v16
    v_mfma_f32_16x16x32_bf16 v[36:39], a[112:115], a[152:155], v[36:39]
    ds_read_b128 a[196:199], v10 offset:31744
    v_mul_f32 v134, v134, v16
    v_mfma_f32_16x16x32_bf16 v[40:43], a[116:119], a[152:155], v[40:43]
    ds_read_b128 a[200:203], v10 offset:32768
    v_mul_f32 v135, v135, v16
    v_mfma_f32_16x16x32_bf16 v[44:47], a[112:115], a[156:159], v[44:47]
    ds_read_b128 a[204:207], v10 offset:33792
    v_mul_f32 v144, v140, v17
    v_mfma_f32_16x16x32_bf16 v[48:51], a[116:119], a[156:159], v[48:51]
    ds_read_b128 a[208:211], v10 offset:34816
    v_mul_f32 v145, v141, v17
    v_mfma_f32_16x16x32_bf16 v[52:55], a[112:115], a[160:163], v[52:55]
    ds_read_b128 a[212:215], v10 offset:35840
    v_mul_f32 v146, v142, v17
    v_mfma_f32_16x16x32_bf16 v[56:59], a[116:119], a[160:163], v[56:59]
    v_mul_f32 v147, v143, v17
    v_mul_f32 v140, v140, v16
    v_mfma_f32_16x16x32_bf16 v[60:63], a[112:115], a[164:167], v[60:63]
    v_mul_f32 v141, v141, v16
    v_mul_f32 v142, v142, v16
    v_mfma_f32_16x16x32_bf16 v[64:67], a[116:119], a[164:167], v[64:67]
    v_mul_f32 v143, v143, v16
    v_mul_f32 v152, v148, v17
    v_mfma_f32_16x16x32_bf16 v[68:71], a[112:115], a[168:171], v[68:71]
    v_mul_f32 v153, v149, v17
    v_mfma_f32_16x16x32_bf16 v[72:75], a[116:119], a[168:171], v[72:75]
    v_mfma_f32_16x16x32_bf16 v[76:79], a[112:115], a[172:175], v[76:79]
    v_mfma_f32_16x16x32_bf16 v[80:83], a[116:119], a[172:175], v[80:83]
    v_mfma_f32_16x16x32_bf16 v[84:87], a[112:115], a[176:179], v[84:87]
    v_mfma_f32_16x16x32_bf16 v[88:91], a[116:119], a[176:179], v[88:91]
    s_waitcnt vmcnt(9)
    s_barrier
    s_waitcnt lgkmcnt(0)
    v_mfma_f32_16x16x32_bf16 v[20:23], a[120:123], a[180:183], v[20:23]
    ds_read_b128 a[144:147], v8 offset:0
    v_accvgpr_read_b32 v244, a128
    v_mfma_f32_16x16x32_bf16 v[24:27], a[124:127], a[180:183], v[24:27]
    ds_read_b128 a[148:151], v8 offset:1024
    v_accvgpr_read_b32 v245, a132
    v_mfma_f32_16x16x32_bf16 v[28:31], a[120:123], a[184:187], v[28:31]
    ds_read_b128 a[152:155], v8 offset:2048
    v_accvgpr_read_b32 v246, a136
    v_mfma_f32_16x16x32_bf16 v[32:35], a[124:127], a[184:187], v[32:35]
    ds_read_b128 a[156:159], v8 offset:3072
    v_accvgpr_read_b32 v247, a140
    v_mfma_f32_16x16x32_bf16 v[36:39], a[120:123], a[188:191], v[36:39]
    ds_read_b128 a[160:163], v8 offset:4096
    v_max3_u32 v244, v244, v245, v246
    v_mfma_f32_16x16x32_bf16 v[40:43], a[124:127], a[188:191], v[40:43]
    ds_read_b128 a[164:167], v8 offset:5120
    v_max_u32 v244, v244, v247
    v_mfma_f32_16x16x32_bf16 v[44:47], a[120:123], a[192:195], v[44:47]
    ds_read_b128 a[168:171], v8 offset:6144
    v_cmp_eq_u32 vcc, -1, v244
    v_mfma_f32_16x16x32_bf16 v[48:51], a[124:127], a[192:195], v[48:51]
    ds_read_b128 a[172:175], v8 offset:7168
    v_mul_f32 v154, v150, v17
    v_mfma_f32_16x16x32_bf16 v[52:55], a[120:123], a[196:199], v[52:55]
    ds_read_b128 a[176:179], v8 offset:8192
    v_mul_f32 v155, v151, v17
    v_mfma_f32_16x16x32_bf16 v[56:59], a[124:127], a[196:199], v[56:59]
    v_mul_f32 v148, v148, v16
    v_mul_f32 v149, v149, v16
    v_mfma_f32_16x16x32_bf16 v[60:63], a[120:123], a[200:203], v[60:63]
    v_mul_f32 v150, v150, v16
    v_mul_f32 v151, v151, v16
    v_mfma_f32_16x16x32_bf16 v[64:67], a[124:127], a[200:203], v[64:67]
    v_mul_f32 v160, v156, v17
    v_mul_f32 v161, v157, v17
    v_mfma_f32_16x16x32_bf16 v[68:71], a[120:123], a[204:207], v[68:71]
    v_mul_f32 v162, v158, v17
    v_mul_f32 v163, v159, v17
    v_mfma_f32_16x16x32_bf16 v[72:75], a[124:127], a[204:207], v[72:75]
    v_mul_f32 v156, v156, v16
    v_mul_f32 v157, v157, v16
    v_mfma_f32_16x16x32_bf16 v[76:79], a[120:123], a[208:211], v[76:79]
    v_mul_f32 v158, v158, v16
    v_mul_f32 v159, v159, v16
    v_mfma_f32_16x16x32_bf16 v[80:83], a[124:127], a[208:211], v[80:83]
    v_mfma_f32_16x16x32_bf16 v[84:87], a[120:123], a[212:215], v[84:87]
    v_mfma_f32_16x16x32_bf16 v[88:91], a[124:127], a[212:215], v[88:91]
    s_cbranch_vccnz L_hf8
L_hb8:
    s_waitcnt lgkmcnt(0)
    v_mfma_f32_16x16x32_bf16 v[20:23], a[128:131], a[144:147], v[20:23]
    ds_read_b128 a[180:183], v8 offset:9216
    v_mfma_f32_16x16x32_bf16 v[24:27], a[132:135], a[144:147], v[24:27]
    ds_read_b128 a[184:187], v8 offset:10240
    v_mfma_f32_16x16x32_bf16 v[28:31], a[128:131], a[148:151], v[28:31]
    ds_read_b128 a[188:191], v8 offset:11264
    v_mfma_f32_16x16x32_bf16 v[32:35], a[132:135], a[148:151], v[32:35]
    ds_read_b128 a[192:195], v8 offset:12288
    v_mfma_f32_16x16x32_bf16 v[36:39], a[128:131], a[152:155], v[36:39]
    ds_read_b128 a[196:199], v8 offset:13312
    v_mfma_f32_16x16x32_bf16 v[40:43], a[132:135], a[152:155], v[40:43]
    ds_read_b128 a[200:203], v8 offset:14336
    v_mfma_f32_16x16x32_bf16 v[44:47], a[128:131], a[156:159], v[44:47]
    ds_read_b128 a[204:207], v8 offset:15360
    v_mfma_f32_16x16x32_bf16 v[48:51], a[132:135], a[156:159], v[48:51]
    ds_read_b128 a[208:211], v8 offset:16384
    v_mfma_f32_16x16x32_bf16 v[52:55], a[128:131], a[160:163], v[52:55]
    ds_read_b128 a[212:215], v8 offset:17408
    v_mfma_f32_16x16x32_bf16 v[56:59], a[132:135], a[160:163], v[56:59]
    v_mfma_f32_16x16x32_bf16 v[60:63], a[128:131], a[164:167], v[60:63]
    v_mfma_f32_16x16x32_bf16 v[64:67], a[132:135], a[164:167], v[64:67]
    v_mfma_f32_16x16x32_bf16 v[68:71], a[128:131], a[168:171], v[68:71]
    v_mfma_f32_16x16x32_bf16 v[72:75], a[132:135], a[168:171], v[72:75]
    v_mfma_f32_16x16x32_bf16 v[76:79], a[128:131], a[172:175], v[76:79]
    v_mfma_f32_16x16x32_bf16 v[80:83], a[132:135], a[172:175], v[80:83]
    v_mfma_f32_16x16x32_bf16 v[84:87], a[128:131], a[176:179], v[84:87]
    v_mfma_f32_16x16x32_bf16 v[88:91], a[132:135], a[176:179], v[88:91]
    s_waitcnt vmcnt(5)
    s_barrier
    s_waitcnt lgkmcnt(0)
    v_mfma_f32_16x16x32_bf16 v[20:23], a[136:139], a[180:183], v[20:23]
    ds_read_b128 a[144:147], v8 offset:18432
    v_mfma_f32_16x16x32_bf16 v[24:27], a[140:143], a[180:183], v[24:27]
    ds_read_b128 a[148:151], v8 offset:19456
    v_mfma_f32_16x16x32_bf16 v[28:31], a[136:139], a[184:187], v[28:31]
    ds_read_b128 a[152:155], v8 offset:20480
    v_mfma_f32_16x16x32_bf16 v[32:35], a[140:143], a[184:187], v[32:35]
    ds_read_b128 a[156:159], v8 offset:21504
    v_mfma_f32_16x16x32_bf16 v[36:39], a[136:139], a[188:191], v[36:39]
    ds_read_b128 a[160:163], v8 offset:22528
    v_mfma_f32_16x16x32_bf16 v[40:43], a[140:143], a[188:191], v[40:43]
    ds_read_b128 a[164:167], v8 offset:23552
    v_mfma_f32_16x16x32_bf16 v[44:47], a[136:139], a[192:195], v[44:47]
    ds_read_b128 a[168:171], v8 offset:24576
    v_mfma_f32_16x16x32_bf16 v[48:51], a[140:143], a[192:195], v[48:51]
    ds_read_b128 a[172:175], v8 offset:25600
    v_mfma_f32_16x16x32_bf16 v[52:55], a[136:139], a[196:199], v[52:55]
    ds_read_b128 a[176:179], v8 offset:26624
    v_mfma_f32_16x16x32_bf16 v[56:59], a[140:143], a[196:199], v[56:59]
    v_mfma_f32_16x16x32_bf16 v[60:63], a[136:139], a[200:203], v[60:63]
    v_mfma_f32_16x16x32_bf16 v[64:67], a[140:143], a[200:203], v[64:67]
    v_mfma_f32_16x16x32_bf16 v[68:71], a[136:139], a[204:207], v[68:71]
    v_mfma_f32_16x16x32_bf16 v[72:75], a[140:143], a[204:207], v[72:75]
    v_mfma_f32_16x16x32_bf16 v[76:79], a[136:139], a[208:211], v[76:79]
    v_mfma_f32_16x16x32_bf16 v[80:83], a[140:143], a[208:211], v[80:83]
    v_mfma_f32_16x16x32_bf16 v[84:87], a[136:139], a[212:215], v[84:87]
    v_mfma_f32_16x16x32_bf16 v[88:91], a[140:143], a[212:215], v[88:91]
    v_pk_fma_f32 v[20:21], v[208:209], v[180:181], v[20:21] op_sel:[0,0,0] op_sel_hi:[1,0,1]
    v_pk_fma_f32 v[22:23], v[210:211], v[180:181], v[22:23] op_sel:[0,0,0] op_sel_hi:[1,0,1]
    v_pk_fma_f32 v[28:29], v[208:209], v[180:181], v[28:29] op_sel:[0,1,0] op_sel_hi:[1,1,1]
    v_pk_mul_f32 v[232:233], v[20:21], v[20:21]
    v_pk_mul_f32 v[234:235], v[22:23], v[22:23]
    v_pk_mul_f32 v[236:237], v[28:29], v[28:29]
    v_pk_fma_f32 v[232:233], v[232:233], v[172:173], v[164:165]
    v_pk_fma_f32 v[234:235], v[234:235], v[174:175], v[166:167]
    v_pk_fma_f32 v[236:237], v[236:237], v[172:173], v[164:165]
    v_pk_mul_f32 v[232:233], v[232:233], v[20:21]
    v_pk_mul_f32 v[234:235], v[234:235], v[22:23]
    v_pk_mul_f32 v[236:237], v[236:237], v[28:29]
    v_exp_f32 v232, v232
    s_add_u32 m0, s48, 57344
    s_nop 0
    buffer_load_dwordx4 v4, s[32:35], s49 offen offset:0 lds
    v_pk_fma_f32 v[30:31], v[210:211], v[180:181], v[30:31] op_sel:[0,1,0] op_sel_hi:[1,1,1]
    v_pk_fma_f32 v[36:37], v[208:209], v[182:183], v[36:37] op_sel:[0,0,0] op_sel_hi:[1,0,1]
    v_exp_f32 v233, v233
    v_pk_mul_f32 v[238:239], v[30:31], v[30:31]
    v_pk_mul_f32 v[240:241], v[36:37], v[36:37]
    v_exp_f32 v234, v234
    v_pk_add_f32 v[232:233], v[232:233], s[60:61]
    v_pk_fma_f32 v[238:239], v[238:239], v[174:175], v[166:167]
    v_exp_f32 v235, v235
    v_pk_fma_f32 v[240:241], v[240:241], v[172:173], v[164:165]
    v_pk_mul_f32 v[238:239], v[238:239], v[30:31]
    v_rcp_f32 v232, v232
    v_pk_add_f32 v[234:235], v[234:235], s[60:61]
    buffer_load_dwordx4 v4, s[32:35], s49 offen offset:1024 lds
    v_pk_mul_f32 v[240:241], v[240:241], v[36:37]
    v_rcp_f32 v233, v233
    v_pk_fma_f32 v[38:39], v[210:211], v[182:183], v[38:39] op_sel:[0,0,0] op_sel_hi:[1,0,1]
    v_pk_fma_f32 v[44:45], v[208:209], v[182:183], v[44:45] op_sel:[0,1,0] op_sel_hi:[1,1,1]
    v_rcp_f32 v234, v234
    v_pk_mul_f32 v[20:21], v[20:21], v[232:233]
    v_pk_mul_f32 v[242:243], v[38:39], v[38:39]
    v_rcp_f32 v235, v235
    v_pk_fma_f32 v[224:225], v[20:21], v[20:21], v[224:225]
    v_pk_fma_f32 v[242:243], v[242:243], v[174:175], v[166:167]
    v_exp_f32 v236, v236
    v_pk_add_f32 v[216:217], v[216:217], v[20:21]
    v_pk_mul_f32 v[22:23], v[22:23], v[234:235]
    buffer_load_dwordx4 v4, s[32:35], s49 offen offset:2048 lds
    v_exp_f32 v237, v237
    v_pk_mul_f32 v[242:243], v[242:243], v[38:39]
    v_pk_fma_f32 v[226:227], v[22:23], v[22:23], v[226:227]
    v_exp_f32 v238, v238
    v_pk_add_f32 v[236:237], v[236:237], s[60:61]
    v_pk_add_f32 v[218:219], v[218:219], v[22:23]
    v_exp_f32 v239, v239
    v_pk_mul_f32 v[244:245], v[44:45], v[44:45]
    v_pk_fma_f32 v[46:47], v[210:211], v[182:183], v[46:47] op_sel:[0,1,0] op_sel_hi:[1,1,1]
    v_rcp_f32 v236, v236
    v_pk_add_f32 v[238:239], v[238:239], s[60:61]
    v_pk_fma_f32 v[244:245], v[244:245], v[172:173], v[164:165]
    v_rcp_f32 v237, v237
    buffer_load_dwordx4 v4, s[32:35], s49 offen offset:3072 lds
    s_add_u32 s49, s49, 16384
    v_pk_mul_f32 v[246:247], v[46:47], v[46:47]
    v_pk_mul_f32 v[244:245], v[244:245], v[44:45]
    v_rcp_f32 v238, v238
    v_pk_mul_f32 v[28:29], v[28:29], v[236:237]
    v_pk_fma_f32 v[246:247], v[246:247], v[174:175], v[166:167]
    v_rcp_f32 v239, v239
    v_pk_fma_f32 v[224:225], v[28:29], v[28:29], v[224:225]
    v_pk_mul_f32 v[246:247], v[246:247], v[46:47]
    v_exp_f32 v240, v240
    v_pk_add_f32 v[216:217], v[216:217], v[28:29]
    v_pk_mul_f32 v[30:31], v[30:31], v[238:239]
    v_exp_f32 v241, v241
    v_pk_fma_f32 v[52:53], v[208:209], v[184:185], v[52:53] op_sel:[0,0,0] op_sel_hi:[1,0,1]
    s_add_u32 m0, s48, 73728
    s_add_u32 s14, s49, s13
    buffer_load_dwordx4 v4, s[32:35], s49 offen offset:0 lds
    v_pk_fma_f32 v[226:227], v[30:31], v[30:31], v[226:227]
    v_exp_f32 v242, v242
    v_pk_add_f32 v[240:241], v[240:241], s[60:61]
    v_pk_add_f32 v[218:219], v[218:219], v[30:31]
    v_exp_f32 v243, v243
    v_pk_mul_f32 v[232:233], v[52:53], v[52:53]
    v_pk_fma_f32 v[54:55], v[210:211], v[184:185], v[54:55] op_sel:[0,0,0] op_sel_hi:[1,0,1]
    v_rcp_f32 v240, v240
    v_pk_add_f32 v[242:243], v[242:243], s[60:61]
    v_pk_fma_f32 v[232:233], v[232:233], v[172:173], v[164:165]
    v_rcp_f32 v241, v241
    v_pk_mul_f32 v[234:235], v[54:55], v[54:55]
    v_pk_mul_f32 v[232:233], v[232:233], v[52:53]
    buffer_load_dwordx4 v4, s[32:35], s49 offen offset:1024 lds
    v_rcp_f32 v242, v242
    v_pk_mul_f32 v[36:37], v[36:37], v[240:241]
    v_pk_fma_f32 v[234:235], v[234:235], v[174:175], v[166:167]
    v_rcp_f32 v243, v243
    v_pk_fma_f32 v[224:225], v[36:37], v[36:37], v[224:225]
    v_pk_mul_f32 v[234:235], v[234:235], v[54:55]
    v_exp_f32 v244, v244
    v_pk_add_f32 v[216:217], v[216:217], v[36:37]
    v_pk_mul_f32 v[38:39], v[38:39], v[242:243]
    v_exp_f32 v245, v245
    v_pk_fma_f32 v[60:61], v[208:209], v[184:185], v[60:61] op_sel:[0,1,0] op_sel_hi:[1,1,1]
    v_pk_fma_f32 v[226:227], v[38:39], v[38:39], v[226:227]
    v_exp_f32 v246, v246
    buffer_load_dwordx4 v4, s[32:35], s49 offen offset:2048 lds
    v_pk_add_f32 v[244:245], v[244:245], s[60:61]
    v_pk_add_f32 v[218:219], v[218:219], v[38:39]
    v_exp_f32 v247, v247
    v_pk_mul_f32 v[236:237], v[60:61], v[60:61]
    v_pk_fma_f32 v[62:63], v[210:211], v[184:185], v[62:63] op_sel:[0,1,0] op_sel_hi:[1,1,1]
    v_rcp_f32 v244, v244
    v_pk_add_f32 v[246:247], v[246:247], s[60:61]
    v_pk_fma_f32 v[236:237], v[236:237], v[172:173], v[164:165]
    v_rcp_f32 v245, v245
    v_pk_mul_f32 v[238:239], v[62:63], v[62:63]
    v_pk_mul_f32 v[236:237], v[236:237], v[60:61]
    v_rcp_f32 v246, v246
    v_pk_mul_f32 v[44:45], v[44:45], v[244:245]
    buffer_load_dwordx4 v4, s[32:35], s49 offen offset:3072 lds
    s_add_u32 m0, s12, 73728
    s_add_u32 s49, s49, 20480
    v_pk_fma_f32 v[238:239], v[238:239], v[174:175], v[166:167]
    v_rcp_f32 v247, v247
    v_pk_fma_f32 v[224:225], v[44:45], v[44:45], v[224:225]
    v_pk_mul_f32 v[238:239], v[238:239], v[62:63]
    v_exp_f32 v232, v232
    v_pk_add_f32 v[216:217], v[216:217], v[44:45]
    v_pk_mul_f32 v[46:47], v[46:47], v[246:247]
    v_exp_f32 v233, v233
    v_pk_fma_f32 v[68:69], v[208:209], v[186:187], v[68:69] op_sel:[0,0,0] op_sel_hi:[1,0,1]
    v_pk_fma_f32 v[226:227], v[46:47], v[46:47], v[226:227]
    v_exp_f32 v234, v234
    v_pk_add_f32 v[232:233], v[232:233], s[60:61]
    v_pk_add_f32 v[218:219], v[218:219], v[46:47]
    buffer_load_dwordx4 v4, s[32:35], s14 offen offset:0 lds
    v_exp_f32 v235, v235
    v_pk_mul_f32 v[240:241], v[68:69], v[68:69]
    v_pk_fma_f32 v[70:71], v[210:211], v[186:187], v[70:71] op_sel:[0,0,0] op_sel_hi:[1,0,1]
    v_rcp_f32 v232, v232
    v_pk_add_f32 v[234:235], v[234:235], s[60:61]
    v_pk_fma_f32 v[240:241], v[240:241], v[172:173], v[164:165]
    v_rcp_f32 v233, v233
    v_pk_mul_f32 v[242:243], v[70:71], v[70:71]
    v_pk_mul_f32 v[240:241], v[240:241], v[68:69]
    v_rcp_f32 v234, v234
    v_pk_mul_f32 v[52:53], v[52:53], v[232:233]
    v_pk_fma_f32 v[242:243], v[242:243], v[174:175], v[166:167]
    v_rcp_f32 v235, v235
    s_add_u32 m0, s48, 94208
    s_nop 0
    buffer_load_dwordx4 v4, s[32:35], s49 offen offset:0 lds
    v_pk_fma_f32 v[224:225], v[52:53], v[52:53], v[224:225]
    v_pk_mul_f32 v[242:243], v[242:243], v[70:71]
    v_exp_f32 v236, v236
    v_pk_add_f32 v[216:217], v[216:217], v[52:53]
    v_pk_mul_f32 v[54:55], v[54:55], v[234:235]
    v_exp_f32 v237, v237
    v_pk_fma_f32 v[76:77], v[208:209], v[186:187], v[76:77] op_sel:[0,1,0] op_sel_hi:[1,1,1]
    v_pk_fma_f32 v[226:227], v[54:55], v[54:55], v[226:227]
    v_exp_f32 v238, v238
    v_pk_add_f32 v[236:237], v[236:237], s[60:61]
    v_pk_add_f32 v[218:219], v[218:219], v[54:55]
    v_exp_f32 v239, v239
    v_pk_mul_f32 v[244:245], v[76:77], v[76:77]
    buffer_load_dwordx4 v4, s[32:35], s49 offen offset:1024 lds
    v_pk_fma_f32 v[78:79], v[210:211], v[186:187], v[78:79] op_sel:[0,1,0] op_sel_hi:[1,1,1]
    v_rcp_f32 v236, v236
    v_pk_add_f32 v[238:239], v[238:239], s[60:61]
    v_pk_fma_f32 v[244:245], v[244:245], v[172:173], v[164:165]
    v_rcp_f32 v237, v237
    v_pk_mul_f32 v[246:247], v[78:79], v[78:79]
    v_pk_mul_f32 v[244:245], v[244:245], v[76:77]
    v_rcp_f32 v238, v238
    v_pk_mul_f32 v[60:61], v[60:61], v[236:237]
    v_pk_fma_f32 v[246:247], v[246:247], v[174:175], v[166:167]
    v_rcp_f32 v239, v239
    v_pk_fma_f32 v[224:225], v[60:61], v[60:61], v[224:225]
    v_pk_mul_f32 v[246:247], v[246:247], v[78:79]
    buffer_load_dwordx4 v4, s[32:35], s49 offen offset:2048 lds
    v_exp_f32 v240, v240
    v_pk_add_f32 v[216:217], v[216:217], v[60:61]
    v_pk_mul_f32 v[62:63], v[62:63], v[238:239]
    v_exp_f32 v241, v241
    v_pk_fma_f32 v[84:85], v[208:209], v[188:189], v[84:85] op_sel:[0,0,0] op_sel_hi:[1,0,1]
    v_pk_fma_f32 v[226:227], v[62:63], v[62:63], v[226:227]
    v_exp_f32 v242, v242
    v_pk_add_f32 v[240:241], v[240:241], s[60:61]
    v_pk_add_f32 v[218:219], v[218:219], v[62:63]
    v_exp_f32 v243, v243
    v_pk_mul_f32 v[232:233], v[84:85], v[84:85]
    v_pk_fma_f32 v[86:87], v[210:211], v[188:189], v[86:87] op_sel:[0,0,0] op_sel_hi:[1,0,1]
    v_rcp_f32 v240, v240
    buffer_load_dwordx4 v4, s[32:35], s49 offen offset:3072 lds
    s_add_u32 s49, s49, 16384
    v_pk_add_f32 v[242:243], v[242:243], s[60:61]
    v_pk_fma_f32 v[232:233], v[232:233], v[172:173], v[164:165]
    v_rcp_f32 v241, v241
    v_pk_mul_f32 v[234:235], v[86:87], v[86:87]
    v_pk_mul_f32 v[232:233], v[232:233], v[84:85]
    v_rcp_f32 v242, v242
    v_pk_mul_f32 v[68:69], v[68:69], v[240:241]
    v_pk_fma_f32 v[234:235], v[234:235], v[174:175], v[166:167]
    v_rcp_f32 v243, v243
    v_pk_fma_f32 v[224:225], v[68:69], v[68:69], v[224:225]
    v_pk_mul_f32 v[234:235], v[234:235], v[86:87]
    v_exp_f32 v244, v244
    v_pk_add_f32 v[216:217], v[216:217], v[68:69]
    s_add_u32 m0, s48, 110592
    s_add_u32 s14, s49, s13
    buffer_load_dwordx4 v4, s[32:35], s49 offen offset:0 lds
    v_pk_mul_f32 v[70:71], v[70:71], v[242:243]
    v_exp_f32 v245, v245
    v_pk_fma_f32 v[24:25], v[212:213], v[180:181], v[24:25] op_sel:[0,0,0] op_sel_hi:[1,0,1]
    v_pk_fma_f32 v[226:227], v[70:71], v[70:71], v[226:227]
    v_exp_f32 v246, v246
    v_pk_add_f32 v[244:245], v[244:245], s[60:61]
    v_pk_add_f32 v[218:219], v[218:219], v[70:71]
    v_exp_f32 v247, v247
    v_pk_mul_f32 v[236:237], v[24:25], v[24:25]
    v_pk_fma_f32 v[26:27], v[214:215], v[180:181], v[26:27] op_sel:[0,0,0] op_sel_hi:[1,0,1]
    v_rcp_f32 v244, v244
    v_pk_add_f32 v[246:247], v[246:247], s[60:61]
    v_pk_fma_f32 v[236:237], v[236:237], v[176:177], v[168:169]
    buffer_load_dwordx4 v4, s[32:35], s49 offen offset:1024 lds
    v_rcp_f32 v245, v245
    v_pk_mul_f32 v[238:239], v[26:27], v[26:27]
    v_pk_mul_f32 v[236:237], v[236:237], v[24:25]
    v_rcp_f32 v246, v246
    v_pk_mul_f32 v[76:77], v[76:77], v[244:245]
    v_pk_fma_f32 v[238:239], v[238:239], v[178:179], v[170:171]
    v_rcp_f32 v247, v247
    v_pk_fma_f32 v[224:225], v[76:77], v[76:77], v[224:225]
    v_pk_mul_f32 v[238:239], v[238:239], v[26:27]
    v_exp_f32 v232, v232
    v_pk_add_f32 v[216:217], v[216:217], v[76:77]
    v_pk_mul_f32 v[78:79], v[78:79], v[246:247]
    v_exp_f32 v233, v233
    buffer_load_dwordx4 v4, s[32:35], s49 offen offset:2048 lds
    v_pk_fma_f32 v[32:33], v[212:213], v[180:181], v[32:33] op_sel:[0,1,0] op_sel_hi:[1,1,1]
    v_pk_fma_f32 v[226:227], v[78:79], v[78:79], v[226:227]
    v_exp_f32 v234, v234
    v_pk_add_f32 v[232:233], v[232:233], s[60:61]
    v_pk_add_f32 v[218:219], v[218:219], v[78:79]
    v_exp_f32 v235, v235
    v_pk_mul_f32 v[240:241], v[32:33], v[32:33]
    v_pk_fma_f32 v[34:35], v[214:215], v[180:181], v[34:35] op_sel:[0,1,0] op_sel_hi:[1,1,1]
    v_rcp_f32 v232, v232
    v_pk_add_f32 v[234:235], v[234:235], s[60:61]
    v_pk_fma_f32 v[240:241], v[240:241], v[176:177], v[168:169]
    v_rcp_f32 v233, v233
    v_pk_mul_f32 v[242:243], v[34:35], v[34:35]
    buffer_load_dwordx4 v4, s[32:35], s49 offen offset:3072 lds
    s_add_u32 m0, s12, 110592
    s_add_u32 s49, s49, 20480
    v_pk_mul_f32 v[240:241], v[240:241], v[32:33]
    v_rcp_f32 v234, v234
    v_pk_mul_f32 v[84:85], v[84:85], v[232:233]
    v_pk_fma_f32 v[242:243], v[242:243], v[178:179], v[170:171]
    v_rcp_f32 v235, v235
    v_pk_fma_f32 v[224:225], v[84:85], v[84:85], v[224:225]
    v_pk_mul_f32 v[242:243], v[242:243], v[34:35]
    v_exp_f32 v236, v236
    v_pk_add_f32 v[216:217], v[216:217], v[84:85]
    v_pk_mul_f32 v[86:87], v[86:87], v[234:235]
    v_exp_f32 v237, v237
    v_pk_fma_f32 v[40:41], v[212:213], v[182:183], v[40:41] op_sel:[0,0,0] op_sel_hi:[1,0,1]
    v_pk_fma_f32 v[226:227], v[86:87], v[86:87], v[226:227]
    buffer_load_dwordx4 v4, s[32:35], s14 offen offset:0 lds
    v_exp_f32 v238, v238
    v_pk_add_f32 v[236:237], v[236:237], s[60:61]
    s_branch L_pgpost_kernel_3_s
.p2align 12
L_pgpost_kernel_3:
    s_branch L_pgpost_kernel_7
L_pgpost_kernel_3_s:
    v_pk_add_f32 v[218:219], v[218:219], v[86:87]
    v_exp_f32 v239, v239
    v_pk_mul_f32 v[244:245], v[40:41], v[40:41]
    v_pk_fma_f32 v[42:43], v[214:215], v[182:183], v[42:43] op_sel:[0,0,0] op_sel_hi:[1,0,1]
    v_add_f32_dpp v190, v216, v216 row_ror:8 row_mask:0xf bank_mask:0x3
    v_rcp_f32 v236, v236
    v_pk_add_f32 v[238:239], v[238:239], s[60:61]
    v_add_f32_dpp v191, v224, v224 row_ror:8 row_mask:0xf bank_mask:0x3
    v_pk_fma_f32 v[244:245], v[244:245], v[176:177], v[168:169]
    v_add_f32_dpp v192, v217, v217 row_ror:8 row_mask:0xf bank_mask:0x3
    v_rcp_f32 v237, v237
    v_pk_mul_f32 v[246:247], v[42:43], v[42:43]
    v_add_f32_dpp v193, v225, v225 row_ror:8 row_mask:0xf bank_mask:0x3
    v_pk_mul_f32 v[244:245], v[244:245], v[40:41]
    v_add_f32_dpp v190, v218, v218 row_ror:8 row_mask:0xf bank_mask:0xc
    v_rcp_f32 v238, v238
    s_add_u32 m0, s48, 131072
    s_nop 0
    buffer_load_dwordx4 v4, s[32:35], s49 offen offset:0 lds
    v_pk_mul_f32 v[24:25], v[24:25], v[236:237]
    v_add_f32_dpp v191, v226, v226 row_ror:8 row_mask:0xf bank_mask:0xc
    v_pk_fma_f32 v[246:247], v[246:247], v[178:179], v[170:171]
    v_add_f32_dpp v192, v219, v219 row_ror:8 row_mask:0xf bank_mask:0xc
    v_rcp_f32 v239, v239
    v_pk_fma_f32 v[228:229], v[24:25], v[24:25], v[228:229]
    v_add_f32_dpp v193, v227, v227 row_ror:8 row_mask:0xf bank_mask:0xc
    v_pk_mul_f32 v[246:247], v[246:247], v[42:43]
    v_exp_f32 v240, v240
    v_pk_add_f32 v[220:221], v[220:221], v[24:25]
    v_add_f32_dpp v194, v190, v190 row_ror:12 row_mask:0xf bank_mask:0x5
    v_pk_mul_f32 v[26:27], v[26:27], v[238:239]
    v_add_f32_dpp v195, v191, v191 row_ror:12 row_mask:0xf bank_mask:0x5
    v_exp_f32 v241, v241
    v_pk_fma_f32 v[48:49], v[212:213], v[182:183], v[48:49] op_sel:[0,1,0] op_sel_hi:[1,1,1]
    v_pk_fma_f32 v[230:231], v[26:27], v[26:27], v[230:231]
    v_add_f32_dpp v194, v192, v192 row_ror:4 row_mask:0xf bank_mask:0xa
    v_exp_f32 v242, v242
    v_pk_add_f32 v[240:241], v[240:241], s[60:61]
    buffer_load_dwordx4 v4, s[32:35], s49 offen offset:1024 lds
    v_add_f32_dpp v195, v193, v193 row_ror:4 row_mask:0xf bank_mask:0xa
    v_pk_add_f32 v[222:223], v[222:223], v[26:27]
    v_exp_f32 v243, v243
    v_pk_mul_f32 v[232:233], v[48:49], v[48:49]
    v_add_f32_dpp v196, v194, v194 quad_perm:[2,3,0,1] row_mask:0xf bank_mask:0xf
    v_pk_fma_f32 v[50:51], v[214:215], v[182:183], v[50:51] op_sel:[0,1,0] op_sel_hi:[1,1,1]
    v_add_f32_dpp v197, v195, v195 quad_perm:[2,3,0,1] row_mask:0xf bank_mask:0xf
    v_rcp_f32 v240, v240
    v_pk_add_f32 v[242:243], v[242:243], s[60:61]
    v_pk_fma_f32 v[232:233], v[232:233], v[176:177], v[168:169]
    v_add_f32_dpp v194, v196, v196 quad_perm:[1,0,3,2] row_mask:0xf bank_mask:0xf
    v_rcp_f32 v241, v241
    v_pk_mul_f32 v[234:235], v[50:51], v[50:51]
    v_add_f32_dpp v195, v197, v197 quad_perm:[1,0,3,2] row_mask:0xf bank_mask:0xf
    v_pk_mul_f32 v[232:233], v[232:233], v[48:49]
    s_mov_b32 exec_lo, 0x11111111
    s_mov_b32 exec_hi, 0x11111111
    buffer_store_dwordx2 v[194:195], v7, s[32:35], s63 offen offset:0 sc1
    s_mov_b64 exec, -1
    v_rcp_f32 v242, v242
    v_pk_mul_f32 v[32:33], v[32:33], v[240:241]
    v_pk_fma_f32 v[234:235], v[234:235], v[178:179], v[170:171]
    buffer_load_dwordx4 v4, s[32:35], s49 offen offset:2048 lds
    v_rcp_f32 v243, v243
    v_pk_fma_f32 v[228:229], v[32:33], v[32:33], v[228:229]
    v_pk_mul_f32 v[234:235], v[234:235], v[50:51]
    v_exp_f32 v244, v244
    v_pk_add_f32 v[220:221], v[220:221], v[32:33]
    v_pk_mul_f32 v[34:35], v[34:35], v[242:243]
    v_exp_f32 v245, v245
    v_pk_fma_f32 v[56:57], v[212:213], v[184:185], v[56:57] op_sel:[0,0,0] op_sel_hi:[1,0,1]
    v_pk_fma_f32 v[230:231], v[34:35], v[34:35], v[230:231]
    v_exp_f32 v246, v246
    v_pk_add_f32 v[244:245], v[244:245], s[60:61]
    v_pk_add_f32 v[222:223], v[222:223], v[34:35]
    v_exp_f32 v247, v247
    buffer_load_dwordx4 v4, s[32:35], s49 offen offset:3072 lds
    s_add_u32 s49, s49, 16384
    v_pk_mul_f32 v[236:237], v[56:57], v[56:57]
    v_pk_fma_f32 v[58:59], v[214:215], v[184:185], v[58:59] op_sel:[0,0,0] op_sel_hi:[1,0,1]
    v_rcp_f32 v244, v244
    v_pk_add_f32 v[246:247], v[246:247], s[60:61]
    v_pk_fma_f32 v[236:237], v[236:237], v[176:177], v[168:169]
    v_rcp_f32 v245, v245
    v_pk_mul_f32 v[238:239], v[58:59], v[58:59]
    v_pk_mul_f32 v[236:237], v[236:237], v[56:57]
    v_rcp_f32 v246, v246
    v_pk_mul_f32 v[40:41], v[40:41], v[244:245]
    v_pk_fma_f32 v[238:239], v[238:239], v[178:179], v[170:171]
    v_rcp_f32 v247, v247
    v_pk_fma_f32 v[228:229], v[40:41], v[40:41], v[228:229]
    buffer_load_dwordx4 a[216:219], v4, s[32:35], s51 offen offset:0
    v_pk_mul_f32 v[238:239], v[238:239], v[58:59]
    v_exp_f32 v232, v232
    v_pk_add_f32 v[220:221], v[220:221], v[40:41]
    v_pk_mul_f32 v[42:43], v[42:43], v[246:247]
    v_exp_f32 v233, v233
    v_pk_fma_f32 v[64:65], v[212:213], v[184:185], v[64:65] op_sel:[0,1,0] op_sel_hi:[1,1,1]
    v_pk_fma_f32 v[230:231], v[42:43], v[42:43], v[230:231]
    v_exp_f32 v234, v234
    v_pk_add_f32 v[232:233], v[232:233], s[60:61]
    v_pk_add_f32 v[222:223], v[222:223], v[42:43]
    v_exp_f32 v235, v235
    v_pk_mul_f32 v[240:241], v[64:65], v[64:65]
    v_pk_fma_f32 v[66:67], v[214:215], v[184:185], v[66:67] op_sel:[0,1,0] op_sel_hi:[1,1,1]
    buffer_load_dwordx4 a[220:223], v4, s[32:35], s51 offen offset:1024
    v_rcp_f32 v232, v232
    v_pk_add_f32 v[234:235], v[234:235], s[60:61]
    v_pk_fma_f32 v[240:241], v[240:241], v[176:177], v[168:169]
    v_rcp_f32 v233, v233
    v_pk_mul_f32 v[242:243], v[66:67], v[66:67]
    v_pk_mul_f32 v[240:241], v[240:241], v[64:65]
    v_rcp_f32 v234, v234
    v_pk_mul_f32 v[48:49], v[48:49], v[232:233]
    v_pk_fma_f32 v[242:243], v[242:243], v[178:179], v[170:171]
    v_rcp_f32 v235, v235
    v_pk_fma_f32 v[228:229], v[48:49], v[48:49], v[228:229]
    v_pk_mul_f32 v[242:243], v[242:243], v[66:67]
    v_exp_f32 v236, v236
    buffer_load_dwordx4 a[224:227], v4, s[32:35], s51 offen offset:2048
    v_pk_add_f32 v[220:221], v[220:221], v[48:49]
    v_pk_mul_f32 v[50:51], v[50:51], v[234:235]
    v_exp_f32 v237, v237
    v_pk_fma_f32 v[72:73], v[212:213], v[186:187], v[72:73] op_sel:[0,0,0] op_sel_hi:[1,0,1]
    v_pk_fma_f32 v[230:231], v[50:51], v[50:51], v[230:231]
    v_exp_f32 v238, v238
    v_pk_add_f32 v[236:237], v[236:237], s[60:61]
    v_pk_add_f32 v[222:223], v[222:223], v[50:51]
    v_exp_f32 v239, v239
    v_pk_mul_f32 v[244:245], v[72:73], v[72:73]
    v_pk_fma_f32 v[74:75], v[214:215], v[186:187], v[74:75] op_sel:[0,0,0] op_sel_hi:[1,0,1]
    v_rcp_f32 v236, v236
    v_pk_add_f32 v[238:239], v[238:239], s[60:61]
    buffer_load_dwordx4 a[228:231], v4, s[32:35], s51 offen offset:3072
    s_add_u32 s51, s51, 4096
    v_pk_fma_f32 v[244:245], v[244:245], v[176:177], v[168:169]
    v_rcp_f32 v237, v237
    v_pk_mul_f32 v[246:247], v[74:75], v[74:75]
    v_pk_mul_f32 v[244:245], v[244:245], v[72:73]
    v_rcp_f32 v238, v238
    v_pk_mul_f32 v[56:57], v[56:57], v[236:237]
    v_pk_fma_f32 v[246:247], v[246:247], v[178:179], v[170:171]
    v_rcp_f32 v239, v239
    v_pk_fma_f32 v[228:229], v[56:57], v[56:57], v[228:229]
    v_pk_mul_f32 v[246:247], v[246:247], v[74:75]
    v_exp_f32 v240, v240
    v_pk_add_f32 v[220:221], v[220:221], v[56:57]
    v_pk_mul_f32 v[58:59], v[58:59], v[238:239]
    buffer_load_dwordx4 a[232:235], v4, s[32:35], s51 offen offset:0
    v_exp_f32 v241, v241
    v_pk_fma_f32 v[80:81], v[212:213], v[186:187], v[80:81] op_sel:[0,1,0] op_sel_hi:[1,1,1]
    v_pk_fma_f32 v[230:231], v[58:59], v[58:59], v[230:231]
    v_exp_f32 v242, v242
    v_pk_add_f32 v[240:241], v[240:241], s[60:61]
    v_pk_add_f32 v[222:223], v[222:223], v[58:59]
    v_exp_f32 v243, v243
    v_pk_mul_f32 v[232:233], v[80:81], v[80:81]
    v_pk_fma_f32 v[82:83], v[214:215], v[186:187], v[82:83] op_sel:[0,1,0] op_sel_hi:[1,1,1]
    v_rcp_f32 v240, v240
    v_pk_add_f32 v[242:243], v[242:243], s[60:61]
    v_pk_fma_f32 v[232:233], v[232:233], v[176:177], v[168:169]
    v_rcp_f32 v241, v241
    buffer_load_dwordx4 a[236:239], v4, s[32:35], s51 offen offset:1024
    v_pk_mul_f32 v[234:235], v[82:83], v[82:83]
    v_pk_mul_f32 v[232:233], v[232:233], v[80:81]
    v_rcp_f32 v242, v242
    v_pk_mul_f32 v[64:65], v[64:65], v[240:241]
    v_pk_fma_f32 v[234:235], v[234:235], v[178:179], v[170:171]
    v_rcp_f32 v243, v243
    v_pk_fma_f32 v[228:229], v[64:65], v[64:65], v[228:229]
    v_pk_mul_f32 v[234:235], v[234:235], v[82:83]
    v_exp_f32 v244, v244
    v_pk_add_f32 v[220:221], v[220:221], v[64:65]
    v_pk_mul_f32 v[66:67], v[66:67], v[242:243]
    v_exp_f32 v245, v245
    v_pk_fma_f32 v[88:89], v[212:213], v[188:189], v[88:89] op_sel:[0,0,0] op_sel_hi:[1,0,1]
    buffer_load_dwordx4 a[240:243], v4, s[32:35], s51 offen offset:2048
    v_pk_fma_f32 v[230:231], v[66:67], v[66:67], v[230:231]
    v_exp_f32 v246, v246
    v_pk_add_f32 v[244:245], v[244:245], s[60:61]
    v_pk_add_f32 v[222:223], v[222:223], v[66:67]
    v_exp_f32 v247, v247
    v_pk_mul_f32 v[236:237], v[88:89], v[88:89]
    v_pk_fma_f32 v[90:91], v[214:215], v[188:189], v[90:91] op_sel:[0,0,0] op_sel_hi:[1,0,1]
    v_rcp_f32 v244, v244
    v_pk_add_f32 v[246:247], v[246:247], s[60:61]
    v_pk_fma_f32 v[236:237], v[236:237], v[176:177], v[168:169]
    v_rcp_f32 v245, v245
    v_pk_mul_f32 v[238:239], v[90:91], v[90:91]
    v_pk_mul_f32 v[236:237], v[236:237], v[88:89]
    buffer_load_dwordx4 a[244:247], v4, s[32:35], s51 offen offset:3072
    s_bfe_u32 s51, 56797, s19
    s_cmp_eq_u32 s51, s41
    s_cselect_b32 s51, s59, s51
    s_mul_i32 s51, s51, 8192
    s_add_u32 s51, s51, s18
    v_rcp_f32 v246, v246
    v_pk_mul_f32 v[72:73], v[72:73], v[244:245]
    v_pk_fma_f32 v[238:239], v[238:239], v[178:179], v[170:171]
    v_rcp_f32 v247, v247
    v_pk_fma_f32 v[228:229], v[72:73], v[72:73], v[228:229]
    v_pk_mul_f32 v[238:239], v[238:239], v[90:91]
    v_exp_f32 v232, v232
    v_pk_add_f32 v[220:221], v[220:221], v[72:73]
    v_pk_mul_f32 v[74:75], v[74:75], v[246:247]
    v_exp_f32 v233, v233
    buffer_load_dwordx4 v[198:201], v4, s[32:35], s62 offen offset:0 sc1
    buffer_load_dwordx4 v[202:205], v4, s[32:35], s62 offen offset:1024 sc1
    v_exp_f32 v234, v234
    v_pk_fma_f32 v[230:231], v[74:75], v[74:75], v[230:231]
    v_pk_add_f32 v[232:233], v[232:233], s[60:61]
    v_exp_f32 v235, v235
    v_pk_add_f32 v[222:223], v[222:223], v[74:75]
    v_rcp_f32 v232, v232
    v_pk_add_f32 v[234:235], v[234:235], s[60:61]
    v_rcp_f32 v233, v233
    v_exp_f32 v236, v236
    v_rcp_f32 v234, v234
    v_pk_mul_f32 v[80:81], v[80:81], v[232:233]
    v_rcp_f32 v235, v235
    v_exp_f32 v237, v237
    v_pk_fma_f32 v[228:229], v[80:81], v[80:81], v[228:229]
    v_exp_f32 v238, v238
    v_pk_mul_f32 v[82:83], v[82:83], v[234:235]
    v_pk_add_f32 v[220:221], v[220:221], v[80:81]
    v_exp_f32 v239, v239
    v_pk_fma_f32 v[230:231], v[82:83], v[82:83], v[230:231]
    v_pk_add_f32 v[236:237], v[236:237], s[60:61]
    v_pk_add_f32 v[238:239], v[238:239], s[60:61]
    v_pk_add_f32 v[222:223], v[222:223], v[82:83]
    v_rcp_f32 v236, v236
    v_rcp_f32 v237, v237
    v_rcp_f32 v238, v238
    v_rcp_f32 v239, v239
    v_pk_mul_f32 v[88:89], v[88:89], v[236:237]
    v_pk_mul_f32 v[90:91], v[90:91], v[238:239]
    v_pk_fma_f32 v[228:229], v[88:89], v[88:89], v[228:229]
    v_pk_fma_f32 v[230:231], v[90:91], v[90:91], v[230:231]
    v_pk_add_f32 v[220:221], v[220:221], v[88:89]
    v_pk_add_f32 v[222:223], v[222:223], v[90:91]
    v_lshrrev_b32 v5, 5, v1
    v_lshl_add_u32 v5, v5, 9, v4
    v_mov_b32 v236, 0x39e38e39
    s_add_u32 s55, s54, 4096
    s_add_u32 s10, s54, 8192
    v_add_f32_dpp v190, v220, v220 row_ror:8 row_mask:0xf bank_mask:0x3
    v_add_f32_dpp v191, v228, v228 row_ror:8 row_mask:0xf bank_mask:0x3
    v_add_f32_dpp v192, v221, v221 row_ror:8 row_mask:0xf bank_mask:0x3
    v_add_f32_dpp v193, v229, v229 row_ror:8 row_mask:0xf bank_mask:0x3
    v_add_f32_dpp v190, v222, v222 row_ror:8 row_mask:0xf bank_mask:0xc
    v_add_f32_dpp v191, v230, v230 row_ror:8 row_mask:0xf bank_mask:0xc
    v_add_f32_dpp v192, v223, v223 row_ror:8 row_mask:0xf bank_mask:0xc
    v_add_f32_dpp v193, v231, v231 row_ror:8 row_mask:0xf bank_mask:0xc
    s_nop 1
    v_add_f32_dpp v194, v190, v190 row_ror:12 row_mask:0xf bank_mask:0x5
    v_add_f32_dpp v195, v191, v191 row_ror:12 row_mask:0xf bank_mask:0x5
    s_nop 0
    v_add_f32_dpp v194, v192, v192 row_ror:4 row_mask:0xf bank_mask:0xa
    v_add_f32_dpp v195, v193, v193 row_ror:4 row_mask:0xf bank_mask:0xa
    s_nop 1
    v_add_f32_dpp v196, v194, v194 quad_perm:[2,3,0,1] row_mask:0xf bank_mask:0xf
    v_add_f32_dpp v197, v195, v195 quad_perm:[2,3,0,1] row_mask:0xf bank_mask:0xf
    s_nop 1
    v_add_f32_dpp v194, v196, v196 quad_perm:[1,0,3,2] row_mask:0xf bank_mask:0xf
    v_add_f32_dpp v195, v197, v197 quad_perm:[1,0,3,2] row_mask:0xf bank_mask:0xf
    s_mov_b32 exec_lo, 0x11111111
    s_mov_b32 exec_hi, 0x11111111
    buffer_store_dwordx2 v[194:195], v7, s[32:35], s63 offen offset:2048 sc1
    s_mov_b64 exec, -1
    s_mov_b32 s28, s16
    s_mov_b32 s29, s17
    s_mov_b32 s30, 4096
    s_mov_b32 s31, 0x20000
    v_and_b32 v234, 4, v2
    v_add_lshl_u32 v234, v234, v2, 1
    v_and_b32 v235, 8, v2
    v_sub_u32 v234, v234, v235
    s_lshl_b32 s44, s43, 1
    v_lshlrev_b32 v222, 7, v2
    s_mul_i32 s38, s36, 331776
    s_mul_i32 s45, s40, 9216
    s_add_u32 s38, s38, s45
    s_add_u32 s38, s38, 58720256
    buffer_load_ushort v248, v234, s[28:31], s44 offen offset:0
    buffer_load_ushort v249, v234, s[28:31], s44 offen offset:32
    s_waitcnt lgkmcnt(0)
    v_mfma_f32_16x16x32_bf16 v[92:95], a[144:147], a[0:3], v[92:95]
    ds_read_b128 a[180:183], v8 offset:27648
    v_mfma_f32_16x16x32_bf16 v[96:99], a[144:147], a[4:7], v[96:99]
    ds_read_b128 a[184:187], v8 offset:28672
    v_mfma_f32_16x16x32_bf16 v[100:103], a[148:151], a[0:3], v[100:103]
    ds_read_b128 a[188:191], v8 offset:29696
    v_mfma_f32_16x16x32_bf16 v[104:107], a[148:151], a[4:7], v[104:107]
    ds_read_b128 a[192:195], v8 offset:30720
    v_mfma_f32_16x16x32_bf16 v[108:111], a[152:155], a[0:3], v[108:111]
    ds_read_b128 a[196:199], v8 offset:31744
    v_mfma_f32_16x16x32_bf16 v[112:115], a[152:155], a[4:7], v[112:115]
    ds_read_b128 a[200:203], v8 offset:32768
    v_mfma_f32_16x16x32_bf16 v[116:119], a[156:159], a[0:3], v[116:119]
    ds_read_b128 a[204:207], v8 offset:33792
    v_mfma_f32_16x16x32_bf16 v[120:123], a[156:159], a[4:7], v[120:123]
    ds_read_b128 a[208:211], v8 offset:34816
    v_mfma_f32_16x16x32_bf16 v[124:127], a[160:163], a[0:3], v[124:127]
    ds_read_b128 a[212:215], v8 offset:35840
    v_mfma_f32_16x16x32_bf16 v[128:131], a[160:163], a[4:7], v[128:131]
    v_mfma_f32_16x16x32_bf16 v[132:135], a[164:167], a[0:3], v[132:135]
    v_mul_f32 v218, v14, v14
    v_mul_f32 v216, 0xc0135761, v14
    v_mfma_f32_16x16x32_bf16 v[136:139], a[164:167], a[4:7], v[136:139]
    v_rcp_f32 v220, v14
    v_mfma_f32_16x16x32_bf16 v[140:143], a[168:171], a[0:3], v[140:143]
    v_mul_f32 v219, v15, v15
    v_mul_f32 v217, 0xc0135761, v15
    v_mfma_f32_16x16x32_bf16 v[144:147], a[168:171], a[4:7], v[144:147]
    v_rcp_f32 v221, v15
    v_mfma_f32_16x16x32_bf16 v[148:151], a[172:175], a[0:3], v[148:151]
    v_mul_f32 v218, v218, v14
    v_mul_f32 v218, 0xbdd2d3e8, v218
    v_mfma_f32_16x16x32_bf16 v[152:155], a[172:175], a[4:7], v[152:155]
    v_mfma_f32_16x16x32_bf16 v[156:159], a[176:179], a[0:3], v[156:159]
    v_mul_f32 v219, v219, v15
    v_mul_f32 v219, 0xbdd2d3e8, v219
    v_mfma_f32_16x16x32_bf16 v[160:163], a[176:179], a[4:7], v[160:163]
    s_waitcnt vmcnt(36)
    s_barrier
    s_waitcnt lgkmcnt(0)
    v_mfma_f32_16x16x32_bf16 v[92:95], a[180:183], a[8:11], v[92:95]
    ds_read_b128 a[144:147], v8 offset:36864
    v_mfma_f32_16x16x32_bf16 v[96:99], a[180:183], a[12:15], v[96:99]
    ds_read_b128 a[148:151], v8 offset:37888
    s_add_u32 m0, s48, 0
    s_add_u32 s14, s49, s13
    buffer_load_dwordx4 v4, s[32:35], s49 offen offset:0 lds
    v_mfma_f32_16x16x32_bf16 v[100:103], a[184:187], a[8:11], v[100:103]
    ds_read_b128 a[152:155], v8 offset:38912
    v_mfma_f32_16x16x32_bf16 v[104:107], a[184:187], a[12:15], v[104:107]
    ds_read_b128 a[156:159], v8 offset:39936
    buffer_load_dwordx4 v4, s[32:35], s49 offen offset:1024 lds
    v_mfma_f32_16x16x32_bf16 v[108:111], a[188:191], a[8:11], v[108:111]
    ds_read_b128 a[160:163], v8 offset:40960
    v_mfma_f32_16x16x32_bf16 v[112:115], a[188:191], a[12:15], v[112:115]
    ds_read_b128 a[164:167], v8 offset:41984
    buffer_load_dwordx4 v4, s[32:35], s49 offen offset:2048 lds
    v_mfma_f32_16x16x32_bf16 v[116:119], a[192:195], a[8:11], v[116:119]
    ds_read_b128 a[168:171], v8 offset:43008
    v_mfma_f32_16x16x32_bf16 v[120:123], a[192:195], a[12:15], v[120:123]
    ds_read_b128 a[172:175], v8 offset:44032
    buffer_load_dwordx4 v4, s[32:35], s49 offen offset:3072 lds
    s_add_u32 m0, s12, 0
    s_add_u32 s49, s49, 20480
    v_mfma_f32_16x16x32_bf16 v[124:127], a[196:199], a[8:11], v[124:127]
    ds_read_b128 a[176:179], v8 offset:45056
    v_mfma_f32_16x16x32_bf16 v[128:131], a[196:199], a[12:15], v[128:131]
    buffer_load_dwordx4 v4, s[32:35], s14 offen offset:0 lds
    v_mfma_f32_16x16x32_bf16 v[132:135], a[200:203], a[8:11], v[132:135]
    v_mfma_f32_16x16x32_bf16 v[136:139], a[200:203], a[12:15], v[136:139]
    v_mfma_f32_16x16x32_bf16 v[140:143], a[204:207], a[8:11], v[140:143]
    v_mfma_f32_16x16x32_bf16 v[144:147], a[204:207], a[12:15], v[144:147]
    v_mfma_f32_16x16x32_bf16 v[148:151], a[208:211], a[8:11], v[148:151]
    v_mfma_f32_16x16x32_bf16 v[152:155], a[208:211], a[12:15], v[152:155]
    v_mfma_f32_16x16x32_bf16 v[156:159], a[212:215], a[8:11], v[156:159]
    v_mfma_f32_16x16x32_bf16 v[160:163], a[212:215], a[12:15], v[160:163]
    s_waitcnt vmcnt(8)
    s_mov_b32 s45, 0
    s_branch L_ps0_chk
L_ps0_spin:
    s_sleep 1
    buffer_load_dwordx4 v[198:201], v4, s[32:35], s62 offen offset:0 sc1
    buffer_load_dwordx4 v[202:205], v4, s[32:35], s62 offen offset:1024 sc1
    s_add_u32 s45, s45, 1
    s_waitcnt vmcnt(0)
L_ps0_chk:
    v_min3_f32 v232, v199, v201, v203
    v_min_f32 v232, v232, v205
    v_cmp_gt_f32 vcc, 0, v232
    s_cmp_ge_u32 s45, 0x100000
    s_cbranch_scc1 L_ps0_go
    s_cbranch_vccnz L_ps0_spin
L_ps0_go:
    v_pk_add_f32 v[198:199], v[198:199], v[200:201]
    v_pk_add_f32 v[202:203], v[202:203], v[204:205]
    v_pk_add_f32 v[198:199], v[198:199], v[202:203]
    s_waitcnt lgkmcnt(0)
    v_mfma_f32_16x16x32_bf16 v[92:95], a[144:147], a[16:19], v[92:95]
    ds_read_b128 a[180:183], v8 offset:46080
    s_nop 0
    v_permlane32_swap_b32 v198, v199
    v_mfma_f32_16x16x32_bf16 v[96:99], a[144:147], a[20:23], v[96:99]
    ds_read_b128 a[184:187], v8 offset:47104
    v_add_f32 v198, v198, v199
    v_mfma_f32_16x16x32_bf16 v[100:103], a[148:151], a[16:19], v[100:103]
    ds_read_b128 a[188:191], v8 offset:48128
    v_mov_b32 v199, v198
    v_mfma_f32_16x16x32_bf16 v[104:107], a[148:151], a[20:23], v[104:107]
    ds_read_b128 a[192:195], v8 offset:49152
    s_nop 0
    v_permlane16_swap_b32 v198, v199
    v_mfma_f32_16x16x32_bf16 v[108:111], a[152:155], a[16:19], v[108:111]
    ds_read_b128 a[196:199], v8 offset:50176
    v_add_f32 v198, v198, v199
    v_mfma_f32_16x16x32_bf16 v[112:115], a[152:155], a[20:23], v[112:115]
    ds_read_b128 a[200:203], v8 offset:51200
    v_mov_b32 v199, v198
    v_mfma_f32_16x16x32_bf16 v[116:119], a[156:159], a[16:19], v[116:119]
    ds_read_b128 a[204:207], v8 offset:52224
    s_nop 0
    v_permlane32_swap_b32 v198, v199
    v_mfma_f32_16x16x32_bf16 v[120:123], a[156:159], a[20:23], v[120:123]
    ds_read_b128 a[208:211], v8 offset:53248
    v_mul_f32 v198, 0xb9e38e39, v198
    v_mfma_f32_16x16x32_bf16 v[124:127], a[160:163], a[16:19], v[124:127]
    ds_read_b128 a[212:215], v8 offset:54272
    v_fma_f32 v199, v199, v236, v11
    v_mfma_f32_16x16x32_bf16 v[128:131], a[160:163], a[20:23], v[128:131]
    buffer_load_dwordx4 a[0:3], v4, s[32:35], s51 offen offset:0
    v_fma_f32 v199, -v198, v198, v199
    v_mfma_f32_16x16x32_bf16 v[132:135], a[164:167], a[16:19], v[132:135]
    v_max_f32 v199, v11, v199
    v_mfma_f32_16x16x32_bf16 v[136:139], a[164:167], a[20:23], v[136:139]
    buffer_load_dwordx4 a[4:7], v4, s[32:35], s51 offen offset:1024
    v_rsq_f32 v199, v199
    v_mfma_f32_16x16x32_bf16 v[140:143], a[168:171], a[16:19], v[140:143]
    s_nop 0
    ds_write_b32 v18, v199 offset:256
    v_mul_f32 v198, v198, v199
    v_mfma_f32_16x16x32_bf16 v[144:147], a[168:171], a[20:23], v[144:147]
    buffer_load_dwordx4 a[8:11], v4, s[32:35], s51 offen offset:2048
    ds_write_b32 v18, v198 offset:384
    ds_read_b128 v[164:167], v19 offset:256
    ds_read_b128 v[172:175], v19 offset:384
    v_mfma_f32_16x16x32_bf16 v[148:151], a[172:175], a[16:19], v[148:151]
    v_mfma_f32_16x16x32_bf16 v[152:155], a[172:175], a[20:23], v[152:155]
    buffer_load_dwordx4 a[12:15], v4, s[32:35], s51 offen offset:3072
    s_add_u32 s51, s51, 4096
    v_mfma_f32_16x16x32_bf16 v[156:159], a[176:179], a[16:19], v[156:159]
    v_mfma_f32_16x16x32_bf16 v[160:163], a[176:179], a[20:23], v[160:163]
    s_barrier
    s_waitcnt lgkmcnt(0)
    v_mfma_f32_16x16x32_bf16 v[92:95], a[180:183], a[24:27], v[92:95]
    ds_read_b128 a[144:147], v9 offset:0
    v_pk_fma_f32 v[20:21], v[20:21], v[164:165], v[172:173]
    v_pk_fma_f32 v[22:23], v[22:23], v[166:167], v[174:175]
    v_pk_fma_f32 v[28:29], v[28:29], v[164:165], v[172:173]
    v_pk_fma_f32 v[30:31], v[30:31], v[166:167], v[174:175]
    v_pk_fma_f32 v[36:37], v[36:37], v[164:165], v[172:173]
    v_pk_fma_f32 v[38:39], v[38:39], v[166:167], v[174:175]
    v_pk_fma_f32 v[44:45], v[44:45], v[164:165], v[172:173]
    v_pk_fma_f32 v[46:47], v[46:47], v[166:167], v[174:175]
    v_pk_fma_f32 v[52:53], v[52:53], v[164:165], v[172:173]
    v_pk_fma_f32 v[54:55], v[54:55], v[166:167], v[174:175]
    v_pk_fma_f32 v[60:61], v[60:61], v[164:165], v[172:173]
    v_pk_fma_f32 v[62:63], v[62:63], v[166:167], v[174:175]
    v_pk_fma_f32 v[68:69], v[68:69], v[164:165], v[172:173]
    v_pk_fma_f32 v[70:71], v[70:71], v[166:167], v[174:175]
    v_pk_fma_f32 v[76:77], v[76:77], v[164:165], v[172:173]
    v_pk_fma_f32 v[78:79], v[78:79], v[166:167], v[174:175]
    v_pk_fma_f32 v[84:85], v[84:85], v[164:165], v[172:173]
    v_pk_fma_f32 v[86:87], v[86:87], v[166:167], v[174:175]
    v_cvt_pk_bf16_f32 v20, v20, v21
    v_mfma_f32_16x16x32_bf16 v[96:99], a[180:183], a[28:31], v[96:99]
    ds_read_b128 a[148:151], v9 offset:1024
    v_cvt_pk_bf16_f32 v21, v22, v23
    v_mfma_f32_16x16x32_bf16 v[100:103], a[184:187], a[24:27], v[100:103]
    ds_read_b128 a[152:155], v9 offset:2048
    v_cvt_pk_bf16_f32 v22, v28, v29
    v_mfma_f32_16x16x32_bf16 v[104:107], a[184:187], a[28:31], v[104:107]
    ds_read_b128 a[156:159], v9 offset:3072
    v_cvt_pk_bf16_f32 v23, v30, v31
    v_mfma_f32_16x16x32_bf16 v[108:111], a[188:191], a[24:27], v[108:111]
    ds_read_b128 a[160:163], v9 offset:4096
    v_cvt_pk_bf16_f32 v36, v36, v37
    v_mfma_f32_16x16x32_bf16 v[112:115], a[188:191], a[28:31], v[112:115]
    ds_read_b128 a[164:167], v9 offset:5120
    v_cvt_pk_bf16_f32 v37, v38, v39
    v_mfma_f32_16x16x32_bf16 v[116:119], a[192:195], a[24:27], v[116:119]
    ds_read_b128 a[168:171], v9 offset:6144
    v_permlane32_swap_b32 v20, v22
    v_mfma_f32_16x16x32_bf16 v[120:123], a[192:195], a[28:31], v[120:123]
    ds_read_b128 a[172:175], v9 offset:7168
    v_mfma_f32_16x16x32_bf16 v[124:127], a[196:199], a[24:27], v[124:127]
    ds_read_b128 a[176:179], v9 offset:8192
    v_permlane32_swap_b32 v21, v23
    v_mfma_f32_16x16x32_bf16 v[128:131], a[196:199], a[28:31], v[128:131]
    buffer_load_dwordx4 v[180:183], v4, s[32:35], s62 offen offset:2048 sc1
    v_mfma_f32_16x16x32_bf16 v[132:135], a[200:203], a[24:27], v[132:135]
    v_min_u32 v20, -2, v20
    v_mfma_f32_16x16x32_bf16 v[136:139], a[200:203], a[28:31], v[136:139]
    buffer_load_dwordx4 v[184:187], v4, s[32:35], s62 offen offset:3072 sc1
    v_mfma_f32_16x16x32_bf16 v[140:143], a[204:207], a[24:27], v[140:143]
    buffer_store_dwordx4 v[20:23], v5, s[32:35], s54 offen offset:0 sc1
    v_cvt_pk_bf16_f32 v38, v44, v45
    v_mfma_f32_16x16x32_bf16 v[144:147], a[204:207], a[28:31], v[144:147]
    s_add_u32 m0, s48, 20480
    s_nop 0
    buffer_load_dwordx4 v4, s[32:35], s49 offen offset:0 lds
    v_mfma_f32_16x16x32_bf16 v[148:151], a[208:211], a[24:27], v[148:151]
    v_cvt_pk_bf16_f32 v39, v46, v47
    v_cvt_pk_bf16_f32 v52, v52, v53
    v_mfma_f32_16x16x32_bf16 v[152:155], a[208:211], a[28:31], v[152:155]
    buffer_load_dwordx4 v4, s[32:35], s49 offen offset:1024 lds
    v_mfma_f32_16x16x32_bf16 v[156:159], a[212:215], a[24:27], v[156:159]
    v_cvt_pk_bf16_f32 v53, v54, v55
    v_permlane32_swap_b32 v36, v38
    v_mfma_f32_16x16x32_bf16 v[160:163], a[212:215], a[28:31], v[160:163]
    v_permlane32_swap_b32 v37, v39
    s_waitcnt lgkmcnt(0)
    v_mfma_f32_16x16x32_bf16 v[92:95], a[144:147], a[32:35], v[92:95]
    ds_read_b128 a[180:183], v9 offset:9216
    v_min_u32 v36, -2, v36
    v_mfma_f32_16x16x32_bf16 v[96:99], a[144:147], a[36:39], v[96:99]
    ds_read_b128 a[184:187], v9 offset:10240
    buffer_store_dwordx4 v[36:39], v5, s[32:35], s54 offen offset:2048 sc1
    v_mfma_f32_16x16x32_bf16 v[100:103], a[148:151], a[32:35], v[100:103]
    ds_read_b128 a[188:191], v9 offset:11264
    v_cvt_pk_bf16_f32 v54, v60, v61
    v_mfma_f32_16x16x32_bf16 v[104:107], a[148:151], a[36:39], v[104:107]
    ds_read_b128 a[192:195], v9 offset:12288
    v_cvt_pk_bf16_f32 v55, v62, v63
    v_mfma_f32_16x16x32_bf16 v[108:111], a[152:155], a[32:35], v[108:111]
    ds_read_b128 a[196:199], v9 offset:13312
    v_cvt_pk_bf16_f32 v68, v68, v69
    v_mfma_f32_16x16x32_bf16 v[112:115], a[152:155], a[36:39], v[112:115]
    ds_read_b128 a[200:203], v9 offset:14336
    v_cvt_pk_bf16_f32 v69, v70, v71
    v_mfma_f32_16x16x32_bf16 v[116:119], a[156:159], a[32:35], v[116:119]
    ds_read_b128 a[204:207], v9 offset:15360
    v_permlane32_swap_b32 v52, v54
    v_mfma_f32_16x16x32_bf16 v[120:123], a[156:159], a[36:39], v[120:123]
    ds_read_b128 a[208:211], v9 offset:16384
    v_mfma_f32_16x16x32_bf16 v[124:127], a[160:163], a[32:35], v[124:127]
    ds_read_b128 a[212:215], v9 offset:17408
    v_permlane32_swap_b32 v53, v55
    v_mfma_f32_16x16x32_bf16 v[128:131], a[160:163], a[36:39], v[128:131]
    buffer_load_dwordx4 a[16:19], v4, s[32:35], s51 offen offset:0
    v_mfma_f32_16x16x32_bf16 v[132:135], a[164:167], a[32:35], v[132:135]
    v_min_u32 v52, -2, v52
    v_mfma_f32_16x16x32_bf16 v[136:139], a[164:167], a[36:39], v[136:139]
    buffer_load_dwordx4 a[20:23], v4, s[32:35], s51 offen offset:1024
    v_mfma_f32_16x16x32_bf16 v[140:143], a[168:171], a[32:35], v[140:143]
    buffer_store_dwordx4 v[52:55], v5, s[32:35], s55 offen offset:0 sc1
    v_cvt_pk_bf16_f32 v70, v76, v77
    v_mfma_f32_16x16x32_bf16 v[144:147], a[168:171], a[36:39], v[144:147]
    buffer_load_dwordx4 a[24:27], v4, s[32:35], s51 offen offset:2048
    v_mfma_f32_16x16x32_bf16 v[148:151], a[172:175], a[32:35], v[148:151]
    v_cvt_pk_bf16_f32 v71, v78, v79
    v_cvt_pk_bf16_f32 v84, v84, v85
    v_mfma_f32_16x16x32_bf16 v[152:155], a[172:175], a[36:39], v[152:155]
    buffer_load_dwordx4 a[28:31], v4, s[32:35], s51 offen offset:3072
    s_bfe_u32 s51, 61166, s19
    s_cmp_eq_u32 s51, s41
    s_cselect_b32 s51, s59, s51
    s_mul_i32 s51, s51, 8192
    s_add_u32 s51, s51, s18
    v_mfma_f32_16x16x32_bf16 v[156:159], a[176:179], a[32:35], v[156:159]
    v_cvt_pk_bf16_f32 v85, v86, v87
    v_permlane32_swap_b32 v68, v70
    v_mfma_f32_16x16x32_bf16 v[160:163], a[176:179], a[36:39], v[160:163]
    v_permlane32_swap_b32 v69, v71
    s_barrier
    s_waitcnt lgkmcnt(0)
    v_mfma_f32_16x16x32_bf16 v[92:95], a[180:183], a[40:43], v[92:95]
    ds_read_b128 a[144:147], v9 offset:18432
    v_min_u32 v68, -2, v68
    v_mfma_f32_16x16x32_bf16 v[96:99], a[180:183], a[44:47], v[96:99]
    ds_read_b128 a[148:151], v9 offset:19456
    buffer_store_dwordx4 v[68:71], v5, s[32:35], s55 offen offset:2048 sc1
    v_mfma_f32_16x16x32_bf16 v[100:103], a[184:187], a[40:43], v[100:103]
    ds_read_b128 a[152:155], v9 offset:20480
    s_nop 1
    v_permlane32_swap_b32 v84, v86
    v_mfma_f32_16x16x32_bf16 v[104:107], a[184:187], a[44:47], v[104:107]
    ds_read_b128 a[156:159], v9 offset:21504
    v_mfma_f32_16x16x32_bf16 v[108:111], a[188:191], a[40:43], v[108:111]
    ds_read_b128 a[160:163], v9 offset:22528
    v_permlane32_swap_b32 v85, v87
    v_mfma_f32_16x16x32_bf16 v[112:115], a[188:191], a[44:47], v[112:115]
    ds_read_b128 a[164:167], v9 offset:23552
    v_mfma_f32_16x16x32_bf16 v[116:119], a[192:195], a[40:43], v[116:119]
    ds_read_b128 a[168:171], v9 offset:24576
    v_min_u32 v84, -2, v84
    v_mfma_f32_16x16x32_bf16 v[120:123], a[192:195], a[44:47], v[120:123]
    ds_read_b128 a[172:175], v9 offset:25600
    s_mov_b32 exec_hi, 0
    buffer_store_dwordx4 v[84:87], v5, s[32:35], s10 offen offset:0 sc1
    s_mov_b32 exec_hi, -1
    v_mfma_f32_16x16x32_bf16 v[124:127], a[196:199], a[40:43], v[124:127]
    ds_read_b128 a[176:179], v9 offset:26624
    v_mfma_f32_16x16x32_bf16 v[128:131], a[196:199], a[44:47], v[128:131]
    v_mfma_f32_16x16x32_bf16 v[132:135], a[200:203], a[40:43], v[132:135]
    v_mfma_f32_16x16x32_bf16 v[136:139], a[200:203], a[44:47], v[136:139]
    v_mfma_f32_16x16x32_bf16 v[140:143], a[204:207], a[40:43], v[140:143]
    s_branch L_pgpost_kernel_4_s
.p2align 12
L_pgpost_kernel_4:
    s_branch L_pgpost_kernel_8
L_pgpost_kernel_4_s:
    v_mfma_f32_16x16x32_bf16 v[144:147], a[204:207], a[44:47], v[144:147]
    v_mfma_f32_16x16x32_bf16 v[148:151], a[208:211], a[40:43], v[148:151]
    v_mfma_f32_16x16x32_bf16 v[152:155], a[208:211], a[44:47], v[152:155]
    v_mfma_f32_16x16x32_bf16 v[156:159], a[212:215], a[40:43], v[156:159]
    v_mfma_f32_16x16x32_bf16 v[160:163], a[212:215], a[44:47], v[160:163]
    s_waitcnt vmcnt(11)
    s_mov_b32 s45, 0
    s_branch L_ps1_chk
L_ps1_spin:
    s_sleep 1
    buffer_load_dwordx4 v[180:183], v4, s[32:35], s62 offen offset:2048 sc1
    buffer_load_dwordx4 v[184:187], v4, s[32:35], s62 offen offset:3072 sc1
    s_add_u32 s45, s45, 1
    s_waitcnt vmcnt(0)
L_ps1_chk:
    v_min3_f32 v232, v181, v183, v185
    v_min_f32 v232, v232, v187
    v_cmp_gt_f32 vcc, 0, v232
    s_cmp_ge_u32 s45, 0x100000
    s_cbranch_scc1 L_ps1_go
    s_cbranch_vccnz L_ps1_spin
L_ps1_go:
    v_pk_add_f32 v[180:181], v[180:181], v[182:183]
    v_pk_add_f32 v[184:185], v[184:185], v[186:187]
    v_pk_add_f32 v[180:181], v[180:181], v[184:185]
    s_waitcnt lgkmcnt(0)
    v_mfma_f32_16x16x32_bf16 v[92:95], a[144:147], a[48:51], v[92:95]
    ds_read_b128 a[180:183], v9 offset:27648
    s_nop 0
    v_permlane32_swap_b32 v180, v181
    v_mfma_f32_16x16x32_bf16 v[96:99], a[144:147], a[52:55], v[96:99]
    ds_read_b128 a[184:187], v9 offset:28672
    v_add_f32 v180, v180, v181
    v_mfma_f32_16x16x32_bf16 v[100:103], a[148:151], a[48:51], v[100:103]
    ds_read_b128 a[188:191], v9 offset:29696
    v_mov_b32 v181, v180
    v_mfma_f32_16x16x32_bf16 v[104:107], a[148:151], a[52:55], v[104:107]
    ds_read_b128 a[192:195], v9 offset:30720
    s_nop 0
    v_permlane16_swap_b32 v180, v181
    v_mfma_f32_16x16x32_bf16 v[108:111], a[152:155], a[48:51], v[108:111]
    ds_read_b128 a[196:199], v9 offset:31744
    v_add_f32 v180, v180, v181
    v_mfma_f32_16x16x32_bf16 v[112:115], a[152:155], a[52:55], v[112:115]
    ds_read_b128 a[200:203], v9 offset:32768
    v_mov_b32 v181, v180
    v_mfma_f32_16x16x32_bf16 v[116:119], a[156:159], a[48:51], v[116:119]
    ds_read_b128 a[204:207], v9 offset:33792
    s_nop 0
    v_permlane32_swap_b32 v180, v181
    v_mfma_f32_16x16x32_bf16 v[120:123], a[156:159], a[52:55], v[120:123]
    ds_read_b128 a[208:211], v9 offset:34816
    v_mul_f32 v180, 0xb9e38e39, v180
    v_mfma_f32_16x16x32_bf16 v[124:127], a[160:163], a[48:51], v[124:127]
    ds_read_b128 a[212:215], v9 offset:35840
    v_fma_f32 v181, v181, v236, v12
    v_mfma_f32_16x16x32_bf16 v[128:131], a[160:163], a[52:55], v[128:131]
    v_fma_f32 v181, -v180, v180, v181
    v_mfma_f32_16x16x32_bf16 v[132:135], a[164:167], a[48:51], v[132:135]
    v_max_f32 v181, v12, v181
    v_mfma_f32_16x16x32_bf16 v[136:139], a[164:167], a[52:55], v[136:139]
    v_rsq_f32 v181, v181
    v_mfma_f32_16x16x32_bf16 v[140:143], a[168:171], a[48:51], v[140:143]
    s_nop 0
    ds_write_b32 v18, v181 offset:320
    v_mul_f32 v180, v180, v181
    v_mfma_f32_16x16x32_bf16 v[144:147], a[168:171], a[52:55], v[144:147]
    ds_write_b32 v18, v180 offset:448
    ds_read_b128 v[168:171], v19 offset:320
    ds_read_b128 v[176:179], v19 offset:448
    v_mfma_f32_16x16x32_bf16 v[148:151], a[172:175], a[48:51], v[148:151]
    v_mfma_f32_16x16x32_bf16 v[152:155], a[172:175], a[52:55], v[152:155]
    v_mfma_f32_16x16x32_bf16 v[156:159], a[176:179], a[48:51], v[156:159]
    v_mfma_f32_16x16x32_bf16 v[160:163], a[176:179], a[52:55], v[160:163]
    s_barrier
    s_waitcnt lgkmcnt(0)
    v_mfma_f32_16x16x32_bf16 v[92:95], a[180:183], a[56:59], v[92:95]
    ds_read_b128 a[144:147], v9 offset:36864
    v_pk_fma_f32 v[24:25], v[24:25], v[168:169], v[176:177]
    v_pk_fma_f32 v[26:27], v[26:27], v[170:171], v[178:179]
    v_pk_fma_f32 v[32:33], v[32:33], v[168:169], v[176:177]
    v_pk_fma_f32 v[34:35], v[34:35], v[170:171], v[178:179]
    v_pk_fma_f32 v[40:41], v[40:41], v[168:169], v[176:177]
    v_pk_fma_f32 v[42:43], v[42:43], v[170:171], v[178:179]
    v_pk_fma_f32 v[48:49], v[48:49], v[168:169], v[176:177]
    v_pk_fma_f32 v[50:51], v[50:51], v[170:171], v[178:179]
    v_pk_fma_f32 v[56:57], v[56:57], v[168:169], v[176:177]
    v_pk_fma_f32 v[58:59], v[58:59], v[170:171], v[178:179]
    v_pk_fma_f32 v[64:65], v[64:65], v[168:169], v[176:177]
    v_pk_fma_f32 v[66:67], v[66:67], v[170:171], v[178:179]
    v_pk_fma_f32 v[72:73], v[72:73], v[168:169], v[176:177]
    v_pk_fma_f32 v[74:75], v[74:75], v[170:171], v[178:179]
    v_pk_fma_f32 v[80:81], v[80:81], v[168:169], v[176:177]
    v_pk_fma_f32 v[82:83], v[82:83], v[170:171], v[178:179]
    v_pk_fma_f32 v[88:89], v[88:89], v[168:169], v[176:177]
    v_pk_fma_f32 v[90:91], v[90:91], v[170:171], v[178:179]
    v_cvt_pk_bf16_f32 v24, v24, v25
    v_mfma_f32_16x16x32_bf16 v[96:99], a[180:183], a[60:63], v[96:99]
    ds_read_b128 a[148:151], v9 offset:37888
    v_cvt_pk_bf16_f32 v25, v26, v27
    v_mfma_f32_16x16x32_bf16 v[100:103], a[184:187], a[56:59], v[100:103]
    ds_read_b128 a[152:155], v9 offset:38912
    v_cvt_pk_bf16_f32 v26, v32, v33
    v_mfma_f32_16x16x32_bf16 v[104:107], a[184:187], a[60:63], v[104:107]
    ds_read_b128 a[156:159], v9 offset:39936
    v_cvt_pk_bf16_f32 v27, v34, v35
    v_mfma_f32_16x16x32_bf16 v[108:111], a[188:191], a[56:59], v[108:111]
    ds_read_b128 a[160:163], v9 offset:40960
    v_cvt_pk_bf16_f32 v40, v40, v41
    v_mfma_f32_16x16x32_bf16 v[112:115], a[188:191], a[60:63], v[112:115]
    ds_read_b128 a[164:167], v9 offset:41984
    v_cvt_pk_bf16_f32 v41, v42, v43
    v_mfma_f32_16x16x32_bf16 v[116:119], a[192:195], a[56:59], v[116:119]
    ds_read_b128 a[168:171], v9 offset:43008
    v_permlane32_swap_b32 v24, v26
    v_mfma_f32_16x16x32_bf16 v[120:123], a[192:195], a[60:63], v[120:123]
    ds_read_b128 a[172:175], v9 offset:44032
    v_mfma_f32_16x16x32_bf16 v[124:127], a[196:199], a[56:59], v[124:127]
    ds_read_b128 a[176:179], v9 offset:45056
    v_permlane32_swap_b32 v25, v27
    v_mfma_f32_16x16x32_bf16 v[128:131], a[196:199], a[60:63], v[128:131]
    v_min_u32 v24, -2, v24
    v_mfma_f32_16x16x32_bf16 v[132:135], a[200:203], a[56:59], v[132:135]
    buffer_store_dwordx4 v[24:27], v5, s[32:35], s54 offen offset:512 sc1
    v_cvt_pk_bf16_f32 v42, v48, v49
    v_mfma_f32_16x16x32_bf16 v[136:139], a[200:203], a[60:63], v[136:139]
    v_cvt_pk_bf16_f32 v43, v50, v51
    v_cvt_pk_bf16_f32 v56, v56, v57
    v_mfma_f32_16x16x32_bf16 v[140:143], a[204:207], a[56:59], v[140:143]
    v_cvt_pk_bf16_f32 v57, v58, v59
    v_permlane32_swap_b32 v40, v42
    v_mfma_f32_16x16x32_bf16 v[144:147], a[204:207], a[60:63], v[144:147]
    v_permlane32_swap_b32 v41, v43
    v_mfma_f32_16x16x32_bf16 v[148:151], a[208:211], a[56:59], v[148:151]
    v_min_u32 v40, -2, v40
    v_mfma_f32_16x16x32_bf16 v[152:155], a[208:211], a[60:63], v[152:155]
    buffer_store_dwordx4 v[40:43], v5, s[32:35], s54 offen offset:2560 sc1
    v_cvt_pk_bf16_f32 v58, v64, v65
    v_mfma_f32_16x16x32_bf16 v[156:159], a[212:215], a[56:59], v[156:159]
    v_cvt_pk_bf16_f32 v59, v66, v67
    v_cvt_pk_bf16_f32 v72, v72, v73
    v_mfma_f32_16x16x32_bf16 v[160:163], a[212:215], a[60:63], v[160:163]
    v_cvt_pk_bf16_f32 v73, v74, v75
    v_permlane32_swap_b32 v56, v58
    s_waitcnt lgkmcnt(0)
    v_mfma_f32_16x16x32_bf16 v[92:95], a[144:147], a[64:67], v[92:95]
    ds_read_b128 a[180:183], v9 offset:46080
    v_permlane32_swap_b32 v57, v59
    v_mfma_f32_16x16x32_bf16 v[96:99], a[144:147], a[68:71], v[96:99]
    ds_read_b128 a[184:187], v9 offset:47104
    v_mfma_f32_16x16x32_bf16 v[100:103], a[148:151], a[64:67], v[100:103]
    ds_read_b128 a[188:191], v9 offset:48128
    v_min_u32 v56, -2, v56
    v_mfma_f32_16x16x32_bf16 v[104:107], a[148:151], a[68:71], v[104:107]
    ds_read_b128 a[192:195], v9 offset:49152
    buffer_store_dwordx4 v[56:59], v5, s[32:35], s55 offen offset:512 sc1
    v_mfma_f32_16x16x32_bf16 v[108:111], a[152:155], a[64:67], v[108:111]
    ds_read_b128 a[196:199], v9 offset:50176
    v_cvt_pk_bf16_f32 v74, v80, v81
    v_mfma_f32_16x16x32_bf16 v[112:115], a[152:155], a[68:71], v[112:115]
    ds_read_b128 a[200:203], v9 offset:51200
    v_cvt_pk_bf16_f32 v75, v82, v83
    v_mfma_f32_16x16x32_bf16 v[116:119], a[156:159], a[64:67], v[116:119]
    ds_read_b128 a[204:207], v9 offset:52224
    v_cvt_pk_bf16_f32 v88, v88, v89
    v_mfma_f32_16x16x32_bf16 v[120:123], a[156:159], a[68:71], v[120:123]
    ds_read_b128 a[208:211], v9 offset:53248
    v_cvt_pk_bf16_f32 v89, v90, v91
    v_mfma_f32_16x16x32_bf16 v[124:127], a[160:163], a[64:67], v[124:127]
    ds_read_b128 a[212:215], v9 offset:54272
    v_permlane32_swap_b32 v72, v74
    v_mfma_f32_16x16x32_bf16 v[128:131], a[160:163], a[68:71], v[128:131]
    v_permlane32_swap_b32 v73, v75
    v_mfma_f32_16x16x32_bf16 v[132:135], a[164:167], a[64:67], v[132:135]
    v_min_u32 v72, -2, v72
    v_mfma_f32_16x16x32_bf16 v[136:139], a[164:167], a[68:71], v[136:139]
    buffer_store_dwordx4 v[72:75], v5, s[32:35], s55 offen offset:2560 sc1
    s_nop 1
    v_permlane32_swap_b32 v88, v90
    v_mfma_f32_16x16x32_bf16 v[140:143], a[168:171], a[64:67], v[140:143]
    v_permlane32_swap_b32 v89, v91
    v_mfma_f32_16x16x32_bf16 v[144:147], a[168:171], a[68:71], v[144:147]
    v_min_u32 v88, -2, v88
    v_mfma_f32_16x16x32_bf16 v[148:151], a[172:175], a[64:67], v[148:151]
    s_mov_b32 exec_hi, 0
    buffer_store_dwordx4 v[88:91], v5, s[32:35], s10 offen offset:512 sc1
    s_mov_b32 exec_hi, -1
    v_mfma_f32_16x16x32_bf16 v[152:155], a[172:175], a[68:71], v[152:155]
    v_mfma_f32_16x16x32_bf16 v[156:159], a[176:179], a[64:67], v[156:159]
    v_mfma_f32_16x16x32_bf16 v[160:163], a[176:179], a[68:71], v[160:163]
    s_barrier
    s_waitcnt lgkmcnt(0)
    v_mfma_f32_16x16x32_bf16 v[92:95], a[180:183], a[72:75], v[92:95]
    ds_read_b128 a[144:147], v10 offset:0
    v_mfma_f32_16x16x32_bf16 v[96:99], a[180:183], a[76:79], v[96:99]
    ds_read_b128 a[148:151], v10 offset:1024
    v_mfma_f32_16x16x32_bf16 v[100:103], a[184:187], a[72:75], v[100:103]
    ds_read_b128 a[152:155], v10 offset:2048
    v_mfma_f32_16x16x32_bf16 v[104:107], a[184:187], a[76:79], v[104:107]
    ds_read_b128 a[156:159], v10 offset:3072
    v_mfma_f32_16x16x32_bf16 v[108:111], a[188:191], a[72:75], v[108:111]
    ds_read_b128 a[160:163], v10 offset:4096
    v_mfma_f32_16x16x32_bf16 v[112:115], a[188:191], a[76:79], v[112:115]
    ds_read_b128 a[164:167], v10 offset:5120
    v_mfma_f32_16x16x32_bf16 v[116:119], a[192:195], a[72:75], v[116:119]
    ds_read_b128 a[168:171], v10 offset:6144
    v_mfma_f32_16x16x32_bf16 v[120:123], a[192:195], a[76:79], v[120:123]
    ds_read_b128 a[172:175], v10 offset:7168
    v_mfma_f32_16x16x32_bf16 v[124:127], a[196:199], a[72:75], v[124:127]
    ds_read_b128 a[176:179], v10 offset:8192
    v_mfma_f32_16x16x32_bf16 v[128:131], a[196:199], a[76:79], v[128:131]
    buffer_load_dwordx4 v4, s[32:35], s49 offen offset:2048 lds
    v_mfma_f32_16x16x32_bf16 v[132:135], a[200:203], a[72:75], v[132:135]
    v_mfma_f32_16x16x32_bf16 v[136:139], a[200:203], a[76:79], v[136:139]
    buffer_load_dwordx4 v4, s[32:35], s49 offen offset:3072 lds
    s_bfe_u32 s49, 56797, s19
    s_cmp_eq_u32 s49, s41
    s_cselect_b32 s49, s59, s49
    s_mul_i32 s49, s49, 589824
    s_add_u32 s49, s49, s15
    v_mfma_f32_16x16x32_bf16 v[140:143], a[204:207], a[72:75], v[140:143]
    v_mfma_f32_16x16x32_bf16 v[144:147], a[204:207], a[76:79], v[144:147]
    v_mfma_f32_16x16x32_bf16 v[148:151], a[208:211], a[72:75], v[148:151]
    v_mfma_f32_16x16x32_bf16 v[152:155], a[208:211], a[76:79], v[152:155]
    v_mfma_f32_16x16x32_bf16 v[156:159], a[212:215], a[72:75], v[156:159]
    v_mfma_f32_16x16x32_bf16 v[160:163], a[212:215], a[76:79], v[160:163]
    s_waitcnt lgkmcnt(0)
    v_mfma_f32_16x16x32_bf16 v[92:95], a[144:147], a[80:83], v[92:95]
    ds_read_b128 a[180:183], v10 offset:9216
    v_mfma_f32_16x16x32_bf16 v[96:99], a[144:147], a[84:87], v[96:99]
    ds_read_b128 a[184:187], v10 offset:10240
    v_mfma_f32_16x16x32_bf16 v[100:103], a[148:151], a[80:83], v[100:103]
    ds_read_b128 a[188:191], v10 offset:11264
    v_mfma_f32_16x16x32_bf16 v[104:107], a[148:151], a[84:87], v[104:107]
    ds_read_b128 a[192:195], v10 offset:12288
    v_mfma_f32_16x16x32_bf16 v[108:111], a[152:155], a[80:83], v[108:111]
    ds_read_b128 a[196:199], v10 offset:13312
    v_mfma_f32_16x16x32_bf16 v[112:115], a[152:155], a[84:87], v[112:115]
    ds_read_b128 a[200:203], v10 offset:14336
    v_mfma_f32_16x16x32_bf16 v[116:119], a[156:159], a[80:83], v[116:119]
    ds_read_b128 a[204:207], v10 offset:15360
    v_mfma_f32_16x16x32_bf16 v[120:123], a[156:159], a[84:87], v[120:123]
    ds_read_b128 a[208:211], v10 offset:16384
    v_mfma_f32_16x16x32_bf16 v[124:127], a[160:163], a[80:83], v[124:127]
    ds_read_b128 a[212:215], v10 offset:17408
    v_mfma_f32_16x16x32_bf16 v[128:131], a[160:163], a[84:87], v[128:131]
    v_mfma_f32_16x16x32_bf16 v[132:135], a[164:167], a[80:83], v[132:135]
    v_mfma_f32_16x16x32_bf16 v[136:139], a[164:167], a[84:87], v[136:139]
    v_mfma_f32_16x16x32_bf16 v[140:143], a[168:171], a[80:83], v[140:143]
    v_mfma_f32_16x16x32_bf16 v[144:147], a[168:171], a[84:87], v[144:147]
    v_mfma_f32_16x16x32_bf16 v[148:151], a[172:175], a[80:83], v[148:151]
    v_mfma_f32_16x16x32_bf16 v[152:155], a[172:175], a[84:87], v[152:155]
    v_mfma_f32_16x16x32_bf16 v[156:159], a[176:179], a[80:83], v[156:159]
    v_mfma_f32_16x16x32_bf16 v[160:163], a[176:179], a[84:87], v[160:163]
    s_barrier
    s_waitcnt lgkmcnt(0)
    v_mfma_f32_16x16x32_bf16 v[92:95], a[180:183], a[88:91], v[92:95]
    ds_read_b128 a[144:147], v10 offset:18432
    v_mfma_f32_16x16x32_bf16 v[96:99], a[180:183], a[92:95], v[96:99]
    ds_read_b128 a[148:151], v10 offset:19456
    v_mfma_f32_16x16x32_bf16 v[100:103], a[184:187], a[88:91], v[100:103]
    ds_read_b128 a[152:155], v10 offset:20480
    v_mfma_f32_16x16x32_bf16 v[104:107], a[184:187], a[92:95], v[104:107]
    ds_read_b128 a[156:159], v10 offset:21504
    v_mfma_f32_16x16x32_bf16 v[108:111], a[188:191], a[88:91], v[108:111]
    ds_read_b128 a[160:163], v10 offset:22528
    v_mfma_f32_16x16x32_bf16 v[112:115], a[188:191], a[92:95], v[112:115]
    ds_read_b128 a[164:167], v10 offset:23552
    v_mfma_f32_16x16x32_bf16 v[116:119], a[192:195], a[88:91], v[116:119]
    ds_read_b128 a[168:171], v10 offset:24576
    v_mfma_f32_16x16x32_bf16 v[120:123], a[192:195], a[92:95], v[120:123]
    ds_read_b128 a[172:175], v10 offset:25600
    v_mfma_f32_16x16x32_bf16 v[124:127], a[196:199], a[88:91], v[124:127]
    ds_read_b128 a[176:179], v10 offset:26624
    v_mfma_f32_16x16x32_bf16 v[128:131], a[196:199], a[92:95], v[128:131]
    buffer_load_dwordx4 a[32:35], v4, s[32:35], s51 offen offset:0
    v_mfma_f32_16x16x32_bf16 v[132:135], a[200:203], a[88:91], v[132:135]
    v_mfma_f32_16x16x32_bf16 v[136:139], a[200:203], a[92:95], v[136:139]
    buffer_load_dwordx4 a[36:39], v4, s[32:35], s51 offen offset:1024
    v_mfma_f32_16x16x32_bf16 v[140:143], a[204:207], a[88:91], v[140:143]
    v_mfma_f32_16x16x32_bf16 v[144:147], a[204:207], a[92:95], v[144:147]
    buffer_load_dwordx4 a[40:43], v4, s[32:35], s51 offen offset:2048
    v_mfma_f32_16x16x32_bf16 v[148:151], a[208:211], a[88:91], v[148:151]
    v_mfma_f32_16x16x32_bf16 v[152:155], a[208:211], a[92:95], v[152:155]
    buffer_load_dwordx4 a[44:47], v4, s[32:35], s51 offen offset:3072
    s_add_u32 s51, s51, 4096
    v_mfma_f32_16x16x32_bf16 v[156:159], a[212:215], a[88:91], v[156:159]
    v_mfma_f32_16x16x32_bf16 v[160:163], a[212:215], a[92:95], v[160:163]
    s_waitcnt lgkmcnt(0)
    v_mfma_f32_16x16x32_bf16 v[92:95], a[144:147], a[96:99], v[92:95]
    ds_read_b128 a[180:183], v10 offset:27648
    v_mfma_f32_16x16x32_bf16 v[96:99], a[144:147], a[100:103], v[96:99]
    ds_read_b128 a[184:187], v10 offset:28672
    v_mfma_f32_16x16x32_bf16 v[100:103], a[148:151], a[96:99], v[100:103]
    ds_read_b128 a[188:191], v10 offset:29696
    v_mfma_f32_16x16x32_bf16 v[104:107], a[148:151], a[100:103], v[104:107]
    ds_read_b128 a[192:195], v10 offset:30720
    v_mfma_f32_16x16x32_bf16 v[108:111], a[152:155], a[96:99], v[108:111]
    ds_read_b128 a[196:199], v10 offset:31744
    v_mfma_f32_16x16x32_bf16 v[112:115], a[152:155], a[100:103], v[112:115]
    ds_read_b128 a[200:203], v10 offset:32768
    v_mfma_f32_16x16x32_bf16 v[116:119], a[156:159], a[96:99], v[116:119]
    ds_read_b128 a[204:207], v10 offset:33792
    v_mfma_f32_16x16x32_bf16 v[120:123], a[156:159], a[100:103], v[120:123]
    ds_read_b128 a[208:211], v10 offset:34816
    v_mfma_f32_16x16x32_bf16 v[124:127], a[160:163], a[96:99], v[124:127]
    ds_read_b128 a[212:215], v10 offset:35840
    v_mfma_f32_16x16x32_bf16 v[128:131], a[160:163], a[100:103], v[128:131]
    buffer_load_dwordx4 a[48:51], v4, s[32:35], s51 offen offset:0
    v_mfma_f32_16x16x32_bf16 v[132:135], a[164:167], a[96:99], v[132:135]
    v_mfma_f32_16x16x32_bf16 v[136:139], a[164:167], a[100:103], v[136:139]
    buffer_load_dwordx4 a[52:55], v4, s[32:35], s51 offen offset:1024
    v_mfma_f32_16x16x32_bf16 v[140:143], a[168:171], a[96:99], v[140:143]
    v_mfma_f32_16x16x32_bf16 v[144:147], a[168:171], a[100:103], v[144:147]
    buffer_load_dwordx4 a[56:59], v4, s[32:35], s51 offen offset:2048
    v_mfma_f32_16x16x32_bf16 v[148:151], a[172:175], a[96:99], v[148:151]
    v_mfma_f32_16x16x32_bf16 v[152:155], a[172:175], a[100:103], v[152:155]
    buffer_load_dwordx4 a[60:63], v4, s[32:35], s51 offen offset:3072
    s_bfe_u32 s51, 65535, s19
    s_cmp_eq_u32 s51, s41
    s_cselect_b32 s51, s59, s51
    s_mul_i32 s51, s51, 8192
    s_add_u32 s51, s51, s18
    v_mfma_f32_16x16x32_bf16 v[156:159], a[176:179], a[96:99], v[156:159]
    v_mfma_f32_16x16x32_bf16 v[160:163], a[176:179], a[100:103], v[160:163]
    s_barrier
    s_waitcnt lgkmcnt(0)
    v_mfma_f32_16x16x32_bf16 v[92:95], a[180:183], a[104:107], v[92:95]
    ds_read_b128 a[144:147], v8 offset:0
    v_mfma_f32_16x16x32_bf16 v[96:99], a[180:183], a[108:111], v[96:99]
    ds_read_b128 a[148:151], v8 offset:1024
    v_mfma_f32_16x16x32_bf16 v[100:103], a[184:187], a[104:107], v[100:103]
    ds_read_b128 a[152:155], v8 offset:2048
    v_mfma_f32_16x16x32_bf16 v[104:107], a[184:187], a[108:111], v[104:107]
    ds_read_b128 a[156:159], v8 offset:3072
    v_mfma_f32_16x16x32_bf16 v[108:111], a[188:191], a[104:107], v[108:111]
    ds_read_b128 a[160:163], v8 offset:4096
    v_mfma_f32_16x16x32_bf16 v[112:115], a[188:191], a[108:111], v[112:115]
    ds_read_b128 a[164:167], v8 offset:5120
    v_mfma_f32_16x16x32_bf16 v[116:119], a[192:195], a[104:107], v[116:119]
    ds_read_b128 a[168:171], v8 offset:6144
    v_mfma_f32_16x16x32_bf16 v[120:123], a[192:195], a[108:111], v[120:123]
    ds_read_b128 a[172:175], v8 offset:7168
    v_mfma_f32_16x16x32_bf16 v[124:127], a[196:199], a[104:107], v[124:127]
    ds_read_b128 a[176:179], v8 offset:8192
    v_mfma_f32_16x16x32_bf16 v[128:131], a[196:199], a[108:111], v[128:131]
    buffer_load_dwordx4 a[64:67], v4, s[32:35], s51 offen offset:0
    v_mfma_f32_16x16x32_bf16 v[132:135], a[200:203], a[104:107], v[132:135]
    ds_write_b128 v6, v[20:23] offset:0
    v_mfma_f32_16x16x32_bf16 v[136:139], a[200:203], a[108:111], v[136:139]
    buffer_load_dwordx4 a[68:71], v4, s[32:35], s51 offen offset:1024
    v_mfma_f32_16x16x32_bf16 v[140:143], a[204:207], a[104:107], v[140:143]
    ds_write_b128 v6, v[36:39] offset:2048
    v_mfma_f32_16x16x32_bf16 v[144:147], a[204:207], a[108:111], v[144:147]
    buffer_load_dwordx4 a[72:75], v4, s[32:35], s51 offen offset:2048
    v_mfma_f32_16x16x32_bf16 v[148:151], a[208:211], a[104:107], v[148:151]
    ds_write_b128 v6, v[52:55] offset:4096
    v_mfma_f32_16x16x32_bf16 v[152:155], a[208:211], a[108:111], v[152:155]
    buffer_load_dwordx4 a[76:79], v4, s[32:35], s51 offen offset:3072
    s_add_u32 s51, s51, 4096
    v_mfma_f32_16x16x32_bf16 v[156:159], a[212:215], a[104:107], v[156:159]
    ds_write_b128 v6, v[68:71] offset:6144
    v_mfma_f32_16x16x32_bf16 v[160:163], a[212:215], a[108:111], v[160:163]
    s_waitcnt lgkmcnt(0)
    v_mfma_f32_16x16x32_bf16 v[92:95], a[144:147], a[112:115], v[92:95]
    ds_read_b128 a[180:183], v8 offset:9216
    v_mfma_f32_16x16x32_bf16 v[96:99], a[144:147], a[116:119], v[96:99]
    ds_read_b128 a[184:187], v8 offset:10240
    v_mfma_f32_16x16x32_bf16 v[100:103], a[148:151], a[112:115], v[100:103]
    ds_read_b128 a[188:191], v8 offset:11264
    v_mfma_f32_16x16x32_bf16 v[104:107], a[148:151], a[116:119], v[104:107]
    ds_read_b128 a[192:195], v8 offset:12288
    v_mfma_f32_16x16x32_bf16 v[108:111], a[152:155], a[112:115], v[108:111]
    ds_read_b128 a[196:199], v8 offset:13312
    v_mfma_f32_16x16x32_bf16 v[112:115], a[152:155], a[116:119], v[112:115]
    ds_read_b128 a[200:203], v8 offset:14336
    v_mfma_f32_16x16x32_bf16 v[116:119], a[156:159], a[112:115], v[116:119]
    ds_read_b128 a[204:207], v8 offset:15360
    v_mfma_f32_16x16x32_bf16 v[120:123], a[156:159], a[116:119], v[120:123]
    ds_read_b128 a[208:211], v8 offset:16384
    v_mfma_f32_16x16x32_bf16 v[124:127], a[160:163], a[112:115], v[124:127]
    ds_read_b128 a[212:215], v8 offset:17408
    v_mfma_f32_16x16x32_bf16 v[128:131], a[160:163], a[116:119], v[128:131]
    buffer_load_dwordx4 a[80:83], v4, s[32:35], s51 offen offset:0
    v_mfma_f32_16x16x32_bf16 v[132:135], a[164:167], a[112:115], v[132:135]
    s_mov_b32 exec_hi, 0
    ds_write_b128 v6, v[84:87] offset:8192
    s_mov_b32 exec_hi, -1
    v_mfma_f32_16x16x32_bf16 v[136:139], a[164:167], a[116:119], v[136:139]
    buffer_load_dwordx4 a[84:87], v4, s[32:35], s51 offen offset:1024
    v_mfma_f32_16x16x32_bf16 v[140:143], a[168:171], a[112:115], v[140:143]
    ds_write_b128 v6, v[24:27] offset:512
    v_mfma_f32_16x16x32_bf16 v[144:147], a[168:171], a[116:119], v[144:147]
    buffer_load_dwordx4 a[88:91], v4, s[32:35], s51 offen offset:2048
    v_mfma_f32_16x16x32_bf16 v[148:151], a[172:175], a[112:115], v[148:151]
    ds_write_b128 v6, v[40:43] offset:2560
    v_mfma_f32_16x16x32_bf16 v[152:155], a[172:175], a[116:119], v[152:155]
    buffer_load_dwordx4 a[92:95], v4, s[32:35], s51 offen offset:3072
    s_bfe_u32 s51, 0, s19
    s_cmp_eq_u32 s51, s41
    s_cselect_b32 s51, s59, s51
    s_mul_i32 s51, s51, 8192
    s_add_u32 s51, s51, s18
    v_mfma_f32_16x16x32_bf16 v[156:159], a[176:179], a[112:115], v[156:159]
    ds_write_b128 v6, v[56:59] offset:4608
    v_mfma_f32_16x16x32_bf16 v[160:163], a[176:179], a[116:119], v[160:163]
    s_waitcnt vmcnt(16)
    s_barrier
    s_waitcnt lgkmcnt(0)
    v_mfma_f32_16x16x32_bf16 v[92:95], a[180:183], a[120:123], v[92:95]
    ds_read_b128 a[144:147], v8 offset:18432
    v_mfma_f32_16x16x32_bf16 v[96:99], a[180:183], a[124:127], v[96:99]
    ds_read_b128 a[148:151], v8 offset:19456
    v_mfma_f32_16x16x32_bf16 v[100:103], a[184:187], a[120:123], v[100:103]
    ds_read_b128 a[152:155], v8 offset:20480
    v_mfma_f32_16x16x32_bf16 v[104:107], a[184:187], a[124:127], v[104:107]
    ds_read_b128 a[156:159], v8 offset:21504
    v_mfma_f32_16x16x32_bf16 v[108:111], a[188:191], a[120:123], v[108:111]
    ds_read_b128 a[160:163], v8 offset:22528
    v_mfma_f32_16x16x32_bf16 v[112:115], a[188:191], a[124:127], v[112:115]
    ds_read_b128 a[164:167], v8 offset:23552
    v_mfma_f32_16x16x32_bf16 v[116:119], a[192:195], a[120:123], v[116:119]
    ds_read_b128 a[168:171], v8 offset:24576
    v_mfma_f32_16x16x32_bf16 v[120:123], a[192:195], a[124:127], v[120:123]
    ds_read_b128 a[172:175], v8 offset:25600
    v_mfma_f32_16x16x32_bf16 v[124:127], a[196:199], a[120:123], v[124:127]
    ds_read_b128 a[176:179], v8 offset:26624
    v_mfma_f32_16x16x32_bf16 v[128:131], a[196:199], a[124:127], v[128:131]
    buffer_load_dwordx4 a[96:99], v4, s[32:35], s51 offen offset:0
    v_mfma_f32_16x16x32_bf16 v[132:135], a[200:203], a[120:123], v[132:135]
    ds_write_b128 v6, v[72:75] offset:6656
    v_mfma_f32_16x16x32_bf16 v[136:139], a[200:203], a[124:127], v[136:139]
    buffer_load_dwordx4 a[100:103], v4, s[32:35], s51 offen offset:1024
    v_mfma_f32_16x16x32_bf16 v[140:143], a[204:207], a[120:123], v[140:143]
    s_mov_b32 exec_hi, 0
    ds_write_b128 v6, v[88:91] offset:8704
    s_mov_b32 exec_hi, -1
    v_mfma_f32_16x16x32_bf16 v[144:147], a[204:207], a[124:127], v[144:147]
    buffer_load_dwordx4 a[104:107], v4, s[32:35], s51 offen offset:2048
    v_mfma_f32_16x16x32_bf16 v[148:151], a[208:211], a[120:123], v[148:151]
    v_mfma_f32_16x16x32_bf16 v[152:155], a[208:211], a[124:127], v[152:155]
    buffer_load_dwordx4 a[108:111], v4, s[32:35], s51 offen offset:3072
    s_add_u32 s51, s51, 4096
    v_mfma_f32_16x16x32_bf16 v[156:159], a[212:215], a[120:123], v[156:159]
    v_mfma_f32_16x16x32_bf16 v[160:163], a[212:215], a[124:127], v[160:163]
    s_waitcnt lgkmcnt(0)
    v_mfma_f32_16x16x32_bf16 v[92:95], a[144:147], a[128:131], v[92:95]
    ds_read_b128 a[180:183], v8 offset:27648
    v_lshlrev_b32 v240, 16, v248
    v_mfma_f32_16x16x32_bf16 v[96:99], a[144:147], a[132:135], v[96:99]
    ds_read_b128 a[184:187], v8 offset:28672
    v_lshlrev_b32 v241, 16, v248
    v_mfma_f32_16x16x32_bf16 v[100:103], a[148:151], a[128:131], v[100:103]
    ds_read_b128 a[188:191], v8 offset:29696
    v_lshlrev_b32 v242, 16, v248
    v_mfma_f32_16x16x32_bf16 v[104:107], a[148:151], a[132:135], v[104:107]
    ds_read_b128 a[192:195], v8 offset:30720
    v_lshlrev_b32 v243, 16, v248
    v_mfma_f32_16x16x32_bf16 v[108:111], a[152:155], a[128:131], v[108:111]
    ds_read_b128 a[196:199], v8 offset:31744
    v_lshlrev_b32 v244, 16, v249
    v_mfma_f32_16x16x32_bf16 v[112:115], a[152:155], a[132:135], v[112:115]
    ds_read_b128 a[200:203], v8 offset:32768
    v_lshlrev_b32 v245, 16, v249
    v_mfma_f32_16x16x32_bf16 v[116:119], a[156:159], a[128:131], v[116:119]
    ds_read_b128 a[204:207], v8 offset:33792
    v_lshlrev_b32 v246, 16, v249
    v_mfma_f32_16x16x32_bf16 v[120:123], a[156:159], a[132:135], v[120:123]
    ds_read_b128 a[208:211], v8 offset:34816
    v_lshlrev_b32 v247, 16, v249
    v_mfma_f32_16x16x32_bf16 v[124:127], a[160:163], a[128:131], v[124:127]
    ds_read_b128 a[212:215], v8 offset:35840
    v_mfma_f32_16x16x32_bf16 v[128:131], a[160:163], a[132:135], v[128:131]
    buffer_load_dwordx4 a[112:115], v4, s[32:35], s51 offen offset:0
    v_mfma_f32_16x16x32_bf16 v[132:135], a[164:167], a[128:131], v[132:135]
    v_mfma_f32_16x16x32_bf16 v[136:139], a[164:167], a[132:135], v[136:139]
    buffer_load_dwordx4 a[116:119], v4, s[32:35], s51 offen offset:1024
    v_mfma_f32_16x16x32_bf16 v[140:143], a[168:171], a[128:131], v[140:143]
    v_mfma_f32_16x16x32_bf16 v[144:147], a[168:171], a[132:135], v[144:147]
    buffer_load_dwordx4 a[120:123], v4, s[32:35], s51 offen offset:2048
    v_mfma_f32_16x16x32_bf16 v[148:151], a[172:175], a[128:131], v[148:151]
    v_mfma_f32_16x16x32_bf16 v[152:155], a[172:175], a[132:135], v[152:155]
    buffer_load_dwordx4 a[124:127], v4, s[32:35], s51 offen offset:3072
    s_bfe_u32 s51, 4625, s19
    s_cmp_eq_u32 s51, s41
    s_cselect_b32 s51, s59, s51
    s_mul_i32 s51, s51, 8192
    s_add_u32 s51, s51, s18
    v_mfma_f32_16x16x32_bf16 v[156:159], a[176:179], a[128:131], v[156:159]
    v_mfma_f32_16x16x32_bf16 v[160:163], a[176:179], a[132:135], v[160:163]
    s_barrier
    s_waitcnt lgkmcnt(0)
    v_mfma_f32_16x16x32_bf16 v[92:95], a[180:183], a[136:139], v[92:95]
    ds_read_b128 a[144:147], v8 offset:36864
    v_mfma_f32_16x16x32_bf16 v[96:99], a[180:183], a[140:143], v[96:99]
    ds_read_b128 a[148:151], v8 offset:37888
    v_mfma_f32_16x16x32_bf16 v[100:103], a[184:187], a[136:139], v[100:103]
    ds_read_b128 a[152:155], v8 offset:38912
    v_mfma_f32_16x16x32_bf16 v[104:107], a[184:187], a[140:143], v[104:107]
    ds_read_b128 a[156:159], v8 offset:39936
    v_mfma_f32_16x16x32_bf16 v[108:111], a[188:191], a[136:139], v[108:111]
    ds_read_b128 a[160:163], v8 offset:40960
    v_mfma_f32_16x16x32_bf16 v[112:115], a[188:191], a[140:143], v[112:115]
    ds_read_b128 a[164:167], v8 offset:41984
    v_mfma_f32_16x16x32_bf16 v[116:119], a[192:195], a[136:139], v[116:119]
    ds_read_b128 a[168:171], v8 offset:43008
    v_mfma_f32_16x16x32_bf16 v[120:123], a[192:195], a[140:143], v[120:123]
    ds_read_b128 a[172:175], v8 offset:44032
    v_mfma_f32_16x16x32_bf16 v[124:127], a[196:199], a[136:139], v[124:127]
    ds_read_b128 a[176:179], v8 offset:45056
    v_mfma_f32_16x16x32_bf16 v[128:131], a[196:199], a[140:143], v[128:131]
    buffer_load_dwordx4 a[128:131], v4, s[32:35], s51 offen offset:0
    v_mfma_f32_16x16x32_bf16 v[132:135], a[200:203], a[136:139], v[132:135]
    v_mfma_f32_16x16x32_bf16 v[136:139], a[200:203], a[140:143], v[136:139]
    buffer_load_dwordx4 a[132:135], v4, s[32:35], s51 offen offset:1024
    v_mfma_f32_16x16x32_bf16 v[140:143], a[204:207], a[136:139], v[140:143]
    v_mfma_f32_16x16x32_bf16 v[144:147], a[204:207], a[140:143], v[144:147]
    v_mfma_f32_16x16x32_bf16 v[148:151], a[208:211], a[136:139], v[148:151]
    v_mfma_f32_16x16x32_bf16 v[152:155], a[208:211], a[140:143], v[152:155]
    v_mfma_f32_16x16x32_bf16 v[156:159], a[212:215], a[136:139], v[156:159]
    v_mfma_f32_16x16x32_bf16 v[160:163], a[212:215], a[140:143], v[160:163]
    s_add_u32 m0, s48, 73728
    s_add_u32 s14, s49, s13
    buffer_load_dwordx4 v4, s[32:35], s49 offen offset:0 lds
    buffer_load_dwordx4 v4, s[32:35], s49 offen offset:1024 lds
    buffer_load_dwordx4 v4, s[32:35], s49 offen offset:2048 lds
    buffer_load_dwordx4 v4, s[32:35], s49 offen offset:3072 lds
    s_add_u32 m0, s12, 73728
    s_add_u32 s49, s49, 20480
    buffer_load_dwordx4 v4, s[32:35], s14 offen offset:0 lds
    v_bfe_u32 v14, v1, 3, 2
    s_add_u32 s44, s48, 73728
    v_lshl_add_u32 v14, v14, 2, v4
    s_add_u32 s45, s12, 73728
    v_add_u32 v11, s44, v14
    v_add_u32 v12, s45, v14
    s_waitcnt lgkmcnt(0)
    v_mfma_f32_16x16x32_bf16 v[20:23], a[144:147], a[216:219], v[240:243]
    ds_read_b128 a[180:183], v8 offset:46080
    v_mfma_f32_16x16x32_bf16 v[24:27], a[144:147], a[220:223], v[244:247]
    ds_read_b128 a[184:187], v8 offset:47104
    s_add_u32 m0, s48, 94208
    s_nop 0
    buffer_load_dwordx4 v4, s[32:35], s49 offen offset:0 lds
    v_mfma_f32_16x16x32_bf16 v[28:31], a[148:151], a[216:219], v[240:243]
    ds_read_b128 a[188:191], v8 offset:48128
    v_mfma_f32_16x16x32_bf16 v[32:35], a[148:151], a[220:223], v[244:247]
    ds_read_b128 a[192:195], v8 offset:49152
    buffer_load_dwordx4 v4, s[32:35], s49 offen offset:1024 lds
    v_mfma_f32_16x16x32_bf16 v[36:39], a[152:155], a[216:219], v[240:243]
    ds_read_b128 a[196:199], v8 offset:50176
    v_mfma_f32_16x16x32_bf16 v[40:43], a[152:155], a[220:223], v[244:247]
    ds_read_b128 a[200:203], v8 offset:51200
    buffer_load_dwordx4 v4, s[32:35], s49 offen offset:2048 lds
    v_mfma_f32_16x16x32_bf16 v[44:47], a[156:159], a[216:219], v[240:243]
    ds_read_b128 a[204:207], v8 offset:52224
    v_mfma_f32_16x16x32_bf16 v[48:51], a[156:159], a[220:223], v[244:247]
    ds_read_b128 a[208:211], v8 offset:53248
    buffer_load_dwordx4 v4, s[32:35], s49 offen offset:3072 lds
    s_branch L_pgpost_kernel_5_s
.p2align 12
L_pgpost_kernel_5:
    s_branch L_hoppost_kernel_2
L_pgpost_kernel_5_s:
    s_bfe_u32 s49, 61166, s19
    s_cmp_eq_u32 s49, s41
    s_cselect_b32 s49, s59, s49
    s_mul_i32 s49, s49, 589824
    s_add_u32 s49, s49, s15
    v_mfma_f32_16x16x32_bf16 v[52:55], a[160:163], a[216:219], v[240:243]
    ds_read_b128 a[212:215], v8 offset:54272
    v_mfma_f32_16x16x32_bf16 v[56:59], a[160:163], a[220:223], v[244:247]
    s_add_u32 m0, s48, 110592
    s_add_u32 s14, s49, s13
    buffer_load_dwordx4 v4, s[32:35], s49 offen offset:0 lds
    v_mfma_f32_16x16x32_bf16 v[60:63], a[164:167], a[216:219], v[240:243]
    v_mfma_f32_16x16x32_bf16 v[64:67], a[164:167], a[220:223], v[244:247]
    buffer_load_dwordx4 v4, s[32:35], s49 offen offset:1024 lds
    v_mfma_f32_16x16x32_bf16 v[68:71], a[168:171], a[216:219], v[240:243]
    v_mfma_f32_16x16x32_bf16 v[72:75], a[168:171], a[220:223], v[244:247]
    buffer_load_dwordx4 v4, s[32:35], s49 offen offset:2048 lds
    v_mfma_f32_16x16x32_bf16 v[76:79], a[172:175], a[216:219], v[240:243]
    v_mfma_f32_16x16x32_bf16 v[80:83], a[172:175], a[220:223], v[244:247]
    buffer_load_dwordx4 v4, s[32:35], s49 offen offset:3072 lds
    s_add_u32 m0, s12, 110592
    s_add_u32 s49, s49, 20480
    v_mfma_f32_16x16x32_bf16 v[84:87], a[176:179], a[216:219], v[240:243]
    buffer_load_dwordx4 v4, s[32:35], s14 offen offset:0 lds
    v_mfma_f32_16x16x32_bf16 v[88:91], a[176:179], a[220:223], v[244:247]
    s_barrier
    s_mov_b64 exec, 1
    buffer_store_dword v1, off, s[32:35], s52 sc1
    s_mov_b64 exec, -1
    s_waitcnt lgkmcnt(0)
    v_mfma_f32_16x16x32_bf16 v[20:23], a[180:183], a[224:227], v[20:23]
    ds_read_b128 a[144:147], v9 offset:0
    v_mfma_f32_16x16x32_bf16 v[24:27], a[180:183], a[228:231], v[24:27]
    ds_read_b128 a[148:151], v9 offset:1024
    v_mfma_f32_16x16x32_bf16 v[28:31], a[184:187], a[224:227], v[28:31]
    ds_read_b128 a[152:155], v9 offset:2048
    v_mfma_f32_16x16x32_bf16 v[32:35], a[184:187], a[228:231], v[32:35]
    ds_read_b128 a[156:159], v9 offset:3072
    v_mfma_f32_16x16x32_bf16 v[36:39], a[188:191], a[224:227], v[36:39]
    ds_read_b128 a[160:163], v9 offset:4096
    v_mfma_f32_16x16x32_bf16 v[40:43], a[188:191], a[228:231], v[40:43]
    ds_read_b128 a[164:167], v9 offset:5120
    v_mfma_f32_16x16x32_bf16 v[44:47], a[192:195], a[224:227], v[44:47]
    ds_read_b128 a[168:171], v9 offset:6144
    v_mfma_f32_16x16x32_bf16 v[48:51], a[192:195], a[228:231], v[48:51]
    ds_read_b128 a[172:175], v9 offset:7168
    v_mfma_f32_16x16x32_bf16 v[52:55], a[196:199], a[224:227], v[52:55]
    ds_read_b128 a[176:179], v9 offset:8192
    v_mfma_f32_16x16x32_bf16 v[56:59], a[196:199], a[228:231], v[56:59]
    buffer_load_dwordx4 a[136:139], v4, s[32:35], s51 offen offset:2048
    v_mfma_f32_16x16x32_bf16 v[60:63], a[200:203], a[224:227], v[60:63]
    v_mfma_f32_16x16x32_bf16 v[64:67], a[200:203], a[228:231], v[64:67]
    buffer_load_dwordx4 a[140:143], v4, s[32:35], s51 offen offset:3072
    s_add_u32 s51, s51, 4096
    v_mfma_f32_16x16x32_bf16 v[68:71], a[204:207], a[224:227], v[68:71]
    v_mfma_f32_16x16x32_bf16 v[72:75], a[204:207], a[228:231], v[72:75]
    v_mfma_f32_16x16x32_bf16 v[76:79], a[208:211], a[224:227], v[76:79]
    v_mfma_f32_16x16x32_bf16 v[80:83], a[208:211], a[228:231], v[80:83]
    v_mfma_f32_16x16x32_bf16 v[84:87], a[212:215], a[224:227], v[84:87]
    v_mfma_f32_16x16x32_bf16 v[88:91], a[212:215], a[228:231], v[88:91]
    s_waitcnt lgkmcnt(0)
    v_mfma_f32_16x16x32_bf16 v[20:23], a[144:147], a[232:235], v[20:23]
    ds_read_b128 a[180:183], v9 offset:9216
    v_mul_f32 v232, v92, v92
    v_mfma_f32_16x16x32_bf16 v[24:27], a[144:147], a[236:239], v[24:27]
    ds_read_b128 a[184:187], v9 offset:10240
    v_fma_f32 v232, v232, v218, v216
    v_mfma_f32_16x16x32_bf16 v[28:31], a[148:151], a[232:235], v[28:31]
    ds_read_b128 a[188:191], v9 offset:11264
    v_mul_f32 v232, v232, v92
    v_mfma_f32_16x16x32_bf16 v[32:35], a[148:151], a[236:239], v[32:35]
    ds_read_b128 a[192:195], v9 offset:12288
    v_mul_f32 v233, v93, v93
    v_mfma_f32_16x16x32_bf16 v[36:39], a[152:155], a[232:235], v[36:39]
    ds_read_b128 a[196:199], v9 offset:13312
    v_fma_f32 v233, v233, v218, v216
    v_mfma_f32_16x16x32_bf16 v[40:43], a[152:155], a[236:239], v[40:43]
    ds_read_b128 a[200:203], v9 offset:14336
    v_mul_f32 v233, v233, v93
    v_mfma_f32_16x16x32_bf16 v[44:47], a[156:159], a[232:235], v[44:47]
    ds_read_b128 a[204:207], v9 offset:15360
    v_mul_f32 v234, v94, v94
    v_mfma_f32_16x16x32_bf16 v[48:51], a[156:159], a[236:239], v[48:51]
    ds_read_b128 a[208:211], v9 offset:16384
    v_fma_f32 v234, v234, v218, v216
    v_mfma_f32_16x16x32_bf16 v[52:55], a[160:163], a[232:235], v[52:55]
    ds_read_b128 a[212:215], v9 offset:17408
    v_mul_f32 v234, v234, v94
    v_mfma_f32_16x16x32_bf16 v[56:59], a[160:163], a[236:239], v[56:59]
    s_add_u32 m0, s48, 131072
    s_nop 0
    buffer_load_dwordx4 v4, s[32:35], s49 offen offset:0 lds
    v_mfma_f32_16x16x32_bf16 v[60:63], a[164:167], a[232:235], v[60:63]
    s_waitcnt vmcnt(13)
    ds_read2st64_b32 v[14:15], v11 offset0:0 offset1:4
    ds_read2st64_b32 v[16:17], v11 offset0:8 offset1:12
    v_mfma_f32_16x16x32_bf16 v[64:67], a[164:167], a[236:239], v[64:67]
    buffer_load_dwordx4 v4, s[32:35], s49 offen offset:1024 lds
    v_mfma_f32_16x16x32_bf16 v[68:71], a[168:171], a[232:235], v[68:71]
    ds_read_b32 v18, v12 offset:0
    v_mfma_f32_16x16x32_bf16 v[72:75], a[168:171], a[236:239], v[72:75]
    buffer_load_dwordx4 v4, s[32:35], s49 offen offset:2048 lds
    v_mfma_f32_16x16x32_bf16 v[76:79], a[172:175], a[232:235], v[76:79]
    v_exp_f32 v232, v232
    v_mfma_f32_16x16x32_bf16 v[80:83], a[172:175], a[236:239], v[80:83]
    buffer_load_dwordx4 v4, s[32:35], s49 offen offset:3072 lds
    s_bfe_u32 s49, 65535, s19
    s_cmp_eq_u32 s49, s41
    s_cselect_b32 s49, s59, s49
    s_mul_i32 s49, s49, 589824
    s_add_u32 s49, s49, s15
    v_mfma_f32_16x16x32_bf16 v[84:87], a[176:179], a[232:235], v[84:87]
    s_waitcnt lgkmcnt(0)
    v_max3_u32 v14, v14, v15, v16
    v_max3_u32 v14, v14, v17, v18
    v_cmp_eq_u32 vcc, -1, v14
    v_mfma_f32_16x16x32_bf16 v[88:91], a[176:179], a[236:239], v[88:91]
    s_cbranch_vccnz L_zf2
L_zb2:
    s_barrier
    s_waitcnt lgkmcnt(0)
    v_mfma_f32_16x16x32_bf16 v[20:23], a[180:183], a[240:243], v[20:23]
    ds_read_b128 a[144:147], v9 offset:18432
    v_fma_f32 v232, v232, v220, v220
    v_mfma_f32_16x16x32_bf16 v[24:27], a[180:183], a[244:247], v[24:27]
    ds_read_b128 a[148:151], v9 offset:19456
    v_mul_f32 v235, v95, v95
    v_mfma_f32_16x16x32_bf16 v[28:31], a[184:187], a[240:243], v[28:31]
    ds_read_b128 a[152:155], v9 offset:20480
    v_fma_f32 v235, v235, v218, v216
    v_mfma_f32_16x16x32_bf16 v[32:35], a[184:187], a[244:247], v[32:35]
    ds_read_b128 a[156:159], v9 offset:21504
    v_mul_f32 v235, v235, v95
    v_mfma_f32_16x16x32_bf16 v[36:39], a[188:191], a[240:243], v[36:39]
    ds_read_b128 a[160:163], v9 offset:22528
    v_mul_f32 v236, v96, v96
    v_mfma_f32_16x16x32_bf16 v[40:43], a[188:191], a[244:247], v[40:43]
    ds_read_b128 a[164:167], v9 offset:23552
    v_fma_f32 v236, v236, v219, v217
    v_mfma_f32_16x16x32_bf16 v[44:47], a[192:195], a[240:243], v[44:47]
    ds_read_b128 a[168:171], v9 offset:24576
    v_mul_f32 v236, v236, v96
    v_mfma_f32_16x16x32_bf16 v[48:51], a[192:195], a[244:247], v[48:51]
    ds_read_b128 a[172:175], v9 offset:25600
    v_mul_f32 v237, v97, v97
    v_mfma_f32_16x16x32_bf16 v[52:55], a[196:199], a[240:243], v[52:55]
    ds_read_b128 a[176:179], v9 offset:26624
    v_fma_f32 v237, v237, v219, v217
    v_mfma_f32_16x16x32_bf16 v[56:59], a[196:199], a[244:247], v[56:59]
    buffer_load_dwordx4 a[248:251], v4, s[32:35], s38 offen offset:0
    v_mfma_f32_16x16x32_bf16 v[60:63], a[200:203], a[240:243], v[60:63]
    v_rcp_f32 v232, v232
    v_mfma_f32_16x16x32_bf16 v[64:67], a[200:203], a[244:247], v[64:67]
    buffer_load_dwordx4 a[252:255], v4, s[32:35], s38 offen offset:1024
    v_mfma_f32_16x16x32_bf16 v[68:71], a[204:207], a[240:243], v[68:71]
    v_exp_f32 v233, v233
    v_mfma_f32_16x16x32_bf16 v[72:75], a[204:207], a[244:247], v[72:75]
    buffer_load_dwordx4 v[224:227], v4, s[32:35], s38 offen offset:2048
    v_mfma_f32_16x16x32_bf16 v[76:79], a[208:211], a[240:243], v[76:79]
    v_exp_f32 v234, v234
    v_mfma_f32_16x16x32_bf16 v[80:83], a[208:211], a[244:247], v[80:83]
    buffer_load_dwordx4 v[228:231], v4, s[32:35], s38 offen offset:3072
    s_add_u32 s38, s38, 4096
    v_mfma_f32_16x16x32_bf16 v[84:87], a[212:215], a[240:243], v[84:87]
    v_mfma_f32_16x16x32_bf16 v[88:91], a[212:215], a[244:247], v[88:91]
    s_waitcnt lgkmcnt(0)
    v_mfma_f32_16x16x32_bf16 v[20:23], a[144:147], a[0:3], v[20:23]
    ds_read_b128 a[180:183], v9 offset:27648
    v_mul_f32 v92, v92, v232
    v_mfma_f32_16x16x32_bf16 v[24:27], a[144:147], a[4:7], v[24:27]
    ds_read_b128 a[184:187], v9 offset:28672
    v_fma_f32 v233, v233, v220, v220
    v_mfma_f32_16x16x32_bf16 v[28:31], a[148:151], a[0:3], v[28:31]
    ds_read_b128 a[188:191], v9 offset:29696
    v_fma_f32 v234, v234, v220, v220
    v_mfma_f32_16x16x32_bf16 v[32:35], a[148:151], a[4:7], v[32:35]
    ds_read_b128 a[192:195], v9 offset:30720
    v_mul_f32 v237, v237, v97
    v_mfma_f32_16x16x32_bf16 v[36:39], a[152:155], a[0:3], v[36:39]
    ds_read_b128 a[196:199], v9 offset:31744
    v_mul_f32 v238, v98, v98
    v_mfma_f32_16x16x32_bf16 v[40:43], a[152:155], a[4:7], v[40:43]
    ds_read_b128 a[200:203], v9 offset:32768
    v_fma_f32 v238, v238, v219, v217
    v_mfma_f32_16x16x32_bf16 v[44:47], a[156:159], a[0:3], v[44:47]
    ds_read_b128 a[204:207], v9 offset:33792
    v_mul_f32 v238, v238, v98
    v_mfma_f32_16x16x32_bf16 v[48:51], a[156:159], a[4:7], v[48:51]
    ds_read_b128 a[208:211], v9 offset:34816
    v_mul_f32 v239, v99, v99
    v_mfma_f32_16x16x32_bf16 v[52:55], a[160:163], a[0:3], v[52:55]
    ds_read_b128 a[212:215], v9 offset:35840
    v_fma_f32 v239, v239, v219, v217
    v_mfma_f32_16x16x32_bf16 v[56:59], a[160:163], a[4:7], v[56:59]
    s_add_u32 m0, s48, 0
    s_add_u32 s14, s49, s13
    buffer_load_dwordx4 v4, s[32:35], s49 offen offset:0 lds
    v_mfma_f32_16x16x32_bf16 v[60:63], a[164:167], a[0:3], v[60:63]
    s_waitcnt vmcnt(17)
    ds_read2st64_b32 v[14:15], v11 offset0:80 offset1:84
    ds_read2st64_b32 v[16:17], v11 offset0:88 offset1:92
    v_mfma_f32_16x16x32_bf16 v[64:67], a[164:167], a[4:7], v[64:67]
    buffer_load_dwordx4 v4, s[32:35], s49 offen offset:1024 lds
    v_mfma_f32_16x16x32_bf16 v[68:71], a[168:171], a[0:3], v[68:71]
    v_rcp_f32 v233, v233
    v_mfma_f32_16x16x32_bf16 v[72:75], a[168:171], a[4:7], v[72:75]
    buffer_load_dwordx4 v4, s[32:35], s49 offen offset:2048 lds
    v_mfma_f32_16x16x32_bf16 v[76:79], a[172:175], a[0:3], v[76:79]
    v_rcp_f32 v234, v234
    v_mfma_f32_16x16x32_bf16 v[80:83], a[172:175], a[4:7], v[80:83]
    buffer_load_dwordx4 v4, s[32:35], s49 offen offset:3072 lds
    s_add_u32 m0, s12, 0
    s_add_u32 s49, s49, 20480
    v_mfma_f32_16x16x32_bf16 v[84:87], a[176:179], a[0:3], v[84:87]
    s_waitcnt lgkmcnt(0)
    v_max3_u32 v14, v14, v15, v16
    v_max_u32 v14, v14, v17
    v_cmp_eq_u32 vcc, -1, v14
    v_mfma_f32_16x16x32_bf16 v[88:91], a[176:179], a[4:7], v[88:91]
    buffer_load_dwordx4 v4, s[32:35], s14 offen offset:0 lds
    s_cbranch_vccnz L_zf3
L_zb3:
    s_barrier
    s_waitcnt lgkmcnt(0)
    v_mfma_f32_16x16x32_bf16 v[20:23], a[180:183], a[8:11], v[20:23]
    ds_read_b128 a[144:147], v9 offset:36864
    v_mul_f32 v93, v93, v233
    v_mfma_f32_16x16x32_bf16 v[24:27], a[180:183], a[12:15], v[24:27]
    ds_read_b128 a[148:151], v9 offset:37888
    buffer_load_dwordx4 a[216:219], v4, s[32:35], s51 offen offset:0
    v_mul_f32 v94, v94, v234
    v_mfma_f32_16x16x32_bf16 v[28:31], a[184:187], a[8:11], v[28:31]
    ds_read_b128 a[152:155], v9 offset:38912
    v_mul_f32 v239, v239, v99
    v_mfma_f32_16x16x32_bf16 v[32:35], a[184:187], a[12:15], v[32:35]
    ds_read_b128 a[156:159], v9 offset:39936
    buffer_load_dwordx4 a[220:223], v4, s[32:35], s51 offen offset:1024
    v_mul_f32 v232, v100, v100
    v_mfma_f32_16x16x32_bf16 v[36:39], a[188:191], a[8:11], v[36:39]
    ds_read_b128 a[160:163], v9 offset:40960
    v_fma_f32 v232, v232, v218, v216
    v_mfma_f32_16x16x32_bf16 v[40:43], a[188:191], a[12:15], v[40:43]
    ds_read_b128 a[164:167], v9 offset:41984
    buffer_load_dwordx4 a[224:227], v4, s[32:35], s51 offen offset:2048
    v_mul_f32 v232, v232, v100
    v_mfma_f32_16x16x32_bf16 v[44:47], a[192:195], a[8:11], v[44:47]
    ds_read_b128 a[168:171], v9 offset:43008
    v_mul_f32 v233, v101, v101
    v_mfma_f32_16x16x32_bf16 v[48:51], a[192:195], a[12:15], v[48:51]
    ds_read_b128 a[172:175], v9 offset:44032
    buffer_load_dwordx4 a[228:231], v4, s[32:35], s51 offen offset:3072
    s_bfe_u32 s51, 12578, s19
    s_cmp_eq_u32 s51, s41
    s_cselect_b32 s51, s59, s51
    s_mul_i32 s51, s51, 8192
    s_add_u32 s51, s51, s18
    v_fma_f32 v233, v233, v218, v216
    v_mfma_f32_16x16x32_bf16 v[52:55], a[196:199], a[8:11], v[52:55]
    ds_read_b128 a[176:179], v9 offset:45056
    v_mul_f32 v233, v233, v101
    v_mfma_f32_16x16x32_bf16 v[56:59], a[196:199], a[12:15], v[56:59]
    buffer_load_dword v223, v222, s[32:35], s53 offen sc1
    v_mfma_f32_16x16x32_bf16 v[60:63], a[200:203], a[8:11], v[60:63]
    v_exp_f32 v235, v235
    v_mfma_f32_16x16x32_bf16 v[64:67], a[200:203], a[12:15], v[64:67]
    v_mfma_f32_16x16x32_bf16 v[68:71], a[204:207], a[8:11], v[68:71]
    v_exp_f32 v236, v236
    v_mfma_f32_16x16x32_bf16 v[72:75], a[204:207], a[12:15], v[72:75]
    v_mfma_f32_16x16x32_bf16 v[76:79], a[208:211], a[8:11], v[76:79]
    v_exp_f32 v237, v237
    v_mfma_f32_16x16x32_bf16 v[80:83], a[208:211], a[12:15], v[80:83]
    v_mfma_f32_16x16x32_bf16 v[84:87], a[212:215], a[8:11], v[84:87]
    v_mfma_f32_16x16x32_bf16 v[88:91], a[212:215], a[12:15], v[88:91]
    s_waitcnt lgkmcnt(0)
    v_mfma_f32_16x16x32_bf16 v[20:23], a[144:147], a[16:19], v[20:23]
    ds_read_b128 a[180:183], v9 offset:46080
    v_fma_f32 v235, v235, v220, v220
    v_mfma_f32_16x16x32_bf16 v[24:27], a[144:147], a[20:23], v[24:27]
    ds_read_b128 a[184:187], v9 offset:47104
    v_fma_f32 v236, v236, v221, v221
    v_mfma_f32_16x16x32_bf16 v[28:31], a[148:151], a[16:19], v[28:31]
    ds_read_b128 a[188:191], v9 offset:48128
    v_fma_f32 v237, v237, v221, v221
    v_mfma_f32_16x16x32_bf16 v[32:35], a[148:151], a[20:23], v[32:35]
    ds_read_b128 a[192:195], v9 offset:49152
    v_mul_f32 v234, v102, v102
    v_mfma_f32_16x16x32_bf16 v[36:39], a[152:155], a[16:19], v[36:39]
    ds_read_b128 a[196:199], v9 offset:50176
    v_fma_f32 v234, v234, v218, v216
    v_mfma_f32_16x16x32_bf16 v[40:43], a[152:155], a[20:23], v[40:43]
    ds_read_b128 a[200:203], v9 offset:51200
    v_mul_f32 v234, v234, v102
    v_mfma_f32_16x16x32_bf16 v[44:47], a[156:159], a[16:19], v[44:47]
    ds_read_b128 a[204:207], v9 offset:52224
    v_mfma_f32_16x16x32_bf16 v[48:51], a[156:159], a[20:23], v[48:51]
    ds_read_b128 a[208:211], v9 offset:53248
    v_mfma_f32_16x16x32_bf16 v[52:55], a[160:163], a[16:19], v[52:55]
    ds_read_b128 a[212:215], v9 offset:54272
    v_mfma_f32_16x16x32_bf16 v[56:59], a[160:163], a[20:23], v[56:59]
    s_add_u32 m0, s48, 20480
    s_nop 0
    buffer_load_dwordx4 v4, s[32:35], s49 offen offset:0 lds
    v_mfma_f32_16x16x32_bf16 v[60:63], a[164:167], a[16:19], v[60:63]
    s_waitcnt vmcnt(22)
    ds_read2st64_b32 v[14:15], v11 offset0:144 offset1:148
    ds_read2st64_b32 v[16:17], v11 offset0:152 offset1:156
    v_mfma_f32_16x16x32_bf16 v[64:67], a[164:167], a[20:23], v[64:67]
    buffer_load_dwordx4 v4, s[32:35], s49 offen offset:1024 lds
    v_mfma_f32_16x16x32_bf16 v[68:71], a[168:171], a[16:19], v[68:71]
    ds_read_b32 v18, v12 offset:36864
    v_mfma_f32_16x16x32_bf16 v[72:75], a[168:171], a[20:23], v[72:75]
    buffer_load_dwordx4 v4, s[32:35], s49 offen offset:2048 lds
    v_mfma_f32_16x16x32_bf16 v[76:79], a[172:175], a[16:19], v[76:79]
    v_rcp_f32 v235, v235
    v_mfma_f32_16x16x32_bf16 v[80:83], a[172:175], a[20:23], v[80:83]
    buffer_load_dwordx4 v4, s[32:35], s49 offen offset:3072 lds
    s_bfe_u32 s49, 0, s19
    s_cmp_eq_u32 s49, s41
    s_cselect_b32 s49, s59, s49
    s_mul_i32 s49, s49, 589824
    s_add_u32 s49, s49, s15
    v_mfma_f32_16x16x32_bf16 v[84:87], a[176:179], a[16:19], v[84:87]
    s_waitcnt lgkmcnt(0)
    v_max3_u32 v14, v14, v15, v16
    v_max3_u32 v14, v14, v17, v18
    v_cmp_eq_u32 vcc, -1, v14
    v_mfma_f32_16x16x32_bf16 v[88:91], a[176:179], a[20:23], v[88:91]
    s_cbranch_vccnz L_zf4
L_zb4:
    s_barrier
    s_waitcnt lgkmcnt(0)
    v_mfma_f32_16x16x32_bf16 v[20:23], a[180:183], a[24:27], v[20:23]
    ds_read_b128 a[144:147], v10 offset:0
    v_mul_f32 v95, v95, v235
    v_mfma_f32_16x16x32_bf16 v[24:27], a[180:183], a[28:31], v[24:27]
    ds_read_b128 a[148:151], v10 offset:1024
    v_mul_f32 v235, v103, v103
    v_mfma_f32_16x16x32_bf16 v[28:31], a[184:187], a[24:27], v[28:31]
    ds_read_b128 a[152:155], v10 offset:2048
    v_fma_f32 v235, v235, v218, v216
    v_mfma_f32_16x16x32_bf16 v[32:35], a[184:187], a[28:31], v[32:35]
    ds_read_b128 a[156:159], v10 offset:3072
    v_mul_f32 v235, v235, v103
    v_mfma_f32_16x16x32_bf16 v[36:39], a[188:191], a[24:27], v[36:39]
    ds_read_b128 a[160:163], v10 offset:4096
    v_mfma_f32_16x16x32_bf16 v[40:43], a[188:191], a[28:31], v[40:43]
    ds_read_b128 a[164:167], v10 offset:5120
    v_mfma_f32_16x16x32_bf16 v[44:47], a[192:195], a[24:27], v[44:47]
    ds_read_b128 a[168:171], v10 offset:6144
    v_mfma_f32_16x16x32_bf16 v[48:51], a[192:195], a[28:31], v[48:51]
    ds_read_b128 a[172:175], v10 offset:7168
    v_mfma_f32_16x16x32_bf16 v[52:55], a[196:199], a[24:27], v[52:55]
    ds_read_b128 a[176:179], v10 offset:8192
    v_mfma_f32_16x16x32_bf16 v[56:59], a[196:199], a[28:31], v[56:59]
    buffer_load_dwordx4 a[232:235], v4, s[32:35], s51 offen offset:0
    v_mfma_f32_16x16x32_bf16 v[60:63], a[200:203], a[24:27], v[60:63]
    v_rcp_f32 v236, v236
    v_mfma_f32_16x16x32_bf16 v[64:67], a[200:203], a[28:31], v[64:67]
    buffer_load_dwordx4 a[236:239], v4, s[32:35], s51 offen offset:1024
    v_mfma_f32_16x16x32_bf16 v[68:71], a[204:207], a[24:27], v[68:71]
    v_rcp_f32 v237, v237
    v_mfma_f32_16x16x32_bf16 v[72:75], a[204:207], a[28:31], v[72:75]
    buffer_load_dwordx4 a[240:243], v4, s[32:35], s51 offen offset:2048
    v_mfma_f32_16x16x32_bf16 v[76:79], a[208:211], a[24:27], v[76:79]
    v_exp_f32 v238, v238
    v_mfma_f32_16x16x32_bf16 v[80:83], a[208:211], a[28:31], v[80:83]
    buffer_load_dwordx4 a[244:247], v4, s[32:35], s51 offen offset:3072
    s_add_u32 s51, s51, 4096
    v_mfma_f32_16x16x32_bf16 v[84:87], a[212:215], a[24:27], v[84:87]
    v_exp_f32 v239, v239
    v_mfma_f32_16x16x32_bf16 v[88:91], a[212:215], a[28:31], v[88:91]
    v_exp_f32 v232, v232
    s_waitcnt vmcnt(8)
    s_mov_b32 s45, 0
    s_branch L_fz_chk
L_fz_spin:
    s_sleep 1
    buffer_load_dword v223, v222, s[32:35], s53 offen sc1
    s_add_u32 s45, s45, 1
    s_waitcnt vmcnt(0)
L_fz_chk:
    v_cmp_gt_i32 vcc, 0, v223
    s_cmp_ge_u32 s45, 0x100000
    s_cbranch_scc1 L_fz_go
    s_cbranch_vccnz L_fz_spin
L_fz_go:
    s_waitcnt lgkmcnt(0)
    v_mfma_f32_16x16x32_bf16 v[20:23], a[144:147], a[32:35], v[20:23]
    ds_read_b128 a[180:183], v10 offset:9216
    v_mul_f32 v96, v96, v236
    v_mfma_f32_16x16x32_bf16 v[24:27], a[144:147], a[36:39], v[24:27]
    ds_read_b128 a[184:187], v10 offset:10240
    v_mul_f32 v97, v97, v237
    v_mfma_f32_16x16x32_bf16 v[28:31], a[148:151], a[32:35], v[28:31]
    ds_read_b128 a[188:191], v10 offset:11264
    v_fma_f32 v238, v238, v221, v221
    v_mfma_f32_16x16x32_bf16 v[32:35], a[148:151], a[36:39], v[32:35]
    ds_read_b128 a[192:195], v10 offset:12288
    v_fma_f32 v239, v239, v221, v221
    v_mfma_f32_16x16x32_bf16 v[36:39], a[152:155], a[32:35], v[36:39]
    ds_read_b128 a[196:199], v10 offset:13312
    v_fma_f32 v232, v232, v220, v220
    v_mfma_f32_16x16x32_bf16 v[40:43], a[152:155], a[36:39], v[40:43]
    ds_read_b128 a[200:203], v10 offset:14336
    v_mul_f32 v236, v104, v104
    v_mfma_f32_16x16x32_bf16 v[44:47], a[156:159], a[32:35], v[44:47]
    ds_read_b128 a[204:207], v10 offset:15360
    v_fma_f32 v236, v236, v219, v217
    v_mfma_f32_16x16x32_bf16 v[48:51], a[156:159], a[36:39], v[48:51]
    ds_read_b128 a[208:211], v10 offset:16384
    v_mul_f32 v236, v236, v104
    v_mfma_f32_16x16x32_bf16 v[52:55], a[160:163], a[32:35], v[52:55]
    ds_read_b128 a[212:215], v10 offset:17408
    v_mul_f32 v237, v105, v105
    v_mfma_f32_16x16x32_bf16 v[56:59], a[160:163], a[36:39], v[56:59]
    s_add_u32 m0, s48, 36864
    s_add_u32 s14, s49, s13
    buffer_load_dwordx4 v4, s[32:35], s49 offen offset:0 lds
    v_mfma_f32_16x16x32_bf16 v[60:63], a[164:167], a[32:35], v[60:63]
    ds_read2st64_b32 v[14:15], v11 offset0:224 offset1:228
    ds_read2st64_b32 v[16:17], v11 offset0:232 offset1:236
    v_mfma_f32_16x16x32_bf16 v[64:67], a[164:167], a[36:39], v[64:67]
    buffer_load_dwordx4 v4, s[32:35], s49 offen offset:1024 lds
    v_mfma_f32_16x16x32_bf16 v[68:71], a[168:171], a[32:35], v[68:71]
    v_rcp_f32 v238, v238
    v_mfma_f32_16x16x32_bf16 v[72:75], a[168:171], a[36:39], v[72:75]
    buffer_load_dwordx4 v4, s[32:35], s49 offen offset:2048 lds
    v_mfma_f32_16x16x32_bf16 v[76:79], a[172:175], a[32:35], v[76:79]
    v_rcp_f32 v239, v239
    v_mfma_f32_16x16x32_bf16 v[80:83], a[172:175], a[36:39], v[80:83]
    buffer_load_dwordx4 v4, s[32:35], s49 offen offset:3072 lds
    s_add_u32 m0, s12, 36864
    s_add_u32 s49, s49, 20480
    v_mfma_f32_16x16x32_bf16 v[84:87], a[176:179], a[32:35], v[84:87]
    s_waitcnt lgkmcnt(0)
    v_max3_u32 v14, v14, v15, v16
    v_max_u32 v14, v14, v17
    v_cmp_eq_u32 vcc, -1, v14
    v_mfma_f32_16x16x32_bf16 v[88:91], a[176:179], a[36:39], v[88:91]
    buffer_load_dwordx4 v4, s[32:35], s14 offen offset:0 lds
    s_cbranch_vccnz L_zf5
L_zb5:
    s_barrier
    s_waitcnt lgkmcnt(0)
    v_mfma_f32_16x16x32_bf16 v[20:23], a[180:183], a[40:43], v[20:23]
    ds_read_b128 a[144:147], v10 offset:18432
    v_mul_f32 v98, v98, v238
    v_mfma_f32_16x16x32_bf16 v[24:27], a[180:183], a[44:47], v[24:27]
    ds_read_b128 a[148:151], v10 offset:19456
    v_mul_f32 v99, v99, v239
    v_mfma_f32_16x16x32_bf16 v[28:31], a[184:187], a[40:43], v[28:31]
    ds_read_b128 a[152:155], v10 offset:20480
    v_fma_f32 v237, v237, v219, v217
    v_mfma_f32_16x16x32_bf16 v[32:35], a[184:187], a[44:47], v[32:35]
    ds_read_b128 a[156:159], v10 offset:21504
    v_mul_f32 v237, v237, v105
    v_mfma_f32_16x16x32_bf16 v[36:39], a[188:191], a[40:43], v[36:39]
    ds_read_b128 a[160:163], v10 offset:22528
    v_mul_f32 v238, v106, v106
    v_mfma_f32_16x16x32_bf16 v[40:43], a[188:191], a[44:47], v[40:43]
    ds_read_b128 a[164:167], v10 offset:23552
    v_fma_f32 v238, v238, v219, v217
    v_mfma_f32_16x16x32_bf16 v[44:47], a[192:195], a[40:43], v[44:47]
    ds_read_b128 a[168:171], v10 offset:24576
    v_mul_f32 v238, v238, v106
    v_mfma_f32_16x16x32_bf16 v[48:51], a[192:195], a[44:47], v[48:51]
    ds_read_b128 a[172:175], v10 offset:25600
    v_mul_f32 v239, v107, v107
    v_mfma_f32_16x16x32_bf16 v[52:55], a[196:199], a[40:43], v[52:55]
    ds_read_b128 a[176:179], v10 offset:26624
    v_fma_f32 v239, v239, v219, v217
    v_mfma_f32_16x16x32_bf16 v[56:59], a[196:199], a[44:47], v[56:59]
    buffer_load_dwordx4 a[0:3], v4, s[32:35], s51 offen offset:0
    v_mfma_f32_16x16x32_bf16 v[60:63], a[200:203], a[40:43], v[60:63]
    v_rcp_f32 v232, v232
    v_mfma_f32_16x16x32_bf16 v[64:67], a[200:203], a[44:47], v[64:67]
    buffer_load_dwordx4 a[4:7], v4, s[32:35], s51 offen offset:1024
    v_mfma_f32_16x16x32_bf16 v[68:71], a[204:207], a[40:43], v[68:71]
    v_exp_f32 v233, v233
    v_mfma_f32_16x16x32_bf16 v[72:75], a[204:207], a[44:47], v[72:75]
    buffer_load_dwordx4 a[8:11], v4, s[32:35], s51 offen offset:2048
    v_mfma_f32_16x16x32_bf16 v[76:79], a[208:211], a[40:43], v[76:79]
    v_exp_f32 v234, v234
    v_mfma_f32_16x16x32_bf16 v[80:83], a[208:211], a[44:47], v[80:83]
    buffer_load_dwordx4 a[12:15], v4, s[32:35], s51 offen offset:3072
    s_bfe_u32 s51, 9012, s19
    s_cmp_eq_u32 s51, s41
    s_cselect_b32 s51, s59, s51
    s_mul_i32 s51, s51, 8192
    s_add_u32 s51, s51, s18
    v_mfma_f32_16x16x32_bf16 v[84:87], a[212:215], a[40:43], v[84:87]
    v_mfma_f32_16x16x32_bf16 v[88:91], a[212:215], a[44:47], v[88:91]
    s_waitcnt lgkmcnt(0)
    v_mfma_f32_16x16x32_bf16 v[20:23], a[144:147], a[48:51], v[20:23]
    ds_read_b128 a[180:183], v10 offset:27648
    v_mul_f32 v100, v100, v232
    v_mfma_f32_16x16x32_bf16 v[24:27], a[144:147], a[52:55], v[24:27]
    ds_read_b128 a[184:187], v10 offset:28672
    v_fma_f32 v233, v233, v220, v220
    v_mfma_f32_16x16x32_bf16 v[28:31], a[148:151], a[48:51], v[28:31]
    ds_read_b128 a[188:191], v10 offset:29696
    v_fma_f32 v234, v234, v220, v220
    v_mfma_f32_16x16x32_bf16 v[32:35], a[148:151], a[52:55], v[32:35]
    ds_read_b128 a[192:195], v10 offset:30720
    v_mul_f32 v239, v239, v107
    v_mfma_f32_16x16x32_bf16 v[36:39], a[152:155], a[48:51], v[36:39]
    ds_read_b128 a[196:199], v10 offset:31744
    v_mul_f32 v232, v108, v108
    v_mfma_f32_16x16x32_bf16 v[40:43], a[152:155], a[52:55], v[40:43]
    ds_read_b128 a[200:203], v10 offset:32768
    v_fma_f32 v232, v232, v218, v216
    v_mfma_f32_16x16x32_bf16 v[44:47], a[156:159], a[48:51], v[44:47]
    ds_read_b128 a[204:207], v10 offset:33792
    v_mul_f32 v232, v232, v108
    v_mfma_f32_16x16x32_bf16 v[48:51], a[156:159], a[52:55], v[48:51]
    ds_read_b128 a[208:211], v10 offset:34816
    v_mfma_f32_16x16x32_bf16 v[52:55], a[160:163], a[48:51], v[52:55]
    ds_read_b128 a[212:215], v10 offset:35840
    v_add_u32 v11, -73728, v11
    v_add_u32 v12, -73728, v12
    v_mfma_f32_16x16x32_bf16 v[56:59], a[160:163], a[52:55], v[56:59]
    s_add_u32 m0, s48, 57344
    s_nop 0
    buffer_load_dwordx4 v4, s[32:35], s49 offen offset:0 lds
    v_mfma_f32_16x16x32_bf16 v[60:63], a[164:167], a[48:51], v[60:63]
    ds_read2st64_b32 v[14:15], v11 offset0:0 offset1:4
    ds_read2st64_b32 v[16:17], v11 offset0:8 offset1:12
    v_mfma_f32_16x16x32_bf16 v[64:67], a[164:167], a[52:55], v[64:67]
    buffer_load_dwordx4 v4, s[32:35], s49 offen offset:1024 lds
    v_mfma_f32_16x16x32_bf16 v[68:71], a[168:171], a[48:51], v[68:71]
    ds_read_b32 v18, v12 offset:0
    v_mfma_f32_16x16x32_bf16 v[72:75], a[168:171], a[52:55], v[72:75]
    buffer_load_dwordx4 v4, s[32:35], s49 offen offset:2048 lds
    v_mfma_f32_16x16x32_bf16 v[76:79], a[172:175], a[48:51], v[76:79]
    v_rcp_f32 v233, v233
    v_mfma_f32_16x16x32_bf16 v[80:83], a[172:175], a[52:55], v[80:83]
    buffer_load_dwordx4 v4, s[32:35], s49 offen offset:3072 lds
    s_bfe_u32 s49, 4625, s19
    s_cmp_eq_u32 s49, s41
    s_cselect_b32 s49, s59, s49
    s_mul_i32 s49, s49, 589824
    s_add_u32 s49, s49, s15
    v_mfma_f32_16x16x32_bf16 v[84:87], a[176:179], a[48:51], v[84:87]
    s_waitcnt lgkmcnt(0)
    v_max3_u32 v14, v14, v15, v16
    v_max3_u32 v14, v14, v17, v18
    v_cmp_eq_u32 vcc, -1, v14
    v_mfma_f32_16x16x32_bf16 v[88:91], a[176:179], a[52:55], v[88:91]
    s_cbranch_vccnz L_zf6
L_zb6:
    s_barrier
    s_waitcnt lgkmcnt(0)
    v_mfma_f32_16x16x32_bf16 v[20:23], a[180:183], a[56:59], v[20:23]
    ds_read_b128 a[144:147], v8 offset:0
    v_mul_f32 v101, v101, v233
    v_mfma_f32_16x16x32_bf16 v[24:27], a[180:183], a[60:63], v[24:27]
    ds_read_b128 a[148:151], v8 offset:1024
    v_mul_f32 v233, v109, v109
    v_mfma_f32_16x16x32_bf16 v[28:31], a[184:187], a[56:59], v[28:31]
    ds_read_b128 a[152:155], v8 offset:2048
    v_fma_f32 v233, v233, v218, v216
    v_mfma_f32_16x16x32_bf16 v[32:35], a[184:187], a[60:63], v[32:35]
    ds_read_b128 a[156:159], v8 offset:3072
    v_mul_f32 v233, v233, v109
    v_mfma_f32_16x16x32_bf16 v[36:39], a[188:191], a[56:59], v[36:39]
    ds_read_b128 a[160:163], v8 offset:4096
    v_mfma_f32_16x16x32_bf16 v[40:43], a[188:191], a[60:63], v[40:43]
    ds_read_b128 a[164:167], v8 offset:5120
    v_mfma_f32_16x16x32_bf16 v[44:47], a[192:195], a[56:59], v[44:47]
    ds_read_b128 a[168:171], v8 offset:6144
    v_mfma_f32_16x16x32_bf16 v[48:51], a[192:195], a[60:63], v[48:51]
    ds_read_b128 a[172:175], v8 offset:7168
    v_mfma_f32_16x16x32_bf16 v[52:55], a[196:199], a[56:59], v[52:55]
    ds_read_b128 a[176:179], v8 offset:8192
    v_mfma_f32_16x16x32_bf16 v[56:59], a[196:199], a[60:63], v[56:59]
    buffer_load_dwordx4 a[16:19], v4, s[32:35], s51 offen offset:0
    v_mfma_f32_16x16x32_bf16 v[60:63], a[200:203], a[56:59], v[60:63]
    v_rcp_f32 v234, v234
    v_mfma_f32_16x16x32_bf16 v[64:67], a[200:203], a[60:63], v[64:67]
    buffer_load_dwordx4 a[20:23], v4, s[32:35], s51 offen offset:1024
    v_mfma_f32_16x16x32_bf16 v[68:71], a[204:207], a[56:59], v[68:71]
    v_exp_f32 v235, v235
    v_mfma_f32_16x16x32_bf16 v[72:75], a[204:207], a[60:63], v[72:75]
    buffer_load_dwordx4 a[24:27], v4, s[32:35], s51 offen offset:2048
    v_mfma_f32_16x16x32_bf16 v[76:79], a[208:211], a[56:59], v[76:79]
    v_exp_f32 v236, v236
    v_mfma_f32_16x16x32_bf16 v[80:83], a[208:211], a[60:63], v[80:83]
    buffer_load_dwordx4 a[28:31], v4, s[32:35], s51 offen offset:3072
    s_add_u32 s51, s51, 4096
    v_mfma_f32_16x16x32_bf16 v[84:87], a[212:215], a[56:59], v[84:87]
    v_exp_f32 v237, v237
    v_mfma_f32_16x16x32_bf16 v[88:91], a[212:215], a[60:63], v[88:91]
    s_branch L_pgpost_kernel_6_s
.p2align 12
L_pgpost_kernel_6:
    s_branch L_hoppost_kernel_2
L_pgpost_kernel_6_s:
    v_exp_f32 v238, v238
    s_waitcnt lgkmcnt(0)
    v_mfma_f32_16x16x32_bf16 v[20:23], a[144:147], a[64:67], v[20:23]
    ds_read_b128 a[180:183], v8 offset:9216
    v_mul_f32 v102, v102, v234
    v_mfma_f32_16x16x32_bf16 v[24:27], a[144:147], a[68:71], v[24:27]
    ds_read_b128 a[184:187], v8 offset:10240
    v_fma_f32 v235, v235, v220, v220
    v_mfma_f32_16x16x32_bf16 v[28:31], a[148:151], a[64:67], v[28:31]
    ds_read_b128 a[188:191], v8 offset:11264
    v_fma_f32 v236, v236, v221, v221
    v_mfma_f32_16x16x32_bf16 v[32:35], a[148:151], a[68:71], v[32:35]
    ds_read_b128 a[192:195], v8 offset:12288
    v_fma_f32 v237, v237, v221, v221
    v_mfma_f32_16x16x32_bf16 v[36:39], a[152:155], a[64:67], v[36:39]
    ds_read_b128 a[196:199], v8 offset:13312
    v_fma_f32 v238, v238, v221, v221
    v_mfma_f32_16x16x32_bf16 v[40:43], a[152:155], a[68:71], v[40:43]
    ds_read_b128 a[200:203], v8 offset:14336
    v_mul_f32 v234, v110, v110
    v_mfma_f32_16x16x32_bf16 v[44:47], a[156:159], a[64:67], v[44:47]
    ds_read_b128 a[204:207], v8 offset:15360
    v_fma_f32 v234, v234, v218, v216
    v_mfma_f32_16x16x32_bf16 v[48:51], a[156:159], a[68:71], v[48:51]
    ds_read_b128 a[208:211], v8 offset:16384
    v_mul_f32 v234, v234, v110
    v_mfma_f32_16x16x32_bf16 v[52:55], a[160:163], a[64:67], v[52:55]
    ds_read_b128 a[212:215], v8 offset:17408
    v_mfma_f32_16x16x32_bf16 v[56:59], a[160:163], a[68:71], v[56:59]
    s_add_u32 m0, s48, 73728
    s_add_u32 s14, s49, s13
    buffer_load_dwordx4 v4, s[32:35], s49 offen offset:0 lds
    v_mfma_f32_16x16x32_bf16 v[60:63], a[164:167], a[64:67], v[60:63]
    s_waitcnt vmcnt(22)
    ds_read2st64_b32 v[14:15], v11 offset0:80 offset1:84
    ds_read2st64_b32 v[16:17], v11 offset0:88 offset1:92
    v_mfma_f32_16x16x32_bf16 v[64:67], a[164:167], a[68:71], v[64:67]
    buffer_load_dwordx4 v4, s[32:35], s49 offen offset:1024 lds
    v_mfma_f32_16x16x32_bf16 v[68:71], a[168:171], a[64:67], v[68:71]
    v_rcp_f32 v235, v235
    v_mfma_f32_16x16x32_bf16 v[72:75], a[168:171], a[68:71], v[72:75]
    buffer_load_dwordx4 v4, s[32:35], s49 offen offset:2048 lds
    v_mfma_f32_16x16x32_bf16 v[76:79], a[172:175], a[64:67], v[76:79]
    v_rcp_f32 v236, v236
    v_mfma_f32_16x16x32_bf16 v[80:83], a[172:175], a[68:71], v[80:83]
    buffer_load_dwordx4 v4, s[32:35], s49 offen offset:3072 lds
    s_add_u32 m0, s12, 73728
    s_add_u32 s49, s49, 20480
    v_mfma_f32_16x16x32_bf16 v[84:87], a[176:179], a[64:67], v[84:87]
    s_waitcnt lgkmcnt(0)
    v_max3_u32 v14, v14, v15, v16
    v_max_u32 v14, v14, v17
    v_cmp_eq_u32 vcc, -1, v14
    v_mfma_f32_16x16x32_bf16 v[88:91], a[176:179], a[68:71], v[88:91]
    buffer_load_dwordx4 v4, s[32:35], s14 offen offset:0 lds
    s_cbranch_vccnz L_zf7
L_zb7:
    s_barrier
    s_waitcnt lgkmcnt(0)
    v_mfma_f32_16x16x32_bf16 v[20:23], a[180:183], a[72:75], v[20:23]
    ds_read_b128 a[144:147], v8 offset:18432
    v_mul_f32 v103, v103, v235
    v_mfma_f32_16x16x32_bf16 v[24:27], a[180:183], a[76:79], v[24:27]
    ds_read_b128 a[148:151], v8 offset:19456
    v_mul_f32 v104, v104, v236
    v_mfma_f32_16x16x32_bf16 v[28:31], a[184:187], a[72:75], v[28:31]
    ds_read_b128 a[152:155], v8 offset:20480
    v_mul_f32 v235, v111, v111
    v_mfma_f32_16x16x32_bf16 v[32:35], a[184:187], a[76:79], v[32:35]
    ds_read_b128 a[156:159], v8 offset:21504
    v_fma_f32 v235, v235, v218, v216
    v_mfma_f32_16x16x32_bf16 v[36:39], a[188:191], a[72:75], v[36:39]
    ds_read_b128 a[160:163], v8 offset:22528
    v_mul_f32 v235, v235, v111
    v_mfma_f32_16x16x32_bf16 v[40:43], a[188:191], a[76:79], v[40:43]
    ds_read_b128 a[164:167], v8 offset:23552
    v_mul_f32 v236, v112, v112
    v_mfma_f32_16x16x32_bf16 v[44:47], a[192:195], a[72:75], v[44:47]
    ds_read_b128 a[168:171], v8 offset:24576
    v_fma_f32 v236, v236, v219, v217
    v_mfma_f32_16x16x32_bf16 v[48:51], a[192:195], a[76:79], v[48:51]
    ds_read_b128 a[172:175], v8 offset:25600
    v_mul_f32 v236, v236, v112
    v_mfma_f32_16x16x32_bf16 v[52:55], a[196:199], a[72:75], v[52:55]
    ds_read_b128 a[176:179], v8 offset:26624
    v_mfma_f32_16x16x32_bf16 v[56:59], a[196:199], a[76:79], v[56:59]
    buffer_load_dwordx4 a[32:35], v4, s[32:35], s51 offen offset:0
    v_mfma_f32_16x16x32_bf16 v[60:63], a[200:203], a[72:75], v[60:63]
    v_rcp_f32 v237, v237
    v_mfma_f32_16x16x32_bf16 v[64:67], a[200:203], a[76:79], v[64:67]
    buffer_load_dwordx4 a[36:39], v4, s[32:35], s51 offen offset:1024
    v_mfma_f32_16x16x32_bf16 v[68:71], a[204:207], a[72:75], v[68:71]
    v_rcp_f32 v238, v238
    v_mfma_f32_16x16x32_bf16 v[72:75], a[204:207], a[76:79], v[72:75]
    buffer_load_dwordx4 a[40:43], v4, s[32:35], s51 offen offset:2048
    v_mfma_f32_16x16x32_bf16 v[76:79], a[208:211], a[72:75], v[76:79]
    v_exp_f32 v239, v239
    v_mfma_f32_16x16x32_bf16 v[80:83], a[208:211], a[76:79], v[80:83]
    buffer_load_dwordx4 a[44:47], v4, s[32:35], s51 offen offset:3072
    s_bfe_u32 s51, 17491, s19
    s_cmp_eq_u32 s51, s41
    s_cselect_b32 s51, s59, s51
    s_mul_i32 s51, s51, 8192
    s_add_u32 s51, s51, s18
    v_mfma_f32_16x16x32_bf16 v[84:87], a[212:215], a[72:75], v[84:87]
    v_exp_f32 v232, v232
    v_mfma_f32_16x16x32_bf16 v[88:91], a[212:215], a[76:79], v[88:91]
    s_waitcnt lgkmcnt(0)
    v_mfma_f32_16x16x32_bf16 v[20:23], a[144:147], a[80:83], v[20:23]
    ds_read_b128 a[180:183], v8 offset:27648
    v_mul_f32 v105, v105, v237
    v_mfma_f32_16x16x32_bf16 v[24:27], a[144:147], a[84:87], v[24:27]
    ds_read_b128 a[184:187], v8 offset:28672
    v_mul_f32 v106, v106, v238
    v_mfma_f32_16x16x32_bf16 v[28:31], a[148:151], a[80:83], v[28:31]
    ds_read_b128 a[188:191], v8 offset:29696
    v_fma_f32 v239, v239, v221, v221
    v_mfma_f32_16x16x32_bf16 v[32:35], a[148:151], a[84:87], v[32:35]
    ds_read_b128 a[192:195], v8 offset:30720
    v_fma_f32 v232, v232, v220, v220
    v_mfma_f32_16x16x32_bf16 v[36:39], a[152:155], a[80:83], v[36:39]
    ds_read_b128 a[196:199], v8 offset:31744
    v_mul_f32 v237, v113, v113
    v_mfma_f32_16x16x32_bf16 v[40:43], a[152:155], a[84:87], v[40:43]
    ds_read_b128 a[200:203], v8 offset:32768
    v_fma_f32 v237, v237, v219, v217
    v_mfma_f32_16x16x32_bf16 v[44:47], a[156:159], a[80:83], v[44:47]
    ds_read_b128 a[204:207], v8 offset:33792
    v_mul_f32 v237, v237, v113
    v_mfma_f32_16x16x32_bf16 v[48:51], a[156:159], a[84:87], v[48:51]
    ds_read_b128 a[208:211], v8 offset:34816
    v_mul_f32 v238, v114, v114
    v_mfma_f32_16x16x32_bf16 v[52:55], a[160:163], a[80:83], v[52:55]
    ds_read_b128 a[212:215], v8 offset:35840
    v_fma_f32 v238, v238, v219, v217
    v_mfma_f32_16x16x32_bf16 v[56:59], a[160:163], a[84:87], v[56:59]
    s_add_u32 m0, s48, 94208
    s_nop 0
    buffer_load_dwordx4 v4, s[32:35], s49 offen offset:0 lds
    v_mfma_f32_16x16x32_bf16 v[60:63], a[164:167], a[80:83], v[60:63]
    v_rcp_f32 v239, v239
    v_mfma_f32_16x16x32_bf16 v[64:67], a[164:167], a[84:87], v[64:67]
    buffer_load_dwordx4 v4, s[32:35], s49 offen offset:1024 lds
    v_mfma_f32_16x16x32_bf16 v[68:71], a[168:171], a[80:83], v[68:71]
    v_rcp_f32 v232, v232
    v_mfma_f32_16x16x32_bf16 v[72:75], a[168:171], a[84:87], v[72:75]
    buffer_load_dwordx4 v4, s[32:35], s49 offen offset:2048 lds
    v_mfma_f32_16x16x32_bf16 v[76:79], a[172:175], a[80:83], v[76:79]
    v_exp_f32 v233, v233
    v_mfma_f32_16x16x32_bf16 v[80:83], a[172:175], a[84:87], v[80:83]
    buffer_load_dwordx4 v4, s[32:35], s49 offen offset:3072 lds
    s_bfe_u32 s49, 12578, s19
    s_cmp_eq_u32 s49, s41
    s_cselect_b32 s49, s59, s49
    s_mul_i32 s49, s49, 589824
    s_add_u32 s49, s49, s15
    v_mfma_f32_16x16x32_bf16 v[84:87], a[176:179], a[80:83], v[84:87]
    v_mfma_f32_16x16x32_bf16 v[88:91], a[176:179], a[84:87], v[88:91]
    s_waitcnt vmcnt(25)
    s_barrier
    s_waitcnt lgkmcnt(0)
    v_mfma_f32_16x16x32_bf16 v[20:23], a[180:183], a[88:91], v[20:23]
    ds_read_b128 a[144:147], v8 offset:36864
    v_mul_f32 v107, v107, v239
    v_mfma_f32_16x16x32_bf16 v[24:27], a[180:183], a[92:95], v[24:27]
    ds_read_b128 a[148:151], v8 offset:37888
    v_mul_f32 v108, v108, v232
    v_mfma_f32_16x16x32_bf16 v[28:31], a[184:187], a[88:91], v[28:31]
    ds_read_b128 a[152:155], v8 offset:38912
    v_fma_f32 v233, v233, v220, v220
    v_mfma_f32_16x16x32_bf16 v[32:35], a[184:187], a[92:95], v[32:35]
    ds_read_b128 a[156:159], v8 offset:39936
    v_mul_f32 v238, v238, v114
    v_mfma_f32_16x16x32_bf16 v[36:39], a[188:191], a[88:91], v[36:39]
    ds_read_b128 a[160:163], v8 offset:40960
    v_mul_f32 v239, v115, v115
    v_mfma_f32_16x16x32_bf16 v[40:43], a[188:191], a[92:95], v[40:43]
    ds_read_b128 a[164:167], v8 offset:41984
    v_fma_f32 v239, v239, v219, v217
    v_mfma_f32_16x16x32_bf16 v[44:47], a[192:195], a[88:91], v[44:47]
    ds_read_b128 a[168:171], v8 offset:43008
    v_mul_f32 v239, v239, v115
    v_mfma_f32_16x16x32_bf16 v[48:51], a[192:195], a[92:95], v[48:51]
    ds_read_b128 a[172:175], v8 offset:44032
    v_mul_f32 v232, v116, v116
    v_mfma_f32_16x16x32_bf16 v[52:55], a[196:199], a[88:91], v[52:55]
    ds_read_b128 a[176:179], v8 offset:45056
    v_fma_f32 v232, v232, v218, v216
    v_mfma_f32_16x16x32_bf16 v[56:59], a[196:199], a[92:95], v[56:59]
    buffer_load_dwordx4 a[48:51], v4, s[32:35], s51 offen offset:0
    v_mfma_f32_16x16x32_bf16 v[60:63], a[200:203], a[88:91], v[60:63]
    v_rcp_f32 v233, v233
    v_mfma_f32_16x16x32_bf16 v[64:67], a[200:203], a[92:95], v[64:67]
    buffer_load_dwordx4 a[52:55], v4, s[32:35], s51 offen offset:1024
    v_mfma_f32_16x16x32_bf16 v[68:71], a[204:207], a[88:91], v[68:71]
    v_exp_f32 v234, v234
    v_mfma_f32_16x16x32_bf16 v[72:75], a[204:207], a[92:95], v[72:75]
    buffer_load_dwordx4 a[56:59], v4, s[32:35], s51 offen offset:2048
    v_mfma_f32_16x16x32_bf16 v[76:79], a[208:211], a[88:91], v[76:79]
    v_exp_f32 v235, v235
    v_mfma_f32_16x16x32_bf16 v[80:83], a[208:211], a[92:95], v[80:83]
    buffer_load_dwordx4 a[60:63], v4, s[32:35], s51 offen offset:3072
    s_add_u32 s51, s51, 4096
    v_mfma_f32_16x16x32_bf16 v[84:87], a[212:215], a[88:91], v[84:87]
    v_mfma_f32_16x16x32_bf16 v[88:91], a[212:215], a[92:95], v[88:91]
    s_waitcnt lgkmcnt(0)
    v_mfma_f32_16x16x32_bf16 v[20:23], a[144:147], a[96:99], v[20:23]
    ds_read_b128 a[180:183], v8 offset:46080
    v_mul_f32 v109, v109, v233
    v_mfma_f32_16x16x32_bf16 v[24:27], a[144:147], a[100:103], v[24:27]
    ds_read_b128 a[184:187], v8 offset:47104
    v_fma_f32 v234, v234, v220, v220
    v_mfma_f32_16x16x32_bf16 v[28:31], a[148:151], a[96:99], v[28:31]
    ds_read_b128 a[188:191], v8 offset:48128
    v_fma_f32 v235, v235, v220, v220
    v_mfma_f32_16x16x32_bf16 v[32:35], a[148:151], a[100:103], v[32:35]
    ds_read_b128 a[192:195], v8 offset:49152
    v_mul_f32 v232, v232, v116
    v_mfma_f32_16x16x32_bf16 v[36:39], a[152:155], a[96:99], v[36:39]
    ds_read_b128 a[196:199], v8 offset:50176
    v_mul_f32 v233, v117, v117
    v_mfma_f32_16x16x32_bf16 v[40:43], a[152:155], a[100:103], v[40:43]
    ds_read_b128 a[200:203], v8 offset:51200
    v_fma_f32 v233, v233, v218, v216
    v_mfma_f32_16x16x32_bf16 v[44:47], a[156:159], a[96:99], v[44:47]
    ds_read_b128 a[204:207], v8 offset:52224
    v_mul_f32 v233, v233, v117
    v_mfma_f32_16x16x32_bf16 v[48:51], a[156:159], a[100:103], v[48:51]
    ds_read_b128 a[208:211], v8 offset:53248
    v_mfma_f32_16x16x32_bf16 v[52:55], a[160:163], a[96:99], v[52:55]
    ds_read_b128 a[212:215], v8 offset:54272
    v_mfma_f32_16x16x32_bf16 v[56:59], a[160:163], a[100:103], v[56:59]
    s_add_u32 m0, s48, 110592
    s_add_u32 s14, s49, s13
    buffer_load_dwordx4 v4, s[32:35], s49 offen offset:0 lds
    v_mfma_f32_16x16x32_bf16 v[60:63], a[164:167], a[96:99], v[60:63]
    v_rcp_f32 v234, v234
    v_mfma_f32_16x16x32_bf16 v[64:67], a[164:167], a[100:103], v[64:67]
    buffer_load_dwordx4 v4, s[32:35], s49 offen offset:1024 lds
    v_mfma_f32_16x16x32_bf16 v[68:71], a[168:171], a[96:99], v[68:71]
    v_rcp_f32 v235, v235
    v_mfma_f32_16x16x32_bf16 v[72:75], a[168:171], a[100:103], v[72:75]
    buffer_load_dwordx4 v4, s[32:35], s49 offen offset:2048 lds
    v_mfma_f32_16x16x32_bf16 v[76:79], a[172:175], a[96:99], v[76:79]
    v_exp_f32 v236, v236
    v_mfma_f32_16x16x32_bf16 v[80:83], a[172:175], a[100:103], v[80:83]
    buffer_load_dwordx4 v4, s[32:35], s49 offen offset:3072 lds
    s_add_u32 m0, s12, 110592
    s_add_u32 s49, s49, 20480
    v_mfma_f32_16x16x32_bf16 v[84:87], a[176:179], a[96:99], v[84:87]
    v_exp_f32 v237, v237
    v_mfma_f32_16x16x32_bf16 v[88:91], a[176:179], a[100:103], v[88:91]
    buffer_load_dwordx4 v4, s[32:35], s14 offen offset:0 lds
    s_waitcnt vmcnt(26)
    s_barrier
    s_waitcnt lgkmcnt(0)
    v_mfma_f32_16x16x32_bf16 v[20:23], a[180:183], a[104:107], v[20:23]
    ds_read_b128 a[144:147], v9 offset:0
    v_mul_f32 v110, v110, v234
    v_mfma_f32_16x16x32_bf16 v[24:27], a[180:183], a[108:111], v[24:27]
    ds_read_b128 a[148:151], v9 offset:1024
    v_mul_f32 v111, v111, v235
    v_mfma_f32_16x16x32_bf16 v[28:31], a[184:187], a[104:107], v[28:31]
    ds_read_b128 a[152:155], v9 offset:2048
    v_fma_f32 v236, v236, v221, v221
    v_mfma_f32_16x16x32_bf16 v[32:35], a[184:187], a[108:111], v[32:35]
    ds_read_b128 a[156:159], v9 offset:3072
    v_fma_f32 v237, v237, v221, v221
    v_mfma_f32_16x16x32_bf16 v[36:39], a[188:191], a[104:107], v[36:39]
    ds_read_b128 a[160:163], v9 offset:4096
    v_mul_f32 v234, v118, v118
    v_mfma_f32_16x16x32_bf16 v[40:43], a[188:191], a[108:111], v[40:43]
    ds_read_b128 a[164:167], v9 offset:5120
    v_fma_f32 v234, v234, v218, v216
    v_mfma_f32_16x16x32_bf16 v[44:47], a[192:195], a[104:107], v[44:47]
    ds_read_b128 a[168:171], v9 offset:6144
    v_mul_f32 v234, v234, v118
    v_mfma_f32_16x16x32_bf16 v[48:51], a[192:195], a[108:111], v[48:51]
    ds_read_b128 a[172:175], v9 offset:7168
    v_mul_f32 v235, v119, v119
    v_mfma_f32_16x16x32_bf16 v[52:55], a[196:199], a[104:107], v[52:55]
    ds_read_b128 a[176:179], v9 offset:8192
    v_fma_f32 v235, v235, v218, v216
    v_mfma_f32_16x16x32_bf16 v[56:59], a[196:199], a[108:111], v[56:59]
    buffer_load_dwordx4 a[64:67], v4, s[32:35], s51 offen offset:0
    v_mfma_f32_16x16x32_bf16 v[60:63], a[200:203], a[104:107], v[60:63]
    v_rcp_f32 v236, v236
    v_mfma_f32_16x16x32_bf16 v[64:67], a[200:203], a[108:111], v[64:67]
    buffer_load_dwordx4 a[68:71], v4, s[32:35], s51 offen offset:1024
    v_mfma_f32_16x16x32_bf16 v[68:71], a[204:207], a[104:107], v[68:71]
    v_rcp_f32 v237, v237
    v_mfma_f32_16x16x32_bf16 v[72:75], a[204:207], a[108:111], v[72:75]
    buffer_load_dwordx4 a[72:75], v4, s[32:35], s51 offen offset:2048
    v_mfma_f32_16x16x32_bf16 v[76:79], a[208:211], a[104:107], v[76:79]
    v_exp_f32 v238, v238
    v_mfma_f32_16x16x32_bf16 v[80:83], a[208:211], a[108:111], v[80:83]
    buffer_load_dwordx4 a[76:79], v4, s[32:35], s51 offen offset:3072
    s_bfe_u32 s51, 22085, s19
    s_cmp_eq_u32 s51, s41
    s_cselect_b32 s51, s59, s51
    s_mul_i32 s51, s51, 8192
    s_add_u32 s51, s51, s18
    v_mfma_f32_16x16x32_bf16 v[84:87], a[212:215], a[104:107], v[84:87]
    v_mfma_f32_16x16x32_bf16 v[88:91], a[212:215], a[108:111], v[88:91]
    s_waitcnt lgkmcnt(0)
    v_mfma_f32_16x16x32_bf16 v[20:23], a[144:147], a[112:115], v[20:23]
    ds_read_b128 a[180:183], v9 offset:9216
    v_mul_f32 v112, v112, v236
    v_mfma_f32_16x16x32_bf16 v[24:27], a[144:147], a[116:119], v[24:27]
    ds_read_b128 a[184:187], v9 offset:10240
    v_mul_f32 v113, v113, v237
    v_mfma_f32_16x16x32_bf16 v[28:31], a[148:151], a[112:115], v[28:31]
    ds_read_b128 a[188:191], v9 offset:11264
    v_fma_f32 v238, v238, v221, v221
    v_mfma_f32_16x16x32_bf16 v[32:35], a[148:151], a[116:119], v[32:35]
    ds_read_b128 a[192:195], v9 offset:12288
    v_mul_f32 v235, v235, v119
    v_mfma_f32_16x16x32_bf16 v[36:39], a[152:155], a[112:115], v[36:39]
    ds_read_b128 a[196:199], v9 offset:13312
    v_mul_f32 v236, v120, v120
    v_mfma_f32_16x16x32_bf16 v[40:43], a[152:155], a[116:119], v[40:43]
    ds_read_b128 a[200:203], v9 offset:14336
    v_fma_f32 v236, v236, v219, v217
    v_mfma_f32_16x16x32_bf16 v[44:47], a[156:159], a[112:115], v[44:47]
    ds_read_b128 a[204:207], v9 offset:15360
    v_mul_f32 v236, v236, v120
    v_mfma_f32_16x16x32_bf16 v[48:51], a[156:159], a[116:119], v[48:51]
    ds_read_b128 a[208:211], v9 offset:16384
    v_mul_f32 v237, v121, v121
    v_mfma_f32_16x16x32_bf16 v[52:55], a[160:163], a[112:115], v[52:55]
    ds_read_b128 a[212:215], v9 offset:17408
    v_fma_f32 v237, v237, v219, v217
    v_mfma_f32_16x16x32_bf16 v[56:59], a[160:163], a[116:119], v[56:59]
    s_add_u32 m0, s48, 131072
    s_nop 0
    buffer_load_dwordx4 v4, s[32:35], s49 offen offset:0 lds
    v_mfma_f32_16x16x32_bf16 v[60:63], a[164:167], a[112:115], v[60:63]
    v_rcp_f32 v238, v238
    v_mfma_f32_16x16x32_bf16 v[64:67], a[164:167], a[116:119], v[64:67]
    buffer_load_dwordx4 v4, s[32:35], s49 offen offset:1024 lds
    v_mfma_f32_16x16x32_bf16 v[68:71], a[168:171], a[112:115], v[68:71]
    v_exp_f32 v239, v239
    v_mfma_f32_16x16x32_bf16 v[72:75], a[168:171], a[116:119], v[72:75]
    buffer_load_dwordx4 v4, s[32:35], s49 offen offset:2048 lds
    v_mfma_f32_16x16x32_bf16 v[76:79], a[172:175], a[112:115], v[76:79]
    v_exp_f32 v232, v232
    v_mfma_f32_16x16x32_bf16 v[80:83], a[172:175], a[116:119], v[80:83]
    buffer_load_dwordx4 v4, s[32:35], s49 offen offset:3072 lds
    s_bfe_u32 s49, 9012, s19
    s_cmp_eq_u32 s49, s41
    s_cselect_b32 s49, s59, s49
    s_mul_i32 s49, s49, 589824
    s_add_u32 s49, s49, s15
    v_mfma_f32_16x16x32_bf16 v[84:87], a[176:179], a[112:115], v[84:87]
    v_mfma_f32_16x16x32_bf16 v[88:91], a[176:179], a[116:119], v[88:91]
    s_waitcnt vmcnt(25)
    s_barrier
    s_waitcnt lgkmcnt(0)
    v_mfma_f32_16x16x32_bf16 v[20:23], a[180:183], a[120:123], v[20:23]
    ds_read_b128 a[144:147], v9 offset:18432
    v_mul_f32 v114, v114, v238
    v_mfma_f32_16x16x32_bf16 v[24:27], a[180:183], a[124:127], v[24:27]
    ds_read_b128 a[148:151], v9 offset:19456
    v_fma_f32 v239, v239, v221, v221
    v_mfma_f32_16x16x32_bf16 v[28:31], a[184:187], a[120:123], v[28:31]
    ds_read_b128 a[152:155], v9 offset:20480
    v_fma_f32 v232, v232, v220, v220
    v_mfma_f32_16x16x32_bf16 v[32:35], a[184:187], a[124:127], v[32:35]
    ds_read_b128 a[156:159], v9 offset:21504
    v_mul_f32 v237, v237, v121
    v_mfma_f32_16x16x32_bf16 v[36:39], a[188:191], a[120:123], v[36:39]
    ds_read_b128 a[160:163], v9 offset:22528
    v_mul_f32 v238, v122, v122
    v_mfma_f32_16x16x32_bf16 v[40:43], a[188:191], a[124:127], v[40:43]
    ds_read_b128 a[164:167], v9 offset:23552
    v_fma_f32 v238, v238, v219, v217
    v_mfma_f32_16x16x32_bf16 v[44:47], a[192:195], a[120:123], v[44:47]
    ds_read_b128 a[168:171], v9 offset:24576
    v_mul_f32 v238, v238, v122
    v_mfma_f32_16x16x32_bf16 v[48:51], a[192:195], a[124:127], v[48:51]
    ds_read_b128 a[172:175], v9 offset:25600
    v_mfma_f32_16x16x32_bf16 v[52:55], a[196:199], a[120:123], v[52:55]
    ds_read_b128 a[176:179], v9 offset:26624
    v_mfma_f32_16x16x32_bf16 v[56:59], a[196:199], a[124:127], v[56:59]
    buffer_load_dwordx4 a[80:83], v4, s[32:35], s51 offen offset:0
    v_mfma_f32_16x16x32_bf16 v[60:63], a[200:203], a[120:123], v[60:63]
    v_rcp_f32 v239, v239
    v_mfma_f32_16x16x32_bf16 v[64:67], a[200:203], a[124:127], v[64:67]
    buffer_load_dwordx4 a[84:87], v4, s[32:35], s51 offen offset:1024
    v_mfma_f32_16x16x32_bf16 v[68:71], a[204:207], a[120:123], v[68:71]
    v_rcp_f32 v232, v232
    v_mfma_f32_16x16x32_bf16 v[72:75], a[204:207], a[124:127], v[72:75]
    buffer_load_dwordx4 a[88:91], v4, s[32:35], s51 offen offset:2048
    v_mfma_f32_16x16x32_bf16 v[76:79], a[208:211], a[120:123], v[76:79]
    v_exp_f32 v233, v233
    v_mfma_f32_16x16x32_bf16 v[80:83], a[208:211], a[124:127], v[80:83]
    buffer_load_dwordx4 a[92:95], v4, s[32:35], s51 offen offset:3072
    s_add_u32 s51, s51, 4096
    v_mfma_f32_16x16x32_bf16 v[84:87], a[212:215], a[120:123], v[84:87]
    v_exp_f32 v234, v234
    v_mfma_f32_16x16x32_bf16 v[88:91], a[212:215], a[124:127], v[88:91]
    s_waitcnt lgkmcnt(0)
    v_mfma_f32_16x16x32_bf16 v[20:23], a[144:147], a[128:131], v[20:23]
    ds_read_b128 a[180:183], v9 offset:27648
    v_mul_f32 v115, v115, v239
    v_mfma_f32_16x16x32_bf16 v[24:27], a[144:147], a[132:135], v[24:27]
    ds_read_b128 a[184:187], v9 offset:28672
    v_mul_f32 v116, v116, v232
    v_mfma_f32_16x16x32_bf16 v[28:31], a[148:151], a[128:131], v[28:31]
    ds_read_b128 a[188:191], v9 offset:29696
    v_fma_f32 v233, v233, v220, v220
    v_mfma_f32_16x16x32_bf16 v[32:35], a[148:151], a[132:135], v[32:35]
    ds_read_b128 a[192:195], v9 offset:30720
    v_fma_f32 v234, v234, v220, v220
    v_mfma_f32_16x16x32_bf16 v[36:39], a[152:155], a[128:131], v[36:39]
    ds_read_b128 a[196:199], v9 offset:31744
    v_mul_f32 v239, v123, v123
    v_mfma_f32_16x16x32_bf16 v[40:43], a[152:155], a[132:135], v[40:43]
    ds_read_b128 a[200:203], v9 offset:32768
    v_fma_f32 v239, v239, v219, v217
    v_mfma_f32_16x16x32_bf16 v[44:47], a[156:159], a[128:131], v[44:47]
    ds_read_b128 a[204:207], v9 offset:33792
    v_mul_f32 v239, v239, v123
    v_mfma_f32_16x16x32_bf16 v[48:51], a[156:159], a[132:135], v[48:51]
    ds_read_b128 a[208:211], v9 offset:34816
    v_mul_f32 v232, v124, v124
    v_mfma_f32_16x16x32_bf16 v[52:55], a[160:163], a[128:131], v[52:55]
    ds_read_b128 a[212:215], v9 offset:35840
    v_fma_f32 v232, v232, v218, v216
    v_mfma_f32_16x16x32_bf16 v[56:59], a[160:163], a[132:135], v[56:59]
    s_add_u32 m0, s48, 0
    s_add_u32 s14, s49, s13
    buffer_load_dwordx4 v4, s[32:35], s49 offen offset:0 lds
    v_mfma_f32_16x16x32_bf16 v[60:63], a[164:167], a[128:131], v[60:63]
    v_rcp_f32 v233, v233
    v_mfma_f32_16x16x32_bf16 v[64:67], a[164:167], a[132:135], v[64:67]
    buffer_load_dwordx4 v4, s[32:35], s49 offen offset:1024 lds
    v_mfma_f32_16x16x32_bf16 v[68:71], a[168:171], a[128:131], v[68:71]
    v_rcp_f32 v234, v234
    v_mfma_f32_16x16x32_bf16 v[72:75], a[168:171], a[132:135], v[72:75]
    buffer_load_dwordx4 v4, s[32:35], s49 offen offset:2048 lds
    v_mfma_f32_16x16x32_bf16 v[76:79], a[172:175], a[128:131], v[76:79]
    v_exp_f32 v235, v235
    v_mfma_f32_16x16x32_bf16 v[80:83], a[172:175], a[132:135], v[80:83]
    buffer_load_dwordx4 v4, s[32:35], s49 offen offset:3072 lds
    s_add_u32 m0, s12, 0
    s_add_u32 s49, s49, 20480
    v_mfma_f32_16x16x32_bf16 v[84:87], a[176:179], a[128:131], v[84:87]
    v_mfma_f32_16x16x32_bf16 v[88:91], a[176:179], a[132:135], v[88:91]
    buffer_load_dwordx4 v4, s[32:35], s14 offen offset:0 lds
    s_waitcnt vmcnt(26)
    s_barrier
    s_waitcnt lgkmcnt(0)
    v_mfma_f32_16x16x32_bf16 v[20:23], a[180:183], a[136:139], v[20:23]
    ds_read_b128 a[144:147], v9 offset:36864
    v_mul_f32 v117, v117, v233
    v_mfma_f32_16x16x32_bf16 v[24:27], a[180:183], a[140:143], v[24:27]
    ds_read_b128 a[148:151], v9 offset:37888
    v_mul_f32 v118, v118, v234
    v_mfma_f32_16x16x32_bf16 v[28:31], a[184:187], a[136:139], v[28:31]
    ds_read_b128 a[152:155], v9 offset:38912
    v_fma_f32 v235, v235, v220, v220
    v_mfma_f32_16x16x32_bf16 v[32:35], a[184:187], a[140:143], v[32:35]
    ds_read_b128 a[156:159], v9 offset:39936
    v_mul_f32 v232, v232, v124
    v_mfma_f32_16x16x32_bf16 v[36:39], a[188:191], a[136:139], v[36:39]
    ds_read_b128 a[160:163], v9 offset:40960
    v_mul_f32 v233, v125, v125
    v_mfma_f32_16x16x32_bf16 v[40:43], a[188:191], a[140:143], v[40:43]
    ds_read_b128 a[164:167], v9 offset:41984
    v_fma_f32 v233, v233, v218, v216
    v_mfma_f32_16x16x32_bf16 v[44:47], a[192:195], a[136:139], v[44:47]
    ds_read_b128 a[168:171], v9 offset:43008
    v_mul_f32 v233, v233, v125
    v_mfma_f32_16x16x32_bf16 v[48:51], a[192:195], a[140:143], v[48:51]
    ds_read_b128 a[172:175], v9 offset:44032
    v_mul_f32 v234, v126, v126
    v_mfma_f32_16x16x32_bf16 v[52:55], a[196:199], a[136:139], v[52:55]
    ds_read_b128 a[176:179], v9 offset:45056
    v_fma_f32 v234, v234, v218, v216
    v_mfma_f32_16x16x32_bf16 v[56:59], a[196:199], a[140:143], v[56:59]
    buffer_load_dwordx4 a[96:99], v4, s[32:35], s51 offen offset:0
    v_mfma_f32_16x16x32_bf16 v[60:63], a[200:203], a[136:139], v[60:63]
    v_rcp_f32 v235, v235
    v_mfma_f32_16x16x32_bf16 v[64:67], a[200:203], a[140:143], v[64:67]
    buffer_load_dwordx4 a[100:103], v4, s[32:35], s51 offen offset:1024
    v_mfma_f32_16x16x32_bf16 v[68:71], a[204:207], a[136:139], v[68:71]
    v_exp_f32 v236, v236
    v_mfma_f32_16x16x32_bf16 v[72:75], a[204:207], a[140:143], v[72:75]
    buffer_load_dwordx4 a[104:107], v4, s[32:35], s51 offen offset:2048
    v_mfma_f32_16x16x32_bf16 v[76:79], a[208:211], a[136:139], v[76:79]
    v_exp_f32 v237, v237
    v_mfma_f32_16x16x32_bf16 v[80:83], a[208:211], a[140:143], v[80:83]
    buffer_load_dwordx4 a[108:111], v4, s[32:35], s51 offen offset:3072
    s_bfe_u32 s51, 30054, s19
    s_cmp_eq_u32 s51, s41
    s_cselect_b32 s51, s59, s51
    s_mul_i32 s51, s51, 8192
    s_add_u32 s51, s51, s18
    v_mfma_f32_16x16x32_bf16 v[84:87], a[212:215], a[136:139], v[84:87]
    v_mfma_f32_16x16x32_bf16 v[88:91], a[212:215], a[140:143], v[88:91]
    s_waitcnt lgkmcnt(0)
    v_mfma_f32_16x16x32_bf16 v[20:23], a[144:147], a[216:219], v[20:23]
    ds_read_b128 a[180:183], v9 offset:46080
    v_mul_f32 v119, v119, v235
    v_mfma_f32_16x16x32_bf16 v[24:27], a[144:147], a[220:223], v[24:27]
    ds_read_b128 a[184:187], v9 offset:47104
    v_fma_f32 v236, v236, v221, v221
    v_mfma_f32_16x16x32_bf16 v[28:31], a[148:151], a[216:219], v[28:31]
    ds_read_b128 a[188:191], v9 offset:48128
    v_fma_f32 v237, v237, v221, v221
    v_mfma_f32_16x16x32_bf16 v[32:35], a[148:151], a[220:223], v[32:35]
    ds_read_b128 a[192:195], v9 offset:49152
    v_mul_f32 v234, v234, v126
    v_mfma_f32_16x16x32_bf16 v[36:39], a[152:155], a[216:219], v[36:39]
    ds_read_b128 a[196:199], v9 offset:50176
    v_mul_f32 v235, v127, v127
    v_mfma_f32_16x16x32_bf16 v[40:43], a[152:155], a[220:223], v[40:43]
    ds_read_b128 a[200:203], v9 offset:51200
    v_fma_f32 v235, v235, v218, v216
    v_mfma_f32_16x16x32_bf16 v[44:47], a[156:159], a[216:219], v[44:47]
    ds_read_b128 a[204:207], v9 offset:52224
    v_mul_f32 v235, v235, v127
    v_mfma_f32_16x16x32_bf16 v[48:51], a[156:159], a[220:223], v[48:51]
    ds_read_b128 a[208:211], v9 offset:53248
    v_mfma_f32_16x16x32_bf16 v[52:55], a[160:163], a[216:219], v[52:55]
    ds_read_b128 a[212:215], v9 offset:54272
    v_mfma_f32_16x16x32_bf16 v[56:59], a[160:163], a[220:223], v[56:59]
    s_add_u32 m0, s48, 20480
    s_nop 0
    buffer_load_dwordx4 v4, s[32:35], s49 offen offset:0 lds
    v_mfma_f32_16x16x32_bf16 v[60:63], a[164:167], a[216:219], v[60:63]
    v_rcp_f32 v236, v236
    v_mfma_f32_16x16x32_bf16 v[64:67], a[164:167], a[220:223], v[64:67]
    buffer_load_dwordx4 v4, s[32:35], s49 offen offset:1024 lds
    v_mfma_f32_16x16x32_bf16 v[68:71], a[168:171], a[216:219], v[68:71]
    v_rcp_f32 v237, v237
    v_mfma_f32_16x16x32_bf16 v[72:75], a[168:171], a[220:223], v[72:75]
    buffer_load_dwordx4 v4, s[32:35], s49 offen offset:2048 lds
    v_mfma_f32_16x16x32_bf16 v[76:79], a[172:175], a[216:219], v[76:79]
    v_exp_f32 v238, v238
    v_mfma_f32_16x16x32_bf16 v[80:83], a[172:175], a[220:223], v[80:83]
    buffer_load_dwordx4 v4, s[32:35], s49 offen offset:3072 lds
    s_bfe_u32 s49, 17491, s19
    s_cmp_eq_u32 s49, s41
    s_cselect_b32 s49, s59, s49
    s_mul_i32 s49, s49, 589824
    s_add_u32 s49, s49, s15
    v_mfma_f32_16x16x32_bf16 v[84:87], a[176:179], a[216:219], v[84:87]
    v_exp_f32 v239, v239
    v_mfma_f32_16x16x32_bf16 v[88:91], a[176:179], a[220:223], v[88:91]
    s_waitcnt vmcnt(25)
    s_barrier
    s_waitcnt lgkmcnt(0)
    v_mfma_f32_16x16x32_bf16 v[20:23], a[180:183], a[224:227], v[20:23]
    ds_read_b128 a[144:147], v10 offset:0
    v_mul_f32 v120, v120, v236
    v_mfma_f32_16x16x32_bf16 v[24:27], a[180:183], a[228:231], v[24:27]
    ds_read_b128 a[148:151], v10 offset:1024
    v_mul_f32 v121, v121, v237
    v_mfma_f32_16x16x32_bf16 v[28:31], a[184:187], a[224:227], v[28:31]
    ds_read_b128 a[152:155], v10 offset:2048
    v_fma_f32 v238, v238, v221, v221
    v_mfma_f32_16x16x32_bf16 v[32:35], a[184:187], a[228:231], v[32:35]
    ds_read_b128 a[156:159], v10 offset:3072
    v_fma_f32 v239, v239, v221, v221
    v_mfma_f32_16x16x32_bf16 v[36:39], a[188:191], a[224:227], v[36:39]
    ds_read_b128 a[160:163], v10 offset:4096
    v_mul_f32 v236, v128, v128
    v_mfma_f32_16x16x32_bf16 v[40:43], a[188:191], a[228:231], v[40:43]
    ds_read_b128 a[164:167], v10 offset:5120
    v_fma_f32 v236, v236, v219, v217
    v_mfma_f32_16x16x32_bf16 v[44:47], a[192:195], a[224:227], v[44:47]
    ds_read_b128 a[168:171], v10 offset:6144
    v_mul_f32 v236, v236, v128
    v_mfma_f32_16x16x32_bf16 v[48:51], a[192:195], a[228:231], v[48:51]
    ds_read_b128 a[172:175], v10 offset:7168
    v_mul_f32 v237, v129, v129
    v_mfma_f32_16x16x32_bf16 v[52:55], a[196:199], a[224:227], v[52:55]
    ds_read_b128 a[176:179], v10 offset:8192
    v_fma_f32 v237, v237, v219, v217
    v_mfma_f32_16x16x32_bf16 v[56:59], a[196:199], a[228:231], v[56:59]
    buffer_load_dwordx4 a[112:115], v4, s[32:35], s51 offen offset:0
    v_mfma_f32_16x16x32_bf16 v[60:63], a[200:203], a[224:227], v[60:63]
    v_rcp_f32 v238, v238
    v_mfma_f32_16x16x32_bf16 v[64:67], a[200:203], a[228:231], v[64:67]
    buffer_load_dwordx4 a[116:119], v4, s[32:35], s51 offen offset:1024
    s_branch L_pgpost_kernel_7_s
.p2align 12
L_pgpost_kernel_7:
    s_branch L_hoppost_kernel_2
L_pgpost_kernel_7_s:
    v_mfma_f32_16x16x32_bf16 v[68:71], a[204:207], a[224:227], v[68:71]
    v_rcp_f32 v239, v239
    v_mfma_f32_16x16x32_bf16 v[72:75], a[204:207], a[228:231], v[72:75]
    buffer_load_dwordx4 a[120:123], v4, s[32:35], s51 offen offset:2048
    v_mfma_f32_16x16x32_bf16 v[76:79], a[208:211], a[224:227], v[76:79]
    v_exp_f32 v232, v232
    v_mfma_f32_16x16x32_bf16 v[80:83], a[208:211], a[228:231], v[80:83]
    buffer_load_dwordx4 a[124:127], v4, s[32:35], s51 offen offset:3072
    s_add_u32 s51, s51, 4096
    v_mfma_f32_16x16x32_bf16 v[84:87], a[212:215], a[224:227], v[84:87]
    v_mfma_f32_16x16x32_bf16 v[88:91], a[212:215], a[228:231], v[88:91]
    s_waitcnt lgkmcnt(0)
    v_mfma_f32_16x16x32_bf16 v[20:23], a[144:147], a[232:235], v[20:23]
    ds_read_b128 a[180:183], v10 offset:9216
    v_mul_f32 v122, v122, v238
    v_mfma_f32_16x16x32_bf16 v[24:27], a[144:147], a[236:239], v[24:27]
    ds_read_b128 a[184:187], v10 offset:10240
    v_mul_f32 v123, v123, v239
    v_mfma_f32_16x16x32_bf16 v[28:31], a[148:151], a[232:235], v[28:31]
    ds_read_b128 a[188:191], v10 offset:11264
    v_fma_f32 v232, v232, v220, v220
    v_mfma_f32_16x16x32_bf16 v[32:35], a[148:151], a[236:239], v[32:35]
    ds_read_b128 a[192:195], v10 offset:12288
    v_mul_f32 v237, v237, v129
    v_mfma_f32_16x16x32_bf16 v[36:39], a[152:155], a[232:235], v[36:39]
    ds_read_b128 a[196:199], v10 offset:13312
    v_mul_f32 v238, v130, v130
    v_mfma_f32_16x16x32_bf16 v[40:43], a[152:155], a[236:239], v[40:43]
    ds_read_b128 a[200:203], v10 offset:14336
    v_fma_f32 v238, v238, v219, v217
    v_mfma_f32_16x16x32_bf16 v[44:47], a[156:159], a[232:235], v[44:47]
    ds_read_b128 a[204:207], v10 offset:15360
    v_mul_f32 v238, v238, v130
    v_mfma_f32_16x16x32_bf16 v[48:51], a[156:159], a[236:239], v[48:51]
    ds_read_b128 a[208:211], v10 offset:16384
    v_mul_f32 v239, v131, v131
    v_mfma_f32_16x16x32_bf16 v[52:55], a[160:163], a[232:235], v[52:55]
    ds_read_b128 a[212:215], v10 offset:17408
    v_fma_f32 v239, v239, v219, v217
    v_mfma_f32_16x16x32_bf16 v[56:59], a[160:163], a[236:239], v[56:59]
    s_add_u32 m0, s48, 36864
    s_add_u32 s14, s49, s13
    buffer_load_dwordx4 v4, s[32:35], s49 offen offset:0 lds
    v_mfma_f32_16x16x32_bf16 v[60:63], a[164:167], a[232:235], v[60:63]
    v_rcp_f32 v232, v232
    v_mfma_f32_16x16x32_bf16 v[64:67], a[164:167], a[236:239], v[64:67]
    buffer_load_dwordx4 v4, s[32:35], s49 offen offset:1024 lds
    v_mfma_f32_16x16x32_bf16 v[68:71], a[168:171], a[232:235], v[68:71]
    v_exp_f32 v233, v233
    v_mfma_f32_16x16x32_bf16 v[72:75], a[168:171], a[236:239], v[72:75]
    buffer_load_dwordx4 v4, s[32:35], s49 offen offset:2048 lds
    v_mfma_f32_16x16x32_bf16 v[76:79], a[172:175], a[232:235], v[76:79]
    v_exp_f32 v234, v234
    v_mfma_f32_16x16x32_bf16 v[80:83], a[172:175], a[236:239], v[80:83]
    buffer_load_dwordx4 v4, s[32:35], s49 offen offset:3072 lds
    s_add_u32 m0, s12, 36864
    s_add_u32 s49, s49, 20480
    v_mfma_f32_16x16x32_bf16 v[84:87], a[176:179], a[232:235], v[84:87]
    v_mfma_f32_16x16x32_bf16 v[88:91], a[176:179], a[236:239], v[88:91]
    buffer_load_dwordx4 v4, s[32:35], s14 offen offset:0 lds
    s_waitcnt vmcnt(26)
    s_barrier
    s_waitcnt lgkmcnt(0)
    v_mfma_f32_16x16x32_bf16 v[20:23], a[180:183], a[240:243], v[20:23]
    ds_read_b128 a[144:147], v10 offset:18432
    v_mul_f32 v124, v124, v232
    v_mfma_f32_16x16x32_bf16 v[24:27], a[180:183], a[244:247], v[24:27]
    ds_read_b128 a[148:151], v10 offset:19456
    v_fma_f32 v233, v233, v220, v220
    v_mfma_f32_16x16x32_bf16 v[28:31], a[184:187], a[240:243], v[28:31]
    ds_read_b128 a[152:155], v10 offset:20480
    v_fma_f32 v234, v234, v220, v220
    v_mfma_f32_16x16x32_bf16 v[32:35], a[184:187], a[244:247], v[32:35]
    ds_read_b128 a[156:159], v10 offset:21504
    v_mul_f32 v239, v239, v131
    v_mfma_f32_16x16x32_bf16 v[36:39], a[188:191], a[240:243], v[36:39]
    ds_read_b128 a[160:163], v10 offset:22528
    v_mul_f32 v232, v132, v132
    v_mfma_f32_16x16x32_bf16 v[40:43], a[188:191], a[244:247], v[40:43]
    ds_read_b128 a[164:167], v10 offset:23552
    v_fma_f32 v232, v232, v218, v216
    v_mfma_f32_16x16x32_bf16 v[44:47], a[192:195], a[240:243], v[44:47]
    ds_read_b128 a[168:171], v10 offset:24576
    v_mul_f32 v232, v232, v132
    v_mfma_f32_16x16x32_bf16 v[48:51], a[192:195], a[244:247], v[48:51]
    ds_read_b128 a[172:175], v10 offset:25600
    v_mfma_f32_16x16x32_bf16 v[52:55], a[196:199], a[240:243], v[52:55]
    ds_read_b128 a[176:179], v10 offset:26624
    v_mfma_f32_16x16x32_bf16 v[56:59], a[196:199], a[244:247], v[56:59]
    buffer_load_dwordx4 a[128:131], v4, s[32:35], s51 offen offset:0
    v_mfma_f32_16x16x32_bf16 v[60:63], a[200:203], a[240:243], v[60:63]
    v_rcp_f32 v233, v233
    v_mfma_f32_16x16x32_bf16 v[64:67], a[200:203], a[244:247], v[64:67]
    buffer_load_dwordx4 a[132:135], v4, s[32:35], s51 offen offset:1024
    v_mfma_f32_16x16x32_bf16 v[68:71], a[204:207], a[240:243], v[68:71]
    v_rcp_f32 v234, v234
    v_mfma_f32_16x16x32_bf16 v[72:75], a[204:207], a[244:247], v[72:75]
    buffer_load_dwordx4 a[136:139], v4, s[32:35], s51 offen offset:2048
    v_mfma_f32_16x16x32_bf16 v[76:79], a[208:211], a[240:243], v[76:79]
    v_exp_f32 v235, v235
    v_mfma_f32_16x16x32_bf16 v[80:83], a[208:211], a[244:247], v[80:83]
    buffer_load_dwordx4 a[140:143], v4, s[32:35], s51 offen offset:3072
    s_bfe_u32 s51, 26488, s19
    s_cmp_eq_u32 s51, s41
    s_cselect_b32 s51, s59, s51
    s_mul_i32 s51, s51, 8192
    s_add_u32 s51, s51, s18
    v_mfma_f32_16x16x32_bf16 v[84:87], a[212:215], a[240:243], v[84:87]
    v_exp_f32 v236, v236
    v_mfma_f32_16x16x32_bf16 v[88:91], a[212:215], a[244:247], v[88:91]
    s_waitcnt lgkmcnt(0)
    v_mfma_f32_16x16x32_bf16 v[20:23], a[144:147], a[0:3], v[20:23]
    ds_read_b128 a[180:183], v10 offset:27648
    v_mul_f32 v125, v125, v233
    v_mfma_f32_16x16x32_bf16 v[24:27], a[144:147], a[4:7], v[24:27]
    ds_read_b128 a[184:187], v10 offset:28672
    v_mul_f32 v126, v126, v234
    v_mfma_f32_16x16x32_bf16 v[28:31], a[148:151], a[0:3], v[28:31]
    ds_read_b128 a[188:191], v10 offset:29696
    v_fma_f32 v235, v235, v220, v220
    v_mfma_f32_16x16x32_bf16 v[32:35], a[148:151], a[4:7], v[32:35]
    ds_read_b128 a[192:195], v10 offset:30720
    v_fma_f32 v236, v236, v221, v221
    v_mfma_f32_16x16x32_bf16 v[36:39], a[152:155], a[0:3], v[36:39]
    ds_read_b128 a[196:199], v10 offset:31744
    v_mul_f32 v233, v133, v133
    v_mfma_f32_16x16x32_bf16 v[40:43], a[152:155], a[4:7], v[40:43]
    ds_read_b128 a[200:203], v10 offset:32768
    v_fma_f32 v233, v233, v218, v216
    v_mfma_f32_16x16x32_bf16 v[44:47], a[156:159], a[0:3], v[44:47]
    ds_read_b128 a[204:207], v10 offset:33792
    v_mul_f32 v233, v233, v133
    v_mfma_f32_16x16x32_bf16 v[48:51], a[156:159], a[4:7], v[48:51]
    ds_read_b128 a[208:211], v10 offset:34816
    v_mul_f32 v234, v134, v134
    v_mfma_f32_16x16x32_bf16 v[52:55], a[160:163], a[0:3], v[52:55]
    ds_read_b128 a[212:215], v10 offset:35840
    v_fma_f32 v234, v234, v218, v216
    v_mfma_f32_16x16x32_bf16 v[56:59], a[160:163], a[4:7], v[56:59]
    s_add_u32 m0, s48, 57344
    s_nop 0
    buffer_load_dwordx4 v4, s[32:35], s49 offen offset:0 lds
    v_mfma_f32_16x16x32_bf16 v[60:63], a[164:167], a[0:3], v[60:63]
    v_rcp_f32 v235, v235
    v_mfma_f32_16x16x32_bf16 v[64:67], a[164:167], a[4:7], v[64:67]
    buffer_load_dwordx4 v4, s[32:35], s49 offen offset:1024 lds
    v_mfma_f32_16x16x32_bf16 v[68:71], a[168:171], a[0:3], v[68:71]
    v_rcp_f32 v236, v236
    v_mfma_f32_16x16x32_bf16 v[72:75], a[168:171], a[4:7], v[72:75]
    buffer_load_dwordx4 v4, s[32:35], s49 offen offset:2048 lds
    v_mfma_f32_16x16x32_bf16 v[76:79], a[172:175], a[0:3], v[76:79]
    v_exp_f32 v237, v237
    v_mfma_f32_16x16x32_bf16 v[80:83], a[172:175], a[4:7], v[80:83]
    buffer_load_dwordx4 v4, s[32:35], s49 offen offset:3072 lds
    s_bfe_u32 s49, 22085, s19
    s_cmp_eq_u32 s49, s41
    s_cselect_b32 s49, s59, s49
    s_mul_i32 s49, s49, 589824
    s_add_u32 s49, s49, s15
    v_mfma_f32_16x16x32_bf16 v[84:87], a[176:179], a[0:3], v[84:87]
    v_mfma_f32_16x16x32_bf16 v[88:91], a[176:179], a[4:7], v[88:91]
    s_waitcnt vmcnt(25)
    s_barrier
    s_waitcnt lgkmcnt(0)
    v_mfma_f32_16x16x32_bf16 v[20:23], a[180:183], a[8:11], v[20:23]
    ds_read_b128 a[144:147], v8 offset:0
    v_mul_f32 v127, v127, v235
    v_mfma_f32_16x16x32_bf16 v[24:27], a[180:183], a[12:15], v[24:27]
    ds_read_b128 a[148:151], v8 offset:1024
    v_mul_f32 v128, v128, v236
    v_mfma_f32_16x16x32_bf16 v[28:31], a[184:187], a[8:11], v[28:31]
    ds_read_b128 a[152:155], v8 offset:2048
    v_fma_f32 v237, v237, v221, v221
    v_mfma_f32_16x16x32_bf16 v[32:35], a[184:187], a[12:15], v[32:35]
    ds_read_b128 a[156:159], v8 offset:3072
    v_mul_f32 v234, v234, v134
    v_mfma_f32_16x16x32_bf16 v[36:39], a[188:191], a[8:11], v[36:39]
    ds_read_b128 a[160:163], v8 offset:4096
    v_mul_f32 v235, v135, v135
    v_mfma_f32_16x16x32_bf16 v[40:43], a[188:191], a[12:15], v[40:43]
    ds_read_b128 a[164:167], v8 offset:5120
    v_fma_f32 v235, v235, v218, v216
    v_mfma_f32_16x16x32_bf16 v[44:47], a[192:195], a[8:11], v[44:47]
    ds_read_b128 a[168:171], v8 offset:6144
    v_mul_f32 v235, v235, v135
    v_mfma_f32_16x16x32_bf16 v[48:51], a[192:195], a[12:15], v[48:51]
    ds_read_b128 a[172:175], v8 offset:7168
    v_mul_f32 v236, v136, v136
    v_mfma_f32_16x16x32_bf16 v[52:55], a[196:199], a[8:11], v[52:55]
    ds_read_b128 a[176:179], v8 offset:8192
    v_fma_f32 v236, v236, v219, v217
    v_mfma_f32_16x16x32_bf16 v[56:59], a[196:199], a[12:15], v[56:59]
    buffer_load_dwordx4 a[216:219], v4, s[32:35], s51 offen offset:0
    v_mfma_f32_16x16x32_bf16 v[60:63], a[200:203], a[8:11], v[60:63]
    v_rcp_f32 v237, v237
    v_mfma_f32_16x16x32_bf16 v[64:67], a[200:203], a[12:15], v[64:67]
    buffer_load_dwordx4 a[220:223], v4, s[32:35], s51 offen offset:1024
    v_mfma_f32_16x16x32_bf16 v[68:71], a[204:207], a[8:11], v[68:71]
    v_exp_f32 v238, v238
    v_mfma_f32_16x16x32_bf16 v[72:75], a[204:207], a[12:15], v[72:75]
    buffer_load_dwordx4 a[224:227], v4, s[32:35], s51 offen offset:2048
    v_mfma_f32_16x16x32_bf16 v[76:79], a[208:211], a[8:11], v[76:79]
    v_exp_f32 v239, v239
    v_mfma_f32_16x16x32_bf16 v[80:83], a[208:211], a[12:15], v[80:83]
    buffer_load_dwordx4 a[228:231], v4, s[32:35], s51 offen offset:3072
    s_add_u32 s51, s51, 4096
    v_mfma_f32_16x16x32_bf16 v[84:87], a[212:215], a[8:11], v[84:87]
    v_mfma_f32_16x16x32_bf16 v[88:91], a[212:215], a[12:15], v[88:91]
    s_waitcnt lgkmcnt(0)
    v_mfma_f32_16x16x32_bf16 v[20:23], a[144:147], a[16:19], v[20:23]
    ds_read_b128 a[180:183], v8 offset:9216
    v_mul_f32 v129, v129, v237
    v_mfma_f32_16x16x32_bf16 v[24:27], a[144:147], a[20:23], v[24:27]
    ds_read_b128 a[184:187], v8 offset:10240
    v_fma_f32 v238, v238, v221, v221
    v_mfma_f32_16x16x32_bf16 v[28:31], a[148:151], a[16:19], v[28:31]
    ds_read_b128 a[188:191], v8 offset:11264
    v_fma_f32 v239, v239, v221, v221
    v_mfma_f32_16x16x32_bf16 v[32:35], a[148:151], a[20:23], v[32:35]
    ds_read_b128 a[192:195], v8 offset:12288
    v_mul_f32 v236, v236, v136
    v_mfma_f32_16x16x32_bf16 v[36:39], a[152:155], a[16:19], v[36:39]
    ds_read_b128 a[196:199], v8 offset:13312
    v_mul_f32 v237, v137, v137
    v_mfma_f32_16x16x32_bf16 v[40:43], a[152:155], a[20:23], v[40:43]
    ds_read_b128 a[200:203], v8 offset:14336
    v_fma_f32 v237, v237, v219, v217
    v_mfma_f32_16x16x32_bf16 v[44:47], a[156:159], a[16:19], v[44:47]
    ds_read_b128 a[204:207], v8 offset:15360
    v_mul_f32 v237, v237, v137
    v_mfma_f32_16x16x32_bf16 v[48:51], a[156:159], a[20:23], v[48:51]
    ds_read_b128 a[208:211], v8 offset:16384
    v_mfma_f32_16x16x32_bf16 v[52:55], a[160:163], a[16:19], v[52:55]
    ds_read_b128 a[212:215], v8 offset:17408
    v_mfma_f32_16x16x32_bf16 v[56:59], a[160:163], a[20:23], v[56:59]
    s_add_u32 m0, s48, 73728
    s_add_u32 s14, s49, s13
    buffer_load_dwordx4 v4, s[32:35], s49 offen offset:0 lds
    v_mfma_f32_16x16x32_bf16 v[60:63], a[164:167], a[16:19], v[60:63]
    v_rcp_f32 v238, v238
    v_mfma_f32_16x16x32_bf16 v[64:67], a[164:167], a[20:23], v[64:67]
    buffer_load_dwordx4 v4, s[32:35], s49 offen offset:1024 lds
    v_mfma_f32_16x16x32_bf16 v[68:71], a[168:171], a[16:19], v[68:71]
    v_rcp_f32 v239, v239
    v_mfma_f32_16x16x32_bf16 v[72:75], a[168:171], a[20:23], v[72:75]
    buffer_load_dwordx4 v4, s[32:35], s49 offen offset:2048 lds
    v_mfma_f32_16x16x32_bf16 v[76:79], a[172:175], a[16:19], v[76:79]
    v_exp_f32 v232, v232
    v_mfma_f32_16x16x32_bf16 v[80:83], a[172:175], a[20:23], v[80:83]
    buffer_load_dwordx4 v4, s[32:35], s49 offen offset:3072 lds
    s_add_u32 m0, s12, 73728
    s_add_u32 s49, s49, 20480
    v_mfma_f32_16x16x32_bf16 v[84:87], a[176:179], a[16:19], v[84:87]
    v_exp_f32 v233, v233
    v_mfma_f32_16x16x32_bf16 v[88:91], a[176:179], a[20:23], v[88:91]
    buffer_load_dwordx4 v4, s[32:35], s14 offen offset:0 lds
    s_waitcnt vmcnt(26)
    s_barrier
    s_waitcnt lgkmcnt(0)
    v_mfma_f32_16x16x32_bf16 v[20:23], a[180:183], a[24:27], v[20:23]
    ds_read_b128 a[144:147], v8 offset:18432
    v_mul_f32 v130, v130, v238
    v_mfma_f32_16x16x32_bf16 v[24:27], a[180:183], a[28:31], v[24:27]
    ds_read_b128 a[148:151], v8 offset:19456
    v_mul_f32 v131, v131, v239
    v_mfma_f32_16x16x32_bf16 v[28:31], a[184:187], a[24:27], v[28:31]
    ds_read_b128 a[152:155], v8 offset:20480
    v_fma_f32 v232, v232, v220, v220
    v_mfma_f32_16x16x32_bf16 v[32:35], a[184:187], a[28:31], v[32:35]
    ds_read_b128 a[156:159], v8 offset:21504
    v_fma_f32 v233, v233, v220, v220
    v_mfma_f32_16x16x32_bf16 v[36:39], a[188:191], a[24:27], v[36:39]
    ds_read_b128 a[160:163], v8 offset:22528
    v_mul_f32 v238, v138, v138
    v_mfma_f32_16x16x32_bf16 v[40:43], a[188:191], a[28:31], v[40:43]
    ds_read_b128 a[164:167], v8 offset:23552
    v_fma_f32 v238, v238, v219, v217
    v_mfma_f32_16x16x32_bf16 v[44:47], a[192:195], a[24:27], v[44:47]
    ds_read_b128 a[168:171], v8 offset:24576
    v_mul_f32 v238, v238, v138
    v_mfma_f32_16x16x32_bf16 v[48:51], a[192:195], a[28:31], v[48:51]
    ds_read_b128 a[172:175], v8 offset:25600
    v_mul_f32 v239, v139, v139
    v_mfma_f32_16x16x32_bf16 v[52:55], a[196:199], a[24:27], v[52:55]
    ds_read_b128 a[176:179], v8 offset:26624
    v_fma_f32 v239, v239, v219, v217
    v_mfma_f32_16x16x32_bf16 v[56:59], a[196:199], a[28:31], v[56:59]
    buffer_load_dwordx4 a[232:235], v4, s[32:35], s51 offen offset:0
    v_mfma_f32_16x16x32_bf16 v[60:63], a[200:203], a[24:27], v[60:63]
    v_rcp_f32 v232, v232
    v_mfma_f32_16x16x32_bf16 v[64:67], a[200:203], a[28:31], v[64:67]
    buffer_load_dwordx4 a[236:239], v4, s[32:35], s51 offen offset:1024
    v_mfma_f32_16x16x32_bf16 v[68:71], a[204:207], a[24:27], v[68:71]
    v_rcp_f32 v233, v233
    v_mfma_f32_16x16x32_bf16 v[72:75], a[204:207], a[28:31], v[72:75]
    buffer_load_dwordx4 a[240:243], v4, s[32:35], s51 offen offset:2048
    v_mfma_f32_16x16x32_bf16 v[76:79], a[208:211], a[24:27], v[76:79]
    v_exp_f32 v234, v234
    v_mfma_f32_16x16x32_bf16 v[80:83], a[208:211], a[28:31], v[80:83]
    buffer_load_dwordx4 a[244:247], v4, s[32:35], s51 offen offset:3072
    s_bfe_u32 s51, 34967, s19
    s_cmp_eq_u32 s51, s41
    s_cselect_b32 s51, s59, s51
    s_mul_i32 s51, s51, 8192
    s_add_u32 s51, s51, s18
    v_mfma_f32_16x16x32_bf16 v[84:87], a[212:215], a[24:27], v[84:87]
    v_mfma_f32_16x16x32_bf16 v[88:91], a[212:215], a[28:31], v[88:91]
    s_waitcnt lgkmcnt(0)
    v_mfma_f32_16x16x32_bf16 v[20:23], a[144:147], a[32:35], v[20:23]
    ds_read_b128 a[180:183], v8 offset:27648
    v_mul_f32 v132, v132, v232
    v_mfma_f32_16x16x32_bf16 v[24:27], a[144:147], a[36:39], v[24:27]
    ds_read_b128 a[184:187], v8 offset:28672
    v_mul_f32 v133, v133, v233
    v_mfma_f32_16x16x32_bf16 v[28:31], a[148:151], a[32:35], v[28:31]
    ds_read_b128 a[188:191], v8 offset:29696
    v_fma_f32 v234, v234, v220, v220
    v_mfma_f32_16x16x32_bf16 v[32:35], a[148:151], a[36:39], v[32:35]
    ds_read_b128 a[192:195], v8 offset:30720
    v_mul_f32 v239, v239, v139
    v_mfma_f32_16x16x32_bf16 v[36:39], a[152:155], a[32:35], v[36:39]
    ds_read_b128 a[196:199], v8 offset:31744
    v_mul_f32 v232, v140, v140
    v_mfma_f32_16x16x32_bf16 v[40:43], a[152:155], a[36:39], v[40:43]
    ds_read_b128 a[200:203], v8 offset:32768
    v_fma_f32 v232, v232, v218, v216
    v_mfma_f32_16x16x32_bf16 v[44:47], a[156:159], a[32:35], v[44:47]
    ds_read_b128 a[204:207], v8 offset:33792
    v_mul_f32 v232, v232, v140
    v_mfma_f32_16x16x32_bf16 v[48:51], a[156:159], a[36:39], v[48:51]
    ds_read_b128 a[208:211], v8 offset:34816
    v_mul_f32 v233, v141, v141
    v_mfma_f32_16x16x32_bf16 v[52:55], a[160:163], a[32:35], v[52:55]
    ds_read_b128 a[212:215], v8 offset:35840
    v_fma_f32 v233, v233, v218, v216
    v_mfma_f32_16x16x32_bf16 v[56:59], a[160:163], a[36:39], v[56:59]
    s_add_u32 m0, s48, 94208
    s_nop 0
    buffer_load_dwordx4 v4, s[32:35], s49 offen offset:0 lds
    v_mfma_f32_16x16x32_bf16 v[60:63], a[164:167], a[32:35], v[60:63]
    v_rcp_f32 v234, v234
    v_mfma_f32_16x16x32_bf16 v[64:67], a[164:167], a[36:39], v[64:67]
    buffer_load_dwordx4 v4, s[32:35], s49 offen offset:1024 lds
    v_mfma_f32_16x16x32_bf16 v[68:71], a[168:171], a[32:35], v[68:71]
    v_exp_f32 v235, v235
    v_mfma_f32_16x16x32_bf16 v[72:75], a[168:171], a[36:39], v[72:75]
    buffer_load_dwordx4 v4, s[32:35], s49 offen offset:2048 lds
    v_mfma_f32_16x16x32_bf16 v[76:79], a[172:175], a[32:35], v[76:79]
    v_exp_f32 v236, v236
    v_mfma_f32_16x16x32_bf16 v[80:83], a[172:175], a[36:39], v[80:83]
    buffer_load_dwordx4 v4, s[32:35], s49 offen offset:3072 lds
    s_bfe_u32 s49, 30054, s19
    s_cmp_eq_u32 s49, s41
    s_cselect_b32 s49, s59, s49
    s_mul_i32 s49, s49, 589824
    s_add_u32 s49, s49, s15
    v_mfma_f32_16x16x32_bf16 v[84:87], a[176:179], a[32:35], v[84:87]
    v_mfma_f32_16x16x32_bf16 v[88:91], a[176:179], a[36:39], v[88:91]
    s_waitcnt vmcnt(25)
    s_barrier
    s_waitcnt lgkmcnt(0)
    v_mfma_f32_16x16x32_bf16 v[20:23], a[180:183], a[40:43], v[20:23]
    ds_read_b128 a[144:147], v8 offset:36864
    v_mul_f32 v134, v134, v234
    v_mfma_f32_16x16x32_bf16 v[24:27], a[180:183], a[44:47], v[24:27]
    ds_read_b128 a[148:151], v8 offset:37888
    v_fma_f32 v235, v235, v220, v220
    v_mfma_f32_16x16x32_bf16 v[28:31], a[184:187], a[40:43], v[28:31]
    ds_read_b128 a[152:155], v8 offset:38912
    v_fma_f32 v236, v236, v221, v221
    v_mfma_f32_16x16x32_bf16 v[32:35], a[184:187], a[44:47], v[32:35]
    ds_read_b128 a[156:159], v8 offset:39936
    v_mul_f32 v233, v233, v141
    v_mfma_f32_16x16x32_bf16 v[36:39], a[188:191], a[40:43], v[36:39]
    ds_read_b128 a[160:163], v8 offset:40960
    v_mul_f32 v234, v142, v142
    v_mfma_f32_16x16x32_bf16 v[40:43], a[188:191], a[44:47], v[40:43]
    ds_read_b128 a[164:167], v8 offset:41984
    v_fma_f32 v234, v234, v218, v216
    v_mfma_f32_16x16x32_bf16 v[44:47], a[192:195], a[40:43], v[44:47]
    ds_read_b128 a[168:171], v8 offset:43008
    v_mul_f32 v234, v234, v142
    v_mfma_f32_16x16x32_bf16 v[48:51], a[192:195], a[44:47], v[48:51]
    ds_read_b128 a[172:175], v8 offset:44032
    v_mfma_f32_16x16x32_bf16 v[52:55], a[196:199], a[40:43], v[52:55]
    ds_read_b128 a[176:179], v8 offset:45056
    v_mfma_f32_16x16x32_bf16 v[56:59], a[196:199], a[44:47], v[56:59]
    buffer_load_dwordx4 a[0:3], v4, s[32:35], s51 offen offset:0
    v_mfma_f32_16x16x32_bf16 v[60:63], a[200:203], a[40:43], v[60:63]
    v_rcp_f32 v235, v235
    v_mfma_f32_16x16x32_bf16 v[64:67], a[200:203], a[44:47], v[64:67]
    buffer_load_dwordx4 a[4:7], v4, s[32:35], s51 offen offset:1024
    v_mfma_f32_16x16x32_bf16 v[68:71], a[204:207], a[40:43], v[68:71]
    v_rcp_f32 v236, v236
    v_mfma_f32_16x16x32_bf16 v[72:75], a[204:207], a[44:47], v[72:75]
    buffer_load_dwordx4 a[8:11], v4, s[32:35], s51 offen offset:2048
    v_mfma_f32_16x16x32_bf16 v[76:79], a[208:211], a[40:43], v[76:79]
    v_exp_f32 v237, v237
    v_mfma_f32_16x16x32_bf16 v[80:83], a[208:211], a[44:47], v[80:83]
    buffer_load_dwordx4 a[12:15], v4, s[32:35], s51 offen offset:3072
    s_add_u32 s51, s51, 4096
    v_mfma_f32_16x16x32_bf16 v[84:87], a[212:215], a[40:43], v[84:87]
    v_exp_f32 v238, v238
    v_mfma_f32_16x16x32_bf16 v[88:91], a[212:215], a[44:47], v[88:91]
    s_waitcnt lgkmcnt(0)
    v_mfma_f32_16x16x32_bf16 v[20:23], a[144:147], a[48:51], v[20:23]
    ds_read_b128 a[180:183], v8 offset:46080
    v_mul_f32 v135, v135, v235
    v_mfma_f32_16x16x32_bf16 v[24:27], a[144:147], a[52:55], v[24:27]
    ds_read_b128 a[184:187], v8 offset:47104
    v_mul_f32 v136, v136, v236
    v_mfma_f32_16x16x32_bf16 v[28:31], a[148:151], a[48:51], v[28:31]
    ds_read_b128 a[188:191], v8 offset:48128
    v_fma_f32 v237, v237, v221, v221
    v_mfma_f32_16x16x32_bf16 v[32:35], a[148:151], a[52:55], v[32:35]
    ds_read_b128 a[192:195], v8 offset:49152
    v_fma_f32 v238, v238, v221, v221
    v_mfma_f32_16x16x32_bf16 v[36:39], a[152:155], a[48:51], v[36:39]
    ds_read_b128 a[196:199], v8 offset:50176
    v_mul_f32 v235, v143, v143
    v_mfma_f32_16x16x32_bf16 v[40:43], a[152:155], a[52:55], v[40:43]
    ds_read_b128 a[200:203], v8 offset:51200
    v_fma_f32 v235, v235, v218, v216
    v_mfma_f32_16x16x32_bf16 v[44:47], a[156:159], a[48:51], v[44:47]
    ds_read_b128 a[204:207], v8 offset:52224
    v_mul_f32 v235, v235, v143
    v_mfma_f32_16x16x32_bf16 v[48:51], a[156:159], a[52:55], v[48:51]
    ds_read_b128 a[208:211], v8 offset:53248
    v_mul_f32 v236, v144, v144
    v_mfma_f32_16x16x32_bf16 v[52:55], a[160:163], a[48:51], v[52:55]
    ds_read_b128 a[212:215], v8 offset:54272
    v_fma_f32 v236, v236, v219, v217
    v_mfma_f32_16x16x32_bf16 v[56:59], a[160:163], a[52:55], v[56:59]
    s_add_u32 m0, s48, 110592
    s_add_u32 s14, s49, s13
    buffer_load_dwordx4 v4, s[32:35], s49 offen offset:0 lds
    v_mfma_f32_16x16x32_bf16 v[60:63], a[164:167], a[48:51], v[60:63]
    v_rcp_f32 v237, v237
    v_mfma_f32_16x16x32_bf16 v[64:67], a[164:167], a[52:55], v[64:67]
    buffer_load_dwordx4 v4, s[32:35], s49 offen offset:1024 lds
    v_mfma_f32_16x16x32_bf16 v[68:71], a[168:171], a[48:51], v[68:71]
    v_rcp_f32 v238, v238
    v_mfma_f32_16x16x32_bf16 v[72:75], a[168:171], a[52:55], v[72:75]
    buffer_load_dwordx4 v4, s[32:35], s49 offen offset:2048 lds
    v_mfma_f32_16x16x32_bf16 v[76:79], a[172:175], a[48:51], v[76:79]
    v_exp_f32 v239, v239
    v_mfma_f32_16x16x32_bf16 v[80:83], a[172:175], a[52:55], v[80:83]
    buffer_load_dwordx4 v4, s[32:35], s49 offen offset:3072 lds
    s_add_u32 m0, s12, 110592
    s_add_u32 s49, s49, 20480
    v_mfma_f32_16x16x32_bf16 v[84:87], a[176:179], a[48:51], v[84:87]
    v_mfma_f32_16x16x32_bf16 v[88:91], a[176:179], a[52:55], v[88:91]
    buffer_load_dwordx4 v4, s[32:35], s14 offen offset:0 lds
    s_waitcnt vmcnt(26)
    s_barrier
    s_waitcnt lgkmcnt(0)
    v_mfma_f32_16x16x32_bf16 v[20:23], a[180:183], a[56:59], v[20:23]
    ds_read_b128 a[144:147], v9 offset:0
    v_mul_f32 v137, v137, v237
    v_mfma_f32_16x16x32_bf16 v[24:27], a[180:183], a[60:63], v[24:27]
    ds_read_b128 a[148:151], v9 offset:1024
    v_mul_f32 v138, v138, v238
    v_mfma_f32_16x16x32_bf16 v[28:31], a[184:187], a[56:59], v[28:31]
    ds_read_b128 a[152:155], v9 offset:2048
    v_fma_f32 v239, v239, v221, v221
    v_mfma_f32_16x16x32_bf16 v[32:35], a[184:187], a[60:63], v[32:35]
    ds_read_b128 a[156:159], v9 offset:3072
    v_mul_f32 v236, v236, v144
    v_mfma_f32_16x16x32_bf16 v[36:39], a[188:191], a[56:59], v[36:39]
    ds_read_b128 a[160:163], v9 offset:4096
    v_mul_f32 v237, v145, v145
    v_mfma_f32_16x16x32_bf16 v[40:43], a[188:191], a[60:63], v[40:43]
    ds_read_b128 a[164:167], v9 offset:5120
    v_fma_f32 v237, v237, v219, v217
    v_mfma_f32_16x16x32_bf16 v[44:47], a[192:195], a[56:59], v[44:47]
    ds_read_b128 a[168:171], v9 offset:6144
    v_mul_f32 v237, v237, v145
    v_mfma_f32_16x16x32_bf16 v[48:51], a[192:195], a[60:63], v[48:51]
    ds_read_b128 a[172:175], v9 offset:7168
    v_mul_f32 v238, v146, v146
    v_mfma_f32_16x16x32_bf16 v[52:55], a[196:199], a[56:59], v[52:55]
    ds_read_b128 a[176:179], v9 offset:8192
    v_fma_f32 v238, v238, v219, v217
    v_mfma_f32_16x16x32_bf16 v[56:59], a[196:199], a[60:63], v[56:59]
    buffer_load_dwordx4 a[16:19], v4, s[32:35], s51 offen offset:0
    v_mfma_f32_16x16x32_bf16 v[60:63], a[200:203], a[56:59], v[60:63]
    v_rcp_f32 v239, v239
    v_mfma_f32_16x16x32_bf16 v[64:67], a[200:203], a[60:63], v[64:67]
    buffer_load_dwordx4 a[20:23], v4, s[32:35], s51 offen offset:1024
    v_mfma_f32_16x16x32_bf16 v[68:71], a[204:207], a[56:59], v[68:71]
    v_exp_f32 v232, v232
    v_mfma_f32_16x16x32_bf16 v[72:75], a[204:207], a[60:63], v[72:75]
    buffer_load_dwordx4 a[24:27], v4, s[32:35], s51 offen offset:2048
    v_mfma_f32_16x16x32_bf16 v[76:79], a[208:211], a[56:59], v[76:79]
    v_exp_f32 v233, v233
    v_mfma_f32_16x16x32_bf16 v[80:83], a[208:211], a[60:63], v[80:83]
    buffer_load_dwordx4 a[28:31], v4, s[32:35], s51 offen offset:3072
    s_bfe_u32 s51, 39561, s19
    s_cmp_eq_u32 s51, s41
    s_cselect_b32 s51, s59, s51
    s_mul_i32 s51, s51, 8192
    s_add_u32 s51, s51, s18
    v_mfma_f32_16x16x32_bf16 v[84:87], a[212:215], a[56:59], v[84:87]
    v_mfma_f32_16x16x32_bf16 v[88:91], a[212:215], a[60:63], v[88:91]
    s_waitcnt lgkmcnt(0)
    v_mfma_f32_16x16x32_bf16 v[20:23], a[144:147], a[64:67], v[20:23]
    ds_read_b128 a[180:183], v9 offset:9216
    v_mul_f32 v139, v139, v239
    v_mfma_f32_16x16x32_bf16 v[24:27], a[144:147], a[68:71], v[24:27]
    ds_read_b128 a[184:187], v9 offset:10240
    v_fma_f32 v232, v232, v220, v220
    v_mfma_f32_16x16x32_bf16 v[28:31], a[148:151], a[64:67], v[28:31]
    ds_read_b128 a[188:191], v9 offset:11264
    v_fma_f32 v233, v233, v220, v220
    v_mfma_f32_16x16x32_bf16 v[32:35], a[148:151], a[68:71], v[32:35]
    ds_read_b128 a[192:195], v9 offset:12288
    v_mul_f32 v238, v238, v146
    v_mfma_f32_16x16x32_bf16 v[36:39], a[152:155], a[64:67], v[36:39]
    ds_read_b128 a[196:199], v9 offset:13312
    v_mul_f32 v239, v147, v147
    v_mfma_f32_16x16x32_bf16 v[40:43], a[152:155], a[68:71], v[40:43]
    ds_read_b128 a[200:203], v9 offset:14336
    v_fma_f32 v239, v239, v219, v217
    v_mfma_f32_16x16x32_bf16 v[44:47], a[156:159], a[64:67], v[44:47]
    ds_read_b128 a[204:207], v9 offset:15360
    v_mul_f32 v239, v239, v147
    v_mfma_f32_16x16x32_bf16 v[48:51], a[156:159], a[68:71], v[48:51]
    ds_read_b128 a[208:211], v9 offset:16384
    v_mfma_f32_16x16x32_bf16 v[52:55], a[160:163], a[64:67], v[52:55]
    ds_read_b128 a[212:215], v9 offset:17408
    v_mfma_f32_16x16x32_bf16 v[56:59], a[160:163], a[68:71], v[56:59]
    s_add_u32 m0, s48, 131072
    s_nop 0
    buffer_load_dwordx4 v4, s[32:35], s49 offen offset:0 lds
    v_mfma_f32_16x16x32_bf16 v[60:63], a[164:167], a[64:67], v[60:63]
    v_rcp_f32 v232, v232
    v_mfma_f32_16x16x32_bf16 v[64:67], a[164:167], a[68:71], v[64:67]
    buffer_load_dwordx4 v4, s[32:35], s49 offen offset:1024 lds
    v_mfma_f32_16x16x32_bf16 v[68:71], a[168:171], a[64:67], v[68:71]
    v_rcp_f32 v233, v233
    v_mfma_f32_16x16x32_bf16 v[72:75], a[168:171], a[68:71], v[72:75]
    buffer_load_dwordx4 v4, s[32:35], s49 offen offset:2048 lds
    v_mfma_f32_16x16x32_bf16 v[76:79], a[172:175], a[64:67], v[76:79]
    v_exp_f32 v234, v234
    v_mfma_f32_16x16x32_bf16 v[80:83], a[172:175], a[68:71], v[80:83]
    buffer_load_dwordx4 v4, s[32:35], s49 offen offset:3072 lds
    s_bfe_u32 s49, 26488, s19
    s_cmp_eq_u32 s49, s41
    s_cselect_b32 s49, s59, s49
    s_mul_i32 s49, s49, 589824
    s_add_u32 s49, s49, s15
    v_mfma_f32_16x16x32_bf16 v[84:87], a[176:179], a[64:67], v[84:87]
    v_exp_f32 v235, v235
    v_mfma_f32_16x16x32_bf16 v[88:91], a[176:179], a[68:71], v[88:91]
    s_waitcnt vmcnt(25)
    s_barrier
    s_waitcnt lgkmcnt(0)
    v_mfma_f32_16x16x32_bf16 v[20:23], a[180:183], a[72:75], v[20:23]
    ds_read_b128 a[144:147], v9 offset:18432
    v_mul_f32 v140, v140, v232
    v_mfma_f32_16x16x32_bf16 v[24:27], a[180:183], a[76:79], v[24:27]
    ds_read_b128 a[148:151], v9 offset:19456
    v_mul_f32 v141, v141, v233
    v_mfma_f32_16x16x32_bf16 v[28:31], a[184:187], a[72:75], v[28:31]
    ds_read_b128 a[152:155], v9 offset:20480
    v_fma_f32 v234, v234, v220, v220
    v_mfma_f32_16x16x32_bf16 v[32:35], a[184:187], a[76:79], v[32:35]
    ds_read_b128 a[156:159], v9 offset:21504
    v_fma_f32 v235, v235, v220, v220
    v_mfma_f32_16x16x32_bf16 v[36:39], a[188:191], a[72:75], v[36:39]
    ds_read_b128 a[160:163], v9 offset:22528
    v_mul_f32 v232, v148, v148
    v_mfma_f32_16x16x32_bf16 v[40:43], a[188:191], a[76:79], v[40:43]
    ds_read_b128 a[164:167], v9 offset:23552
    v_fma_f32 v232, v232, v218, v216
    v_mfma_f32_16x16x32_bf16 v[44:47], a[192:195], a[72:75], v[44:47]
    ds_read_b128 a[168:171], v9 offset:24576
    v_mul_f32 v232, v232, v148
    v_mfma_f32_16x16x32_bf16 v[48:51], a[192:195], a[76:79], v[48:51]
    ds_read_b128 a[172:175], v9 offset:25600
    v_mul_f32 v233, v149, v149
    v_mfma_f32_16x16x32_bf16 v[52:55], a[196:199], a[72:75], v[52:55]
    ds_read_b128 a[176:179], v9 offset:26624
    v_fma_f32 v233, v233, v218, v216
    s_branch L_pgpost_kernel_8_s
.p2align 12
L_pgpost_kernel_8:
    s_branch L_hoppost_kernel_2
L_pgpost_kernel_8_s:
    v_mfma_f32_16x16x32_bf16 v[56:59], a[196:199], a[76:79], v[56:59]
    buffer_load_dwordx4 a[32:35], v4, s[32:35], s51 offen offset:0
    v_mfma_f32_16x16x32_bf16 v[60:63], a[200:203], a[72:75], v[60:63]
    v_rcp_f32 v234, v234
    v_mfma_f32_16x16x32_bf16 v[64:67], a[200:203], a[76:79], v[64:67]
    buffer_load_dwordx4 a[36:39], v4, s[32:35], s51 offen offset:1024
    v_mfma_f32_16x16x32_bf16 v[68:71], a[204:207], a[72:75], v[68:71]
    v_rcp_f32 v235, v235
    v_mfma_f32_16x16x32_bf16 v[72:75], a[204:207], a[76:79], v[72:75]
    buffer_load_dwordx4 a[40:43], v4, s[32:35], s51 offen offset:2048
    v_mfma_f32_16x16x32_bf16 v[76:79], a[208:211], a[72:75], v[76:79]
    v_exp_f32 v236, v236
    v_mfma_f32_16x16x32_bf16 v[80:83], a[208:211], a[76:79], v[80:83]
    buffer_load_dwordx4 a[44:47], v4, s[32:35], s51 offen offset:3072
    s_add_u32 s51, s51, 4096
    v_mfma_f32_16x16x32_bf16 v[84:87], a[212:215], a[72:75], v[84:87]
    v_mfma_f32_16x16x32_bf16 v[88:91], a[212:215], a[76:79], v[88:91]
    s_waitcnt lgkmcnt(0)
    v_mfma_f32_16x16x32_bf16 v[20:23], a[144:147], a[80:83], v[20:23]
    ds_read_b128 a[180:183], v9 offset:27648
    v_mul_f32 v142, v142, v234
    v_mfma_f32_16x16x32_bf16 v[24:27], a[144:147], a[84:87], v[24:27]
    ds_read_b128 a[184:187], v9 offset:28672
    v_mul_f32 v143, v143, v235
    v_mfma_f32_16x16x32_bf16 v[28:31], a[148:151], a[80:83], v[28:31]
    ds_read_b128 a[188:191], v9 offset:29696
    v_fma_f32 v236, v236, v221, v221
    v_mfma_f32_16x16x32_bf16 v[32:35], a[148:151], a[84:87], v[32:35]
    ds_read_b128 a[192:195], v9 offset:30720
    v_mul_f32 v233, v233, v149
    v_mfma_f32_16x16x32_bf16 v[36:39], a[152:155], a[80:83], v[36:39]
    ds_read_b128 a[196:199], v9 offset:31744
    v_mul_f32 v234, v150, v150
    v_mfma_f32_16x16x32_bf16 v[40:43], a[152:155], a[84:87], v[40:43]
    ds_read_b128 a[200:203], v9 offset:32768
    v_fma_f32 v234, v234, v218, v216
    v_mfma_f32_16x16x32_bf16 v[44:47], a[156:159], a[80:83], v[44:47]
    ds_read_b128 a[204:207], v9 offset:33792
    v_mul_f32 v234, v234, v150
    v_mfma_f32_16x16x32_bf16 v[48:51], a[156:159], a[84:87], v[48:51]
    ds_read_b128 a[208:211], v9 offset:34816
    v_mul_f32 v235, v151, v151
    v_mfma_f32_16x16x32_bf16 v[52:55], a[160:163], a[80:83], v[52:55]
    ds_read_b128 a[212:215], v9 offset:35840
    v_fma_f32 v235, v235, v218, v216
    v_mfma_f32_16x16x32_bf16 v[56:59], a[160:163], a[84:87], v[56:59]
    s_add_u32 m0, s48, 0
    s_add_u32 s14, s49, s13
    buffer_load_dwordx4 v4, s[32:35], s49 offen offset:0 lds
    v_mfma_f32_16x16x32_bf16 v[60:63], a[164:167], a[80:83], v[60:63]
    v_rcp_f32 v236, v236
    v_mfma_f32_16x16x32_bf16 v[64:67], a[164:167], a[84:87], v[64:67]
    buffer_load_dwordx4 v4, s[32:35], s49 offen offset:1024 lds
    v_mfma_f32_16x16x32_bf16 v[68:71], a[168:171], a[80:83], v[68:71]
    v_exp_f32 v237, v237
    v_mfma_f32_16x16x32_bf16 v[72:75], a[168:171], a[84:87], v[72:75]
    buffer_load_dwordx4 v4, s[32:35], s49 offen offset:2048 lds
    v_mfma_f32_16x16x32_bf16 v[76:79], a[172:175], a[80:83], v[76:79]
    v_exp_f32 v238, v238
    v_mfma_f32_16x16x32_bf16 v[80:83], a[172:175], a[84:87], v[80:83]
    buffer_load_dwordx4 v4, s[32:35], s49 offen offset:3072 lds
    s_add_u32 m0, s12, 0
    s_add_u32 s49, s49, 20480
    v_mfma_f32_16x16x32_bf16 v[84:87], a[176:179], a[80:83], v[84:87]
    v_mfma_f32_16x16x32_bf16 v[88:91], a[176:179], a[84:87], v[88:91]
    buffer_load_dwordx4 v4, s[32:35], s14 offen offset:0 lds
    s_waitcnt vmcnt(26)
    s_barrier
    s_waitcnt lgkmcnt(0)
    v_mfma_f32_16x16x32_bf16 v[20:23], a[180:183], a[88:91], v[20:23]
    ds_read_b128 a[144:147], v9 offset:36864
    v_mul_f32 v144, v144, v236
    v_mfma_f32_16x16x32_bf16 v[24:27], a[180:183], a[92:95], v[24:27]
    ds_read_b128 a[148:151], v9 offset:37888
    v_fma_f32 v237, v237, v221, v221
    v_mfma_f32_16x16x32_bf16 v[28:31], a[184:187], a[88:91], v[28:31]
    ds_read_b128 a[152:155], v9 offset:38912
    v_fma_f32 v238, v238, v221, v221
    v_mfma_f32_16x16x32_bf16 v[32:35], a[184:187], a[92:95], v[32:35]
    ds_read_b128 a[156:159], v9 offset:39936
    v_mul_f32 v235, v235, v151
    v_mfma_f32_16x16x32_bf16 v[36:39], a[188:191], a[88:91], v[36:39]
    ds_read_b128 a[160:163], v9 offset:40960
    v_mul_f32 v236, v152, v152
    v_mfma_f32_16x16x32_bf16 v[40:43], a[188:191], a[92:95], v[40:43]
    ds_read_b128 a[164:167], v9 offset:41984
    v_fma_f32 v236, v236, v219, v217
    v_mfma_f32_16x16x32_bf16 v[44:47], a[192:195], a[88:91], v[44:47]
    ds_read_b128 a[168:171], v9 offset:43008
    v_mul_f32 v236, v236, v152
    v_mfma_f32_16x16x32_bf16 v[48:51], a[192:195], a[92:95], v[48:51]
    ds_read_b128 a[172:175], v9 offset:44032
    v_mfma_f32_16x16x32_bf16 v[52:55], a[196:199], a[88:91], v[52:55]
    ds_read_b128 a[176:179], v9 offset:45056
    v_mfma_f32_16x16x32_bf16 v[56:59], a[196:199], a[92:95], v[56:59]
    buffer_load_dwordx4 a[48:51], v4, s[32:35], s51 offen offset:0
    v_mfma_f32_16x16x32_bf16 v[60:63], a[200:203], a[88:91], v[60:63]
    v_rcp_f32 v237, v237
    v_mfma_f32_16x16x32_bf16 v[64:67], a[200:203], a[92:95], v[64:67]
    buffer_load_dwordx4 a[52:55], v4, s[32:35], s51 offen offset:1024
    v_mfma_f32_16x16x32_bf16 v[68:71], a[204:207], a[88:91], v[68:71]
    v_rcp_f32 v238, v238
    v_mfma_f32_16x16x32_bf16 v[72:75], a[204:207], a[92:95], v[72:75]
    buffer_load_dwordx4 a[56:59], v4, s[32:35], s51 offen offset:2048
    v_mfma_f32_16x16x32_bf16 v[76:79], a[208:211], a[88:91], v[76:79]
    v_exp_f32 v239, v239
    v_mfma_f32_16x16x32_bf16 v[80:83], a[208:211], a[92:95], v[80:83]
    buffer_load_dwordx4 a[60:63], v4, s[32:35], s51 offen offset:3072
    s_bfe_u32 s51, 47530, s19
    s_cmp_eq_u32 s51, s41
    s_cselect_b32 s51, s59, s51
    s_mul_i32 s51, s51, 8192
    s_add_u32 s51, s51, s18
    v_mfma_f32_16x16x32_bf16 v[84:87], a[212:215], a[88:91], v[84:87]
    v_exp_f32 v232, v232
    v_mfma_f32_16x16x32_bf16 v[88:91], a[212:215], a[92:95], v[88:91]
    s_waitcnt lgkmcnt(0)
    v_mfma_f32_16x16x32_bf16 v[20:23], a[144:147], a[96:99], v[20:23]
    ds_read_b128 a[180:183], v9 offset:46080
    v_mul_f32 v145, v145, v237
    v_mfma_f32_16x16x32_bf16 v[24:27], a[144:147], a[100:103], v[24:27]
    ds_read_b128 a[184:187], v9 offset:47104
    v_mul_f32 v146, v146, v238
    v_mfma_f32_16x16x32_bf16 v[28:31], a[148:151], a[96:99], v[28:31]
    ds_read_b128 a[188:191], v9 offset:48128
    v_fma_f32 v239, v239, v221, v221
    v_mfma_f32_16x16x32_bf16 v[32:35], a[148:151], a[100:103], v[32:35]
    ds_read_b128 a[192:195], v9 offset:49152
    v_fma_f32 v232, v232, v220, v220
    v_mfma_f32_16x16x32_bf16 v[36:39], a[152:155], a[96:99], v[36:39]
    ds_read_b128 a[196:199], v9 offset:50176
    v_mul_f32 v237, v153, v153
    v_mfma_f32_16x16x32_bf16 v[40:43], a[152:155], a[100:103], v[40:43]
    ds_read_b128 a[200:203], v9 offset:51200
    v_fma_f32 v237, v237, v219, v217
    v_mfma_f32_16x16x32_bf16 v[44:47], a[156:159], a[96:99], v[44:47]
    ds_read_b128 a[204:207], v9 offset:52224
    v_mul_f32 v237, v237, v153
    v_mfma_f32_16x16x32_bf16 v[48:51], a[156:159], a[100:103], v[48:51]
    ds_read_b128 a[208:211], v9 offset:53248
    v_mul_f32 v238, v154, v154
    v_mfma_f32_16x16x32_bf16 v[52:55], a[160:163], a[96:99], v[52:55]
    ds_read_b128 a[212:215], v9 offset:54272
    v_fma_f32 v238, v238, v219, v217
    v_mfma_f32_16x16x32_bf16 v[56:59], a[160:163], a[100:103], v[56:59]
    s_add_u32 m0, s48, 20480
    s_nop 0
    buffer_load_dwordx4 v4, s[32:35], s49 offen offset:0 lds
    v_mfma_f32_16x16x32_bf16 v[60:63], a[164:167], a[96:99], v[60:63]
    v_rcp_f32 v239, v239
    v_mfma_f32_16x16x32_bf16 v[64:67], a[164:167], a[100:103], v[64:67]
    buffer_load_dwordx4 v4, s[32:35], s49 offen offset:1024 lds
    v_mfma_f32_16x16x32_bf16 v[68:71], a[168:171], a[96:99], v[68:71]
    v_rcp_f32 v232, v232
    v_mfma_f32_16x16x32_bf16 v[72:75], a[168:171], a[100:103], v[72:75]
    buffer_load_dwordx4 v4, s[32:35], s49 offen offset:2048 lds
    v_mfma_f32_16x16x32_bf16 v[76:79], a[172:175], a[96:99], v[76:79]
    v_exp_f32 v233, v233
    v_mfma_f32_16x16x32_bf16 v[80:83], a[172:175], a[100:103], v[80:83]
    buffer_load_dwordx4 v4, s[32:35], s49 offen offset:3072 lds
    s_bfe_u32 s49, 34967, s19
    s_cmp_eq_u32 s49, s41
    s_cselect_b32 s49, s59, s49
    s_mul_i32 s49, s49, 589824
    s_add_u32 s49, s49, s15
    v_mfma_f32_16x16x32_bf16 v[84:87], a[176:179], a[96:99], v[84:87]
    v_mfma_f32_16x16x32_bf16 v[88:91], a[176:179], a[100:103], v[88:91]
    s_waitcnt vmcnt(25)
    s_barrier
    s_waitcnt lgkmcnt(0)
    v_mfma_f32_16x16x32_bf16 v[20:23], a[180:183], a[104:107], v[20:23]
    ds_read_b128 a[144:147], v10 offset:0
    v_mul_f32 v147, v147, v239
    v_mfma_f32_16x16x32_bf16 v[24:27], a[180:183], a[108:111], v[24:27]
    ds_read_b128 a[148:151], v10 offset:1024
    v_mul_f32 v148, v148, v232
    v_mfma_f32_16x16x32_bf16 v[28:31], a[184:187], a[104:107], v[28:31]
    ds_read_b128 a[152:155], v10 offset:2048
    v_fma_f32 v233, v233, v220, v220
    v_mfma_f32_16x16x32_bf16 v[32:35], a[184:187], a[108:111], v[32:35]
    ds_read_b128 a[156:159], v10 offset:3072
    v_mul_f32 v238, v238, v154
    v_mfma_f32_16x16x32_bf16 v[36:39], a[188:191], a[104:107], v[36:39]
    ds_read_b128 a[160:163], v10 offset:4096
    v_mul_f32 v239, v155, v155
    v_mfma_f32_16x16x32_bf16 v[40:43], a[188:191], a[108:111], v[40:43]
    ds_read_b128 a[164:167], v10 offset:5120
    v_fma_f32 v239, v239, v219, v217
    v_mfma_f32_16x16x32_bf16 v[44:47], a[192:195], a[104:107], v[44:47]
    ds_read_b128 a[168:171], v10 offset:6144
    v_mul_f32 v239, v239, v155
    v_mfma_f32_16x16x32_bf16 v[48:51], a[192:195], a[108:111], v[48:51]
    ds_read_b128 a[172:175], v10 offset:7168
    v_mul_f32 v232, v156, v156
    v_mfma_f32_16x16x32_bf16 v[52:55], a[196:199], a[104:107], v[52:55]
    ds_read_b128 a[176:179], v10 offset:8192
    v_fma_f32 v232, v232, v218, v216
    v_mfma_f32_16x16x32_bf16 v[56:59], a[196:199], a[108:111], v[56:59]
    buffer_load_dwordx4 a[64:67], v4, s[32:35], s51 offen offset:0
    v_mfma_f32_16x16x32_bf16 v[60:63], a[200:203], a[104:107], v[60:63]
    v_rcp_f32 v233, v233
    v_mfma_f32_16x16x32_bf16 v[64:67], a[200:203], a[108:111], v[64:67]
    buffer_load_dwordx4 a[68:71], v4, s[32:35], s51 offen offset:1024
    v_mfma_f32_16x16x32_bf16 v[68:71], a[204:207], a[104:107], v[68:71]
    v_exp_f32 v234, v234
    v_mfma_f32_16x16x32_bf16 v[72:75], a[204:207], a[108:111], v[72:75]
    buffer_load_dwordx4 a[72:75], v4, s[32:35], s51 offen offset:2048
    v_mfma_f32_16x16x32_bf16 v[76:79], a[208:211], a[104:107], v[76:79]
    v_exp_f32 v235, v235
    v_mfma_f32_16x16x32_bf16 v[80:83], a[208:211], a[108:111], v[80:83]
    buffer_load_dwordx4 a[76:79], v4, s[32:35], s51 offen offset:3072
    s_add_u32 s51, s51, 4096
    v_mfma_f32_16x16x32_bf16 v[84:87], a[212:215], a[104:107], v[84:87]
    v_mfma_f32_16x16x32_bf16 v[88:91], a[212:215], a[108:111], v[88:91]
    s_waitcnt lgkmcnt(0)
    v_mfma_f32_16x16x32_bf16 v[20:23], a[144:147], a[112:115], v[20:23]
    ds_read_b128 a[180:183], v10 offset:9216
    v_mfma_f32_16x16x32_bf16 v[24:27], a[144:147], a[116:119], v[24:27]
    ds_read_b128 a[184:187], v10 offset:10240
    s_add_u32 m0, s48, 36864
    s_add_u32 s14, s49, s13
    buffer_load_dwordx4 v4, s[32:35], s49 offen offset:0 lds
    v_mfma_f32_16x16x32_bf16 v[28:31], a[148:151], a[112:115], v[28:31]
    ds_read_b128 a[188:191], v10 offset:11264
    v_mfma_f32_16x16x32_bf16 v[32:35], a[148:151], a[116:119], v[32:35]
    ds_read_b128 a[192:195], v10 offset:12288
    buffer_load_dwordx4 v4, s[32:35], s49 offen offset:1024 lds
    v_mfma_f32_16x16x32_bf16 v[36:39], a[152:155], a[112:115], v[36:39]
    ds_read_b128 a[196:199], v10 offset:13312
    v_mfma_f32_16x16x32_bf16 v[40:43], a[152:155], a[116:119], v[40:43]
    ds_read_b128 a[200:203], v10 offset:14336
    buffer_load_dwordx4 v4, s[32:35], s49 offen offset:2048 lds
    v_mfma_f32_16x16x32_bf16 v[44:47], a[156:159], a[112:115], v[44:47]
    ds_read_b128 a[204:207], v10 offset:15360
    v_mfma_f32_16x16x32_bf16 v[48:51], a[156:159], a[116:119], v[48:51]
    ds_read_b128 a[208:211], v10 offset:16384
    buffer_load_dwordx4 v4, s[32:35], s49 offen offset:3072 lds
    s_add_u32 m0, s12, 36864
    s_add_u32 s49, s49, 20480
    v_mfma_f32_16x16x32_bf16 v[52:55], a[160:163], a[112:115], v[52:55]
    ds_read_b128 a[212:215], v10 offset:17408
    v_mfma_f32_16x16x32_bf16 v[56:59], a[160:163], a[116:119], v[56:59]
    buffer_load_dwordx4 v4, s[32:35], s14 offen offset:0 lds
    v_mfma_f32_16x16x32_bf16 v[60:63], a[164:167], a[112:115], v[60:63]
    v_mfma_f32_16x16x32_bf16 v[64:67], a[164:167], a[116:119], v[64:67]
    s_add_u32 m0, s48, 57344
    s_nop 0
    buffer_load_dwordx4 v4, s[32:35], s49 offen offset:0 lds
    v_mfma_f32_16x16x32_bf16 v[68:71], a[168:171], a[112:115], v[68:71]
    v_mfma_f32_16x16x32_bf16 v[72:75], a[168:171], a[116:119], v[72:75]
    buffer_load_dwordx4 v4, s[32:35], s49 offen offset:1024 lds
    v_mfma_f32_16x16x32_bf16 v[76:79], a[172:175], a[112:115], v[76:79]
    v_mfma_f32_16x16x32_bf16 v[80:83], a[172:175], a[116:119], v[80:83]
    buffer_load_dwordx4 v4, s[32:35], s49 offen offset:2048 lds
    v_mfma_f32_16x16x32_bf16 v[84:87], a[176:179], a[112:115], v[84:87]
    buffer_load_dwordx4 v4, s[32:35], s49 offen offset:3072 lds
    s_bfe_u32 s49, 39561, s19
    s_cmp_eq_u32 s49, s41
    s_cselect_b32 s49, s59, s49
    s_mul_i32 s49, s49, 589824
    s_add_u32 s49, s49, s15
    v_mfma_f32_16x16x32_bf16 v[88:91], a[176:179], a[116:119], v[88:91]
    s_waitcnt vmcnt(30)
    s_barrier
    s_waitcnt lgkmcnt(0)
    v_mfma_f32_16x16x32_bf16 v[20:23], a[180:183], a[120:123], v[20:23]
    ds_read_b128 a[144:147], v10 offset:18432
    v_mul_f32 v149, v149, v233
    v_mfma_f32_16x16x32_bf16 v[24:27], a[180:183], a[124:127], v[24:27]
    ds_read_b128 a[148:151], v10 offset:19456
    v_fma_f32 v234, v234, v220, v220
    v_mfma_f32_16x16x32_bf16 v[28:31], a[184:187], a[120:123], v[28:31]
    ds_read_b128 a[152:155], v10 offset:20480
    v_fma_f32 v235, v235, v220, v220
    v_mfma_f32_16x16x32_bf16 v[32:35], a[184:187], a[124:127], v[32:35]
    ds_read_b128 a[156:159], v10 offset:21504
    v_mul_f32 v232, v232, v156
    v_mfma_f32_16x16x32_bf16 v[36:39], a[188:191], a[120:123], v[36:39]
    ds_read_b128 a[160:163], v10 offset:22528
    v_mul_f32 v233, v157, v157
    v_mfma_f32_16x16x32_bf16 v[40:43], a[188:191], a[124:127], v[40:43]
    ds_read_b128 a[164:167], v10 offset:23552
    v_fma_f32 v233, v233, v218, v216
    v_mfma_f32_16x16x32_bf16 v[44:47], a[192:195], a[120:123], v[44:47]
    ds_read_b128 a[168:171], v10 offset:24576
    v_mul_f32 v233, v233, v157
    v_mfma_f32_16x16x32_bf16 v[48:51], a[192:195], a[124:127], v[48:51]
    ds_read_b128 a[172:175], v10 offset:25600
    v_mfma_f32_16x16x32_bf16 v[52:55], a[196:199], a[120:123], v[52:55]
    ds_read_b128 a[176:179], v10 offset:26624
    v_mfma_f32_16x16x32_bf16 v[56:59], a[196:199], a[124:127], v[56:59]
    buffer_load_dwordx4 a[80:83], v4, s[32:35], s51 offen offset:0
    v_mfma_f32_16x16x32_bf16 v[60:63], a[200:203], a[120:123], v[60:63]
    v_rcp_f32 v234, v234
    v_mfma_f32_16x16x32_bf16 v[64:67], a[200:203], a[124:127], v[64:67]
    buffer_load_dwordx4 a[84:87], v4, s[32:35], s51 offen offset:1024
    v_mfma_f32_16x16x32_bf16 v[68:71], a[204:207], a[120:123], v[68:71]
    v_rcp_f32 v235, v235
    v_mfma_f32_16x16x32_bf16 v[72:75], a[204:207], a[124:127], v[72:75]
    buffer_load_dwordx4 a[88:91], v4, s[32:35], s51 offen offset:2048
    v_mfma_f32_16x16x32_bf16 v[76:79], a[208:211], a[120:123], v[76:79]
    v_exp_f32 v236, v236
    v_mfma_f32_16x16x32_bf16 v[80:83], a[208:211], a[124:127], v[80:83]
    buffer_load_dwordx4 a[92:95], v4, s[32:35], s51 offen offset:3072
    s_bfe_u32 s51, 43963, s19
    s_cmp_eq_u32 s51, s41
    s_cselect_b32 s51, s59, s51
    s_mul_i32 s51, s51, 8192
    s_add_u32 s51, s51, s18
    v_mfma_f32_16x16x32_bf16 v[84:87], a[212:215], a[120:123], v[84:87]
    v_exp_f32 v237, v237
    v_mfma_f32_16x16x32_bf16 v[88:91], a[212:215], a[124:127], v[88:91]
    s_waitcnt lgkmcnt(0)
    v_mfma_f32_16x16x32_bf16 v[20:23], a[144:147], a[128:131], v[20:23]
    ds_read_b128 a[180:183], v10 offset:27648
    v_mfma_f32_16x16x32_bf16 v[24:27], a[144:147], a[132:135], v[24:27]
    ds_read_b128 a[184:187], v10 offset:28672
    s_add_u32 m0, s48, 73728
    s_add_u32 s14, s49, s13
    buffer_load_dwordx4 v4, s[32:35], s49 offen offset:0 lds
    v_mfma_f32_16x16x32_bf16 v[28:31], a[148:151], a[128:131], v[28:31]
    ds_read_b128 a[188:191], v10 offset:29696
    v_mfma_f32_16x16x32_bf16 v[32:35], a[148:151], a[132:135], v[32:35]
    ds_read_b128 a[192:195], v10 offset:30720
    buffer_load_dwordx4 v4, s[32:35], s49 offen offset:1024 lds
    v_mfma_f32_16x16x32_bf16 v[36:39], a[152:155], a[128:131], v[36:39]
    ds_read_b128 a[196:199], v10 offset:31744
    v_mfma_f32_16x16x32_bf16 v[40:43], a[152:155], a[132:135], v[40:43]
    ds_read_b128 a[200:203], v10 offset:32768
    buffer_load_dwordx4 v4, s[32:35], s49 offen offset:2048 lds
    v_mfma_f32_16x16x32_bf16 v[44:47], a[156:159], a[128:131], v[44:47]
    ds_read_b128 a[204:207], v10 offset:33792
    v_mfma_f32_16x16x32_bf16 v[48:51], a[156:159], a[132:135], v[48:51]
    ds_read_b128 a[208:211], v10 offset:34816
    buffer_load_dwordx4 v4, s[32:35], s49 offen offset:3072 lds
    s_add_u32 m0, s12, 73728
    s_add_u32 s49, s49, 20480
    v_mfma_f32_16x16x32_bf16 v[52:55], a[160:163], a[128:131], v[52:55]
    ds_read_b128 a[212:215], v10 offset:35840
    v_mfma_f32_16x16x32_bf16 v[56:59], a[160:163], a[132:135], v[56:59]
    buffer_load_dwordx4 v4, s[32:35], s14 offen offset:0 lds
    v_mfma_f32_16x16x32_bf16 v[60:63], a[164:167], a[128:131], v[60:63]
    v_mfma_f32_16x16x32_bf16 v[64:67], a[164:167], a[132:135], v[64:67]
    s_add_u32 m0, s48, 94208
    s_nop 0
    buffer_load_dwordx4 v4, s[32:35], s49 offen offset:0 lds
    v_mfma_f32_16x16x32_bf16 v[68:71], a[168:171], a[128:131], v[68:71]
    v_mfma_f32_16x16x32_bf16 v[72:75], a[168:171], a[132:135], v[72:75]
    buffer_load_dwordx4 v4, s[32:35], s49 offen offset:1024 lds
    v_mfma_f32_16x16x32_bf16 v[76:79], a[172:175], a[128:131], v[76:79]
    v_mfma_f32_16x16x32_bf16 v[80:83], a[172:175], a[132:135], v[80:83]
    buffer_load_dwordx4 v4, s[32:35], s49 offen offset:2048 lds
    v_mfma_f32_16x16x32_bf16 v[84:87], a[176:179], a[128:131], v[84:87]
    buffer_load_dwordx4 v4, s[32:35], s49 offen offset:3072 lds
    s_bfe_u32 s49, 47530, s19
    s_cmp_eq_u32 s49, s41
    s_cselect_b32 s49, s59, s49
    s_mul_i32 s49, s49, 589824
    s_add_u32 s49, s49, s15
    v_mfma_f32_16x16x32_bf16 v[88:91], a[176:179], a[132:135], v[88:91]
    s_waitcnt vmcnt(34)
    s_barrier
    s_waitcnt lgkmcnt(0)
    v_mfma_f32_16x16x32_bf16 v[20:23], a[180:183], a[136:139], v[20:23]
    ds_read_b128 a[144:147], v8 offset:0
    v_mul_f32 v150, v150, v234
    v_mfma_f32_16x16x32_bf16 v[24:27], a[180:183], a[140:143], v[24:27]
    ds_read_b128 a[148:151], v8 offset:1024
    v_mul_f32 v151, v151, v235
    v_mfma_f32_16x16x32_bf16 v[28:31], a[184:187], a[136:139], v[28:31]
    ds_read_b128 a[152:155], v8 offset:2048
    v_fma_f32 v236, v236, v221, v221
    v_mfma_f32_16x16x32_bf16 v[32:35], a[184:187], a[140:143], v[32:35]
    ds_read_b128 a[156:159], v8 offset:3072
    v_fma_f32 v237, v237, v221, v221
    v_mfma_f32_16x16x32_bf16 v[36:39], a[188:191], a[136:139], v[36:39]
    ds_read_b128 a[160:163], v8 offset:4096
    v_mul_f32 v234, v158, v158
    v_mfma_f32_16x16x32_bf16 v[40:43], a[188:191], a[140:143], v[40:43]
    ds_read_b128 a[164:167], v8 offset:5120
    v_fma_f32 v234, v234, v218, v216
    v_mfma_f32_16x16x32_bf16 v[44:47], a[192:195], a[136:139], v[44:47]
    ds_read_b128 a[168:171], v8 offset:6144
    v_mul_f32 v234, v234, v158
    v_mfma_f32_16x16x32_bf16 v[48:51], a[192:195], a[140:143], v[48:51]
    ds_read_b128 a[172:175], v8 offset:7168
    v_mul_f32 v235, v159, v159
    v_mfma_f32_16x16x32_bf16 v[52:55], a[196:199], a[136:139], v[52:55]
    ds_read_b128 a[176:179], v8 offset:8192
    v_fma_f32 v235, v235, v218, v216
    v_mfma_f32_16x16x32_bf16 v[56:59], a[196:199], a[140:143], v[56:59]
    buffer_load_dwordx4 a[96:99], v4, s[32:35], s51 offen offset:0
    v_mfma_f32_16x16x32_bf16 v[60:63], a[200:203], a[136:139], v[60:63]
    v_rcp_f32 v236, v236
    v_mfma_f32_16x16x32_bf16 v[64:67], a[200:203], a[140:143], v[64:67]
    buffer_load_dwordx4 a[100:103], v4, s[32:35], s51 offen offset:1024
    v_mfma_f32_16x16x32_bf16 v[68:71], a[204:207], a[136:139], v[68:71]
    v_rcp_f32 v237, v237
    v_mfma_f32_16x16x32_bf16 v[72:75], a[204:207], a[140:143], v[72:75]
    buffer_load_dwordx4 a[104:107], v4, s[32:35], s51 offen offset:2048
    v_mfma_f32_16x16x32_bf16 v[76:79], a[208:211], a[136:139], v[76:79]
    v_exp_f32 v238, v238
    v_mfma_f32_16x16x32_bf16 v[80:83], a[208:211], a[140:143], v[80:83]
    buffer_load_dwordx4 a[108:111], v4, s[32:35], s51 offen offset:3072
    s_add_u32 s51, s51, 4096
    v_mfma_f32_16x16x32_bf16 v[84:87], a[212:215], a[136:139], v[84:87]
    v_mfma_f32_16x16x32_bf16 v[88:91], a[212:215], a[140:143], v[88:91]
    s_waitcnt lgkmcnt(0)
    v_mfma_f32_16x16x32_bf16 v[20:23], a[144:147], a[216:219], v[20:23]
    ds_read_b128 a[180:183], v8 offset:9216
    v_mul_f32 v152, v152, v236
    v_mfma_f32_16x16x32_bf16 v[24:27], a[144:147], a[220:223], v[24:27]
    ds_read_b128 a[184:187], v8 offset:10240
    v_mul_f32 v153, v153, v237
    v_mfma_f32_16x16x32_bf16 v[28:31], a[148:151], a[216:219], v[28:31]
    ds_read_b128 a[188:191], v8 offset:11264
    v_fma_f32 v238, v238, v221, v221
    v_mfma_f32_16x16x32_bf16 v[32:35], a[148:151], a[220:223], v[32:35]
    ds_read_b128 a[192:195], v8 offset:12288
    v_mul_f32 v235, v235, v159
    v_mfma_f32_16x16x32_bf16 v[36:39], a[152:155], a[216:219], v[36:39]
    ds_read_b128 a[196:199], v8 offset:13312
    v_mul_f32 v236, v160, v160
    v_mfma_f32_16x16x32_bf16 v[40:43], a[152:155], a[220:223], v[40:43]
    ds_read_b128 a[200:203], v8 offset:14336
    v_fma_f32 v236, v236, v219, v217
    v_mfma_f32_16x16x32_bf16 v[44:47], a[156:159], a[216:219], v[44:47]
    ds_read_b128 a[204:207], v8 offset:15360
    v_mul_f32 v236, v236, v160
    v_mfma_f32_16x16x32_bf16 v[48:51], a[156:159], a[220:223], v[48:51]
    ds_read_b128 a[208:211], v8 offset:16384
    v_mul_f32 v237, v161, v161
    v_mfma_f32_16x16x32_bf16 v[52:55], a[160:163], a[216:219], v[52:55]
    ds_read_b128 a[212:215], v8 offset:17408
    v_fma_f32 v237, v237, v219, v217
    v_mfma_f32_16x16x32_bf16 v[56:59], a[160:163], a[220:223], v[56:59]
    s_add_u32 m0, s48, 110592
    s_add_u32 s14, s49, s13
    buffer_load_dwordx4 v4, s[32:35], s49 offen offset:0 lds
    v_mfma_f32_16x16x32_bf16 v[60:63], a[164:167], a[216:219], v[60:63]
    v_rcp_f32 v238, v238
    v_mfma_f32_16x16x32_bf16 v[64:67], a[164:167], a[220:223], v[64:67]
    buffer_load_dwordx4 v4, s[32:35], s49 offen offset:1024 lds
    v_mfma_f32_16x16x32_bf16 v[68:71], a[168:171], a[216:219], v[68:71]
    v_exp_f32 v239, v239
    v_mfma_f32_16x16x32_bf16 v[72:75], a[168:171], a[220:223], v[72:75]
    buffer_load_dwordx4 v4, s[32:35], s49 offen offset:2048 lds
    v_mfma_f32_16x16x32_bf16 v[76:79], a[172:175], a[216:219], v[76:79]
    v_exp_f32 v232, v232
    v_mfma_f32_16x16x32_bf16 v[80:83], a[172:175], a[220:223], v[80:83]
    buffer_load_dwordx4 v4, s[32:35], s49 offen offset:3072 lds
    s_add_u32 m0, s12, 110592
    s_add_u32 s49, s49, 20480
    v_mfma_f32_16x16x32_bf16 v[84:87], a[176:179], a[216:219], v[84:87]
    v_mfma_f32_16x16x32_bf16 v[88:91], a[176:179], a[220:223], v[88:91]
    buffer_load_dwordx4 v4, s[32:35], s14 offen offset:0 lds
    s_waitcnt vmcnt(35)
    s_barrier
    s_waitcnt lgkmcnt(0)
    v_mfma_f32_16x16x32_bf16 v[20:23], a[180:183], a[224:227], v[20:23]
    ds_read_b128 a[144:147], v8 offset:18432
    v_mul_f32 v154, v154, v238
    v_mfma_f32_16x16x32_bf16 v[24:27], a[180:183], a[228:231], v[24:27]
    ds_read_b128 a[148:151], v8 offset:19456
    v_fma_f32 v239, v239, v221, v221
    v_mfma_f32_16x16x32_bf16 v[28:31], a[184:187], a[224:227], v[28:31]
    ds_read_b128 a[152:155], v8 offset:20480
    v_fma_f32 v232, v232, v220, v220
    v_mfma_f32_16x16x32_bf16 v[32:35], a[184:187], a[228:231], v[32:35]
    ds_read_b128 a[156:159], v8 offset:21504
    v_mul_f32 v237, v237, v161
    v_mfma_f32_16x16x32_bf16 v[36:39], a[188:191], a[224:227], v[36:39]
    ds_read_b128 a[160:163], v8 offset:22528
    v_mul_f32 v238, v162, v162
    v_mfma_f32_16x16x32_bf16 v[40:43], a[188:191], a[228:231], v[40:43]
    ds_read_b128 a[164:167], v8 offset:23552
    v_fma_f32 v238, v238, v219, v217
    v_mfma_f32_16x16x32_bf16 v[44:47], a[192:195], a[224:227], v[44:47]
    ds_read_b128 a[168:171], v8 offset:24576
    v_mul_f32 v238, v238, v162
    v_mfma_f32_16x16x32_bf16 v[48:51], a[192:195], a[228:231], v[48:51]
    ds_read_b128 a[172:175], v8 offset:25600
    v_mfma_f32_16x16x32_bf16 v[52:55], a[196:199], a[224:227], v[52:55]
    ds_read_b128 a[176:179], v8 offset:26624
    v_mfma_f32_16x16x32_bf16 v[56:59], a[196:199], a[228:231], v[56:59]
    buffer_load_dwordx4 a[112:115], v4, s[32:35], s51 offen offset:0
    v_mfma_f32_16x16x32_bf16 v[60:63], a[200:203], a[224:227], v[60:63]
    v_rcp_f32 v239, v239
    v_mfma_f32_16x16x32_bf16 v[64:67], a[200:203], a[228:231], v[64:67]
    buffer_load_dwordx4 a[116:119], v4, s[32:35], s51 offen offset:1024
    v_mfma_f32_16x16x32_bf16 v[68:71], a[204:207], a[224:227], v[68:71]
    v_rcp_f32 v232, v232
    v_mfma_f32_16x16x32_bf16 v[72:75], a[204:207], a[228:231], v[72:75]
    buffer_load_dwordx4 a[120:123], v4, s[32:35], s51 offen offset:2048
    v_mfma_f32_16x16x32_bf16 v[76:79], a[208:211], a[224:227], v[76:79]
    v_exp_f32 v233, v233
    v_mfma_f32_16x16x32_bf16 v[80:83], a[208:211], a[228:231], v[80:83]
    buffer_load_dwordx4 a[124:127], v4, s[32:35], s51 offen offset:3072
    v_mfma_f32_16x16x32_bf16 v[84:87], a[212:215], a[224:227], v[84:87]
    v_exp_f32 v234, v234
    v_mfma_f32_16x16x32_bf16 v[88:91], a[212:215], a[228:231], v[88:91]
    s_waitcnt lgkmcnt(0)
    v_mfma_f32_16x16x32_bf16 v[20:23], a[144:147], a[232:235], v[20:23]
    ds_read_b128 a[180:183], v8 offset:27648
    v_mul_f32 v155, v155, v239
    v_mfma_f32_16x16x32_bf16 v[24:27], a[144:147], a[236:239], v[24:27]
    ds_read_b128 a[184:187], v8 offset:28672
    v_mul_f32 v156, v156, v232
    v_mfma_f32_16x16x32_bf16 v[28:31], a[148:151], a[232:235], v[28:31]
    ds_read_b128 a[188:191], v8 offset:29696
    v_fma_f32 v233, v233, v220, v220
    v_mfma_f32_16x16x32_bf16 v[32:35], a[148:151], a[236:239], v[32:35]
    ds_read_b128 a[192:195], v8 offset:30720
    v_fma_f32 v234, v234, v220, v220
    v_mfma_f32_16x16x32_bf16 v[36:39], a[152:155], a[232:235], v[36:39]
    ds_read_b128 a[196:199], v8 offset:31744
    v_mul_f32 v239, v163, v163
    v_mfma_f32_16x16x32_bf16 v[40:43], a[152:155], a[236:239], v[40:43]
    ds_read_b128 a[200:203], v8 offset:32768
    v_fma_f32 v239, v239, v219, v217
    v_mfma_f32_16x16x32_bf16 v[44:47], a[156:159], a[232:235], v[44:47]
    ds_read_b128 a[204:207], v8 offset:33792
    v_mul_f32 v239, v239, v163
    v_mfma_f32_16x16x32_bf16 v[48:51], a[156:159], a[236:239], v[48:51]
    ds_read_b128 a[208:211], v8 offset:34816
    v_mfma_f32_16x16x32_bf16 v[52:55], a[160:163], a[232:235], v[52:55]
    ds_read_b128 a[212:215], v8 offset:35840
    v_mfma_f32_16x16x32_bf16 v[56:59], a[160:163], a[236:239], v[56:59]
    s_add_u32 m0, s48, 131072
    s_nop 0
    buffer_load_dwordx4 v4, s[32:35], s49 offen offset:0 lds
    v_mfma_f32_16x16x32_bf16 v[60:63], a[164:167], a[232:235], v[60:63]
    v_rcp_f32 v233, v233
    v_mfma_f32_16x16x32_bf16 v[64:67], a[164:167], a[236:239], v[64:67]
    buffer_load_dwordx4 v4, s[32:35], s49 offen offset:1024 lds
    v_mfma_f32_16x16x32_bf16 v[68:71], a[168:171], a[232:235], v[68:71]
    v_rcp_f32 v234, v234
    v_mfma_f32_16x16x32_bf16 v[72:75], a[168:171], a[236:239], v[72:75]
    buffer_load_dwordx4 v4, s[32:35], s49 offen offset:2048 lds
    v_mfma_f32_16x16x32_bf16 v[76:79], a[172:175], a[232:235], v[76:79]
    v_exp_f32 v235, v235
    v_mfma_f32_16x16x32_bf16 v[80:83], a[172:175], a[236:239], v[80:83]
    buffer_load_dwordx4 v4, s[32:35], s49 offen offset:3072 lds
    s_bfe_u32 s49, 43963, s19
    s_cmp_eq_u32 s49, s41
    s_cselect_b32 s49, s59, s49
    s_mul_i32 s49, s49, 589824
    s_add_u32 s49, s49, s15
    v_mfma_f32_16x16x32_bf16 v[84:87], a[176:179], a[232:235], v[84:87]
    v_exp_f32 v236, v236
    v_mfma_f32_16x16x32_bf16 v[88:91], a[176:179], a[236:239], v[88:91]
    s_waitcnt vmcnt(34)
    s_barrier
    s_waitcnt lgkmcnt(0)
    v_mfma_f32_16x16x32_bf16 v[20:23], a[180:183], a[240:243], v[20:23]
    ds_read_b128 a[144:147], v8 offset:36864
    v_mul_f32 v157, v157, v233
    v_mfma_f32_16x16x32_bf16 v[24:27], a[180:183], a[244:247], v[24:27]
    ds_read_b128 a[148:151], v8 offset:37888
    v_mul_f32 v158, v158, v234
    v_mfma_f32_16x16x32_bf16 v[28:31], a[184:187], a[240:243], v[28:31]
    ds_read_b128 a[152:155], v8 offset:38912
    v_fma_f32 v235, v235, v220, v220
    v_mfma_f32_16x16x32_bf16 v[32:35], a[184:187], a[244:247], v[32:35]
    ds_read_b128 a[156:159], v8 offset:39936
    v_fma_f32 v236, v236, v221, v221
    v_mfma_f32_16x16x32_bf16 v[36:39], a[188:191], a[240:243], v[36:39]
    ds_read_b128 a[160:163], v8 offset:40960
    v_mfma_f32_16x16x32_bf16 v[40:43], a[188:191], a[244:247], v[40:43]
    ds_read_b128 a[164:167], v8 offset:41984
    v_mfma_f32_16x16x32_bf16 v[44:47], a[192:195], a[240:243], v[44:47]
    ds_read_b128 a[168:171], v8 offset:43008
    v_mfma_f32_16x16x32_bf16 v[48:51], a[192:195], a[244:247], v[48:51]
    ds_read_b128 a[172:175], v8 offset:44032
    v_mfma_f32_16x16x32_bf16 v[52:55], a[196:199], a[240:243], v[52:55]
    ds_read_b128 a[176:179], v8 offset:45056
    v_mfma_f32_16x16x32_bf16 v[56:59], a[196:199], a[244:247], v[56:59]
    s_branch L_pgpost_kernel_9_s
.p2align 12
L_pgpost_kernel_9:
    s_branch L_hoppost_kernel_0
L_pgpost_kernel_9_s:
    buffer_load_dwordx4 v[208:211], v4, s[32:35], s38 offen offset:0
    v_mfma_f32_16x16x32_bf16 v[60:63], a[200:203], a[240:243], v[60:63]
    v_rcp_f32 v235, v235
    v_mfma_f32_16x16x32_bf16 v[64:67], a[200:203], a[244:247], v[64:67]
    buffer_load_dwordx4 v[212:215], v4, s[32:35], s38 offen offset:1024
    v_mfma_f32_16x16x32_bf16 v[68:71], a[204:207], a[240:243], v[68:71]
    v_rcp_f32 v236, v236
    v_mfma_f32_16x16x32_bf16 v[72:75], a[204:207], a[244:247], v[72:75]
    buffer_load_dwordx4 v[188:191], v4, s[32:35], s38 offen offset:2048
    v_mfma_f32_16x16x32_bf16 v[76:79], a[208:211], a[240:243], v[76:79]
    v_exp_f32 v237, v237
    v_mfma_f32_16x16x32_bf16 v[80:83], a[208:211], a[244:247], v[80:83]
    buffer_load_dwordx4 v[192:195], v4, s[32:35], s38 offen offset:3072
    s_add_u32 s38, s38, 4096
    v_mfma_f32_16x16x32_bf16 v[84:87], a[212:215], a[240:243], v[84:87]
    v_exp_f32 v238, v238
    v_mfma_f32_16x16x32_bf16 v[88:91], a[212:215], a[244:247], v[88:91]
    v_exp_f32 v239, v239
    s_waitcnt lgkmcnt(0)
    v_mfma_f32_16x16x32_bf16 v[20:23], a[144:147], a[0:3], v[20:23]
    ds_read_b128 a[180:183], v8 offset:46080
    v_mul_f32 v159, v159, v235
    v_mfma_f32_16x16x32_bf16 v[24:27], a[144:147], a[4:7], v[24:27]
    ds_read_b128 a[184:187], v8 offset:47104
    v_mul_f32 v160, v160, v236
    v_mfma_f32_16x16x32_bf16 v[28:31], a[148:151], a[0:3], v[28:31]
    ds_read_b128 a[188:191], v8 offset:48128
    v_fma_f32 v237, v237, v221, v221
    v_mfma_f32_16x16x32_bf16 v[32:35], a[148:151], a[4:7], v[32:35]
    ds_read_b128 a[192:195], v8 offset:49152
    v_fma_f32 v238, v238, v221, v221
    v_mfma_f32_16x16x32_bf16 v[36:39], a[152:155], a[0:3], v[36:39]
    ds_read_b128 a[196:199], v8 offset:50176
    v_fma_f32 v239, v239, v221, v221
    v_mfma_f32_16x16x32_bf16 v[40:43], a[152:155], a[4:7], v[40:43]
    ds_read_b128 a[200:203], v8 offset:51200
    v_mfma_f32_16x16x32_bf16 v[44:47], a[156:159], a[0:3], v[44:47]
    ds_read_b128 a[204:207], v8 offset:52224
    v_mfma_f32_16x16x32_bf16 v[48:51], a[156:159], a[4:7], v[48:51]
    ds_read_b128 a[208:211], v8 offset:53248
    v_mfma_f32_16x16x32_bf16 v[52:55], a[160:163], a[0:3], v[52:55]
    ds_read_b128 a[212:215], v8 offset:54272
    v_mfma_f32_16x16x32_bf16 v[56:59], a[160:163], a[4:7], v[56:59]
    s_add_u32 m0, s48, 0
    s_add_u32 s14, s49, s13
    buffer_load_dwordx4 v4, s[32:35], s49 offen offset:0 lds
    v_mfma_f32_16x16x32_bf16 v[60:63], a[164:167], a[0:3], v[60:63]
    v_rcp_f32 v237, v237
    v_mfma_f32_16x16x32_bf16 v[64:67], a[164:167], a[4:7], v[64:67]
    buffer_load_dwordx4 v4, s[32:35], s49 offen offset:1024 lds
    v_mfma_f32_16x16x32_bf16 v[68:71], a[168:171], a[0:3], v[68:71]
    v_rcp_f32 v238, v238
    v_mfma_f32_16x16x32_bf16 v[72:75], a[168:171], a[4:7], v[72:75]
    buffer_load_dwordx4 v4, s[32:35], s49 offen offset:2048 lds
    v_mfma_f32_16x16x32_bf16 v[76:79], a[172:175], a[0:3], v[76:79]
    v_rcp_f32 v239, v239
    v_mfma_f32_16x16x32_bf16 v[80:83], a[172:175], a[4:7], v[80:83]
    buffer_load_dwordx4 v4, s[32:35], s49 offen offset:3072 lds
    s_add_u32 m0, s12, 0
    s_add_u32 s49, s49, 20480
    v_mfma_f32_16x16x32_bf16 v[84:87], a[176:179], a[0:3], v[84:87]
    v_mul_f32 v161, v161, v237
    v_mul_f32 v162, v162, v238
    v_mfma_f32_16x16x32_bf16 v[88:91], a[176:179], a[4:7], v[88:91]
    buffer_load_dwordx4 v4, s[32:35], s14 offen offset:0 lds
    s_waitcnt vmcnt(39)
    s_barrier
    s_waitcnt lgkmcnt(0)
    v_mfma_f32_16x16x32_bf16 v[20:23], a[180:183], a[8:11], v[20:23]
    ds_read_b128 a[144:147], v9 offset:0
    v_mul_f32 v163, v163, v239
    v_mfma_f32_16x16x32_bf16 v[24:27], a[180:183], a[12:15], v[24:27]
    ds_read_b128 a[148:151], v9 offset:1024
    s_add_u32 s44, s40, 0
    v_mfma_f32_16x16x32_bf16 v[28:31], a[184:187], a[8:11], v[28:31]
    ds_read_b128 a[152:155], v9 offset:2048
    s_and_b32 s44, s44, 3
    v_mfma_f32_16x16x32_bf16 v[32:35], a[184:187], a[12:15], v[32:35]
    ds_read_b128 a[156:159], v9 offset:3072
    s_mul_i32 s45, s44, 73728
    v_mfma_f32_16x16x32_bf16 v[36:39], a[188:191], a[8:11], v[36:39]
    ds_read_b128 a[160:163], v9 offset:4096
    v_add_u32 v5, s45, v4
    v_mfma_f32_16x16x32_bf16 v[40:43], a[188:191], a[12:15], v[40:43]
    ds_read_b128 a[164:167], v9 offset:5120
    s_add_u32 s44, s40, 1
    v_mfma_f32_16x16x32_bf16 v[44:47], a[192:195], a[8:11], v[44:47]
    ds_read_b128 a[168:171], v9 offset:6144
    s_and_b32 s44, s44, 3
    v_mfma_f32_16x16x32_bf16 v[48:51], a[192:195], a[12:15], v[48:51]
    ds_read_b128 a[172:175], v9 offset:7168
    s_mul_i32 s45, s44, 73728
    v_mfma_f32_16x16x32_bf16 v[52:55], a[196:199], a[8:11], v[52:55]
    ds_read_b128 a[176:179], v9 offset:8192
    v_add_u32 v7, s45, v4
    v_mfma_f32_16x16x32_bf16 v[56:59], a[196:199], a[12:15], v[56:59]
    buffer_load_dwordx4 v[196:199], v4, s[32:35], s38 offen offset:0
    s_add_u32 s38, s38, 28672
    v_mfma_f32_16x16x32_bf16 v[60:63], a[200:203], a[8:11], v[60:63]
    s_mul_i32 s44, s44, 15360
    s_add_u32 s44, s44, 0
    v_mfma_f32_16x16x32_bf16 v[64:67], a[200:203], a[12:15], v[64:67]
    buffer_load_dwordx4 v[200:203], v4, s[32:35], s38 offen offset:0
    v_mfma_f32_16x16x32_bf16 v[68:71], a[204:207], a[8:11], v[68:71]
    v_add_u32 v14, s44, v4
    s_add_u32 s44, s40, 2
    v_mfma_f32_16x16x32_bf16 v[72:75], a[204:207], a[12:15], v[72:75]
    buffer_load_dwordx4 v[204:207], v4, s[32:35], s38 offen offset:1024
    v_mfma_f32_16x16x32_bf16 v[76:79], a[208:211], a[8:11], v[76:79]
    s_and_b32 s44, s44, 3
    s_mul_i32 s45, s44, 73728
    v_mfma_f32_16x16x32_bf16 v[80:83], a[208:211], a[12:15], v[80:83]
    buffer_load_dwordx4 v[164:167], v4, s[32:35], s38 offen offset:2048
    v_mfma_f32_16x16x32_bf16 v[84:87], a[212:215], a[8:11], v[84:87]
    v_mfma_f32_16x16x32_bf16 v[88:91], a[212:215], a[12:15], v[88:91]
    s_waitcnt lgkmcnt(0)
    v_mfma_f32_16x16x32_bf16 v[20:23], a[144:147], a[16:19], v[20:23]
    ds_read_b128 a[180:183], v9 offset:9216
    v_add_u32 v11, s45, v4
    v_mfma_f32_16x16x32_bf16 v[24:27], a[144:147], a[20:23], v[24:27]
    ds_read_b128 a[184:187], v9 offset:10240
    s_mul_i32 s44, s44, 15360
    v_mfma_f32_16x16x32_bf16 v[28:31], a[148:151], a[16:19], v[28:31]
    ds_read_b128 a[188:191], v9 offset:11264
    s_add_u32 s44, s44, 5120
    v_mfma_f32_16x16x32_bf16 v[32:35], a[148:151], a[20:23], v[32:35]
    ds_read_b128 a[192:195], v9 offset:12288
    v_add_u32 v15, s44, v4
    v_mfma_f32_16x16x32_bf16 v[36:39], a[152:155], a[16:19], v[36:39]
    ds_read_b128 a[196:199], v9 offset:13312
    s_add_u32 s44, s40, 3
    v_mfma_f32_16x16x32_bf16 v[40:43], a[152:155], a[20:23], v[40:43]
    ds_read_b128 a[200:203], v9 offset:14336
    s_and_b32 s44, s44, 3
    v_mfma_f32_16x16x32_bf16 v[44:47], a[156:159], a[16:19], v[44:47]
    ds_read_b128 a[204:207], v9 offset:15360
    s_mul_i32 s45, s44, 73728
    v_mfma_f32_16x16x32_bf16 v[48:51], a[156:159], a[20:23], v[48:51]
    ds_read_b128 a[208:211], v9 offset:16384
    v_add_u32 v12, s45, v4
    v_mfma_f32_16x16x32_bf16 v[52:55], a[160:163], a[16:19], v[52:55]
    ds_read_b128 a[212:215], v9 offset:17408
    s_mul_i32 s44, s44, 15360
    v_mfma_f32_16x16x32_bf16 v[56:59], a[160:163], a[20:23], v[56:59]
    s_add_u32 m0, s48, 20480
    s_nop 0
    buffer_load_dwordx4 v4, s[32:35], s49 offen offset:0 lds
    v_mfma_f32_16x16x32_bf16 v[60:63], a[164:167], a[16:19], v[60:63]
    s_add_u32 s44, s44, 10240
    v_add_u32 v16, s44, v4
    v_mfma_f32_16x16x32_bf16 v[64:67], a[164:167], a[20:23], v[64:67]
    buffer_load_dwordx4 v4, s[32:35], s49 offen offset:1024 lds
    v_mfma_f32_16x16x32_bf16 v[68:71], a[168:171], a[16:19], v[68:71]
    v_and_b32 v17, 4, v2
    v_add_u32 v17, v17, v2
    v_mfma_f32_16x16x32_bf16 v[72:75], a[168:171], a[20:23], v[72:75]
    buffer_load_dwordx4 v4, s[32:35], s49 offen offset:2048 lds
    v_mfma_f32_16x16x32_bf16 v[76:79], a[172:175], a[16:19], v[76:79]
    v_lshrrev_b32 v18, 3, v2
    v_mad_i32_i24 v17, v18, -4, v17
    v_mfma_f32_16x16x32_bf16 v[80:83], a[172:175], a[20:23], v[80:83]
    buffer_load_dwordx4 v4, s[32:35], s49 offen offset:3072 lds
    v_mfma_f32_16x16x32_bf16 v[84:87], a[176:179], a[16:19], v[84:87]
    v_mfma_f32_16x16x32_bf16 v[88:91], a[176:179], a[20:23], v[88:91]
    s_waitcnt vmcnt(38)
    s_barrier
    s_waitcnt lgkmcnt(0)
    v_mfma_f32_16x16x32_bf16 v[20:23], a[180:183], a[24:27], v[20:23]
    ds_read_b128 a[144:147], v9 offset:18432
    v_mul_u32_u24 v17, 1152, v17
    v_mfma_f32_16x16x32_bf16 v[24:27], a[180:183], a[28:31], v[24:27]
    ds_read_b128 a[148:151], v9 offset:19456
    v_lshl_add_u32 v18, v3, 3, v17
    v_mfma_f32_16x16x32_bf16 v[28:31], a[184:187], a[24:27], v[28:31]
    ds_read_b128 a[152:155], v9 offset:20480
    v_lshl_add_u32 v17, v3, 4, v17
    v_mfma_f32_16x16x32_bf16 v[32:35], a[184:187], a[28:31], v[32:35]
    ds_read_b128 a[156:159], v9 offset:21504
    v_and_b32 v222, 1, v1
    v_mfma_f32_16x16x32_bf16 v[36:39], a[188:191], a[24:27], v[36:39]
    ds_read_b128 a[160:163], v9 offset:22528
    v_lshlrev_b32 v222, 10, v222
    v_mfma_f32_16x16x32_bf16 v[40:43], a[188:191], a[28:31], v[40:43]
    ds_read_b128 a[164:167], v9 offset:23552
    v_bfe_u32 v223, v1, 1, 2
    v_mfma_f32_16x16x32_bf16 v[44:47], a[192:195], a[24:27], v[44:47]
    ds_read_b128 a[168:171], v9 offset:24576
    v_lshl_add_u32 v222, v223, 6, v222
    v_mfma_f32_16x16x32_bf16 v[48:51], a[192:195], a[28:31], v[48:51]
    ds_read_b128 a[172:175], v9 offset:25600
    s_mul_i32 s39, s37, 294912
    v_mfma_f32_16x16x32_bf16 v[52:55], a[196:199], a[24:27], v[52:55]
    ds_read_b128 a[176:179], v9 offset:26624
    s_lshl_b32 s44, s40, 11
    v_mfma_f32_16x16x32_bf16 v[56:59], a[196:199], a[28:31], v[56:59]
    buffer_load_dwordx4 v[172:175], v4, s[32:35], s38 offen offset:3072
    s_add_u32 s38, s38, 4096
    v_mfma_f32_16x16x32_bf16 v[60:63], a[200:203], a[24:27], v[60:63]
    s_add_u32 s39, s39, s44
    s_add_u32 s39, s39, 36700160
    v_mfma_f32_16x16x32_bf16 v[64:67], a[200:203], a[28:31], v[64:67]
    buffer_load_dwordx4 v[180:183], v4, s[32:35], s38 offen offset:0
    v_mfma_f32_16x16x32_bf16 v[68:71], a[204:207], a[24:27], v[68:71]
    s_mov_b32 s24, s20
    s_mov_b32 s25, s21
    v_mfma_f32_16x16x32_bf16 v[72:75], a[204:207], a[28:31], v[72:75]
    buffer_load_dwordx4 v[184:187], v4, s[32:35], s38 offen offset:1024
    v_mfma_f32_16x16x32_bf16 v[76:79], a[208:211], a[24:27], v[76:79]
    s_mov_b32 s26, 2359296
    s_mov_b32 s27, 0x20000
    v_mfma_f32_16x16x32_bf16 v[80:83], a[208:211], a[28:31], v[80:83]
    buffer_load_dwordx4 v[168:171], v4, s[32:35], s38 offen offset:2048
    v_mfma_f32_16x16x32_bf16 v[84:87], a[212:215], a[24:27], v[84:87]
    v_mfma_f32_16x16x32_bf16 v[88:91], a[212:215], a[28:31], v[88:91]
    s_waitcnt lgkmcnt(0)
    v_mfma_f32_16x16x32_bf16 v[20:23], a[144:147], a[32:35], v[20:23]
    ds_read_b128 a[180:183], v9 offset:27648
    v_mfma_f32_16x16x32_bf16 v[24:27], a[144:147], a[36:39], v[24:27]
    ds_read_b128 a[184:187], v9 offset:28672
    v_mfma_f32_16x16x32_bf16 v[28:31], a[148:151], a[32:35], v[28:31]
    ds_read_b128 a[188:191], v9 offset:29696
    v_mfma_f32_16x16x32_bf16 v[32:35], a[148:151], a[36:39], v[32:35]
    ds_read_b128 a[192:195], v9 offset:30720
    v_mfma_f32_16x16x32_bf16 v[36:39], a[152:155], a[32:35], v[36:39]
    ds_read_b128 a[196:199], v9 offset:31744
    v_mfma_f32_16x16x32_bf16 v[40:43], a[152:155], a[36:39], v[40:43]
    ds_read_b128 a[200:203], v9 offset:32768
    v_mfma_f32_16x16x32_bf16 v[44:47], a[156:159], a[32:35], v[44:47]
    ds_read_b128 a[204:207], v9 offset:33792
    v_mfma_f32_16x16x32_bf16 v[48:51], a[156:159], a[36:39], v[48:51]
    ds_read_b128 a[208:211], v9 offset:34816
    v_mfma_f32_16x16x32_bf16 v[52:55], a[160:163], a[32:35], v[52:55]
    ds_read_b128 a[212:215], v9 offset:35840
    v_mfma_f32_16x16x32_bf16 v[56:59], a[160:163], a[36:39], v[56:59]
    buffer_load_dwordx4 v[176:179], v4, s[32:35], s38 offen offset:3072
    s_add_u32 s38, s38, 4096
    v_mfma_f32_16x16x32_bf16 v[60:63], a[164:167], a[32:35], v[60:63]
    v_mfma_f32_16x16x32_bf16 v[64:67], a[164:167], a[36:39], v[64:67]
    buffer_load_dwordx4 v[240:243], v4, s[32:35], s38 offen offset:0
    s_add_u32 s38, s38, 28672
    v_mfma_f32_16x16x32_bf16 v[68:71], a[168:171], a[32:35], v[68:71]
    v_mfma_f32_16x16x32_bf16 v[72:75], a[168:171], a[36:39], v[72:75]
    buffer_load_dwordx4 v[244:247], v4, s[32:35], s38 offen offset:0
    v_mfma_f32_16x16x32_bf16 v[76:79], a[172:175], a[32:35], v[76:79]
    v_mfma_f32_16x16x32_bf16 v[80:83], a[172:175], a[36:39], v[80:83]
    buffer_load_dwordx4 v[248:251], v4, s[32:35], s38 offen offset:1024
    v_mfma_f32_16x16x32_bf16 v[84:87], a[176:179], a[32:35], v[84:87]
    v_mfma_f32_16x16x32_bf16 v[88:91], a[176:179], a[36:39], v[88:91]
    s_waitcnt vmcnt(42)
    s_waitcnt vmcnt(33)
    s_waitcnt vmcnt(25)
    s_barrier
    s_waitcnt lgkmcnt(0)
    v_mfma_f32_16x16x32_bf16 v[20:23], a[180:183], a[40:43], v[20:23]
    ds_read_b128 a[144:147], v9 offset:36864
    v_mfma_f32_16x16x32_bf16 v[24:27], a[180:183], a[44:47], v[24:27]
    ds_read_b128 a[148:151], v9 offset:37888
    v_mfma_f32_16x16x32_bf16 v[28:31], a[184:187], a[40:43], v[28:31]
    ds_read_b128 a[152:155], v9 offset:46080
    v_mfma_f32_16x16x32_bf16 v[32:35], a[184:187], a[44:47], v[32:35]
    ds_read_b128 a[156:159], v9 offset:47104
    v_mfma_f32_16x16x32_bf16 v[36:39], a[188:191], a[40:43], v[36:39]
    ds_read_b128 a[160:163], v10 offset:0
    v_mfma_f32_16x16x32_bf16 v[40:43], a[188:191], a[44:47], v[40:43]
    ds_read_b128 a[164:167], v10 offset:1024
    v_mfma_f32_16x16x32_bf16 v[44:47], a[192:195], a[40:43], v[44:47]
    ds_read_b128 a[168:171], v10 offset:9216
    v_mfma_f32_16x16x32_bf16 v[48:51], a[192:195], a[44:47], v[48:51]
    ds_read_b128 a[172:175], v10 offset:10240
    v_mfma_f32_16x16x32_bf16 v[52:55], a[196:199], a[40:43], v[52:55]
    ds_read_b128 a[176:179], v10 offset:18432
    v_mfma_f32_16x16x32_bf16 v[56:59], a[196:199], a[44:47], v[56:59]
    buffer_load_dwordx4 v[252:255], v4, s[32:35], s38 offen offset:2048
    v_mfma_f32_16x16x32_bf16 v[60:63], a[200:203], a[40:43], v[60:63]
    v_mfma_f32_16x16x32_bf16 v[64:67], a[200:203], a[44:47], v[64:67]
    buffer_load_dwordx4 a[128:131], v4, s[32:35], s38 offen offset:3072
    s_add_u32 s38, s38, 4096
    v_mfma_f32_16x16x32_bf16 v[68:71], a[204:207], a[40:43], v[68:71]
    v_mfma_f32_16x16x32_bf16 v[72:75], a[204:207], a[44:47], v[72:75]
    buffer_load_dwordx4 a[132:135], v4, s[32:35], s38 offen offset:0
    v_mfma_f32_16x16x32_bf16 v[76:79], a[208:211], a[40:43], v[76:79]
    v_mfma_f32_16x16x32_bf16 v[80:83], a[208:211], a[44:47], v[80:83]
    buffer_load_dwordx4 a[136:139], v4, s[32:35], s38 offen offset:1024
    v_mfma_f32_16x16x32_bf16 v[84:87], a[212:215], a[40:43], v[84:87]
    v_mfma_f32_16x16x32_bf16 v[88:91], a[212:215], a[44:47], v[88:91]
    s_waitcnt vmcnt(20)
    s_waitcnt vmcnt(12)
    s_barrier
    s_waitcnt lgkmcnt(0)
    v_mfma_f32_16x16x32_bf16 v[20:23], a[144:147], a[48:51], v[20:23]
    ds_read_b128 a[180:183], v10 offset:19456
    buffer_load_dwordx4 a[140:143], v4, s[32:35], s38 offen offset:2048
    v_mfma_f32_16x16x32_bf16 v[24:27], a[144:147], a[52:55], v[24:27]
    ds_read_b128 a[184:187], v10 offset:27648
    v_mfma_f32_16x16x32_bf16 v[28:31], a[148:151], a[48:51], v[28:31]
    ds_read_b128 a[188:191], v10 offset:28672
    v_mfma_f32_16x16x32_bf16 v[32:35], a[148:151], a[52:55], v[32:35]
    ds_read_b128 a[192:195], v8 offset:0
    v_mfma_f32_16x16x32_bf16 v[20:23], a[152:155], a[56:59], v[20:23]
    ds_read_b128 a[196:199], v8 offset:1024
    buffer_load_dwordx4 a[216:219], v4, s[32:35], s38 offen offset:3072
    s_add_u32 s38, s38, 4096
    v_mfma_f32_16x16x32_bf16 v[24:27], a[152:155], a[60:63], v[24:27]
    ds_read_b128 a[200:203], v8 offset:9216
    v_mfma_f32_16x16x32_bf16 v[28:31], a[156:159], a[56:59], v[28:31]
    ds_read_b128 a[204:207], v8 offset:10240
    v_mfma_f32_16x16x32_bf16 v[32:35], a[156:159], a[60:63], v[32:35]
    ds_read_b128 a[208:211], v8 offset:18432
    v_mfma_f32_16x16x32_bf16 v[20:23], a[160:163], a[64:67], v[20:23]
    ds_read_b128 a[212:215], v8 offset:19456
    buffer_load_dwordx4 a[220:223], v4, s[32:35], s38 offen offset:0
    s_add_u32 s38, s38, 28672
    v_mfma_f32_16x16x32_bf16 v[24:27], a[160:163], a[68:71], v[24:27]
    v_mfma_f32_16x16x32_bf16 v[28:31], a[164:167], a[64:67], v[28:31]
    v_mfma_f32_16x16x32_bf16 v[32:35], a[164:167], a[68:71], v[32:35]
    v_mfma_f32_16x16x32_bf16 v[20:23], a[168:171], a[72:75], v[20:23]
    buffer_load_dwordx4 a[224:227], v4, s[32:35], s38 offen offset:0
    v_mfma_f32_16x16x32_bf16 v[24:27], a[168:171], a[76:79], v[24:27]
    v_mfma_f32_16x16x32_bf16 v[28:31], a[172:175], a[72:75], v[28:31]
    v_mfma_f32_16x16x32_bf16 v[32:35], a[172:175], a[76:79], v[32:35]
    v_mfma_f32_16x16x32_bf16 v[20:23], a[176:179], a[80:83], v[20:23]
    buffer_load_dwordx4 a[228:231], v4, s[32:35], s38 offen offset:1024
    v_mfma_f32_16x16x32_bf16 v[24:27], a[176:179], a[84:87], v[24:27]
    s_waitcnt lgkmcnt(0)
    v_mfma_f32_16x16x32_bf16 v[28:31], a[180:183], a[80:83], v[28:31]
    ds_read_b128 a[144:147], v8 offset:27648
    v_mfma_f32_16x16x32_bf16 v[32:35], a[180:183], a[84:87], v[32:35]
    ds_read_b128 a[148:151], v8 offset:28672
    v_mfma_f32_16x16x32_bf16 v[20:23], a[184:187], a[88:91], v[20:23]
    ds_read_b128 a[152:155], v9 offset:38912
    buffer_load_dwordx4 a[232:235], v4, s[32:35], s38 offen offset:2048
    v_mfma_f32_16x16x32_bf16 v[24:27], a[184:187], a[92:95], v[24:27]
    ds_read_b128 a[156:159], v9 offset:48128
    v_mfma_f32_16x16x32_bf16 v[28:31], a[188:191], a[88:91], v[28:31]
    ds_read_b128 a[160:163], v10 offset:2048
    v_mfma_f32_16x16x32_bf16 v[32:35], a[188:191], a[92:95], v[32:35]
    ds_read_b128 a[164:167], v10 offset:11264
    v_mfma_f32_16x16x32_bf16 v[20:23], a[192:195], a[96:99], v[20:23]
    ds_read_b128 a[168:171], v10 offset:20480
    buffer_load_dwordx4 a[236:239], v4, s[32:35], s38 offen offset:3072
    s_add_u32 s38, s38, 4096
    v_mfma_f32_16x16x32_bf16 v[24:27], a[192:195], a[100:103], v[24:27]
    ds_read_b128 a[172:175], v10 offset:29696
    v_mfma_f32_16x16x32_bf16 v[28:31], a[196:199], a[96:99], v[28:31]
    ds_read_b128 a[176:179], v8 offset:2048
    v_mfma_f32_16x16x32_bf16 v[32:35], a[196:199], a[100:103], v[32:35]
    v_mfma_f32_16x16x32_bf16 v[20:23], a[200:203], a[104:107], v[20:23]
    buffer_load_dwordx4 a[240:243], v4, s[32:35], s38 offen offset:0
    v_mfma_f32_16x16x32_bf16 v[24:27], a[200:203], a[108:111], v[24:27]
    v_mfma_f32_16x16x32_bf16 v[28:31], a[204:207], a[104:107], v[28:31]
    v_mfma_f32_16x16x32_bf16 v[32:35], a[204:207], a[108:111], v[32:35]
    v_mfma_f32_16x16x32_bf16 v[20:23], a[208:211], a[112:115], v[20:23]
    buffer_load_dwordx4 a[244:247], v4, s[32:35], s38 offen offset:1024
    v_mfma_f32_16x16x32_bf16 v[24:27], a[208:211], a[116:119], v[24:27]
    v_mfma_f32_16x16x32_bf16 v[28:31], a[212:215], a[112:115], v[28:31]
    v_mfma_f32_16x16x32_bf16 v[32:35], a[212:215], a[116:119], v[32:35]
    s_waitcnt lgkmcnt(0)
    v_mfma_f32_16x16x32_bf16 v[20:23], a[144:147], a[120:123], v[20:23]
    ds_read_b128 a[180:183], v8 offset:11264
    buffer_load_dwordx4 a[0:3], v4, s[32:35], s38 offen offset:2048
    v_mfma_f32_16x16x32_bf16 v[24:27], a[144:147], a[124:127], v[24:27]
    ds_read_b128 a[184:187], v8 offset:20480
    v_mfma_f32_16x16x32_bf16 v[28:31], a[148:151], a[120:123], v[28:31]
    ds_read_b128 a[188:191], v8 offset:29696
    v_mfma_f32_16x16x32_bf16 v[32:35], a[148:151], a[124:127], v[32:35]
    ds_read_b128 a[192:195], v9 offset:39936
    v_mfma_f32_16x16x32_bf16 v[36:39], a[152:155], a[48:51], v[36:39]
    ds_read_b128 a[196:199], v9 offset:49152
    buffer_load_dwordx4 a[4:7], v4, s[32:35], s38 offen offset:3072
    s_add_u32 s38, s38, 4096
    v_mfma_f32_16x16x32_bf16 v[40:43], a[152:155], a[52:55], v[40:43]
    ds_read_b128 a[200:203], v10 offset:3072
    v_mfma_f32_16x16x32_bf16 v[36:39], a[156:159], a[56:59], v[36:39]
    ds_read_b128 a[204:207], v10 offset:12288
    v_mfma_f32_16x16x32_bf16 v[40:43], a[156:159], a[60:63], v[40:43]
    ds_read_b128 a[208:211], v10 offset:21504
    v_mfma_f32_16x16x32_bf16 v[36:39], a[160:163], a[64:67], v[36:39]
    ds_read_b128 a[212:215], v10 offset:30720
    buffer_load_dwordx4 a[8:11], v4, s[32:35], s38 offen offset:0
    s_add_u32 s38, s38, 28672
    v_mfma_f32_16x16x32_bf16 v[40:43], a[160:163], a[68:71], v[40:43]
    v_mul_f32 v20, v20, v92
    v_mul_f32 v21, v21, v93
    v_mfma_f32_16x16x32_bf16 v[36:39], a[164:167], a[72:75], v[36:39]
    v_mul_f32 v22, v22, v94
    v_mul_f32 v23, v23, v95
    v_mfma_f32_16x16x32_bf16 v[40:43], a[164:167], a[76:79], v[40:43]
    v_cvt_pk_bf16_f32 v92, v20, v21
    v_cvt_pk_bf16_f32 v93, v22, v23
    v_mfma_f32_16x16x32_bf16 v[36:39], a[168:171], a[80:83], v[36:39]
    buffer_load_dwordx4 a[12:15], v4, s[32:35], s38 offen offset:0
    v_mul_f32 v24, v24, v96
    v_mfma_f32_16x16x32_bf16 v[40:43], a[168:171], a[84:87], v[40:43]
    v_mul_f32 v25, v25, v97
    v_mul_f32 v26, v26, v98
    v_mfma_f32_16x16x32_bf16 v[36:39], a[172:175], a[88:91], v[36:39]
    v_mul_f32 v27, v27, v99
    v_cvt_pk_bf16_f32 v96, v24, v25
    v_mfma_f32_16x16x32_bf16 v[40:43], a[172:175], a[92:95], v[40:43]
    v_cvt_pk_bf16_f32 v97, v26, v27
    v_mul_f32 v28, v28, v100
    v_mfma_f32_16x16x32_bf16 v[36:39], a[176:179], a[96:99], v[36:39]
    buffer_load_dwordx4 a[16:19], v4, s[32:35], s38 offen offset:1024
    v_mul_f32 v29, v29, v101
    v_mfma_f32_16x16x32_bf16 v[40:43], a[176:179], a[100:103], v[40:43]
    v_mul_f32 v30, v30, v102
    v_mul_f32 v31, v31, v103
    s_waitcnt lgkmcnt(0)
    v_mfma_f32_16x16x32_bf16 v[36:39], a[180:183], a[104:107], v[36:39]
    ds_read_b128 a[144:147], v8 offset:3072
    v_cvt_pk_bf16_f32 v94, v28, v29
    v_mfma_f32_16x16x32_bf16 v[40:43], a[180:183], a[108:111], v[40:43]
    ds_read_b128 a[148:151], v8 offset:12288
    v_cvt_pk_bf16_f32 v95, v30, v31
    v_mfma_f32_16x16x32_bf16 v[36:39], a[184:187], a[112:115], v[36:39]
    ds_read_b128 a[152:155], v8 offset:21504
    buffer_load_dwordx4 a[20:23], v4, s[32:35], s38 offen offset:2048
    v_mfma_f32_16x16x32_bf16 v[40:43], a[184:187], a[116:119], v[40:43]
    ds_read_b128 a[156:159], v8 offset:30720
    v_mul_f32 v32, v32, v104
    v_mfma_f32_16x16x32_bf16 v[36:39], a[188:191], a[120:123], v[36:39]
    ds_read_b128 a[160:163], v9 offset:40960
    v_mul_f32 v33, v33, v105
    v_mfma_f32_16x16x32_bf16 v[40:43], a[188:191], a[124:127], v[40:43]
    ds_read_b128 a[164:167], v9 offset:50176
    v_mul_f32 v34, v34, v106
    v_mfma_f32_16x16x32_bf16 v[44:47], a[192:195], a[48:51], v[44:47]
    ds_read_b128 a[168:171], v10 offset:4096
    s_add_u32 s57, s56, 0
    buffer_store_dwordx4 v[92:95], v4, s[32:35], s57 offen sc1
    v_mfma_f32_16x16x32_bf16 v[48:51], a[192:195], a[52:55], v[48:51]
    ds_read_b128 a[172:175], v10 offset:13312
    v_mul_f32 v35, v35, v107
    v_mfma_f32_16x16x32_bf16 v[44:47], a[196:199], a[56:59], v[44:47]
    ds_read_b128 a[176:179], v10 offset:22528
    v_cvt_pk_bf16_f32 v98, v32, v33
    v_mfma_f32_16x16x32_bf16 v[48:51], a[196:199], a[60:63], v[48:51]
    v_cvt_pk_bf16_f32 v99, v34, v35
    v_mfma_f32_16x16x32_bf16 v[44:47], a[200:203], a[64:67], v[44:47]
    s_add_u32 s57, s56, 73728
    buffer_store_dwordx4 v[96:99], v4, s[32:35], s57 offen sc1
    v_mfma_f32_16x16x32_bf16 v[48:51], a[200:203], a[68:71], v[48:51]
    v_mfma_f32_16x16x32_bf16 v[44:47], a[204:207], a[72:75], v[44:47]
    v_mul_f32 v36, v36, v108
    v_mul_f32 v37, v37, v109
    v_mfma_f32_16x16x32_bf16 v[48:51], a[204:207], a[76:79], v[48:51]
    v_mul_f32 v38, v38, v110
    v_mul_f32 v39, v39, v111
    v_mfma_f32_16x16x32_bf16 v[44:47], a[208:211], a[80:83], v[44:47]
    buffer_load_dwordx4 a[24:27], v4, s[32:35], s38 offen offset:3072
    s_add_u32 s38, s38, 4096
    v_cvt_pk_bf16_f32 v108, v36, v37
    v_mfma_f32_16x16x32_bf16 v[48:51], a[208:211], a[84:87], v[48:51]
    v_cvt_pk_bf16_f32 v109, v38, v39
    v_mul_f32 v40, v40, v112
    v_mfma_f32_16x16x32_bf16 v[44:47], a[212:215], a[88:91], v[44:47]
    v_mul_f32 v41, v41, v113
    v_mul_f32 v42, v42, v114
    v_mfma_f32_16x16x32_bf16 v[48:51], a[212:215], a[92:95], v[48:51]
    v_mul_f32 v43, v43, v115
    v_cvt_pk_bf16_f32 v112, v40, v41
    s_waitcnt lgkmcnt(0)
    v_mfma_f32_16x16x32_bf16 v[44:47], a[144:147], a[96:99], v[44:47]
    ds_read_b128 a[180:183], v10 offset:31744
    buffer_load_dwordx4 a[28:31], v4, s[32:35], s38 offen offset:0
    v_mfma_f32_16x16x32_bf16 v[48:51], a[144:147], a[100:103], v[48:51]
    ds_read_b128 a[184:187], v8 offset:4096
    v_cvt_pk_bf16_f32 v113, v42, v43
    v_mfma_f32_16x16x32_bf16 v[44:47], a[148:151], a[104:107], v[44:47]
    ds_read_b128 a[188:191], v8 offset:13312
    v_mfma_f32_16x16x32_bf16 v[48:51], a[148:151], a[108:111], v[48:51]
    ds_read_b128 a[192:195], v8 offset:22528
    v_mfma_f32_16x16x32_bf16 v[44:47], a[152:155], a[112:115], v[44:47]
    ds_read_b128 a[196:199], v8 offset:31744
    buffer_load_dwordx4 a[32:35], v4, s[32:35], s38 offen offset:1024
    v_mfma_f32_16x16x32_bf16 v[48:51], a[152:155], a[116:119], v[48:51]
    ds_read_b128 a[200:203], v9 offset:41984
    v_mfma_f32_16x16x32_bf16 v[44:47], a[156:159], a[120:123], v[44:47]
    ds_read_b128 a[204:207], v9 offset:51200
    v_mfma_f32_16x16x32_bf16 v[48:51], a[156:159], a[124:127], v[48:51]
    ds_read_b128 a[208:211], v10 offset:5120
    v_mfma_f32_16x16x32_bf16 v[52:55], a[160:163], a[48:51], v[52:55]
    ds_read_b128 a[212:215], v10 offset:14336
    buffer_load_dwordx4 a[36:39], v4, s[32:35], s38 offen offset:2048
    v_mfma_f32_16x16x32_bf16 v[56:59], a[160:163], a[52:55], v[56:59]
    v_mfma_f32_16x16x32_bf16 v[52:55], a[164:167], a[56:59], v[52:55]
    v_mfma_f32_16x16x32_bf16 v[56:59], a[164:167], a[60:63], v[56:59]
    v_mfma_f32_16x16x32_bf16 v[52:55], a[168:171], a[64:67], v[52:55]
    buffer_load_dwordx4 a[40:43], v4, s[32:35], s38 offen offset:3072
    s_add_u32 s38, s38, 4096
    v_mfma_f32_16x16x32_bf16 v[56:59], a[168:171], a[68:71], v[56:59]
    v_mfma_f32_16x16x32_bf16 v[52:55], a[172:175], a[72:75], v[52:55]
    v_mul_f32 v44, v44, v116
    v_mul_f32 v45, v45, v117
    v_mfma_f32_16x16x32_bf16 v[56:59], a[172:175], a[76:79], v[56:59]
    v_mul_f32 v46, v46, v118
    v_mul_f32 v47, v47, v119
    v_mfma_f32_16x16x32_bf16 v[52:55], a[176:179], a[80:83], v[52:55]
    buffer_load_dwordx4 a[44:47], v4, s[32:35], s38 offen offset:0
    s_add_u32 s38, s38, 28672
    v_cvt_pk_bf16_f32 v110, v44, v45
    v_mfma_f32_16x16x32_bf16 v[56:59], a[176:179], a[84:87], v[56:59]
    v_cvt_pk_bf16_f32 v111, v46, v47
    v_mul_f32 v48, v48, v120
    s_waitcnt lgkmcnt(0)
    v_mfma_f32_16x16x32_bf16 v[52:55], a[180:183], a[88:91], v[52:55]
    ds_read_b128 a[144:147], v10 offset:23552
    v_mul_f32 v49, v49, v121
    v_mfma_f32_16x16x32_bf16 v[56:59], a[180:183], a[92:95], v[56:59]
    ds_read_b128 a[148:151], v10 offset:32768
    v_mul_f32 v50, v50, v122
    v_mfma_f32_16x16x32_bf16 v[52:55], a[184:187], a[96:99], v[52:55]
    ds_read_b128 a[152:155], v8 offset:5120
    s_add_u32 s57, s56, 16384
    buffer_store_dwordx4 v[108:111], v4, s[32:35], s57 offen sc1
    v_mfma_f32_16x16x32_bf16 v[56:59], a[184:187], a[100:103], v[56:59]
    ds_read_b128 a[156:159], v8 offset:14336
    v_mul_f32 v51, v51, v123
    v_mfma_f32_16x16x32_bf16 v[52:55], a[188:191], a[104:107], v[52:55]
    ds_read_b128 a[160:163], v8 offset:23552
    v_cvt_pk_bf16_f32 v114, v48, v49
    v_mfma_f32_16x16x32_bf16 v[56:59], a[188:191], a[108:111], v[56:59]
    ds_read_b128 a[164:167], v8 offset:32768
    v_cvt_pk_bf16_f32 v115, v50, v51
    v_mfma_f32_16x16x32_bf16 v[52:55], a[192:195], a[112:115], v[52:55]
    ds_read_b128 a[168:171], v9 offset:43008
    buffer_load_dwordx4 v[28:31], v4, s[32:35], s38 offen offset:0
    v_mfma_f32_16x16x32_bf16 v[56:59], a[192:195], a[116:119], v[56:59]
    ds_read_b128 a[172:175], v9 offset:52224
    v_mfma_f32_16x16x32_bf16 v[52:55], a[196:199], a[120:123], v[52:55]
    ds_read_b128 a[176:179], v10 offset:6144
    v_mfma_f32_16x16x32_bf16 v[56:59], a[196:199], a[124:127], v[56:59]
    v_mfma_f32_16x16x32_bf16 v[60:63], a[200:203], a[48:51], v[60:63]
    s_add_u32 s57, s56, 90112
    buffer_store_dwordx4 v[112:115], v4, s[32:35], s57 offen sc1
    v_mfma_f32_16x16x32_bf16 v[64:67], a[200:203], a[52:55], v[64:67]
    v_mfma_f32_16x16x32_bf16 v[60:63], a[204:207], a[56:59], v[60:63]
    v_mfma_f32_16x16x32_bf16 v[64:67], a[204:207], a[60:63], v[64:67]
    v_mfma_f32_16x16x32_bf16 v[60:63], a[208:211], a[64:67], v[60:63]
    s_waitcnt vmcnt(9)
    s_mov_b64 exec, 1
    buffer_store_dword v1, off, s[32:35], s8 sc1
    s_mov_b64 exec, -1
    s_add_u32 s8, s8, 65536
    v_mfma_f32_16x16x32_bf16 v[64:67], a[208:211], a[68:71], v[64:67]
    buffer_load_dwordx4 v[100:103], v4, s[32:35], s38 offen offset:1024
    v_mfma_f32_16x16x32_bf16 v[60:63], a[212:215], a[72:75], v[60:63]
    v_mul_f32 v52, v52, v124
    v_mul_f32 v53, v53, v125
    v_mfma_f32_16x16x32_bf16 v[64:67], a[212:215], a[76:79], v[64:67]
    v_mul_f32 v54, v54, v126
    v_mul_f32 v55, v55, v127
    s_waitcnt lgkmcnt(0)
    v_mfma_f32_16x16x32_bf16 v[60:63], a[144:147], a[80:83], v[60:63]
    ds_read_b128 a[180:183], v10 offset:15360
    v_cvt_pk_bf16_f32 v124, v52, v53
    v_mfma_f32_16x16x32_bf16 v[64:67], a[144:147], a[84:87], v[64:67]
    ds_read_b128 a[184:187], v10 offset:24576
    buffer_load_dwordx4 v[32:35], v4, s[32:35], s38 offen offset:2048
    v_mfma_f32_16x16x32_bf16 v[60:63], a[148:151], a[88:91], v[60:63]
    ds_read_b128 a[188:191], v10 offset:33792
    v_cvt_pk_bf16_f32 v125, v54, v55
    v_mfma_f32_16x16x32_bf16 v[64:67], a[148:151], a[92:95], v[64:67]
    ds_read_b128 a[192:195], v8 offset:6144
    s_branch L_pgpost_kernel_10_s
.p2align 12
L_pgpost_kernel_10:
    s_branch L_hoppost_kernel_0
L_pgpost_kernel_10_s:
    v_mul_f32 v56, v56, v128
    v_mfma_f32_16x16x32_bf16 v[60:63], a[152:155], a[96:99], v[60:63]
    ds_read_b128 a[196:199], v8 offset:15360
    v_mul_f32 v57, v57, v129
    v_mfma_f32_16x16x32_bf16 v[64:67], a[152:155], a[100:103], v[64:67]
    ds_read_b128 a[200:203], v8 offset:24576
    buffer_load_dwordx4 v[104:107], v4, s[32:35], s38 offen offset:3072
    s_add_u32 s38, s38, 4096
    v_mfma_f32_16x16x32_bf16 v[60:63], a[156:159], a[104:107], v[60:63]
    ds_read_b128 a[204:207], v8 offset:33792
    v_mul_f32 v58, v58, v130
    v_mfma_f32_16x16x32_bf16 v[64:67], a[156:159], a[108:111], v[64:67]
    ds_read_b128 a[208:211], v9 offset:44032
    v_mul_f32 v59, v59, v131
    v_mfma_f32_16x16x32_bf16 v[60:63], a[160:163], a[112:115], v[60:63]
    ds_read_b128 a[212:215], v9 offset:53248
    v_cvt_pk_bf16_f32 v128, v56, v57
    v_mfma_f32_16x16x32_bf16 v[64:67], a[160:163], a[116:119], v[64:67]
    buffer_load_dwordx4 v[36:39], v4, s[32:35], s38 offen offset:0
    v_cvt_pk_bf16_f32 v129, v58, v59
    v_mfma_f32_16x16x32_bf16 v[60:63], a[164:167], a[120:123], v[60:63]
    v_mfma_f32_16x16x32_bf16 v[64:67], a[164:167], a[124:127], v[64:67]
    v_mfma_f32_16x16x32_bf16 v[68:71], a[168:171], a[48:51], v[68:71]
    v_mfma_f32_16x16x32_bf16 v[72:75], a[168:171], a[52:55], v[72:75]
    buffer_load_dwordx4 v[40:43], v4, s[32:35], s38 offen offset:1024
    v_mfma_f32_16x16x32_bf16 v[68:71], a[172:175], a[56:59], v[68:71]
    v_mfma_f32_16x16x32_bf16 v[72:75], a[172:175], a[60:63], v[72:75]
    v_mfma_f32_16x16x32_bf16 v[68:71], a[176:179], a[64:67], v[68:71]
    v_mfma_f32_16x16x32_bf16 v[72:75], a[176:179], a[68:71], v[72:75]
    buffer_load_dwordx4 v[44:47], v4, s[32:35], s38 offen offset:2048
    s_waitcnt lgkmcnt(0)
    v_mfma_f32_16x16x32_bf16 v[68:71], a[180:183], a[72:75], v[68:71]
    ds_read_b128 a[144:147], v10 offset:7168
    v_mul_f32 v60, v60, v132
    v_mfma_f32_16x16x32_bf16 v[72:75], a[180:183], a[76:79], v[72:75]
    ds_read_b128 a[148:151], v10 offset:16384
    v_mul_f32 v61, v61, v133
    v_mfma_f32_16x16x32_bf16 v[68:71], a[184:187], a[80:83], v[68:71]
    ds_read_b128 a[152:155], v10 offset:25600
    v_mul_f32 v62, v62, v134
    v_mfma_f32_16x16x32_bf16 v[72:75], a[184:187], a[84:87], v[72:75]
    ds_read_b128 a[156:159], v10 offset:34816
    buffer_load_dwordx4 v[116:119], v4, s[32:35], s38 offen offset:3072
    s_add_u32 s38, s38, 4096
    v_mfma_f32_16x16x32_bf16 v[68:71], a[188:191], a[88:91], v[68:71]
    ds_read_b128 a[160:163], v8 offset:7168
    v_mul_f32 v63, v63, v135
    v_mfma_f32_16x16x32_bf16 v[72:75], a[188:191], a[92:95], v[72:75]
    ds_read_b128 a[164:167], v8 offset:16384
    v_cvt_pk_bf16_f32 v126, v60, v61
    v_mfma_f32_16x16x32_bf16 v[68:71], a[192:195], a[96:99], v[68:71]
    ds_read_b128 a[168:171], v8 offset:25600
    v_cvt_pk_bf16_f32 v127, v62, v63
    v_mfma_f32_16x16x32_bf16 v[72:75], a[192:195], a[100:103], v[72:75]
    ds_read_b128 a[172:175], v8 offset:34816
    buffer_load_dwordx4 v[108:111], v4, s[32:35], s38 offen offset:0
    s_add_u32 s38, s38, 28672
    v_mfma_f32_16x16x32_bf16 v[68:71], a[196:199], a[104:107], v[68:71]
    ds_read_b128 a[176:179], v9 offset:45056
    v_mul_f32 v64, v64, v136
    v_mfma_f32_16x16x32_bf16 v[72:75], a[196:199], a[108:111], v[72:75]
    v_mul_f32 v65, v65, v137
    v_mul_f32 v66, v66, v138
    v_mfma_f32_16x16x32_bf16 v[68:71], a[200:203], a[112:115], v[68:71]
    v_mul_f32 v67, v67, v139
    v_cvt_pk_bf16_f32 v130, v64, v65
    v_mfma_f32_16x16x32_bf16 v[72:75], a[200:203], a[116:119], v[72:75]
    s_add_u32 s57, s56, 32768
    buffer_store_dwordx4 v[124:127], v4, s[32:35], s57 offen sc1
    v_cvt_pk_bf16_f32 v131, v66, v67
    v_mfma_f32_16x16x32_bf16 v[68:71], a[204:207], a[120:123], v[68:71]
    v_mfma_f32_16x16x32_bf16 v[72:75], a[204:207], a[124:127], v[72:75]
    v_mfma_f32_16x16x32_bf16 v[76:79], a[208:211], a[48:51], v[76:79]
    s_waitcnt vmcnt(10)
    s_mov_b64 exec, 1
    buffer_store_dword v1, off, s[32:35], s8 sc1
    s_mov_b64 exec, -1
    s_add_u32 s8, s8, 65536
    v_mfma_f32_16x16x32_bf16 v[80:83], a[208:211], a[52:55], v[80:83]
    buffer_load_dword v223, v222, s[32:35], s9 offen sc1
    s_add_u32 s57, s56, 106496
    buffer_store_dwordx4 v[128:131], v4, s[32:35], s57 offen sc1
    v_mfma_f32_16x16x32_bf16 v[76:79], a[212:215], a[56:59], v[76:79]
    v_mfma_f32_16x16x32_bf16 v[80:83], a[212:215], a[60:63], v[80:83]
    s_waitcnt lgkmcnt(0)
    v_mfma_f32_16x16x32_bf16 v[76:79], a[144:147], a[64:67], v[76:79]
    ds_read_b128 a[180:183], v9 offset:54272
    v_mfma_f32_16x16x32_bf16 v[80:83], a[144:147], a[68:71], v[80:83]
    ds_read_b128 a[184:187], v10 offset:8192
    buffer_load_dwordx4 v[48:51], v4, s[32:35], s38 offen offset:0
    v_mfma_f32_16x16x32_bf16 v[76:79], a[148:151], a[72:75], v[76:79]
    ds_read_b128 a[188:191], v10 offset:17408
    v_mul_f32 v68, v68, v140
    v_mfma_f32_16x16x32_bf16 v[80:83], a[148:151], a[76:79], v[80:83]
    ds_read_b128 a[192:195], v10 offset:26624
    v_mul_f32 v69, v69, v141
    v_mfma_f32_16x16x32_bf16 v[76:79], a[152:155], a[80:83], v[76:79]
    ds_read_b128 a[196:199], v10 offset:35840
    v_mul_f32 v70, v70, v142
    v_mfma_f32_16x16x32_bf16 v[80:83], a[152:155], a[84:87], v[80:83]
    ds_read_b128 a[200:203], v8 offset:8192
    buffer_load_dwordx4 v[120:123], v4, s[32:35], s38 offen offset:1024
    v_mfma_f32_16x16x32_bf16 v[76:79], a[156:159], a[88:91], v[76:79]
    ds_read_b128 a[204:207], v8 offset:17408
    v_mul_f32 v71, v71, v143
    v_mfma_f32_16x16x32_bf16 v[80:83], a[156:159], a[92:95], v[80:83]
    ds_read_b128 a[208:211], v8 offset:26624
    v_cvt_pk_bf16_f32 v140, v68, v69
    v_mfma_f32_16x16x32_bf16 v[76:79], a[160:163], a[96:99], v[76:79]
    ds_read_b128 a[212:215], v8 offset:35840
    v_cvt_pk_bf16_f32 v141, v70, v71
    v_mfma_f32_16x16x32_bf16 v[80:83], a[160:163], a[100:103], v[80:83]
    buffer_load_dwordx4 v[112:115], v4, s[32:35], s38 offen offset:2048
    v_mul_f32 v72, v72, v144
    v_mfma_f32_16x16x32_bf16 v[76:79], a[164:167], a[104:107], v[76:79]
    v_mul_f32 v73, v73, v145
    v_mul_f32 v74, v74, v146
    v_mfma_f32_16x16x32_bf16 v[80:83], a[164:167], a[108:111], v[80:83]
    v_mul_f32 v75, v75, v147
    v_cvt_pk_bf16_f32 v144, v72, v73
    v_mfma_f32_16x16x32_bf16 v[76:79], a[168:171], a[112:115], v[76:79]
    v_cvt_pk_bf16_f32 v145, v74, v75
    v_mfma_f32_16x16x32_bf16 v[80:83], a[168:171], a[116:119], v[80:83]
    buffer_load_dwordx4 v[52:55], v4, s[32:35], s38 offen offset:3072
    s_add_u32 s38, s38, 4096
    v_mfma_f32_16x16x32_bf16 v[76:79], a[172:175], a[120:123], v[76:79]
    v_mfma_f32_16x16x32_bf16 v[80:83], a[172:175], a[124:127], v[80:83]
    v_mfma_f32_16x16x32_bf16 v[84:87], a[176:179], a[48:51], v[84:87]
    v_mfma_f32_16x16x32_bf16 v[88:91], a[176:179], a[52:55], v[88:91]
    buffer_load_dwordx4 v[56:59], v4, s[32:35], s38 offen offset:0
    s_waitcnt lgkmcnt(0)
    v_mfma_f32_16x16x32_bf16 v[84:87], a[180:183], a[56:59], v[84:87]
    v_mfma_f32_16x16x32_bf16 v[88:91], a[180:183], a[60:63], v[88:91]
    v_mfma_f32_16x16x32_bf16 v[84:87], a[184:187], a[64:67], v[84:87]
    v_mfma_f32_16x16x32_bf16 v[88:91], a[184:187], a[68:71], v[88:91]
    buffer_load_dwordx4 v[60:63], v4, s[32:35], s38 offen offset:1024
    v_mfma_f32_16x16x32_bf16 v[84:87], a[188:191], a[72:75], v[84:87]
    v_mul_f32 v76, v76, v148
    v_mul_f32 v77, v77, v149
    v_mfma_f32_16x16x32_bf16 v[88:91], a[188:191], a[76:79], v[88:91]
    v_mul_f32 v78, v78, v150
    v_mul_f32 v79, v79, v151
    v_mfma_f32_16x16x32_bf16 v[84:87], a[192:195], a[80:83], v[84:87]
    v_cvt_pk_bf16_f32 v142, v76, v77
    v_cvt_pk_bf16_f32 v143, v78, v79
    v_mfma_f32_16x16x32_bf16 v[88:91], a[192:195], a[84:87], v[88:91]
    buffer_load_dwordx4 v[132:135], v4, s[32:35], s38 offen offset:2048
    v_mul_f32 v80, v80, v152
    v_mfma_f32_16x16x32_bf16 v[84:87], a[196:199], a[88:91], v[84:87]
    v_mul_f32 v81, v81, v153
    v_mul_f32 v82, v82, v154
    v_mfma_f32_16x16x32_bf16 v[88:91], a[196:199], a[92:95], v[88:91]
    v_mul_f32 v83, v83, v155
    v_cvt_pk_bf16_f32 v146, v80, v81
    v_mfma_f32_16x16x32_bf16 v[84:87], a[200:203], a[96:99], v[84:87]
    v_cvt_pk_bf16_f32 v147, v82, v83
    v_mfma_f32_16x16x32_bf16 v[88:91], a[200:203], a[100:103], v[88:91]
    s_add_u32 s57, s56, 49152
    buffer_store_dwordx4 v[140:143], v4, s[32:35], s57 offen sc1
    v_mfma_f32_16x16x32_bf16 v[84:87], a[204:207], a[104:107], v[84:87]
    v_mfma_f32_16x16x32_bf16 v[88:91], a[204:207], a[108:111], v[88:91]
    v_mfma_f32_16x16x32_bf16 v[84:87], a[208:211], a[112:115], v[84:87]
    v_mfma_f32_16x16x32_bf16 v[88:91], a[208:211], a[116:119], v[88:91]
    s_add_u32 s57, s56, 122880
    buffer_store_dwordx4 v[144:147], v4, s[32:35], s57 offen sc1
    v_mfma_f32_16x16x32_bf16 v[84:87], a[212:215], a[120:123], v[84:87]
    v_mfma_f32_16x16x32_bf16 v[88:91], a[212:215], a[124:127], v[88:91]
    s_nop 7
    v_mul_f32 v84, v84, v156
    v_mul_f32 v85, v85, v157
    v_mul_f32 v86, v86, v158
    v_mul_f32 v87, v87, v159
    v_cvt_pk_bf16_f32 v156, v84, v85
    v_cvt_pk_bf16_f32 v157, v86, v87
    s_add_u32 s57, s58, 65536
    buffer_store_dwordx2 v[156:157], v13, s[32:35], s57 offen sc1
    v_mul_f32 v88, v88, v160
    v_mul_f32 v89, v89, v161
    v_mul_f32 v90, v90, v162
    v_mul_f32 v91, v91, v163
    v_cvt_pk_bf16_f32 v160, v88, v89
    v_cvt_pk_bf16_f32 v161, v90, v91
    s_add_u32 s57, s58, 139264
    buffer_store_dwordx2 v[160:161], v13, s[32:35], s57 offen sc1
    s_waitcnt vmcnt(11)
    s_mov_b64 exec, 1
    buffer_store_dword v1, off, s[32:35], s8 sc1
    s_mov_b64 exec, -1
    s_add_u32 s8, s8, 65536
    s_mov_b32 s45, 0
    s_branch L_fu1_chk
L_fu1_spin:
    s_sleep 1
    buffer_load_dword v223, v222, s[32:35], s9 offen sc1
    s_add_u32 s45, s45, 1
    s_waitcnt vmcnt(0)
L_fu1_chk:
    v_cmp_gt_i32 vcc, 0, v223
    s_cmp_ge_u32 s45, 0x100000
    s_cbranch_scc1 L_fu1_go
    s_cbranch_vccnz L_fu1_spin
L_fu1_go:
    s_add_u32 s9, s9, 65536
    buffer_load_dwordx4 v[124:127], v5, s[32:35], s39 offen offset:0
    buffer_load_dwordx4 v[64:67], v7, s[32:35], s39 offen offset:0
    buffer_load_dwordx4 v[136:139], v11, s[32:35], s39 offen offset:0
    buffer_load_dwordx4 v[128:131], v12, s[32:35], s39 offen offset:0
    buffer_load_dwordx4 v[68:71], v5, s[32:35], s39 offen offset:1024
    buffer_load_dwordx4 v[72:75], v7, s[32:35], s39 offen offset:1024
    buffer_load_dwordx4 a[48:51], v11, s[32:35], s39 offen offset:1024
    buffer_load_dwordx4 a[52:55], v12, s[32:35], s39 offen offset:1024
    s_add_u32 s39, s39, 8192
    buffer_load_dwordx4 a[56:59], v5, s[32:35], s39 offen offset:0
    buffer_load_dwordx4 a[60:63], v7, s[32:35], s39 offen offset:0
    buffer_load_dwordx4 a[64:67], v11, s[32:35], s39 offen offset:0
    buffer_load_dwordx4 a[68:71], v12, s[32:35], s39 offen offset:0
    buffer_load_dwordx4 a[72:75], v5, s[32:35], s39 offen offset:1024
    buffer_load_dwordx4 a[76:79], v7, s[32:35], s39 offen offset:1024
    buffer_load_dwordx4 a[80:83], v11, s[32:35], s39 offen offset:1024
    buffer_load_dwordx4 a[84:87], v12, s[32:35], s39 offen offset:1024
    s_add_u32 s39, s39, 8192
    s_waitcnt vmcnt(12)
    s_mov_b64 exec, 1
    buffer_store_dword v1, off, s[32:35], s8 sc1
    s_mov_b64 exec, -1
    s_add_u32 s8, s8, 65536
    v_mfma_f32_16x16x32_bf16 v[232:235], a[248:251], v[124:127], 0
    buffer_load_dword v223, v222, s[32:35], s9 offen sc1
    v_mfma_f32_16x16x32_bf16 a[144:147], a[248:251], v[64:67], 0
    buffer_load_dwordx4 v[76:79], v4, s[32:35], s38 offen offset:3072
    s_add_u32 s38, s38, 4096
    v_mfma_f32_16x16x32_bf16 a[148:151], a[248:251], v[136:139], 0
    v_mfma_f32_16x16x32_bf16 a[152:155], a[248:251], v[128:131], 0
    v_mfma_f32_16x16x32_bf16 v[236:239], a[252:255], v[124:127], 0
    v_mfma_f32_16x16x32_bf16 a[156:159], a[252:255], v[64:67], 0
    buffer_load_dwordx4 v[148:151], v4, s[32:35], s38 offen offset:0
    s_add_u32 s38, s38, 28672
    v_mfma_f32_16x16x32_bf16 a[160:163], a[252:255], v[136:139], 0
    v_mfma_f32_16x16x32_bf16 a[164:167], a[252:255], v[128:131], 0
    v_mfma_f32_16x16x32_bf16 v[20:23], v[224:227], v[124:127], 0
    v_mfma_f32_16x16x32_bf16 a[168:171], v[224:227], v[64:67], 0
    buffer_load_dwordx4 a[88:91], v4, s[32:35], s38 offen offset:0
    v_mfma_f32_16x16x32_bf16 a[172:175], v[224:227], v[136:139], 0
    v_mfma_f32_16x16x32_bf16 a[176:179], v[224:227], v[128:131], 0
    v_mfma_f32_16x16x32_bf16 v[24:27], v[228:231], v[124:127], 0
    v_mfma_f32_16x16x32_bf16 a[180:183], v[228:231], v[64:67], 0
    buffer_load_dwordx4 a[92:95], v4, s[32:35], s38 offen offset:1024
    v_mfma_f32_16x16x32_bf16 a[184:187], v[228:231], v[136:139], 0
    v_mfma_f32_16x16x32_bf16 a[188:191], v[228:231], v[128:131], 0
    v_mfma_f32_16x16x32_bf16 v[92:95], v[196:199], v[124:127], 0
    v_mfma_f32_16x16x32_bf16 a[192:195], v[196:199], v[64:67], 0
    buffer_load_dwordx4 a[96:99], v4, s[32:35], s38 offen offset:2048
    v_mfma_f32_16x16x32_bf16 a[196:199], v[196:199], v[136:139], 0
    v_mfma_f32_16x16x32_bf16 a[200:203], v[196:199], v[128:131], 0
    s_waitcnt vmcnt(5)
    s_mov_b32 s45, 0
    s_branch L_fu2_chk
L_fu2_spin:
    s_sleep 1
    buffer_load_dword v223, v222, s[32:35], s9 offen sc1
    s_add_u32 s45, s45, 1
    s_waitcnt vmcnt(0)
L_fu2_chk:
    v_cmp_gt_i32 vcc, 0, v223
    s_cmp_ge_u32 s45, 0x100000
    s_cbranch_scc1 L_fu2_go
    s_cbranch_vccnz L_fu2_spin
L_fu2_go:
    s_add_u32 s9, s9, 65536
    v_mfma_f32_16x16x32_bf16 v[96:99], v[196:199], v[68:71], 0
    v_mfma_f32_16x16x32_bf16 a[204:207], v[196:199], v[72:75], 0
    buffer_load_dwordx4 v[80:83], v5, s[32:35], s39 offen offset:0
    v_mfma_f32_16x16x32_bf16 a[208:211], v[196:199], a[48:51], 0
    v_mfma_f32_16x16x32_bf16 a[212:215], v[196:199], a[52:55], 0
    v_mfma_f32_16x16x32_bf16 v[232:235], v[208:211], v[68:71], v[232:235]
    v_mfma_f32_16x16x32_bf16 a[144:147], v[208:211], v[72:75], a[144:147]
    buffer_load_dwordx4 v[152:155], v7, s[32:35], s39 offen offset:0
    v_mfma_f32_16x16x32_bf16 a[148:151], v[208:211], a[48:51], a[148:151]
    v_mfma_f32_16x16x32_bf16 a[152:155], v[208:211], a[52:55], a[152:155]
    v_mfma_f32_16x16x32_bf16 v[236:239], v[212:215], v[68:71], v[236:239]
    v_mfma_f32_16x16x32_bf16 a[156:159], v[212:215], v[72:75], a[156:159]
    buffer_load_dword v223, v222, s[32:35], s9 offen sc1
    buffer_load_dwordx4 a[100:103], v11, s[32:35], s39 offen offset:0
    v_mfma_f32_16x16x32_bf16 a[160:163], v[212:215], a[48:51], a[160:163]
    v_mfma_f32_16x16x32_bf16 a[164:167], v[212:215], a[52:55], a[164:167]
    v_mfma_f32_16x16x32_bf16 v[20:23], v[188:191], v[68:71], v[20:23]
    v_mfma_f32_16x16x32_bf16 a[168:171], v[188:191], v[72:75], a[168:171]
    buffer_load_dwordx4 v[140:143], v12, s[32:35], s39 offen offset:0
    v_mfma_f32_16x16x32_bf16 a[172:175], v[188:191], a[48:51], a[172:175]
    v_mfma_f32_16x16x32_bf16 a[176:179], v[188:191], a[52:55], a[176:179]
    v_mfma_f32_16x16x32_bf16 v[24:27], v[192:195], v[68:71], v[24:27]
    v_mfma_f32_16x16x32_bf16 a[180:183], v[192:195], v[72:75], a[180:183]
    buffer_load_dwordx4 a[104:107], v5, s[32:35], s39 offen offset:1024
    v_mfma_f32_16x16x32_bf16 a[184:187], v[192:195], a[48:51], a[184:187]
    v_mfma_f32_16x16x32_bf16 a[188:191], v[192:195], a[52:55], a[188:191]
    v_mfma_f32_16x16x32_bf16 v[232:235], v[200:203], a[56:59], v[232:235]
    v_mfma_f32_16x16x32_bf16 a[144:147], v[200:203], a[60:63], a[144:147]
    buffer_load_dwordx4 a[108:111], v7, s[32:35], s39 offen offset:1024
    v_mfma_f32_16x16x32_bf16 a[148:151], v[200:203], a[64:67], a[148:151]
    v_mfma_f32_16x16x32_bf16 a[152:155], v[200:203], a[68:71], a[152:155]
    v_mfma_f32_16x16x32_bf16 v[236:239], v[204:207], a[56:59], v[236:239]
    v_mfma_f32_16x16x32_bf16 a[156:159], v[204:207], a[60:63], a[156:159]
    buffer_load_dwordx4 a[112:115], v11, s[32:35], s39 offen offset:1024
    v_mfma_f32_16x16x32_bf16 a[160:163], v[204:207], a[64:67], a[160:163]
    v_mfma_f32_16x16x32_bf16 a[164:167], v[204:207], a[68:71], a[164:167]
    v_mfma_f32_16x16x32_bf16 v[20:23], v[164:167], a[56:59], v[20:23]
    v_mfma_f32_16x16x32_bf16 a[168:171], v[164:167], a[60:63], a[168:171]
    buffer_load_dwordx4 a[116:119], v12, s[32:35], s39 offen offset:1024
    s_add_u32 s39, s39, 8192
    v_mfma_f32_16x16x32_bf16 a[172:175], v[164:167], a[64:67], a[172:175]
    v_mfma_f32_16x16x32_bf16 a[176:179], v[164:167], a[68:71], a[176:179]
    v_mfma_f32_16x16x32_bf16 v[24:27], v[172:175], a[56:59], v[24:27]
    v_mfma_f32_16x16x32_bf16 a[180:183], v[172:175], a[60:63], a[180:183]
    buffer_load_dwordx4 v[144:147], v5, s[32:35], s39 offen offset:0
    v_mfma_f32_16x16x32_bf16 a[184:187], v[172:175], a[64:67], a[184:187]
    v_mfma_f32_16x16x32_bf16 a[188:191], v[172:175], a[68:71], a[188:191]
    v_mfma_f32_16x16x32_bf16 v[92:95], v[240:243], a[56:59], v[92:95]
    v_mfma_f32_16x16x32_bf16 a[192:195], v[240:243], a[60:63], a[192:195]
    buffer_load_dwordx4 a[120:123], v7, s[32:35], s39 offen offset:0
    v_mfma_f32_16x16x32_bf16 a[196:199], v[240:243], a[64:67], a[196:199]
    v_mfma_f32_16x16x32_bf16 a[200:203], v[240:243], a[68:71], a[200:203]
    v_mfma_f32_16x16x32_bf16 v[96:99], v[240:243], a[72:75], v[96:99]
    v_mfma_f32_16x16x32_bf16 a[204:207], v[240:243], a[76:79], a[204:207]
    buffer_load_dwordx4 a[124:127], v11, s[32:35], s39 offen offset:0
    v_mfma_f32_16x16x32_bf16 a[208:211], v[240:243], a[80:83], a[208:211]
    v_mfma_f32_16x16x32_bf16 a[212:215], v[240:243], a[84:87], a[212:215]
    v_mfma_f32_16x16x32_bf16 v[232:235], v[180:183], a[72:75], v[232:235]
    v_mfma_f32_16x16x32_bf16 a[144:147], v[180:183], a[76:79], a[144:147]
    buffer_load_dwordx4 v[84:87], v12, s[32:35], s39 offen offset:0
    v_mfma_f32_16x16x32_bf16 a[148:151], v[180:183], a[80:83], a[148:151]
    v_mfma_f32_16x16x32_bf16 a[152:155], v[180:183], a[84:87], a[152:155]
    v_mfma_f32_16x16x32_bf16 v[236:239], v[184:187], a[72:75], v[236:239]
    v_mfma_f32_16x16x32_bf16 a[156:159], v[184:187], a[76:79], a[156:159]
    buffer_load_dwordx4 v[156:159], v5, s[32:35], s39 offen offset:1024
    v_mfma_f32_16x16x32_bf16 a[160:163], v[184:187], a[80:83], a[160:163]
    v_mfma_f32_16x16x32_bf16 a[164:167], v[184:187], a[84:87], a[164:167]
    s_waitcnt vmcnt(11)
    s_mov_b32 s45, 0
    s_branch L_fu3_chk
L_fu3_spin:
    s_sleep 1
    buffer_load_dword v223, v222, s[32:35], s9 offen sc1
    s_add_u32 s45, s45, 1
    s_waitcnt vmcnt(0)
L_fu3_chk:
    v_cmp_gt_i32 vcc, 0, v223
    s_cmp_ge_u32 s45, 0x100000
    s_cbranch_scc1 L_fu3_go
    s_cbranch_vccnz L_fu3_spin
L_fu3_go:
    s_add_u32 s9, s9, 65536
    v_mfma_f32_16x16x32_bf16 v[20:23], v[168:171], a[72:75], v[20:23]
    v_mfma_f32_16x16x32_bf16 a[168:171], v[168:171], a[76:79], a[168:171]
    buffer_load_dwordx4 v[88:91], v7, s[32:35], s39 offen offset:1024
    v_mfma_f32_16x16x32_bf16 a[172:175], v[168:171], a[80:83], a[172:175]
    v_mfma_f32_16x16x32_bf16 a[176:179], v[168:171], a[84:87], a[176:179]
    v_mfma_f32_16x16x32_bf16 v[24:27], v[176:179], a[72:75], v[24:27]
    v_mfma_f32_16x16x32_bf16 a[180:183], v[176:179], a[76:79], a[180:183]
    buffer_load_dwordx4 v[160:163], v11, s[32:35], s39 offen offset:1024
    v_mfma_f32_16x16x32_bf16 a[184:187], v[176:179], a[80:83], a[184:187]
    v_mfma_f32_16x16x32_bf16 a[188:191], v[176:179], a[84:87], a[188:191]
    s_waitcnt vmcnt(11)
    v_mfma_f32_16x16x32_bf16 v[232:235], v[244:247], v[80:83], v[232:235]
    v_mfma_f32_16x16x32_bf16 a[144:147], v[244:247], v[152:155], a[144:147]
    buffer_load_dwordx4 a[248:251], v12, s[32:35], s39 offen offset:1024
    s_add_u32 s39, s39, 8192
    v_mfma_f32_16x16x32_bf16 a[148:151], v[244:247], a[100:103], a[148:151]
    v_mfma_f32_16x16x32_bf16 a[152:155], v[244:247], v[140:143], a[152:155]
    v_mfma_f32_16x16x32_bf16 v[236:239], v[248:251], v[80:83], v[236:239]
    v_mfma_f32_16x16x32_bf16 a[156:159], v[248:251], v[152:155], a[156:159]
    buffer_load_dwordx4 a[252:255], v5, s[32:35], s39 offen offset:0
    v_mfma_f32_16x16x32_bf16 a[160:163], v[248:251], a[100:103], a[160:163]
    v_mfma_f32_16x16x32_bf16 a[164:167], v[248:251], v[140:143], a[164:167]
    v_mfma_f32_16x16x32_bf16 v[20:23], v[252:255], v[80:83], v[20:23]
    v_mfma_f32_16x16x32_bf16 a[168:171], v[252:255], v[152:155], a[168:171]
    buffer_load_dwordx4 v[224:227], v7, s[32:35], s39 offen offset:0
    v_mfma_f32_16x16x32_bf16 a[172:175], v[252:255], a[100:103], a[172:175]
    v_mfma_f32_16x16x32_bf16 a[176:179], v[252:255], v[140:143], a[176:179]
    v_mfma_f32_16x16x32_bf16 v[24:27], a[128:131], v[80:83], v[24:27]
    v_mfma_f32_16x16x32_bf16 a[180:183], a[128:131], v[152:155], a[180:183]
    buffer_load_dwordx4 v[228:231], v11, s[32:35], s39 offen offset:0
    v_mfma_f32_16x16x32_bf16 a[184:187], a[128:131], a[100:103], a[184:187]
    v_mfma_f32_16x16x32_bf16 a[188:191], a[128:131], v[140:143], a[188:191]
    v_mfma_f32_16x16x32_bf16 v[92:95], a[220:223], v[80:83], v[92:95]
    v_mfma_f32_16x16x32_bf16 a[192:195], a[220:223], v[152:155], a[192:195]
    buffer_load_dwordx4 v[124:127], v12, s[32:35], s39 offen offset:0
    v_mfma_f32_16x16x32_bf16 a[196:199], a[220:223], a[100:103], a[196:199]
    v_mfma_f32_16x16x32_bf16 a[200:203], a[220:223], v[140:143], a[200:203]
    buffer_load_dword v223, v222, s[32:35], s9 offen sc1
    s_waitcnt vmcnt(13)
    v_mfma_f32_16x16x32_bf16 v[96:99], a[220:223], a[104:107], v[96:99]
    v_mfma_f32_16x16x32_bf16 a[204:207], a[220:223], a[108:111], a[204:207]
    buffer_load_dwordx4 v[64:67], v5, s[32:35], s39 offen offset:1024
    v_mfma_f32_16x16x32_bf16 a[208:211], a[220:223], a[112:115], a[208:211]
    v_mfma_f32_16x16x32_bf16 a[212:215], a[220:223], a[116:119], a[212:215]
    v_mfma_f32_16x16x32_bf16 v[232:235], a[132:135], a[104:107], v[232:235]
    v_mfma_f32_16x16x32_bf16 a[144:147], a[132:135], a[108:111], a[144:147]
    buffer_load_dwordx4 v[136:139], v7, s[32:35], s39 offen offset:1024
    v_mfma_f32_16x16x32_bf16 a[148:151], a[132:135], a[112:115], a[148:151]
    v_mfma_f32_16x16x32_bf16 a[152:155], a[132:135], a[116:119], a[152:155]
    v_mfma_f32_16x16x32_bf16 v[236:239], a[136:139], a[104:107], v[236:239]
    v_mfma_f32_16x16x32_bf16 a[156:159], a[136:139], a[108:111], a[156:159]
    buffer_load_dwordx4 v[128:131], v11, s[32:35], s39 offen offset:1024
    v_mfma_f32_16x16x32_bf16 a[160:163], a[136:139], a[112:115], a[160:163]
    v_mfma_f32_16x16x32_bf16 a[164:167], a[136:139], a[116:119], a[164:167]
    v_mfma_f32_16x16x32_bf16 v[20:23], a[140:143], a[104:107], v[20:23]
    v_mfma_f32_16x16x32_bf16 a[168:171], a[140:143], a[108:111], a[168:171]
    buffer_load_dwordx4 v[196:199], v12, s[32:35], s39 offen offset:1024
    s_add_u32 s39, s39, 8192
    v_mfma_f32_16x16x32_bf16 a[172:175], a[140:143], a[112:115], a[172:175]
    v_mfma_f32_16x16x32_bf16 a[176:179], a[140:143], a[116:119], a[176:179]
    v_mfma_f32_16x16x32_bf16 v[24:27], a[216:219], a[104:107], v[24:27]
    v_mfma_f32_16x16x32_bf16 a[180:183], a[216:219], a[108:111], a[180:183]
    buffer_load_dwordx4 v[208:211], v5, s[32:35], s39 offen offset:0
    v_mfma_f32_16x16x32_bf16 a[184:187], a[216:219], a[112:115], a[184:187]
    v_mfma_f32_16x16x32_bf16 a[188:191], a[216:219], a[116:119], a[188:191]
    s_waitcnt vmcnt(14)
    v_mfma_f32_16x16x32_bf16 v[232:235], a[224:227], v[144:147], v[232:235]
    v_mfma_f32_16x16x32_bf16 a[144:147], a[224:227], a[120:123], a[144:147]
    buffer_load_dwordx4 v[212:215], v7, s[32:35], s39 offen offset:0
    v_mfma_f32_16x16x32_bf16 a[148:151], a[224:227], a[124:127], a[148:151]
    v_mfma_f32_16x16x32_bf16 a[152:155], a[224:227], v[84:87], a[152:155]
    v_mfma_f32_16x16x32_bf16 v[236:239], a[228:231], v[144:147], v[236:239]
    v_mfma_f32_16x16x32_bf16 a[156:159], a[228:231], a[120:123], a[156:159]
    buffer_load_dwordx4 v[188:191], v11, s[32:35], s39 offen offset:0
    v_mfma_f32_16x16x32_bf16 a[160:163], a[228:231], a[124:127], a[160:163]
    v_mfma_f32_16x16x32_bf16 a[164:167], a[228:231], v[84:87], a[164:167]
    v_mfma_f32_16x16x32_bf16 v[20:23], a[232:235], v[144:147], v[20:23]
    v_mfma_f32_16x16x32_bf16 a[168:171], a[232:235], a[120:123], a[168:171]
    buffer_load_dwordx4 v[68:71], v12, s[32:35], s39 offen offset:0
    v_mfma_f32_16x16x32_bf16 a[172:175], a[232:235], a[124:127], a[172:175]
    v_mfma_f32_16x16x32_bf16 a[176:179], a[232:235], v[84:87], a[176:179]
    v_mfma_f32_16x16x32_bf16 v[24:27], a[236:239], v[144:147], v[24:27]
    v_mfma_f32_16x16x32_bf16 a[180:183], a[236:239], a[120:123], a[180:183]
    buffer_load_dwordx4 v[72:75], v5, s[32:35], s39 offen offset:1024
    v_mfma_f32_16x16x32_bf16 a[184:187], a[236:239], a[124:127], a[184:187]
    v_mfma_f32_16x16x32_bf16 a[188:191], a[236:239], v[84:87], a[188:191]
    v_mfma_f32_16x16x32_bf16 v[92:95], a[8:11], v[144:147], v[92:95]
    v_mfma_f32_16x16x32_bf16 a[192:195], a[8:11], a[120:123], a[192:195]
    buffer_load_dwordx4 a[48:51], v7, s[32:35], s39 offen offset:1024
    v_mfma_f32_16x16x32_bf16 a[196:199], a[8:11], a[124:127], a[196:199]
    v_mfma_f32_16x16x32_bf16 a[200:203], a[8:11], v[84:87], a[200:203]
    s_waitcnt vmcnt(10)
    s_mov_b32 s45, 0
    s_branch L_fu4_chk
L_fu4_spin:
    s_sleep 1
    buffer_load_dword v223, v222, s[32:35], s9 offen sc1
    s_add_u32 s45, s45, 1
    s_waitcnt vmcnt(0)
L_fu4_chk:
    v_cmp_gt_i32 vcc, 0, v223
    s_cmp_ge_u32 s45, 0x100000
    s_cbranch_scc1 L_fu4_go
    s_cbranch_vccnz L_fu4_spin
L_fu4_go:
    s_add_u32 s9, s9, 65536
    v_mfma_f32_16x16x32_bf16 v[96:99], a[8:11], v[156:159], v[96:99]
    v_mfma_f32_16x16x32_bf16 a[204:207], a[8:11], v[88:91], a[204:207]
    buffer_load_dwordx4 a[52:55], v11, s[32:35], s39 offen offset:1024
    v_mfma_f32_16x16x32_bf16 a[208:211], a[8:11], v[160:163], a[208:211]
    v_mfma_f32_16x16x32_bf16 a[212:215], a[8:11], a[248:251], a[212:215]
    v_mfma_f32_16x16x32_bf16 v[232:235], a[240:243], v[156:159], v[232:235]
    v_mfma_f32_16x16x32_bf16 a[144:147], a[240:243], v[88:91], a[144:147]
    buffer_load_dwordx4 v[192:195], v12, s[32:35], s39 offen offset:1024
    s_add_u32 s39, s39, 8192
    v_mfma_f32_16x16x32_bf16 a[148:151], a[240:243], v[160:163], a[148:151]
    v_mfma_f32_16x16x32_bf16 a[152:155], a[240:243], a[248:251], a[152:155]
    v_mfma_f32_16x16x32_bf16 v[236:239], a[244:247], v[156:159], v[236:239]
    v_mfma_f32_16x16x32_bf16 a[156:159], a[244:247], v[88:91], a[156:159]
    buffer_load_dwordx4 v[200:203], v5, s[32:35], s39 offen offset:0
    v_mfma_f32_16x16x32_bf16 a[160:163], a[244:247], v[160:163], a[160:163]
    v_mfma_f32_16x16x32_bf16 a[164:167], a[244:247], a[248:251], a[164:167]
    v_mfma_f32_16x16x32_bf16 v[20:23], a[0:3], v[156:159], v[20:23]
    v_mfma_f32_16x16x32_bf16 a[168:171], a[0:3], v[88:91], a[168:171]
    buffer_load_dwordx4 v[204:207], v7, s[32:35], s39 offen offset:0
    v_mfma_f32_16x16x32_bf16 a[172:175], a[0:3], v[160:163], a[172:175]
    v_mfma_f32_16x16x32_bf16 a[176:179], a[0:3], a[248:251], a[176:179]
    v_mfma_f32_16x16x32_bf16 v[24:27], a[4:7], v[156:159], v[24:27]
    v_mfma_f32_16x16x32_bf16 a[180:183], a[4:7], v[88:91], a[180:183]
    buffer_load_dwordx4 v[164:167], v11, s[32:35], s39 offen offset:0
    v_mfma_f32_16x16x32_bf16 a[184:187], a[4:7], v[160:163], a[184:187]
    v_mfma_f32_16x16x32_bf16 a[188:191], a[4:7], a[248:251], a[188:191]
    v_mfma_f32_16x16x32_bf16 v[232:235], a[12:15], a[252:255], v[232:235]
    v_mfma_f32_16x16x32_bf16 a[144:147], a[12:15], v[224:227], a[144:147]
    buffer_load_dwordx4 v[172:175], v12, s[32:35], s39 offen offset:0
    v_mfma_f32_16x16x32_bf16 a[148:151], a[12:15], v[228:231], a[148:151]
    v_mfma_f32_16x16x32_bf16 a[152:155], a[12:15], v[124:127], a[152:155]
    v_mfma_f32_16x16x32_bf16 v[236:239], a[16:19], a[252:255], v[236:239]
    v_mfma_f32_16x16x32_bf16 a[156:159], a[16:19], v[224:227], a[156:159]
    buffer_load_dwordx4 a[56:59], v5, s[32:35], s39 offen offset:1024
    v_mfma_f32_16x16x32_bf16 a[160:163], a[16:19], v[228:231], a[160:163]
    v_mfma_f32_16x16x32_bf16 a[164:167], a[16:19], v[124:127], a[164:167]
    v_mfma_f32_16x16x32_bf16 v[20:23], a[20:23], a[252:255], v[20:23]
    v_mfma_f32_16x16x32_bf16 a[168:171], a[20:23], v[224:227], a[168:171]
    buffer_load_dwordx4 a[60:63], v7, s[32:35], s39 offen offset:1024
    v_mfma_f32_16x16x32_bf16 a[172:175], a[20:23], v[228:231], a[172:175]
    v_mfma_f32_16x16x32_bf16 a[176:179], a[20:23], v[124:127], a[176:179]
    v_mfma_f32_16x16x32_bf16 v[24:27], a[24:27], a[252:255], v[24:27]
    v_mfma_f32_16x16x32_bf16 a[180:183], a[24:27], v[224:227], a[180:183]
    buffer_load_dwordx4 a[64:67], v11, s[32:35], s39 offen offset:1024
    v_mfma_f32_16x16x32_bf16 a[184:187], a[24:27], v[228:231], a[184:187]
    v_mfma_f32_16x16x32_bf16 a[188:191], a[24:27], v[124:127], a[188:191]
    v_mfma_f32_16x16x32_bf16 v[92:95], a[44:47], a[252:255], v[92:95]
    v_mfma_f32_16x16x32_bf16 a[192:195], a[44:47], v[224:227], a[192:195]
    buffer_load_dwordx4 a[68:71], v12, s[32:35], s39 offen offset:1024
    s_add_u32 s39, s39, 8192
    v_mfma_f32_16x16x32_bf16 a[196:199], a[44:47], v[228:231], a[196:199]
    v_mfma_f32_16x16x32_bf16 a[200:203], a[44:47], v[124:127], a[200:203]
    s_waitcnt vmcnt(16)
    v_mfma_f32_16x16x32_bf16 v[96:99], a[44:47], v[64:67], v[96:99]
    v_mfma_f32_16x16x32_bf16 a[204:207], a[44:47], v[136:139], a[204:207]
    buffer_load_dwordx4 v[240:243], v5, s[32:35], s39 offen offset:0
    v_mfma_f32_16x16x32_bf16 a[208:211], a[44:47], v[128:131], a[208:211]
    v_mfma_f32_16x16x32_bf16 a[212:215], a[44:47], v[196:199], a[212:215]
    v_mfma_f32_16x16x32_bf16 v[232:235], a[28:31], v[64:67], v[232:235]
    v_mfma_f32_16x16x32_bf16 a[144:147], a[28:31], v[136:139], a[144:147]
    buffer_load_dwordx4 v[180:183], v7, s[32:35], s39 offen offset:0
    v_mfma_f32_16x16x32_bf16 a[148:151], a[28:31], v[128:131], a[148:151]
    v_mfma_f32_16x16x32_bf16 a[152:155], a[28:31], v[196:199], a[152:155]
    v_mfma_f32_16x16x32_bf16 v[236:239], a[32:35], v[64:67], v[236:239]
    v_mfma_f32_16x16x32_bf16 a[156:159], a[32:35], v[136:139], a[156:159]
    buffer_load_dwordx4 v[184:187], v11, s[32:35], s39 offen offset:0
    v_mfma_f32_16x16x32_bf16 a[160:163], a[32:35], v[128:131], a[160:163]
    v_mfma_f32_16x16x32_bf16 a[164:167], a[32:35], v[196:199], a[164:167]
    v_mfma_f32_16x16x32_bf16 v[20:23], a[36:39], v[64:67], v[20:23]
    v_mfma_f32_16x16x32_bf16 a[168:171], a[36:39], v[136:139], a[168:171]
    buffer_load_dwordx4 v[168:171], v12, s[32:35], s39 offen offset:0
    v_mfma_f32_16x16x32_bf16 a[172:175], a[36:39], v[128:131], a[172:175]
    v_mfma_f32_16x16x32_bf16 a[176:179], a[36:39], v[196:199], a[176:179]
    v_mfma_f32_16x16x32_bf16 v[24:27], a[40:43], v[64:67], v[24:27]
    v_mfma_f32_16x16x32_bf16 a[180:183], a[40:43], v[136:139], a[180:183]
    buffer_load_dwordx4 a[72:75], v5, s[32:35], s39 offen offset:1024
    v_mfma_f32_16x16x32_bf16 a[184:187], a[40:43], v[128:131], a[184:187]
    v_mfma_f32_16x16x32_bf16 a[188:191], a[40:43], v[196:199], a[188:191]
    s_barrier
    s_waitcnt vmcnt(17)
    v_mfma_f32_16x16x32_bf16 v[232:235], v[28:31], v[208:211], v[232:235]
    v_mfma_f32_16x16x32_bf16 a[144:147], v[28:31], v[212:215], a[144:147]
    buffer_load_dwordx4 a[76:79], v7, s[32:35], s39 offen offset:1024
    v_mfma_f32_16x16x32_bf16 a[148:151], v[28:31], v[188:191], a[148:151]
    v_mfma_f32_16x16x32_bf16 a[152:155], v[28:31], v[68:71], a[152:155]
    v_mfma_f32_16x16x32_bf16 v[236:239], v[100:103], v[208:211], v[236:239]
    v_mfma_f32_16x16x32_bf16 a[156:159], v[100:103], v[212:215], a[156:159]
    buffer_load_dwordx4 a[80:83], v11, s[32:35], s39 offen offset:1024
    v_mfma_f32_16x16x32_bf16 a[160:163], v[100:103], v[188:191], a[160:163]
    v_mfma_f32_16x16x32_bf16 a[164:167], v[100:103], v[68:71], a[164:167]
    v_mfma_f32_16x16x32_bf16 v[20:23], v[32:35], v[208:211], v[20:23]
    v_mfma_f32_16x16x32_bf16 a[168:171], v[32:35], v[212:215], a[168:171]
    buffer_load_dwordx4 a[84:87], v12, s[32:35], s39 offen offset:1024
    s_add_u32 s39, s39, 8192
    v_mfma_f32_16x16x32_bf16 a[172:175], v[32:35], v[188:191], a[172:175]
    v_mfma_f32_16x16x32_bf16 a[176:179], v[32:35], v[68:71], a[176:179]
    v_mfma_f32_16x16x32_bf16 v[24:27], v[104:107], v[208:211], v[24:27]
    v_mfma_f32_16x16x32_bf16 a[180:183], v[104:107], v[212:215], a[180:183]
    buffer_load_dwordx4 v[176:179], v4, s[32:35], s38 offen offset:3072
    s_add_u32 s38, s38, 4096
    v_mfma_f32_16x16x32_bf16 a[184:187], v[104:107], v[188:191], a[184:187]
    v_mfma_f32_16x16x32_bf16 a[188:191], v[104:107], v[68:71], a[188:191]
    v_mfma_f32_16x16x32_bf16 v[92:95], v[108:111], v[208:211], v[92:95]
    v_mfma_f32_16x16x32_bf16 a[192:195], v[108:111], v[212:215], a[192:195]
    buffer_load_dwordx4 v[244:247], v4, s[32:35], s38 offen offset:0
    v_mfma_f32_16x16x32_bf16 a[196:199], v[108:111], v[188:191], a[196:199]
    v_mfma_f32_16x16x32_bf16 a[200:203], v[108:111], v[68:71], a[200:203]
    s_waitcnt vmcnt(18)
    v_mfma_f32_16x16x32_bf16 v[96:99], v[108:111], v[72:75], v[96:99]
    v_mfma_f32_16x16x32_bf16 a[204:207], v[108:111], a[48:51], a[204:207]
    buffer_load_dwordx4 v[248:251], v4, s[32:35], s38 offen offset:1024
    s_branch L_pgpost_kernel_11_s
.p2align 12
L_pgpost_kernel_11:
    s_branch L_hoppost_kernel_0
L_pgpost_kernel_11_s:
    v_mfma_f32_16x16x32_bf16 a[208:211], v[108:111], a[52:55], a[208:211]
    v_mfma_f32_16x16x32_bf16 a[212:215], v[108:111], v[192:195], a[212:215]
    v_mfma_f32_16x16x32_bf16 v[232:235], v[36:39], v[72:75], v[232:235]
    v_mfma_f32_16x16x32_bf16 a[144:147], v[36:39], a[48:51], a[144:147]
    buffer_load_dwordx4 v[252:255], v4, s[32:35], s38 offen offset:2048
    v_mfma_f32_16x16x32_bf16 a[148:151], v[36:39], a[52:55], a[148:151]
    v_mfma_f32_16x16x32_bf16 a[152:155], v[36:39], v[192:195], a[152:155]
    v_mfma_f32_16x16x32_bf16 v[236:239], v[40:43], v[72:75], v[236:239]
    v_mfma_f32_16x16x32_bf16 a[156:159], v[40:43], a[48:51], a[156:159]
    buffer_load_dwordx4 a[128:131], v4, s[32:35], s38 offen offset:3072
    s_add_u32 s38, s38, 4096
    v_mfma_f32_16x16x32_bf16 a[160:163], v[40:43], a[52:55], a[160:163]
    v_mfma_f32_16x16x32_bf16 a[164:167], v[40:43], v[192:195], a[164:167]
    v_mfma_f32_16x16x32_bf16 v[20:23], v[44:47], v[72:75], v[20:23]
    v_mfma_f32_16x16x32_bf16 a[168:171], v[44:47], a[48:51], a[168:171]
    buffer_load_dwordx4 v[80:83], v4, s[32:35], s38 offen offset:0
    s_add_u32 s38, s38, 36864
    v_mfma_f32_16x16x32_bf16 a[172:175], v[44:47], a[52:55], a[172:175]
    v_mfma_f32_16x16x32_bf16 a[176:179], v[44:47], v[192:195], a[176:179]
    v_mfma_f32_16x16x32_bf16 v[24:27], v[116:119], v[72:75], v[24:27]
    v_mfma_f32_16x16x32_bf16 a[180:183], v[116:119], a[48:51], a[180:183]
    buffer_load_dwordx4 v[152:155], v5, s[32:35], s39 offen offset:0
    v_mfma_f32_16x16x32_bf16 a[184:187], v[116:119], a[52:55], a[184:187]
    v_mfma_f32_16x16x32_bf16 a[188:191], v[116:119], v[192:195], a[188:191]
    s_waitcnt vmcnt(19)
    v_mfma_f32_16x16x32_bf16 v[232:235], v[48:51], v[200:203], v[232:235]
    v_mfma_f32_16x16x32_bf16 a[144:147], v[48:51], v[204:207], a[144:147]
    buffer_load_dwordx4 a[100:103], v7, s[32:35], s39 offen offset:0
    v_mfma_f32_16x16x32_bf16 a[148:151], v[48:51], v[164:167], a[148:151]
    v_mfma_f32_16x16x32_bf16 a[152:155], v[48:51], v[172:175], a[152:155]
    buffer_load_dwordx4 v[216:219], v4, s[32:35], s7 offen
    buffer_load_dwordx4 v[140:143], v4, s[32:35], s7 offen offset:1024
    v_mfma_f32_16x16x32_bf16 v[236:239], v[120:123], v[200:203], v[236:239]
    v_mfma_f32_16x16x32_bf16 a[156:159], v[120:123], v[204:207], a[156:159]
    buffer_load_dwordx4 a[220:223], v11, s[32:35], s39 offen offset:0
    v_mfma_f32_16x16x32_bf16 a[160:163], v[120:123], v[164:167], a[160:163]
    v_mfma_f32_16x16x32_bf16 a[164:167], v[120:123], v[172:175], a[164:167]
    v_mfma_f32_16x16x32_bf16 v[20:23], v[112:115], v[200:203], v[20:23]
    v_mfma_f32_16x16x32_bf16 a[168:171], v[112:115], v[204:207], a[168:171]
    buffer_load_dwordx4 a[132:135], v12, s[32:35], s39 offen offset:0
    v_mfma_f32_16x16x32_bf16 a[172:175], v[112:115], v[164:167], a[172:175]
    v_mfma_f32_16x16x32_bf16 a[176:179], v[112:115], v[172:175], a[176:179]
    buffer_load_dwordx2 v[220:221], v13, s[32:35], s7 offen offset:2048
    v_mfma_f32_16x16x32_bf16 v[24:27], v[52:55], v[200:203], v[24:27]
    v_mfma_f32_16x16x32_bf16 a[180:183], v[52:55], v[204:207], a[180:183]
    buffer_load_dwordx4 a[136:139], v5, s[32:35], s39 offen offset:1024
    v_mfma_f32_16x16x32_bf16 a[184:187], v[52:55], v[164:167], a[184:187]
    v_mfma_f32_16x16x32_bf16 a[188:191], v[52:55], v[172:175], a[188:191]
    v_mfma_f32_16x16x32_bf16 v[92:95], v[148:151], v[200:203], v[92:95]
    v_mfma_f32_16x16x32_bf16 a[192:195], v[148:151], v[204:207], a[192:195]
    buffer_load_dwordx4 a[140:143], v7, s[32:35], s39 offen offset:1024
    v_mfma_f32_16x16x32_bf16 a[196:199], v[148:151], v[164:167], a[196:199]
    v_mfma_f32_16x16x32_bf16 a[200:203], v[148:151], v[172:175], a[200:203]
    s_waitcnt vmcnt(23)
    v_mfma_f32_16x16x32_bf16 v[96:99], v[148:151], a[56:59], v[96:99]
    v_mfma_f32_16x16x32_bf16 a[204:207], v[148:151], a[60:63], a[204:207]
    buffer_load_dwordx4 a[104:107], v11, s[32:35], s39 offen offset:1024
    v_mfma_f32_16x16x32_bf16 a[208:211], v[148:151], a[64:67], a[208:211]
    v_mfma_f32_16x16x32_bf16 a[212:215], v[148:151], a[68:71], a[212:215]
    v_mfma_f32_16x16x32_bf16 v[232:235], v[56:59], a[56:59], v[232:235]
    v_mfma_f32_16x16x32_bf16 a[144:147], v[56:59], a[60:63], a[144:147]
    buffer_load_dwordx4 a[108:111], v12, s[32:35], s39 offen offset:1024
    s_add_u32 s39, s39, 8192
    v_mfma_f32_16x16x32_bf16 a[148:151], v[56:59], a[64:67], a[148:151]
    v_mfma_f32_16x16x32_bf16 a[152:155], v[56:59], a[68:71], a[152:155]
    v_mfma_f32_16x16x32_bf16 v[236:239], v[60:63], a[56:59], v[236:239]
    v_mfma_f32_16x16x32_bf16 a[156:159], v[60:63], a[60:63], a[156:159]
    buffer_load_dwordx4 a[112:115], v4, s[32:35], s38 offen offset:0
    s_sub_u32 s38, s38, 8192
    v_mfma_f32_16x16x32_bf16 a[160:163], v[60:63], a[64:67], a[160:163]
    v_mfma_f32_16x16x32_bf16 a[164:167], v[60:63], a[68:71], a[164:167]
    v_mfma_f32_16x16x32_bf16 v[20:23], v[132:135], a[56:59], v[20:23]
    v_mfma_f32_16x16x32_bf16 a[168:171], v[132:135], a[60:63], a[168:171]
    buffer_load_dwordx4 a[116:119], v4, s[32:35], s38 offen offset:0
    s_add_u32 s38, s38, 4096
    v_mfma_f32_16x16x32_bf16 a[172:175], v[132:135], a[64:67], a[172:175]
    v_mfma_f32_16x16x32_bf16 a[176:179], v[132:135], a[68:71], a[176:179]
    v_mfma_f32_16x16x32_bf16 v[24:27], v[76:79], a[56:59], v[24:27]
    v_mfma_f32_16x16x32_bf16 a[180:183], v[76:79], a[60:63], a[180:183]
    buffer_load_dwordx4 a[216:219], v4, s[32:35], s38 offen offset:0
    s_sub_u32 s38, s38, 4096
    v_mfma_f32_16x16x32_bf16 a[184:187], v[76:79], a[64:67], a[184:187]
    v_mfma_f32_16x16x32_bf16 a[188:191], v[76:79], a[68:71], a[188:191]
    s_waitcnt vmcnt(24)
    v_mfma_f32_16x16x32_bf16 v[232:235], a[88:91], v[240:243], v[232:235]
    v_mfma_f32_16x16x32_bf16 a[144:147], a[88:91], v[180:183], a[144:147]
    buffer_load_dwordx4 a[224:227], v4, s[32:35], s38 offen offset:1024
    s_add_u32 s38, s38, 4096
    v_mfma_f32_16x16x32_bf16 a[148:151], a[88:91], v[184:187], a[148:151]
    v_mfma_f32_16x16x32_bf16 a[152:155], a[88:91], v[168:171], a[152:155]
    v_mfma_f32_16x16x32_bf16 v[236:239], a[92:95], v[240:243], v[236:239]
    v_mfma_f32_16x16x32_bf16 a[156:159], a[92:95], v[180:183], a[156:159]
    buffer_load_dwordx4 a[228:231], v4, s[32:35], s38 offen offset:1024
    s_sub_u32 s38, s38, 4096
    v_mfma_f32_16x16x32_bf16 a[160:163], a[92:95], v[184:187], a[160:163]
    v_mfma_f32_16x16x32_bf16 a[164:167], a[92:95], v[168:171], a[164:167]
    v_mfma_f32_16x16x32_bf16 v[20:23], a[96:99], v[240:243], v[20:23]
    v_mfma_f32_16x16x32_bf16 a[168:171], a[96:99], v[180:183], a[168:171]
    buffer_load_dwordx4 a[232:235], v4, s[32:35], s38 offen offset:2048
    s_add_u32 s38, s38, 4096
    v_mfma_f32_16x16x32_bf16 a[172:175], a[96:99], v[184:187], a[172:175]
    v_mfma_f32_16x16x32_bf16 a[176:179], a[96:99], v[168:171], a[176:179]
    s_waitcnt vmcnt(22)
    v_mfma_f32_16x16x32_bf16 v[24:27], v[176:179], v[240:243], v[24:27]
    v_mfma_f32_16x16x32_bf16 a[180:183], v[176:179], v[180:183], a[180:183]
    buffer_load_dwordx4 a[236:239], v4, s[32:35], s38 offen offset:2048
    s_sub_u32 s38, s38, 4096
    v_mfma_f32_16x16x32_bf16 a[184:187], v[176:179], v[184:187], a[184:187]
    v_mfma_f32_16x16x32_bf16 a[188:191], v[176:179], v[168:171], a[188:191]
    s_waitcnt vmcnt(18)
    v_mfma_f32_16x16x32_bf16 v[92:95], v[80:83], v[240:243], v[92:95]
    v_mfma_f32_16x16x32_bf16 a[192:195], v[80:83], v[180:183], a[192:195]
    buffer_load_dwordx4 v[144:147], v4, s[32:35], s38 offen offset:3072
    s_add_u32 s38, s38, 4096
    v_mfma_f32_16x16x32_bf16 a[196:199], v[80:83], v[184:187], a[196:199]
    v_mfma_f32_16x16x32_bf16 a[200:203], v[80:83], v[168:171], a[200:203]
    v_mfma_f32_16x16x32_bf16 v[96:99], v[80:83], a[72:75], v[96:99]
    v_mfma_f32_16x16x32_bf16 a[204:207], v[80:83], a[76:79], a[204:207]
    buffer_load_dwordx4 a[120:123], v4, s[32:35], s38 offen offset:3072
    v_mfma_f32_16x16x32_bf16 a[208:211], v[80:83], a[80:83], a[208:211]
    v_mfma_f32_16x16x32_bf16 a[212:215], v[80:83], a[84:87], a[212:215]
    v_mfma_f32_16x16x32_bf16 v[232:235], v[244:247], a[72:75], v[232:235]
    v_mfma_f32_16x16x32_bf16 a[144:147], v[244:247], a[76:79], a[144:147]
    v_mfma_f32_16x16x32_bf16 a[148:151], v[244:247], a[80:83], a[148:151]
    v_mfma_f32_16x16x32_bf16 a[152:155], v[244:247], a[84:87], a[152:155]
    v_mfma_f32_16x16x32_bf16 v[236:239], v[248:251], a[72:75], v[236:239]
    v_mfma_f32_16x16x32_bf16 a[156:159], v[248:251], a[76:79], a[156:159]
    v_mfma_f32_16x16x32_bf16 a[160:163], v[248:251], a[80:83], a[160:163]
    v_mfma_f32_16x16x32_bf16 a[164:167], v[248:251], a[84:87], a[164:167]
    v_mfma_f32_16x16x32_bf16 v[20:23], v[252:255], a[72:75], v[20:23]
    v_mfma_f32_16x16x32_bf16 a[168:171], v[252:255], a[76:79], a[168:171]
    v_mfma_f32_16x16x32_bf16 a[172:175], v[252:255], a[80:83], a[172:175]
    v_mfma_f32_16x16x32_bf16 a[176:179], v[252:255], a[84:87], a[176:179]
    v_mfma_f32_16x16x32_bf16 v[24:27], a[128:131], a[72:75], v[24:27]
    v_mfma_f32_16x16x32_bf16 a[180:183], a[128:131], a[76:79], a[180:183]
    v_mfma_f32_16x16x32_bf16 a[184:187], a[128:131], a[80:83], a[184:187]
    v_mfma_f32_16x16x32_bf16 a[188:191], a[128:131], a[84:87], a[188:191]
    s_waitcnt vmcnt(14)
    s_waitcnt vmcnt(8)
    v_mfma_f32_16x16x32_bf16 v[92:95], a[112:115], v[152:155], v[92:95]
    v_mfma_f32_16x16x32_bf16 a[192:195], a[112:115], a[100:103], a[192:195]
    v_mfma_f32_16x16x32_bf16 a[196:199], a[112:115], a[220:223], a[196:199]
    v_mfma_f32_16x16x32_bf16 a[200:203], a[112:115], a[132:135], a[200:203]
    v_mfma_f32_16x16x32_bf16 v[96:99], a[112:115], a[136:139], v[96:99]
    v_mfma_f32_16x16x32_bf16 a[204:207], a[112:115], a[140:143], a[204:207]
    v_mfma_f32_16x16x32_bf16 a[208:211], a[112:115], a[104:107], a[208:211]
    v_mfma_f32_16x16x32_bf16 a[212:215], a[112:115], a[108:111], a[212:215]
    s_waitcnt vmcnt(7)
    v_mfma_f32_16x16x32_bf16 v[232:235], a[116:119], v[152:155], v[232:235]
    v_mfma_f32_16x16x32_bf16 a[144:147], a[116:119], a[100:103], a[144:147]
    v_mfma_f32_16x16x32_bf16 a[148:151], a[116:119], a[220:223], a[148:151]
    v_mfma_f32_16x16x32_bf16 a[152:155], a[116:119], a[132:135], a[152:155]
    s_mov_b32 exec_hi, 0
    ds_write_b128 v14, a[192:195] offset:4096
    ds_write_b128 v15, a[196:199] offset:4096
    ds_write_b128 v16, a[200:203] offset:4096
    s_mov_b32 exec_hi, -1
    s_waitcnt vmcnt(6)
    v_mfma_f32_16x16x32_bf16 v[232:235], a[216:219], a[136:139], v[232:235]
    v_mfma_f32_16x16x32_bf16 a[144:147], a[216:219], a[140:143], a[144:147]
    v_mfma_f32_16x16x32_bf16 a[148:151], a[216:219], a[104:107], a[148:151]
    v_mfma_f32_16x16x32_bf16 a[152:155], a[216:219], a[108:111], a[152:155]
    s_mov_b32 exec_lo, 0
    ds_write_b128 v14, a[204:207] offset:4096
    ds_write_b128 v15, a[208:211] offset:4096
    ds_write_b128 v16, a[212:215] offset:4096
    v_mov_b32 v92, v96
    v_mov_b32 v93, v97
    v_mov_b32 v94, v98
    v_mov_b32 v95, v99
    s_mov_b32 exec_lo, -1
    s_waitcnt vmcnt(5)
    v_mfma_f32_16x16x32_bf16 v[236:239], a[224:227], v[152:155], v[236:239]
    v_mfma_f32_16x16x32_bf16 a[156:159], a[224:227], a[100:103], a[156:159]
    v_mfma_f32_16x16x32_bf16 a[160:163], a[224:227], a[220:223], a[160:163]
    v_mfma_f32_16x16x32_bf16 a[164:167], a[224:227], a[132:135], a[164:167]
    s_nop 1
    ds_write_b128 v14, a[144:147] offset:0
    ds_write_b128 v15, a[148:151] offset:0
    ds_write_b128 v16, a[152:155] offset:0
    s_waitcnt vmcnt(4)
    v_mfma_f32_16x16x32_bf16 v[236:239], a[228:231], a[136:139], v[236:239]
    v_mfma_f32_16x16x32_bf16 a[156:159], a[228:231], a[140:143], a[156:159]
    v_mfma_f32_16x16x32_bf16 a[160:163], a[228:231], a[104:107], a[160:163]
    v_mfma_f32_16x16x32_bf16 a[164:167], a[228:231], a[108:111], a[164:167]
    s_waitcnt vmcnt(3)
    v_mfma_f32_16x16x32_bf16 v[20:23], a[232:235], v[152:155], v[20:23]
    v_mfma_f32_16x16x32_bf16 a[168:171], a[232:235], a[100:103], a[168:171]
    v_mfma_f32_16x16x32_bf16 a[172:175], a[232:235], a[220:223], a[172:175]
    v_mfma_f32_16x16x32_bf16 a[176:179], a[232:235], a[132:135], a[176:179]
    s_nop 1
    ds_write_b128 v14, a[156:159] offset:1024
    ds_write_b128 v15, a[160:163] offset:1024
    ds_write_b128 v16, a[164:167] offset:1024
    s_waitcnt vmcnt(2)
    v_mfma_f32_16x16x32_bf16 v[20:23], a[236:239], a[136:139], v[20:23]
    v_mfma_f32_16x16x32_bf16 a[168:171], a[236:239], a[140:143], a[168:171]
    v_mfma_f32_16x16x32_bf16 a[172:175], a[236:239], a[104:107], a[172:175]
    v_mfma_f32_16x16x32_bf16 a[176:179], a[236:239], a[108:111], a[176:179]
    s_waitcnt vmcnt(1)
    v_mfma_f32_16x16x32_bf16 v[24:27], v[144:147], v[152:155], v[24:27]
    v_mfma_f32_16x16x32_bf16 a[180:183], v[144:147], a[100:103], a[180:183]
    v_mfma_f32_16x16x32_bf16 a[184:187], v[144:147], a[220:223], a[184:187]
    v_mfma_f32_16x16x32_bf16 a[188:191], v[144:147], a[132:135], a[188:191]
    s_nop 1
    ds_write_b128 v14, a[168:171] offset:2048
    ds_write_b128 v15, a[172:175] offset:2048
    ds_write_b128 v16, a[176:179] offset:2048
    s_waitcnt vmcnt(0)
    v_mfma_f32_16x16x32_bf16 v[24:27], a[120:123], a[136:139], v[24:27]
    v_mfma_f32_16x16x32_bf16 a[180:183], a[120:123], a[140:143], a[180:183]
    v_mfma_f32_16x16x32_bf16 a[184:187], a[120:123], a[104:107], a[184:187]
    v_mfma_f32_16x16x32_bf16 a[188:191], a[120:123], a[108:111], a[188:191]
    s_nop 7
    ds_write_b128 v14, a[180:183] offset:3072
    ds_write_b128 v15, a[184:187] offset:3072
    ds_write_b128 v16, a[188:191] offset:3072
    s_mul_i32 s44, s40, 15360
    s_add_u32 s44, s44, 0
    v_add_u32 v10, s44, v4
    s_waitcnt lgkmcnt(0)
    s_barrier
    ds_read_b128 v[28:31], v10 offset:0
    ds_read_b128 v[32:35], v10 offset:5120
    ds_read_b128 v[36:39], v10 offset:10240
    ds_read_b128 v[40:43], v10 offset:1024
    ds_read_b128 v[44:47], v10 offset:6144
    ds_read_b128 v[48:51], v10 offset:11264
    ds_read_b128 v[52:55], v10 offset:2048
    ds_read_b128 v[56:59], v10 offset:7168
    ds_read_b128 v[60:63], v10 offset:12288
    ds_read_b128 v[64:67], v10 offset:3072
    ds_read_b128 v[68:71], v10 offset:8192
    ds_read_b128 v[72:75], v10 offset:13312
    ds_read_b128 v[76:79], v10 offset:4096
    ds_read_b128 v[80:83], v10 offset:9216
    ds_read_b128 v[84:87], v10 offset:14336
    s_waitcnt lgkmcnt(12)
    v_lshlrev_b32 v100, 16, v216
    v_and_b32 v101, 0xffff0000, v216
    v_lshlrev_b32 v102, 16, v217
    v_and_b32 v103, 0xffff0000, v217
    v_pk_add_f32 v[232:233], v[232:233], v[28:29]
    v_pk_add_f32 v[234:235], v[234:235], v[30:31]
    v_pk_add_f32 v[32:33], v[32:33], v[36:37]
    v_pk_add_f32 v[34:35], v[34:35], v[38:39]
    v_pk_add_f32 v[232:233], v[232:233], v[32:33]
    v_pk_add_f32 v[234:235], v[234:235], v[34:35]
    v_pk_add_f32 v[232:233], v[232:233], v[100:101]
    v_pk_add_f32 v[234:235], v[234:235], v[102:103]
    v_cvt_pk_bf16_f32 v216, v232, v233
    v_cvt_pk_bf16_f32 v217, v234, v235
    s_waitcnt lgkmcnt(9)
    v_lshlrev_b32 v104, 16, v218
    v_and_b32 v105, 0xffff0000, v218
    v_lshlrev_b32 v106, 16, v219
    v_and_b32 v107, 0xffff0000, v219
    v_pk_add_f32 v[236:237], v[236:237], v[40:41]
    v_pk_add_f32 v[238:239], v[238:239], v[42:43]
    v_pk_add_f32 v[44:45], v[44:45], v[48:49]
    v_pk_add_f32 v[46:47], v[46:47], v[50:51]
    v_pk_add_f32 v[236:237], v[236:237], v[44:45]
    v_pk_add_f32 v[238:239], v[238:239], v[46:47]
    v_pk_add_f32 v[236:237], v[236:237], v[104:105]
    v_pk_add_f32 v[238:239], v[238:239], v[106:107]
    v_cvt_pk_bf16_f32 v218, v236, v237
    v_cvt_pk_bf16_f32 v219, v238, v239
    buffer_store_dwordx4 v[216:219], v17, s[24:27], s6 offen offset:0
    s_waitcnt lgkmcnt(6)
    v_lshlrev_b32 v100, 16, v140
    v_and_b32 v101, 0xffff0000, v140
    v_lshlrev_b32 v102, 16, v141
    v_and_b32 v103, 0xffff0000, v141
    v_pk_add_f32 v[20:21], v[20:21], v[52:53]
    v_pk_add_f32 v[22:23], v[22:23], v[54:55]
    v_pk_add_f32 v[56:57], v[56:57], v[60:61]
    v_pk_add_f32 v[58:59], v[58:59], v[62:63]
    v_pk_add_f32 v[20:21], v[20:21], v[56:57]
    v_pk_add_f32 v[22:23], v[22:23], v[58:59]
    v_pk_add_f32 v[20:21], v[20:21], v[100:101]
    v_pk_add_f32 v[22:23], v[22:23], v[102:103]
    v_cvt_pk_bf16_f32 v140, v20, v21
    v_cvt_pk_bf16_f32 v141, v22, v23
    s_waitcnt lgkmcnt(3)
    v_lshlrev_b32 v104, 16, v142
    v_and_b32 v105, 0xffff0000, v142
    v_lshlrev_b32 v106, 16, v143
    v_and_b32 v107, 0xffff0000, v143
    v_pk_add_f32 v[24:25], v[24:25], v[64:65]
    v_pk_add_f32 v[26:27], v[26:27], v[66:67]
    v_pk_add_f32 v[68:69], v[68:69], v[72:73]
    v_pk_add_f32 v[70:71], v[70:71], v[74:75]
    v_pk_add_f32 v[24:25], v[24:25], v[68:69]
    v_pk_add_f32 v[26:27], v[26:27], v[70:71]
    v_pk_add_f32 v[24:25], v[24:25], v[104:105]
    v_pk_add_f32 v[26:27], v[26:27], v[106:107]
    v_cvt_pk_bf16_f32 v142, v24, v25
    v_cvt_pk_bf16_f32 v143, v26, v27
    buffer_store_dwordx4 v[140:143], v17, s[24:27], s6 offen offset:64
    s_waitcnt lgkmcnt(0)
    v_lshlrev_b32 v100, 16, v220
    v_and_b32 v101, 0xffff0000, v220
    v_lshlrev_b32 v102, 16, v221
    v_and_b32 v103, 0xffff0000, v221
    v_pk_add_f32 v[92:93], v[92:93], v[76:77]
    v_pk_add_f32 v[94:95], v[94:95], v[78:79]
    v_pk_add_f32 v[80:81], v[80:81], v[84:85]
    v_pk_add_f32 v[82:83], v[82:83], v[86:87]
    v_pk_add_f32 v[92:93], v[92:93], v[80:81]
    v_pk_add_f32 v[94:95], v[94:95], v[82:83]
    v_mov_b32 v76, v92
    v_mov_b32 v77, v93
    v_mov_b32 v78, v94
    v_mov_b32 v79, v95
    v_permlane32_swap_b32 v92, v76
    v_permlane32_swap_b32 v93, v77
    v_permlane32_swap_b32 v94, v78
    v_permlane32_swap_b32 v95, v79
    s_mov_b32 exec_hi, 0
    v_pk_add_f32 v[92:93], v[92:93], v[76:77]
    v_pk_add_f32 v[94:95], v[94:95], v[78:79]
    v_pk_add_f32 v[92:93], v[92:93], v[100:101]
    v_pk_add_f32 v[94:95], v[94:95], v[102:103]
    v_cvt_pk_bf16_f32 v220, v92, v93
    v_cvt_pk_bf16_f32 v221, v94, v95
    buffer_store_dwordx2 v[220:221], v18, s[24:27], s6 offen offset:128
L_end_post_kernel:
    s_endpgm
L_hf0:
    s_sub_u32 s44, s50, 8192
    s_mov_b32 s45, 0
L_hf0_l:
    buffer_load_dwordx4 a[0:3], v4, s[32:35], s44 offen offset:0 sc1
    buffer_load_dwordx4 a[4:7], v5, s[32:35], s44 offen offset:0 sc1
    buffer_load_dwordx4 a[8:11], v4, s[32:35], s44 offen offset:1024 sc1
    buffer_load_dwordx4 a[12:15], v5, s[32:35], s44 offen offset:1024 sc1
    s_nop 0
    s_add_u32 s45, s45, 1
    s_waitcnt vmcnt(0)
    v_accvgpr_read_b32 v244, a0
    v_accvgpr_read_b32 v245, a4
    v_accvgpr_read_b32 v246, a8
    v_accvgpr_read_b32 v247, a12
    v_max3_u32 v244, v244, v245, v246
    v_max_u32 v244, v244, v247
    v_cmp_eq_u32 vcc, -1, v244
    s_cmp_ge_u32 s45, 0x100000
    s_cbranch_scc1 L_hb0
    s_cbranch_vccnz L_hf0_l
    s_branch L_hb0
L_hf1:
    s_sub_u32 s44, s50, 10240
    s_mov_b32 s45, 0
L_hf1_l:
    buffer_load_dwordx4 a[16:19], v4, s[32:35], s44 offen offset:0 sc1
    buffer_load_dwordx4 a[20:23], v5, s[32:35], s44 offen offset:0 sc1
    buffer_load_dwordx4 a[24:27], v4, s[32:35], s44 offen offset:1024 sc1
    buffer_load_dwordx4 a[28:31], v5, s[32:35], s44 offen offset:1024 sc1
    s_nop 0
    s_add_u32 s45, s45, 1
    s_waitcnt vmcnt(0)
    v_accvgpr_read_b32 v244, a16
    v_accvgpr_read_b32 v245, a20
    v_accvgpr_read_b32 v246, a24
    v_accvgpr_read_b32 v247, a28
    v_max3_u32 v244, v244, v245, v246
    v_max_u32 v244, v244, v247
    v_cmp_eq_u32 vcc, -1, v244
    s_cmp_ge_u32 s45, 0x100000
    s_cbranch_scc1 L_hb1
    s_cbranch_vccnz L_hf1_l
    s_branch L_hb1
L_hf2:
    s_sub_u32 s44, s50, 10240
    s_mov_b32 s45, 0
L_hf2_l:
    buffer_load_dwordx4 a[32:35], v4, s[32:35], s44 offen offset:0 sc1
    buffer_load_dwordx4 a[36:39], v5, s[32:35], s44 offen offset:0 sc1
    buffer_load_dwordx4 a[40:43], v4, s[32:35], s44 offen offset:1024 sc1
    buffer_load_dwordx4 a[44:47], v5, s[32:35], s44 offen offset:1024 sc1
    s_nop 0
    s_add_u32 s45, s45, 1
    s_waitcnt vmcnt(0)
    v_accvgpr_read_b32 v244, a32
    v_accvgpr_read_b32 v245, a36
    v_accvgpr_read_b32 v246, a40
    v_accvgpr_read_b32 v247, a44
    v_max3_u32 v244, v244, v245, v246
    v_max_u32 v244, v244, v247
    v_cmp_eq_u32 vcc, -1, v244
    s_cmp_ge_u32 s45, 0x100000
    s_cbranch_scc1 L_hb2
    s_cbranch_vccnz L_hf2_l
    s_branch L_hb2
L_hf3:
    s_sub_u32 s44, s50, 10240
    s_mov_b32 s45, 0
L_hf3_l:
    buffer_load_dwordx4 a[48:51], v4, s[32:35], s44 offen offset:0 sc1
    buffer_load_dwordx4 a[52:55], v5, s[32:35], s44 offen offset:0 sc1
    buffer_load_dwordx4 a[56:59], v4, s[32:35], s44 offen offset:1024 sc1
    buffer_load_dwordx4 a[60:63], v5, s[32:35], s44 offen offset:1024 sc1
    s_nop 0
    s_add_u32 s45, s45, 1
    s_waitcnt vmcnt(0)
    v_accvgpr_read_b32 v244, a48
    v_accvgpr_read_b32 v245, a52
    v_accvgpr_read_b32 v246, a56
    v_accvgpr_read_b32 v247, a60
    v_max3_u32 v244, v244, v245, v246
    v_max_u32 v244, v244, v247
    v_cmp_eq_u32 vcc, -1, v244
    s_cmp_ge_u32 s45, 0x100000
    s_cbranch_scc1 L_hb3
    s_cbranch_vccnz L_hf3_l
    s_branch L_hb3
L_hsf:
    s_mov_b32 s45, 0
    s_branch L_hs_chk
L_hs_spin:
    s_sleep 1
    buffer_load_dwordx4 v[198:201], v4, s[32:35], s11 offen offset:0 sc1
    buffer_load_dwordx4 v[204:207], v4, s[32:35], s11 offen offset:1024 sc1
    s_nop 0
    s_add_u32 s45, s45, 1
    s_waitcnt vmcnt(0)
L_hs_chk:
    v_min3_f32 v234, v199, v201, v205
    v_min_f32 v234, v234, v207
    v_cmp_gt_f32 vcc, 0, v234
    s_cmp_ge_u32 s45, 0x100000
    s_cbranch_scc1 L_hs_go
    s_cbranch_vccnz L_hs_spin
L_hs_go:
    s_branch L_hsb
L_hf4:
    s_sub_u32 s44, s50, 10240
    s_mov_b32 s45, 0
L_hf4_l:
    buffer_load_dwordx4 a[64:67], v4, s[32:35], s44 offen offset:0 sc1
    buffer_load_dwordx4 a[68:71], v5, s[32:35], s44 offen offset:0 sc1
    buffer_load_dwordx4 a[72:75], v4, s[32:35], s44 offen offset:1024 sc1
    buffer_load_dwordx4 a[76:79], v5, s[32:35], s44 offen offset:1024 sc1
    s_nop 0
    s_add_u32 s45, s45, 1
    s_waitcnt vmcnt(0)
    v_accvgpr_read_b32 v244, a64
    v_accvgpr_read_b32 v245, a68
    v_accvgpr_read_b32 v246, a72
    v_accvgpr_read_b32 v247, a76
    v_max3_u32 v244, v244, v245, v246
    v_max_u32 v244, v244, v247
    v_cmp_eq_u32 vcc, -1, v244
    s_cmp_ge_u32 s45, 0x100000
    s_cbranch_scc1 L_hb4
    s_cbranch_vccnz L_hf4_l
    s_branch L_hb4
L_hf5:
    s_sub_u32 s44, s50, 8192
    s_mov_b32 s45, 0
L_hf5_l:
    buffer_load_dwordx4 a[80:83], v4, s[32:35], s44 offen offset:0 sc1
    buffer_load_dwordx4 a[84:87], v5, s[32:35], s44 offen offset:0 sc1
    buffer_load_dwordx4 a[88:91], v4, s[32:35], s44 offen offset:1024 sc1
    buffer_load_dwordx4 a[92:95], v5, s[32:35], s44 offen offset:1024 sc1
    s_nop 0
    s_add_u32 s45, s45, 1
    s_waitcnt vmcnt(0)
    v_accvgpr_read_b32 v244, a80
    v_accvgpr_read_b32 v245, a84
    v_accvgpr_read_b32 v246, a88
    v_accvgpr_read_b32 v247, a92
    v_max3_u32 v244, v244, v245, v246
    v_max_u32 v244, v244, v247
    v_cmp_eq_u32 vcc, -1, v244
    s_cmp_ge_u32 s45, 0x100000
    s_cbranch_scc1 L_hb5
    s_cbranch_vccnz L_hf5_l
    s_branch L_hb5
L_hf6:
    s_sub_u32 s44, s50, 6144
    s_mov_b32 s45, 0
L_hf6_l:
    buffer_load_dwordx4 a[96:99], v4, s[32:35], s44 offen offset:0 sc1
    buffer_load_dwordx4 a[100:103], v5, s[32:35], s44 offen offset:0 sc1
    buffer_load_dwordx4 a[104:107], v4, s[32:35], s44 offen offset:1024 sc1
    buffer_load_dwordx4 a[108:111], v5, s[32:35], s44 offen offset:1024 sc1
    s_nop 0
    s_add_u32 s45, s45, 1
    s_waitcnt vmcnt(0)
    v_accvgpr_read_b32 v244, a96
    v_accvgpr_read_b32 v245, a100
    v_accvgpr_read_b32 v246, a104
    v_accvgpr_read_b32 v247, a108
    v_max3_u32 v244, v244, v245, v246
    v_max_u32 v244, v244, v247
    v_cmp_eq_u32 vcc, -1, v244
    s_cmp_ge_u32 s45, 0x100000
    s_cbranch_scc1 L_hb6
    s_cbranch_vccnz L_hf6_l
    s_branch L_hb6
L_hf7:
    s_sub_u32 s44, s50, 4096
    s_mov_b32 s45, 0
L_hf7_l:
    buffer_load_dwordx4 a[112:115], v4, s[32:35], s44 offen offset:0 sc1
    buffer_load_dwordx4 a[116:119], v5, s[32:35], s44 offen offset:0 sc1
    buffer_load_dwordx4 a[120:123], v4, s[32:35], s44 offen offset:1024 sc1
    buffer_load_dwordx4 a[124:127], v5, s[32:35], s44 offen offset:1024 sc1
    s_nop 0
    s_add_u32 s45, s45, 1
    s_waitcnt vmcnt(0)
    v_accvgpr_read_b32 v244, a112
    v_accvgpr_read_b32 v245, a116
    v_accvgpr_read_b32 v246, a120
    v_accvgpr_read_b32 v247, a124
    v_max3_u32 v244, v244, v245, v246
    v_max_u32 v244, v244, v247
    v_cmp_eq_u32 vcc, -1, v244
    s_cmp_ge_u32 s45, 0x100000
    s_cbranch_scc1 L_hb7
    s_cbranch_vccnz L_hf7_l
    s_branch L_hb7
L_hf8:
    s_sub_u32 s44, s50, 2048
    s_mov_b32 s45, 0
L_hf8_l:
    buffer_load_dwordx4 a[128:131], v4, s[32:35], s44 offen offset:0 sc1
    buffer_load_dwordx4 a[132:135], v5, s[32:35], s44 offen offset:0 sc1
    buffer_load_dwordx4 a[136:139], v4, s[32:35], s44 offen offset:1024 sc1
    buffer_load_dwordx4 a[140:143], v5, s[32:35], s44 offen offset:1024 sc1
    s_nop 0
    s_add_u32 s45, s45, 1
    s_waitcnt vmcnt(0)
    v_accvgpr_read_b32 v244, a128
    v_accvgpr_read_b32 v245, a132
    v_accvgpr_read_b32 v246, a136
    v_accvgpr_read_b32 v247, a140
    v_max3_u32 v244, v244, v245, v246
    v_max_u32 v244, v244, v247
    v_cmp_eq_u32 vcc, -1, v244
    s_cmp_ge_u32 s45, 0x100000
    s_cbranch_scc1 L_hb8
    s_cbranch_vccnz L_hf8_l
    s_branch L_hb8
L_zf2:
    s_bfe_u32 s44, 56797, s19
    s_cmp_eq_u32 s44, s41
    s_cselect_b32 s44, s59, s44
    s_mul_i32 s44, s44, 589824
    s_add_u32 s44, s44, s15
    s_add_u32 s46, s44, s13
    s_mov_b32 s45, 0
L_zf2_l:
    s_add_u32 m0, s48, 73728
    s_nop 0
    buffer_load_dwordx4 v4, s[32:35], s44 offen offset:0 sc1 lds
    buffer_load_dwordx4 v4, s[32:35], s44 offen offset:1024 sc1 lds
    buffer_load_dwordx4 v4, s[32:35], s44 offen offset:2048 sc1 lds
    buffer_load_dwordx4 v4, s[32:35], s44 offen offset:3072 sc1 lds
    s_add_u32 m0, s12, 73728
    s_nop 0
    buffer_load_dwordx4 v4, s[32:35], s46 offen sc1 lds
    s_add_u32 s45, s45, 1
    s_waitcnt vmcnt(0)
    ds_read2st64_b32 v[14:15], v11 offset0:0 offset1:4
    ds_read2st64_b32 v[16:17], v11 offset0:8 offset1:12
    ds_read_b32 v18, v12 offset:0
    s_waitcnt lgkmcnt(0)
    v_max3_u32 v14, v14, v15, v16
    v_max3_u32 v14, v14, v17, v18
    v_cmp_eq_u32 vcc, -1, v14
    s_cmp_ge_u32 s45, 0x100000
    s_cbranch_scc1 L_zb2
    s_cbranch_vccnz L_zf2_l
    s_branch L_zb2
L_zf3:
    s_bfe_u32 s44, 56797, s19
    s_cmp_eq_u32 s44, s41
    s_cselect_b32 s44, s59, s44
    s_mul_i32 s44, s44, 589824
    s_add_u32 s44, s44, s15
    s_add_u32 s44, s44, 20480
    s_add_u32 s46, s44, s13
    s_mov_b32 s45, 0
L_zf3_l:
    s_add_u32 m0, s48, 94208
    s_nop 0
    buffer_load_dwordx4 v4, s[32:35], s44 offen offset:0 sc1 lds
    buffer_load_dwordx4 v4, s[32:35], s44 offen offset:1024 sc1 lds
    buffer_load_dwordx4 v4, s[32:35], s44 offen offset:2048 sc1 lds
    buffer_load_dwordx4 v4, s[32:35], s44 offen offset:3072 sc1 lds
    s_add_u32 s45, s45, 1
    s_waitcnt vmcnt(0)
    ds_read2st64_b32 v[14:15], v11 offset0:80 offset1:84
    ds_read2st64_b32 v[16:17], v11 offset0:88 offset1:92
    s_waitcnt lgkmcnt(0)
    v_max3_u32 v14, v14, v15, v16
    v_max_u32 v14, v14, v17
    v_cmp_eq_u32 vcc, -1, v14
    s_cmp_ge_u32 s45, 0x100000
    s_cbranch_scc1 L_zb3
    s_cbranch_vccnz L_zf3_l
    s_branch L_zb3
L_zf4:
    s_bfe_u32 s44, 61166, s19
    s_cmp_eq_u32 s44, s41
    s_cselect_b32 s44, s59, s44
    s_mul_i32 s44, s44, 589824
    s_add_u32 s44, s44, s15
    s_add_u32 s46, s44, s13
    s_mov_b32 s45, 0
L_zf4_l:
    s_add_u32 m0, s48, 110592
    s_nop 0
    buffer_load_dwordx4 v4, s[32:35], s44 offen offset:0 sc1 lds
    buffer_load_dwordx4 v4, s[32:35], s44 offen offset:1024 sc1 lds
    buffer_load_dwordx4 v4, s[32:35], s44 offen offset:2048 sc1 lds
    buffer_load_dwordx4 v4, s[32:35], s44 offen offset:3072 sc1 lds
    s_add_u32 m0, s12, 110592
    s_nop 0
    buffer_load_dwordx4 v4, s[32:35], s46 offen sc1 lds
    s_add_u32 s45, s45, 1
    s_waitcnt vmcnt(0)
    ds_read2st64_b32 v[14:15], v11 offset0:144 offset1:148
    ds_read2st64_b32 v[16:17], v11 offset0:152 offset1:156
    ds_read_b32 v18, v12 offset:36864
    s_waitcnt lgkmcnt(0)
    v_max3_u32 v14, v14, v15, v16
    v_max3_u32 v14, v14, v17, v18
    v_cmp_eq_u32 vcc, -1, v14
    s_cmp_ge_u32 s45, 0x100000
    s_cbranch_scc1 L_zb4
    s_cbranch_vccnz L_zf4_l
    s_branch L_zb4
L_zf5:
    s_bfe_u32 s44, 61166, s19
    s_cmp_eq_u32 s44, s41
    s_cselect_b32 s44, s59, s44
    s_mul_i32 s44, s44, 589824
    s_add_u32 s44, s44, s15
    s_add_u32 s44, s44, 20480
    s_add_u32 s46, s44, s13
    s_mov_b32 s45, 0
L_zf5_l:
    s_add_u32 m0, s48, 131072
    s_nop 0
    buffer_load_dwordx4 v4, s[32:35], s44 offen offset:0 sc1 lds
    buffer_load_dwordx4 v4, s[32:35], s44 offen offset:1024 sc1 lds
    buffer_load_dwordx4 v4, s[32:35], s44 offen offset:2048 sc1 lds
    buffer_load_dwordx4 v4, s[32:35], s44 offen offset:3072 sc1 lds
    s_add_u32 s45, s45, 1
    s_waitcnt vmcnt(0)
    ds_read2st64_b32 v[14:15], v11 offset0:224 offset1:228
    ds_read2st64_b32 v[16:17], v11 offset0:232 offset1:236
    s_waitcnt lgkmcnt(0)
    v_max3_u32 v14, v14, v15, v16
    v_max_u32 v14, v14, v17
    v_cmp_eq_u32 vcc, -1, v14
    s_cmp_ge_u32 s45, 0x100000
    s_cbranch_scc1 L_zb5
    s_cbranch_vccnz L_zf5_l
    s_branch L_zb5
L_zf6:
    s_bfe_u32 s44, 65535, s19
    s_cmp_eq_u32 s44, s41
    s_cselect_b32 s44, s59, s44
    s_mul_i32 s44, s44, 589824
    s_add_u32 s44, s44, s15
    s_add_u32 s46, s44, s13
    s_mov_b32 s45, 0
L_zf6_l:
    s_add_u32 m0, s48, 0
    s_nop 0
    buffer_load_dwordx4 v4, s[32:35], s44 offen offset:0 sc1 lds
    buffer_load_dwordx4 v4, s[32:35], s44 offen offset:1024 sc1 lds
    buffer_load_dwordx4 v4, s[32:35], s44 offen offset:2048 sc1 lds
    buffer_load_dwordx4 v4, s[32:35], s44 offen offset:3072 sc1 lds
    s_add_u32 m0, s12, 0
    s_nop 0
    buffer_load_dwordx4 v4, s[32:35], s46 offen sc1 lds
    s_add_u32 s45, s45, 1
    s_waitcnt vmcnt(0)
    ds_read2st64_b32 v[14:15], v11 offset0:0 offset1:4
    ds_read2st64_b32 v[16:17], v11 offset0:8 offset1:12
    ds_read_b32 v18, v12 offset:0
    s_waitcnt lgkmcnt(0)
    v_max3_u32 v14, v14, v15, v16
    v_max3_u32 v14, v14, v17, v18
    v_cmp_eq_u32 vcc, -1, v14
    s_cmp_ge_u32 s45, 0x100000
    s_cbranch_scc1 L_zb6
    s_cbranch_vccnz L_zf6_l
    s_branch L_zb6
L_zf7:
    s_bfe_u32 s44, 65535, s19
    s_cmp_eq_u32 s44, s41
    s_cselect_b32 s44, s59, s44
    s_mul_i32 s44, s44, 589824
    s_add_u32 s44, s44, s15
    s_add_u32 s44, s44, 20480
    s_add_u32 s46, s44, s13
    s_mov_b32 s45, 0
L_zf7_l:
    s_add_u32 m0, s48, 20480
    s_nop 0
    buffer_load_dwordx4 v4, s[32:35], s44 offen offset:0 sc1 lds
    buffer_load_dwordx4 v4, s[32:35], s44 offen offset:1024 sc1 lds
    buffer_load_dwordx4 v4, s[32:35], s44 offen offset:2048 sc1 lds
    buffer_load_dwordx4 v4, s[32:35], s44 offen offset:3072 sc1 lds
    s_add_u32 s45, s45, 1
    s_waitcnt vmcnt(0)
    ds_read2st64_b32 v[14:15], v11 offset0:80 offset1:84
    ds_read2st64_b32 v[16:17], v11 offset0:88 offset1:92
    s_waitcnt lgkmcnt(0)
    v_max3_u32 v14, v14, v15, v16
    v_max_u32 v14, v14, v17
    v_cmp_eq_u32 vcc, -1, v14
    s_cmp_ge_u32 s45, 0x100000
    s_cbranch_scc1 L_zb7
    s_cbranch_vccnz L_zf7_l
    s_branch L_zb7
L_text_end:
.section .rodata,"a"
.p2align 6
.amdhsa_kernel qkv_kernel
  .amdhsa_next_free_vgpr 288
  .amdhsa_next_free_sgpr 64
  .amdhsa_accum_offset 256
  .amdhsa_group_segment_fixed_size 0
  .amdhsa_kernarg_size 88
  .amdhsa_user_sgpr_count 2
  .amdhsa_user_sgpr_kernarg_segment_ptr 1
  .amdhsa_system_sgpr_workgroup_id_x 1
  .amdhsa_float_denorm_mode_32 3
  .amdhsa_float_denorm_mode_16_64 3
  .amdhsa_ieee_mode 0
  .amdhsa_dx10_clamp 0
.end_amdhsa_kernel
.p2align 6
.amdhsa_kernel attn_kernel
  .amdhsa_next_free_vgpr 220
  .amdhsa_next_free_sgpr 102
  .amdhsa_accum_offset 220
  .amdhsa_group_segment_fixed_size 0
  .amdhsa_kernarg_size 88
  .amdhsa_user_sgpr_count 2
  .amdhsa_user_sgpr_kernarg_segment_ptr 1
  .amdhsa_system_sgpr_workgroup_id_x 1
  .amdhsa_float_denorm_mode_32 3
  .amdhsa_float_denorm_mode_16_64 3
  .amdhsa_ieee_mode 0
  .amdhsa_dx10_clamp 0
.end_amdhsa_kernel
.p2align 6
.amdhsa_kernel post_kernel
  .amdhsa_next_free_vgpr 512
  .amdhsa_next_free_sgpr 64
  .amdhsa_accum_offset 256
  .amdhsa_group_segment_fixed_size 0
  .amdhsa_kernarg_size 88
  .amdhsa_user_sgpr_count 2
  .amdhsa_user_sgpr_kernarg_segment_ptr 1
  .amdhsa_system_sgpr_workgroup_id_x 1
  .amdhsa_float_denorm_mode_32 3
  .amdhsa_float_denorm_mode_16_64 3
  .amdhsa_ieee_mode 0
  .amdhsa_dx10_clamp 0
.end_amdhsa_kernel
```
